```python
import torch

def _softmax(x, axis=-1):
    return torch.softmax(x, dim=axis)
def _gelu(x):
    return torch.nn.functional.gelu(x, approximate="tanh")
def _silu(x):
    return torch.nn.functional.silu(x)
def _sigmoid(x):
    return torch.sigmoid(x)
def _layernorm(x, axis=-1, eps=1e-5):
    m = x.mean(dim=axis, keepdim=True)
    v = x.var(dim=axis, keepdim=True, unbiased=False)
    return (x - m) / torch.sqrt(v + eps)
def _scatter_add(tgt, idx, src, axis=0):
    return tgt.clone().index_add_(axis, idx, src)
def _segment_sum(src, seg, n):
    out = torch.zeros((n,) + src.shape[1:], dtype=src.dtype)
    return out.index_add_(0, seg, src)
def _pad(x, pw):
    flat = tuple(v for pair in reversed(pw) for v in pair)
    return torch.nn.functional.pad(x, flat)

kernel_name = 'gated_mix__grouped_kv_mqa__glu_gated_geglu__prompt'

def setup_inputs():

    _w = (lambda a: (lambda t: t.to(torch.bfloat16) if t.is_floating_point() else t)(torch.as_tensor(a)))
    def _A_setup():
        B, S, D, H = 1, 2048, 576, 32
        Dh = D // H
        return {
            "x": _w((lambda *s: torch.randn(*s, dtype=torch.bfloat16) * 0.05)(B, S, D)),
            "wq": _w((lambda *s: torch.randn(*s, dtype=torch.bfloat16) * 0.8)(D, H * Dh)),
            "wk": _w((lambda *s: torch.randn(*s, dtype=torch.bfloat16) * 0.8)(D, Dh)),
            "wv": _w((lambda *s: torch.randn(*s, dtype=torch.bfloat16) * 0.05)(D, Dh)),
            "wo": _w((lambda *s: torch.randn(*s, dtype=torch.bfloat16) * 0.05)(H * Dh, D)),
        }
    _A_in = _A_setup()

    def _B_setup():
        B, S, Dm, Df = 1, 2048, 576, 4608
        return {
            "x": _w((lambda *s: torch.randn(*s, dtype=torch.bfloat16) * 0.05)(B, S, Dm)),
            "w_gate": _w((lambda *s: torch.randn(*s, dtype=torch.bfloat16) * 0.8)(Dm, Df) * (Dm ** -0.5)),
            "w_up": _w((lambda *s: torch.randn(*s, dtype=torch.bfloat16) * 0.8)(Dm, Df) * (Dm ** -0.5)),
            "w_down": _w((lambda *s: torch.randn(*s, dtype=torch.bfloat16) * 0.8)(Df, Dm) * (Df ** -0.5)),
        }
    _B_in = _B_setup()

    return {
        "A_x": _A_in["x"],
        "A_wq": _A_in["wq"],
        "A_wk": _A_in["wk"],
        "A_wv": _A_in["wv"],
        "A_wo": _A_in["wo"],
        "B_x": _B_in["x"],
        "B_w_gate": _B_in["w_gate"],
        "B_w_up": _B_in["w_up"],
        "B_w_down": _B_in["w_down"],
        "gate_w": _w((lambda *s: torch.randn(*s, dtype=torch.bfloat16) * 0.05)(576) * 16.0),
    }

def reference(A_x, A_wq, A_wk, A_wv, A_wo, B_x, B_w_gate, B_w_up, B_w_down, gate_w):
    def _A_ref(x, wq, wk, wv, wo):
        B, S, D = x.shape
        H = 32
        Dh = D // H
        q = (lambda x, *d: x.permute(*d))((x @ wq).reshape(B, S, H, Dh), 0, 2, 1, 3)
        k = x @ wk
        v = x @ wv
        scores = torch.einsum("bhqd,bkd->bhqk", q, k) * (Dh ** -0.5)
        p = _softmax(scores, axis=-1)
        o = torch.einsum("bhqk,bkd->bhqd", p, v)
        return (lambda x, *d: x.permute(*d))(o, 0, 2, 1, 3).reshape(B, S, H * Dh) @ wo

    def _B_ref(x, w_gate, w_up, w_down):
        g = torch.einsum("bsd,df->bsf", x, w_gate)
        u = torch.einsum("bsd,df->bsf", x, w_up)
        h = _gelu(g) * u
        return torch.einsum("bsf,fd->bsd", h, w_down)

    x = A_x
    g = _sigmoid((x * gate_w).sum(-1, keepdims=True))
    a = _A_ref(x, A_wq, A_wk, A_wv, A_wo)
    b = _B_ref(x, B_w_gate, B_w_up, B_w_down)
    return g * a + (1 - g) * b
```

```asm
; @launch grid=(256,1,1) block=(256,1,1) lds=163840
.amdgcn_target "amdgcn-amd-amdhsa--gfx950"
.text
.p2align 8
.globl gated_mix__grouped_kv_mqa__glu_gated_geglu__prompt_kernel
.type gated_mix__grouped_kv_mqa__glu_gated_geglu__prompt_kernel,@function
gated_mix__grouped_kv_mqa__glu_gated_geglu__prompt_kernel:
  s_cmp_ge_u32 s2, 256
  s_cbranch_scc1 K_exit
  s_load_dwordx16 s[16:31], s[0:1], 0
  s_load_dwordx8 s[32:39], s[0:1], 64
  s_load_dwordx2 s[40:41], s[0:1], 96
  v_lshrrev_b32 v1, 6, v0
  v_and_b32 v0, 63, v0
  v_readfirstlane_b32 s3, v1
  s_getpc_b64 s[98:99]
PCL:
  s_lshr_b32 s11, s2, 3
  s_lshl_b32 s11, s11, 2
  s_add_u32 s11, s11, s3
  v_lshlrev_b32 v166, 7, v0
  v_add_u32 v166, s11, v166
  v_lshlrev_b32 v166, 7, v166
  v_min_u32 v166, A_fb-PCL, v166
  global_load_dword v253, v166, s[98:99]
  s_and_b32 s10, s2, 7
  s_lshr_b32 s11, s2, 3
  s_and_b32 s4, s10, 3
  s_mul_i32 s4, s4, 4
  s_and_b32 s12, s11, 3
  s_add_u32 s4, s4, s12
  s_lshr_b32 s5, s10, 2
  s_mul_i32 s5, s5, 8
  s_lshr_b32 s12, s11, 2
  s_add_u32 s5, s5, s12
  v_lshrrev_b32 v160, 3, v0
  v_lshrrev_b32 v161, 4, v0
  v_and_b32 v163, 7, v0
  v_xor_b32 v164, v163, v161
  v_lshlrev_b32 v164, 4, v164
  v_mul_u32_u24 v165, 1152, v160
  v_add_u32 v9, v164, v165
  v_xor_b32 v10, 64, v9
  v_add_u32 v10, 8192, v10
  v_add_u32 v11, 16384, v9
  v_add_u32 v12, 16384, v10
  s_lshl_b32 s9, s3, 12
  s_lshl_b32 s15, s3, 5
  s_lshl_b32 s8, s4, 7
  s_add_u32 s8, s8, s15
  s_mul_i32 s8, s8, 1152
  s_mul_i32 s6, s5, 1
  s_mul_i32 s12, s4, 2
  s_add_u32 s6, s6, s12
  s_and_b32 s6, s6, 7
  s_lshl_b32 s88, s6, 7
  s_add_u32 s88, s88, s8
  s_waitcnt lgkmcnt(0)
  s_mov_b32 s44, s16
  s_and_b32 s45, s17, 0xffff
  s_mov_b32 s46, 2359296
  s_mov_b32 s47, 0x20000
  s_add_u32 m0, s9, 0
  s_nop 0
  buffer_load_dwordx4 v9, s[44:47], s88 offen lds
  v_lshlrev_b32 v162, 1, v161
  v_xor_b32 v162, v163, v162
  v_lshlrev_b32 v164, 4, v162
  v_and_b32 v166, 4, v160
  buffer_load_dwordx4 v10, s[44:47], s88 offen offset:1024 lds
  v_add_u32 v166, v166, v160
  v_mul_u32_u24 v1, 9216, v166
  v_add_u32 v1, v1, v164
  v_add_u32 v2, 146432, v1
  buffer_load_dwordx4 v11, s[44:47], s88 offen offset:2048 lds
  v_add_u32 v3, 34816, v1
  v_add_u32 v4, 181248, v1
  s_mul_i32 s12, s5, 576
  s_bitcmp1_b32 s5, 0
  s_cselect_b32 s10, 64, 0
  s_cselect_b32 s13, 0, 512
  buffer_load_dwordx4 v12, s[44:47], s88 offen offset:3072 lds
  s_add_u32 s93, s10, s12
  s_add_u32 s13, s13, s12
  s_mov_b32 s48, s28
  s_and_b32 s49, s29, 0xffff
  s_add_u32 s88, s88, 128
  s_add_u32 m0, s9, 16384
  s_nop 0
  buffer_load_dwordx4 v9, s[44:47], s88 offen lds
  s_mov_b32 s50, 5308416
  s_mov_b32 s51, 0x20000
  s_lshl_b32 s89, s6, 1
  s_add_u32 s89, s89, s3
  buffer_load_dwordx4 v10, s[44:47], s88 offen offset:1024 lds
  s_mul_i32 s89, s89, 294912
  s_add_u32 s89, s89, s93
  buffer_load_dwordx4 v11, s[44:47], s88 offen offset:2048 lds
  buffer_load_dwordx4 v12, s[44:47], s88 offen offset:3072 lds
  s_add_u32 m0, s9, 65536
  s_nop 0
  buffer_load_dwordx4 v1, s[48:51], s89 offen lds
  buffer_load_dwordx4 v2, s[48:51], s89 offen offset:1024 lds
  buffer_load_dwordx4 v3, s[48:51], s89 offen offset:2048 lds
  buffer_load_dwordx4 v4, s[48:51], s89 offen offset:3072 lds
  v_add_u32 v166, s6, v0
  v_subrev_u32 v167, 9, v166
  v_min_u32 v166, v166, v167
  v_lshlrev_b32 v166, 7, v166
  v_add_u32 v222, s8, v166
  v_mul_u32_u24 v166, 7282, v0
  v_lshrrev_b32 v166, 16, v166
  v_mul_u32_u24 v167, 9, v166
  v_sub_u32 v167, v0, v167
  v_lshlrev_b32 v167, 2, v167
  v_add_u32 v167, s3, v167
  v_subrev_u32 v168, 18, v167
  v_min_u32 v167, v167, v168
  s_lshl_b32 s12, s6, 1
  v_add_u32 v167, s12, v167
  v_subrev_u32 v168, 18, v167
  v_min_u32 v167, v167, v168
  v_cmp_lt_u32 vcc, 2, v166
  v_mul_u32_u24 v168, 294912, v167
  v_add_u32 v168, s93, v168
  v_subbrev_co_u32 v169, vcc, 0, v166, vcc
  v_cmp_ne_u32 vcc, 2, v166
  v_lshl_add_u32 v168, v169, 7, v168
  v_lshlrev_b32 v167, 5, v167
  v_cndmask_b32 v23, v167, v168, vcc
  s_mov_b32 s52, s30
  s_and_b32 s53, s31, 0xffff
  s_mov_b32 s54, 5308416
  s_mov_b32 s55, 0x20000
  s_cmp_ge_u32 s3, 2
  s_cselect_b32 s56, s52, s48
  s_cselect_b32 s57, s53, s49
  s_mov_b32 s58, 5308416
  s_mov_b32 s59, 0x20000
  v_add_u32 v5, v164, v165
  v_add_u32 v6, 8192, v5
  v_add_u32 v7, 16384, v5
  v_add_u32 v8, 24576, v5
  s_mov_b32 s60, s32
  s_and_b32 s61, s33, 0xffff
  s_mov_b32 s62, 5308416
  s_mov_b32 s63, 0x20000
  s_mov_b32 s64, s40
  s_and_b32 s65, s41, 0xffff
  s_mov_b32 s66, 46989312
  s_mov_b32 s67, 0x20000
  s_mov_b32 s68, s24
  s_and_b32 s69, s25, 0xffff
  s_mov_b32 s70, 663552
  s_mov_b32 s71, 0x20000
  s_cmp_ge_u32 s3, 2
  s_cselect_b64 s[72:73], -1, 0
  s_cselect_b32 s14, 1, 0
  v_lshrrev_b32 v163, 2, v0
  v_bfe_u32 v166, v0, 3, 2
  s_and_b32 s10, s72, 2
  v_xor_b32 v166, s10, v166
  v_lshlrev_b32 v166, 5, v166
  v_lshl_add_u32 v166, v163, 7, v166
  v_and_b32 v163, 3, v0
  v_lshl_add_u32 v13, v163, 3, v166
  v_xor_b32 v16, 32, v13
  v_add_u32 v14, 65536, v13
  v_add_u32 v17, 65536, v16
  v_add_u32 v15, 131072, v13
  v_add_u32 v18, 131072, v16
  s_and_b32 s10, s3, 1
  v_lshrrev_b32 v163, 4, v0
  v_bfe_u32 v166, v0, 1, 3
  v_xor_b32 v166, v166, v163
  v_lshlrev_b32 v166, 4, v166
  v_and_b32 v163, 15, v0
  v_lshl_add_u32 v166, v163, 7, v166
  s_lshl_b32 s11, s10, 13
  v_add_u32 v24, s11, v166
  v_xor_b32 v25, 64, v24
  v_add_u32 v26, 65536, v24
  v_add_u32 v27, 65536, v25
  v_add_u32 v28, 131072, v24
  v_add_u32 v29, 131072, v25
  v_lshlrev_b32 v21, 4, v0
  s_lshl_b32 s11, s10, 12
  v_add_u32 v19, s11, v21
  v_mov_b32 v20, 0xbdd2d3e8
  s_mul_i32 s10, s2, 3
  s_add_u32 s10, s10, s3
  s_mul_hi_u32 s11, s10, 238609295
  s_mul_i32 s12, s11, 18
  s_sub_u32 s12, s10, s12
  s_lshl_b32 s79, s10, 10
  s_add_u32 s79, s79, 37912576
  s_lshr_b32 s89, s11, 1
  s_lshl_b32 s89, s89, 6
  s_and_b32 s11, s11, 1
  s_lshl_b32 s11, s11, 4
  s_add_u32 s89, s89, s11
  v_bfe_u32 v160, v0, 3, 1
  v_and_b32 v162, 7, v0
  v_lshlrev_b32 v162, 1, v162
  v_lshl_add_u32 v160, v160, 5, v162
  v_add_u32 v160, s89, v160
  v_bfe_u32 v162, v0, 4, 1
  v_mul_u32_u24 v162, 18, v162
  v_lshrrev_b32 v161, 5, v0
  v_lshl_add_u32 v162, v161, 2, v162
  v_lshrrev_b32 v164, 4, v0
  v_mul_u32_u24 v164, 72, v164
  s_cmp_ge_u32 s12, 9
  s_cselect_b32 s89, 1, 0
  s_sub_u32 s11, s12, s89
  s_mul_i32 s11, s11, 36
  s_mul_i32 s80, s89, 9
  s_sub_u32 s12, s12, s80
  s_mul_i32 s89, s89, 288
  s_add_u32 s89, s89, 16
  s_cmp_eq_u32 s12, 8
  s_cselect_b64 vcc, -1, 0
  s_cselect_b32 s11, s89, s11
  s_cselect_b32 s80, 0, 0
  s_cselect_b32 s81, 1, 1
  s_cselect_b32 s82, 18, 2
  s_cselect_b32 s83, 19, 3
  s_cselect_b32 s84, 36, 8
  s_cselect_b32 s85, 37, 9
  s_cselect_b32 s86, 54, 10
  s_cselect_b32 s87, 55, 11
  s_mul_i32 s80, s80, 1152
  s_mul_i32 s81, s81, 1152
  s_mul_i32 s82, s82, 1152
  s_mul_i32 s83, s83, 1152
  s_mul_i32 s84, s84, 1152
  s_mul_i32 s85, s85, 1152
  s_mul_i32 s86, s86, 1152
  s_mul_i32 s87, s87, 1152
  v_cndmask_b32 v162, v162, v164, vcc
  v_add_u32 v162, s11, v162
  v_mul_u32_u24 v162, 1152, v162
  v_add_u32 v226, v160, v162
  s_cmp_lt_u32 s3, 3
  s_cselect_b32 s11, 648, 0
  s_cmp_lt_u32 s10, s11
  s_cselect_b32 s11, 0, 1073741824
  v_add_u32 v226, s11, v226
  v_add_u32 v227, s11, v21
  s_mov_b64 exec, 0
  s_cmp_eq_u32 s3, 0
  s_cbranch_scc1 PAD0
  s_cmp_eq_u32 s3, 1
  s_cbranch_scc1 PAD1
  s_cmp_eq_u32 s3, 2
  s_cbranch_scc1 PAD2
  s_branch PAD3
HOPBACK:
  s_mov_b64 exec, -1
  s_branch MAIN
.p2align 12
MAIN:
PAD0:
  s_cbranch_execz PAD4
  v_readlane_b32 s88, v222, 2
  s_add_u32 m0, s9, 32768
  s_nop 3
  buffer_load_dwordx4 v9, s[44:47], s88 offen lds
  buffer_load_dwordx4 v10, s[44:47], s88 offen offset:1024 lds
  buffer_load_dwordx4 v11, s[44:47], s88 offen offset:2048 lds
  buffer_load_dwordx4 v12, s[44:47], s88 offen offset:3072 lds
  v_readlane_b32 s88, v222, 3
  s_add_u32 m0, s9, 49152
  s_nop 3
  buffer_load_dwordx4 v9, s[44:47], s88 offen lds
  buffer_load_dwordx4 v10, s[44:47], s88 offen offset:1024 lds
  buffer_load_dwordx4 v11, s[44:47], s88 offen offset:2048 lds
  buffer_load_dwordx4 v12, s[44:47], s88 offen offset:3072 lds
  v_readlane_b32 s88, v23, 1
  s_add_u32 m0, s9, 81920
  s_nop 3
  buffer_load_dwordx4 v1, s[48:51], s88 offen lds
  buffer_load_dwordx4 v2, s[48:51], s88 offen offset:1024 lds
  buffer_load_dwordx4 v3, s[48:51], s88 offen offset:2048 lds
  buffer_load_dwordx4 v4, s[48:51], s88 offen offset:3072 lds
  s_waitcnt vmcnt(12)
  s_barrier
  ds_read_b64_tr_b16 v[32:33], v14 offset:0
  ds_read_b64_tr_b16 v[34:35], v14 offset:2048
  ds_read_b64_tr_b16 v[40:41], v14 offset:4096
  ds_read_b64_tr_b16 v[42:43], v14 offset:6144
  ds_read_b128 a[0:3], v24 offset:0
  ds_read_b128 a[16:19], v25 offset:0
  ds_read_b128 a[4:7], v24 offset:2048
  ds_read_b128 a[20:23], v25 offset:2048
  ds_read_b128 a[8:11], v24 offset:4096
  ds_read_b128 a[24:27], v25 offset:4096
  ds_read_b128 a[12:15], v24 offset:6144
  ds_read_b128 a[28:31], v25 offset:6144
  ds_read_b64_tr_b16 v[36:37], v17 offset:0
  ds_read_b64_tr_b16 v[38:39], v17 offset:2048
  ds_read_b64_tr_b16 v[44:45], v17 offset:4096
  ds_read_b64_tr_b16 v[46:47], v17 offset:6144
  s_waitcnt lgkmcnt(11)
  v_mfma_f32_16x16x32_bf16 v[64:67], v[32:35], a[0:3], 0
  ds_read_b64_tr_b16 v[50:51], v14 offset:10240
  ds_read_b64_tr_b16 v[48:49], v14 offset:8192
  v_readlane_b32 s88, v222, 4
  s_add_u32 m0, s9, 98304
  s_waitcnt lgkmcnt(12)
  v_mfma_f32_16x16x32_bf16 v[64:67], v[40:43], a[16:19], v[64:67]
  ds_read_b64_tr_b16 v[54:55], v17 offset:10240
  ds_read_b64_tr_b16 v[52:53], v17 offset:8192
  buffer_load_dwordx4 v9, s[44:47], s88 offen lds
  s_waitcnt lgkmcnt(13)
  v_mfma_f32_16x16x32_bf16 v[72:75], v[32:35], a[4:7], 0
  ds_read_b64_tr_b16 v[56:57], v14 offset:12288
  buffer_load_dwordx4 v10, s[44:47], s88 offen offset:1024 lds
  s_waitcnt lgkmcnt(13)
  v_mfma_f32_16x16x32_bf16 v[72:75], v[40:43], a[20:23], v[72:75]
  ds_read_b64_tr_b16 v[60:61], v17 offset:12288
  ds_read_b64_tr_b16 v[58:59], v14 offset:14336
  buffer_load_dwordx4 v11, s[44:47], s88 offen offset:2048 lds
  s_waitcnt lgkmcnt(14)
  v_mfma_f32_16x16x32_bf16 v[80:83], v[32:35], a[8:11], 0
  ds_read_b64_tr_b16 v[62:63], v17 offset:14336
  buffer_load_dwordx4 v12, s[44:47], s88 offen offset:3072 lds
  v_readlane_b32 s88, v222, 5
  s_add_u32 m0, s9, 114688
  s_waitcnt lgkmcnt(14)
  v_mfma_f32_16x16x32_bf16 v[80:83], v[40:43], a[24:27], v[80:83]
  ds_read_b128 a[48:51], v25 offset:16384
  ds_read_b128 a[32:35], v24 offset:16384
  buffer_load_dwordx4 v9, s[44:47], s88 offen lds
  s_waitcnt lgkmcnt(15)
  v_mfma_f32_16x16x32_bf16 v[88:91], v[32:35], a[12:15], 0
  ds_read_b128 a[52:55], v25 offset:18432
  ds_read_b128 a[36:39], v24 offset:18432
  buffer_load_dwordx4 v10, s[44:47], s88 offen offset:1024 lds
  s_waitcnt lgkmcnt(15)
  v_mfma_f32_16x16x32_bf16 v[88:91], v[40:43], a[28:31], v[88:91]
  ds_read_b128 a[40:43], v24 offset:20480
  buffer_load_dwordx4 v11, s[44:47], s88 offen offset:2048 lds
  s_waitcnt lgkmcnt(15)
  v_mfma_f32_16x16x32_bf16 v[68:71], v[36:39], a[0:3], 0
  ds_read_b128 a[44:47], v24 offset:22528
  ds_read_b128 a[56:59], v25 offset:20480
  buffer_load_dwordx4 v12, s[44:47], s88 offen offset:3072 lds
  v_readlane_b32 s88, v23, 2
  s_add_u32 m0, s9, 131072
  s_waitcnt lgkmcnt(15)
  v_mfma_f32_16x16x32_bf16 v[68:71], v[44:47], a[16:19], v[68:71]
  ds_read_b128 a[60:63], v25 offset:22528
  s_nop 0
  buffer_load_dwordx4 v1, s[48:51], s88 offen lds
  v_mfma_f32_16x16x32_bf16 v[76:79], v[36:39], a[4:7], 0
  buffer_load_dwordx4 v2, s[48:51], s88 offen offset:1024 lds
  v_mfma_f32_16x16x32_bf16 v[76:79], v[44:47], a[20:23], v[76:79]
  buffer_load_dwordx4 v3, s[48:51], s88 offen offset:2048 lds
  v_mfma_f32_16x16x32_bf16 v[84:87], v[36:39], a[8:11], 0
  buffer_load_dwordx4 v4, s[48:51], s88 offen offset:3072 lds
  v_mfma_f32_16x16x32_bf16 v[84:87], v[44:47], a[24:27], v[84:87]
  v_mfma_f32_16x16x32_bf16 v[92:95], v[36:39], a[12:15], 0
  v_mfma_f32_16x16x32_bf16 v[92:95], v[44:47], a[28:31], v[92:95]
  s_waitcnt vmcnt(12) lgkmcnt(0)
  s_barrier
  v_mfma_f32_16x16x32_bf16 v[64:67], v[48:51], a[32:35], v[64:67]
  ds_read_b64_tr_b16 v[32:33], v14 offset:16384
  v_readlane_b32 s88, v222, 6
  s_add_u32 m0, s9, 0
  s_and_b32 s12, s72, 8192
  v_mfma_f32_16x16x32_bf16 v[64:67], v[56:59], a[48:51], v[64:67]
  ds_read_b64_tr_b16 v[34:35], v14 offset:18432
  s_nop 0
  buffer_load_dwordx4 v9, s[44:47], s88 offen lds
  v_add_u32 v236, s12, v19
  v_mfma_f32_16x16x32_bf16 v[72:75], v[48:51], a[36:39], v[72:75]
  ds_read_b64_tr_b16 v[36:37], v17 offset:16384
  v_add_u32 v237, 65536, v19
  s_and_b32 s12, s72, 2048
  v_mfma_f32_16x16x32_bf16 v[72:75], v[56:59], a[52:55], v[72:75]
  ds_read_b64_tr_b16 v[38:39], v17 offset:18432
  buffer_load_dwordx4 v10, s[44:47], s88 offen offset:1024 lds
  ds_read_b128 a[64:67], v24 offset:32768
  ds_read_b128 a[80:83], v25 offset:32768
  v_add_u32 v223, s12, v237
  v_mfma_f32_16x16x32_bf16 v[80:83], v[48:51], a[40:43], v[80:83]
  s_add_u32 s12, s9, 65536
  v_add_u32 v224, s12, v21
  v_xor_b32 v225, 8192, v224
  v_mfma_f32_16x16x32_bf16 v[80:83], v[56:59], a[56:59], v[80:83]
  ds_read_b64_tr_b16 v[40:41], v14 offset:20480
  buffer_load_dwordx4 v11, s[44:47], s88 offen offset:2048 lds
  s_and_b32 s10, s3, 1
  v_mfma_f32_16x16x32_bf16 v[88:91], v[48:51], a[44:47], v[88:91]
  ds_read_b64_tr_b16 v[42:43], v14 offset:22528
  ds_read_b128 a[68:71], v24 offset:34816
  ds_read_b128 a[84:87], v25 offset:34816
  s_lshl_b32 s74, s4, 4
  v_mfma_f32_16x16x32_bf16 v[88:91], v[56:59], a[60:63], v[88:91]
  s_add_u32 s74, s74, s5
  s_mul_i32 s74, s74, 147456
  s_lshl_b32 s11, s10, 12
  v_mfma_f32_16x16x32_bf16 v[68:71], v[52:55], a[32:35], v[68:71]
  ds_read_b64_tr_b16 v[44:45], v17 offset:20480
  buffer_load_dwordx4 v12, s[44:47], s88 offen offset:3072 lds
  v_readlane_b32 s88, v222, 7
  s_add_u32 m0, s9, 16384
  s_add_u32 s74, s74, s11
  v_mfma_f32_16x16x32_bf16 v[68:71], v[60:63], a[48:51], v[68:71]
  ds_read_b64_tr_b16 v[46:47], v17 offset:22528
  ds_read_b128 a[72:75], v24 offset:36864
  ds_read_b128 a[88:91], v25 offset:36864
  s_and_b32 s11, s72, 8192
  v_mfma_f32_16x16x32_bf16 v[76:79], v[52:55], a[36:39], v[76:79]
  buffer_load_dwordx4 v9, s[44:47], s88 offen lds
  s_add_u32 s74, s74, s11
  s_lshl_b32 s11, s5, 1
  v_mfma_f32_16x16x32_bf16 v[76:79], v[60:63], a[52:55], v[76:79]
  ds_read_b128 a[76:79], v24 offset:38912
  ds_read_b128 a[92:95], v25 offset:38912
  s_add_u32 s14, s14, s11
  v_mfma_f32_16x16x32_bf16 v[84:87], v[52:55], a[40:43], v[84:87]
  ds_read_b64_tr_b16 v[48:49], v14 offset:24576
  buffer_load_dwordx4 v10, s[44:47], s88 offen offset:1024 lds
  s_lshl_b32 s11, s4, 1
  v_mfma_f32_16x16x32_bf16 v[84:87], v[60:63], a[56:59], v[84:87]
  ds_read_b64_tr_b16 v[50:51], v14 offset:26624
  s_add_u32 s11, s11, s10
  s_lshr_b32 s12, s11, 2
  v_mfma_f32_16x16x32_bf16 v[92:95], v[52:55], a[44:47], v[92:95]
  ds_read_b64_tr_b16 v[52:53], v17 offset:24576
  s_mul_i32 s78, s12, 18944
  s_add_u32 s78, s78, 37748736
  v_mfma_f32_16x16x32_bf16 v[92:95], v[60:63], a[60:63], v[92:95]
  s_waitcnt lgkmcnt(3)
  s_and_b32 s12, s11, 3
  s_mul_i32 s77, s12, 4480
  s_add_u32 s77, s77, s78
  v_mfma_f32_16x16x32_bf16 v[64:67], v[32:35], a[64:67], v[64:67]
  ds_read_b64_tr_b16 v[54:55], v17 offset:26624
  buffer_load_dwordx4 v11, s[44:47], s88 offen offset:2048 lds
  s_add_u32 s77, s77, 1024
  v_mfma_f32_16x16x32_bf16 v[64:67], v[40:43], a[80:83], v[64:67]
  ds_read_b64_tr_b16 v[56:57], v14 offset:28672
  ds_read_b128 a[96:99], v24 offset:49152
  ds_read_b128 a[112:115], v25 offset:49152
  s_and_b32 s12, s4, 1
  v_mfma_f32_16x16x32_bf16 v[72:75], v[32:35], a[68:71], v[72:75]
  buffer_load_dwordx4 v12, s[44:47], s88 offen offset:3072 lds
  v_readlane_b32 s88, v23, 3
  s_add_u32 m0, s9, 65536
  s_lshl_b32 s12, s12, 9
  v_mfma_f32_16x16x32_bf16 v[72:75], v[40:43], a[84:87], v[72:75]
  ds_read_b64_tr_b16 v[58:59], v14 offset:30720
  ds_read_b128 a[100:103], v24 offset:51200
  ds_read_b128 a[116:119], v25 offset:51200
  s_add_u32 s78, s78, s12
  v_mfma_f32_16x16x32_bf16 v[80:83], v[32:35], a[72:75], v[80:83]
  ds_read_b64_tr_b16 v[60:61], v17 offset:28672
  buffer_load_dwordx4 v1, s[48:51], s88 offen lds
  s_lshl_b32 s12, s10, 3
  v_mfma_f32_16x16x32_bf16 v[80:83], v[40:43], a[88:91], v[80:83]
  ds_read_b128 a[104:107], v24 offset:53248
  ds_read_b128 a[120:123], v25 offset:53248
  s_add_u32 s78, s78, s12
  v_mfma_f32_16x16x32_bf16 v[88:91], v[32:35], a[76:79], v[88:91]
  ds_read_b64_tr_b16 v[62:63], v17 offset:30720
  s_lshl_b32 s12, s14, 5
  s_add_u32 s11, s11, s12
  v_mfma_f32_16x16x32_bf16 v[88:91], v[40:43], a[92:95], v[88:91]
  buffer_load_dwordx4 v2, s[48:51], s88 offen offset:1024 lds
  ds_read_b128 a[108:111], v24 offset:55296
  ds_read_b128 a[124:127], v25 offset:55296
  s_lshl_b32 s75, s11, 11
  v_mfma_f32_16x16x32_bf16 v[68:71], v[36:39], a[64:67], v[68:71]
  s_add_u32 s75, s75, 38797312
  s_lshl_b32 s76, s11, 8
  s_add_u32 s76, s76, 40894464
  v_mfma_f32_16x16x32_bf16 v[68:71], v[44:47], a[80:83], v[68:71]
  buffer_load_dwordx4 v3, s[48:51], s88 offen offset:2048 lds
  s_mov_b32 s92, 0x3eae1a93
  v_lshlrev_b32 v160, 2, v0
  v_mfma_f32_16x16x32_bf16 v[76:79], v[36:39], a[68:71], v[76:79]
  v_add_u32 v160, s3, v160
  v_mul_u32_u24 v161, 7282, v160
  v_lshrrev_b32 v161, 16, v161
  v_mfma_f32_16x16x32_bf16 v[76:79], v[44:47], a[84:87], v[76:79]
  buffer_load_dwordx4 v4, s[48:51], s88 offen offset:3072 lds
  v_mul_u32_u24 v162, 9, v161
  v_sub_u32 v162, v160, v162
  v_mfma_f32_16x16x32_bf16 v[84:87], v[36:39], a[72:75], v[84:87]
  v_cmp_gt_u32 vcc, 27, v160
  v_subrev_u32 v163, 21, v160
  v_lshrrev_b32 v164, 1, v163
  v_mfma_f32_16x16x32_bf16 v[84:87], v[44:47], a[88:91], v[84:87]
  v_and_or_b32 v163, v163, 1, 6
  v_cndmask_b32 v161, v161, v164, vcc
  v_cndmask_b32 v162, v162, v163, vcc
  v_mfma_f32_16x16x32_bf16 v[92:95], v[36:39], a[76:79], v[92:95]
  v_mul_u32_u24 v164, 9363, v160
  v_lshrrev_b32 v164, 16, v164
  v_mul_u32_u24 v163, 7, v164
  v_mfma_f32_16x16x32_bf16 v[92:95], v[44:47], a[92:95], v[92:95]
  s_waitcnt vmcnt(12) lgkmcnt(0)
  s_barrier
  v_mfma_f32_16x16x32_bf16 v[64:67], v[48:51], a[96:99], v[64:67]
  ds_read_b64_tr_b16 v[32:33], v15 offset:0
  v_sub_u32 v163, v160, v163
  v_cmp_eq_u32 vcc, 6, v163
  v_mfma_f32_16x16x32_bf16 v[64:67], v[56:59], a[112:115], v[64:67]
  ds_read_b64_tr_b16 v[34:35], v15 offset:2048
  v_readlane_b32 s88, v222, 8
  v_cndmask_b32_e64 v163, v163, 8, vcc
  v_mfma_f32_16x16x32_bf16 v[72:75], v[48:51], a[100:103], v[72:75]
  ds_read_b64_tr_b16 v[36:37], v18 offset:0
  v_cmp_gt_u32 vcc, 21, v160
  s_nop 1
  v_cndmask_b32 v161, v161, v164, vcc
  v_mfma_f32_16x16x32_bf16 v[72:75], v[56:59], a[116:119], v[72:75]
  ds_read_b64_tr_b16 v[38:39], v18 offset:2048
  ds_read_b128 a[128:131], v26 offset:32768
  ds_read_b128 a[144:147], v27 offset:32768
  v_cndmask_b32 v160, v162, v163, vcc
  v_mfma_f32_16x16x32_bf16 v[80:83], v[48:51], a[104:107], v[80:83]
  s_add_u32 m0, s9, 32768
  s_and_b32 s12, s5, 1
  v_add_u32 v160, s12, v160
  v_cmp_eq_u32 vcc, 9, v160
  v_mfma_f32_16x16x32_bf16 v[80:83], v[56:59], a[120:123], v[80:83]
  ds_read_b64_tr_b16 v[40:41], v15 offset:4096
  buffer_load_dwordx4 v9, s[44:47], s88 offen lds
  s_mul_i32 s12, s5, 331776
  v_mfma_f32_16x16x32_bf16 v[88:91], v[48:51], a[108:111], v[88:91]
  ds_read_b64_tr_b16 v[42:43], v15 offset:6144
  buffer_load_dwordx4 v10, s[44:47], s88 offen offset:1024 lds
  ds_read_b128 a[132:135], v26 offset:34816
  ds_read_b128 a[148:151], v27 offset:34816
  v_lshlrev_b32 v161, 7, v161
  v_mfma_f32_16x16x32_bf16 v[88:91], v[56:59], a[124:127], v[88:91]
  v_cndmask_b32_e64 v160, v160, 0, vcc
  v_mul_u32_u24 v160, 36864, v160
  v_add3_u32 v22, v160, v161, s12
  v_mfma_f32_16x16x32_bf16 v[68:71], v[52:55], a[96:99], v[68:71]
  ds_read_b64_tr_b16 v[44:45], v18 offset:4096
  v_lshrrev_b32 v160, 3, v0
  v_and_b32 v161, 4, v160
  v_mfma_f32_16x16x32_bf16 v[68:71], v[60:63], a[112:115], v[68:71]
  ds_read_b64_tr_b16 v[46:47], v18 offset:6144
  buffer_load_dwordx4 v11, s[44:47], s88 offen offset:2048 lds
  ds_read_b128 a[136:139], v26 offset:36864
  ds_read_b128 a[152:155], v27 offset:36864
  v_add_u32 v160, v160, v161
  v_mfma_f32_16x16x32_bf16 v[76:79], v[52:55], a[100:103], v[76:79]
  v_bfe_u32 v161, v5, 4, 3
  v_mov_b32 v211, 9216
  v_cmp_gt_u32 vcc, 4, v161
  v_mfma_f32_16x16x32_bf16 v[76:79], v[60:63], a[116:119], v[76:79]
  ds_read_b128 a[140:143], v26 offset:38912
  ds_read_b128 a[156:159], v27 offset:38912
  v_mov_b32 v164, s30
  v_mfma_f32_16x16x32_bf16 v[84:87], v[52:55], a[104:107], v[84:87]
  ds_read_b64_tr_b16 v[48:49], v15 offset:8192
  buffer_load_dwordx4 v12, s[44:47], s88 offen offset:3072 lds
  v_readlane_b32 s88, v23, 4
  s_add_u32 m0, s9, 49152
  v_mov_b32 v165, s28
  v_mfma_f32_16x16x32_bf16 v[84:87], v[60:63], a[120:123], v[84:87]
  ds_read_b64_tr_b16 v[50:51], v15 offset:10240
  v_cndmask_b32 v204, v164, v165, vcc
  v_mov_b32 v164, s31
  v_mfma_f32_16x16x32_bf16 v[92:95], v[52:55], a[108:111], v[92:95]
  ds_read_b64_tr_b16 v[52:53], v18 offset:8192
  buffer_load_dwordx4 v1, s[56:59], s88 offen lds
  v_mov_b32 v165, s29
  v_mfma_f32_16x16x32_bf16 v[92:95], v[60:63], a[124:127], v[92:95]
  s_waitcnt lgkmcnt(3)
  v_cndmask_b32 v205, v164, v165, vcc
  v_and_b32 v162, 3, v161
  v_lshlrev_b32 v164, 4, v162
  v_mfma_f32_16x16x32_bf16 v[64:67], v[32:35], a[128:131], v[64:67]
  ds_read_b64_tr_b16 v[54:55], v18 offset:10240
  buffer_load_dwordx4 v2, s[56:59], s88 offen offset:1024 lds
  v_add_u32 v165, s13, v164
  v_mfma_f32_16x16x32_bf16 v[64:67], v[40:43], a[144:147], v[64:67]
  ds_read_b64_tr_b16 v[56:57], v15 offset:12288
  ds_read_b128 a[160:163], v26 offset:49152
  ds_read_b128 a[176:179], v27 offset:49152
  v_mad_u32_u24 v165, v160, v211, v165
  v_mfma_f32_16x16x32_bf16 v[72:75], v[32:35], a[132:135], v[72:75]
  v_add_co_u32 v204, vcc, v204, v165
  v_lshrrev_b32 v163, 2, v161
  s_lshl_b32 s10, s5, 1
  v_mfma_f32_16x16x32_bf16 v[72:75], v[40:43], a[148:151], v[72:75]
  ds_read_b64_tr_b16 v[58:59], v15 offset:14336
  buffer_load_dwordx4 v3, s[56:59], s88 offen offset:2048 lds
  ds_read_b128 a[164:167], v26 offset:51200
  ds_read_b128 a[180:183], v27 offset:51200
  v_addc_co_u32 v205, vcc, 0, v205, vcc
  v_mfma_f32_16x16x32_bf16 v[80:83], v[32:35], a[136:139], v[80:83]
  ds_read_b64_tr_b16 v[60:61], v18 offset:12288
  buffer_load_dwordx4 v4, s[56:59], s88 offen offset:3072 lds
  v_add_u32 v163, s10, v163
  v_mfma_f32_16x16x32_bf16 v[80:83], v[40:43], a[152:155], v[80:83]
  ds_read_b128 a[168:171], v26 offset:53248
  ds_read_b128 a[184:187], v27 offset:53248
  v_min_u32 v164, 20, v164
  v_mfma_f32_16x16x32_bf16 v[88:91], v[32:35], a[140:143], v[88:91]
  ds_read_b64_tr_b16 v[62:63], v18 offset:14336
  v_mad_u32_u24 v164, v163, 36, v164
  v_cmp_gt_u32 vcc, 3, v163
  v_mfma_f32_16x16x32_bf16 v[88:91], v[40:43], a[156:159], v[88:91]
  ds_read_b128 a[172:175], v26 offset:55296
  ds_read_b128 a[188:191], v27 offset:55296
  v_subrev_u32 v165, 3, v163
  v_mfma_f32_16x16x32_bf16 v[68:71], v[36:39], a[128:131], v[68:71]
  v_mov_b32 v166, s22
  v_mov_b32 v167, s20
  v_cndmask_b32 v165, v165, v163, vcc
  v_mfma_f32_16x16x32_bf16 v[68:71], v[44:47], a[144:147], v[68:71]
  v_cndmask_b32 v206, v166, v167, vcc
  v_mov_b32 v166, s23
  v_mov_b32 v167, s21
  v_mfma_f32_16x16x32_bf16 v[76:79], v[36:39], a[132:135], v[76:79]
  v_cndmask_b32 v207, v166, v167, vcc
  v_lshlrev_b32 v165, 4, v165
  v_min_u32 v165, 20, v165
  v_mfma_f32_16x16x32_bf16 v[76:79], v[44:47], a[148:151], v[76:79]
  v_cmp_eq_u32 vcc, 6, v163
  v_mov_b32 v166, s34
  v_mov_b32 v167, s35
  v_mfma_f32_16x16x32_bf16 v[84:87], v[36:39], a[136:139], v[84:87]
  v_cndmask_b32 v206, v206, v166, vcc
  v_cndmask_b32 v207, v207, v167, vcc
  v_cndmask_b32_e64 v165, v165, 0, vcc
  v_mfma_f32_16x16x32_bf16 v[84:87], v[44:47], a[152:155], v[84:87]
  v_cndmask_b32_e64 v169, 36, 2, vcc
  v_sub_u32 v166, 3, v162
  v_lshl_add_u32 v166, v166, 6, v163
  v_mfma_f32_16x16x32_bf16 v[92:95], v[36:39], a[140:143], v[92:95]
  v_cmp_gt_u32 vcc, 7, v166
  v_mov_b32 v166, s18
  v_mov_b32 v167, s19
  v_mfma_f32_16x16x32_bf16 v[92:95], v[44:47], a[156:159], v[92:95]
  s_waitcnt vmcnt(8) lgkmcnt(0)
  s_barrier
  v_mfma_f32_16x16x32_bf16 v[64:67], v[48:51], a[160:163], v[64:67]
  ds_read_b64_tr_b16 v[32:33], v14 offset:0
  v_mov_b32 v168, 1152
  v_cndmask_b32 v206, v166, v206, vcc
  v_mfma_f32_16x16x32_bf16 v[64:67], v[56:59], a[176:179], v[64:67]
  ds_read_b64_tr_b16 v[34:35], v14 offset:2048
  v_readlane_b32 s88, v23, 5
  v_cndmask_b32 v207, v167, v207, vcc
  v_mfma_f32_16x16x32_bf16 v[72:75], v[48:51], a[164:167], v[72:75]
  ds_read_b64_tr_b16 v[36:37], v17 offset:0
  v_cndmask_b32 v164, v164, v165, vcc
  v_cndmask_b32 v212, v168, v169, vcc
  v_mfma_f32_16x16x32_bf16 v[72:75], v[56:59], a[180:183], v[72:75]
  ds_read_b64_tr_b16 v[38:39], v17 offset:2048
  ds_read_b128 a[192:195], v24 offset:0
  ds_read_b128 a[208:211], v25 offset:0
  v_mad_u32_u24 v164, v160, v212, v164
  v_mfma_f32_16x16x32_bf16 v[80:83], v[48:51], a[168:171], v[80:83]
  s_add_u32 m0, s9, 81920
  v_add_co_u32 v206, vcc, v206, v164
  v_cndmask_b32 v208, v204, v206, s[72:73]
  v_cndmask_b32 v210, v211, v212, s[72:73]
  v_mfma_f32_16x16x32_bf16 v[80:83], v[56:59], a[184:187], v[80:83]
  ds_read_b64_tr_b16 v[40:41], v14 offset:4096
  buffer_load_dwordx4 v1, s[52:55], s88 offen lds
  v_addc_co_u32 v207, vcc, 0, v207, vcc
  v_mfma_f32_16x16x32_bf16 v[88:91], v[48:51], a[172:175], v[88:91]
  ds_read_b64_tr_b16 v[42:43], v14 offset:6144
  buffer_load_dwordx4 v2, s[52:55], s88 offen offset:1024 lds
  ds_read_b128 a[196:199], v24 offset:2048
  ds_read_b128 a[212:215], v25 offset:2048
  v_mfma_f32_16x16x32_bf16 v[88:91], v[56:59], a[188:191], v[88:91]
  v_cndmask_b32 v209, v205, v207, s[72:73]
  s_mov_b32 s100, 146432
  v_mfma_f32_16x16x32_bf16 v[68:71], v[52:55], a[160:163], v[68:71]
  ds_read_b64_tr_b16 v[44:45], v17 offset:4096
  s_mov_b32 s101, 0
  v_mfma_f32_16x16x32_bf16 v[68:71], v[60:63], a[176:179], v[68:71]
  ds_read_b64_tr_b16 v[46:47], v17 offset:6144
  buffer_load_dwordx4 v3, s[52:55], s88 offen offset:2048 lds
  ds_read_b128 a[200:203], v24 offset:4096
  ds_read_b128 a[216:219], v25 offset:4096
  v_mfma_f32_16x16x32_bf16 v[76:79], v[52:55], a[164:167], v[76:79]
  v_lshlrev_b32 v218, 4, v212
  v_subrev_u32 v218, 1024, v218
  v_mfma_f32_16x16x32_bf16 v[76:79], v[60:63], a[180:183], v[76:79]
  ds_read_b128 a[204:207], v24 offset:6144
  ds_read_b128 a[220:223], v25 offset:6144
  v_mfma_f32_16x16x32_bf16 v[84:87], v[52:55], a[168:171], v[84:87]
  ds_read_b64_tr_b16 v[48:49], v14 offset:8192
  buffer_load_dwordx4 v4, s[52:55], s88 offen offset:3072 lds
  v_readlane_b32 s88, v23, 6
  s_add_u32 m0, s9, 98304
  v_mfma_f32_16x16x32_bf16 v[84:87], v[60:63], a[184:187], v[84:87]
  ds_read_b64_tr_b16 v[50:51], v14 offset:10240
  v_ashrrev_i32 v219, 31, v218
  v_mfma_f32_16x16x32_bf16 v[92:95], v[52:55], a[172:175], v[92:95]
  ds_read_b64_tr_b16 v[52:53], v17 offset:8192
  buffer_load_dwordx4 v1, s[52:55], s88 offen lds
  v_mfma_f32_16x16x32_bf16 v[92:95], v[60:63], a[188:191], v[92:95]
  s_waitcnt lgkmcnt(3)
  v_lshlrev_b32 v220, 4, v210
  v_subrev_u32 v220, 1024, v220
  v_mfma_f32_16x16x32_bf16 v[64:67], v[32:35], a[192:195], v[64:67]
  ds_read_b64_tr_b16 v[54:55], v17 offset:10240
  buffer_load_dwordx4 v2, s[52:55], s88 offen offset:1024 lds
  v_mfma_f32_16x16x32_bf16 v[64:67], v[40:43], a[208:211], v[64:67]
  ds_read_b64_tr_b16 v[56:57], v14 offset:12288
  ds_read_b128 a[224:227], v24 offset:16384
  ds_read_b128 a[240:243], v25 offset:16384
  v_mfma_f32_16x16x32_bf16 v[72:75], v[32:35], a[196:199], v[72:75]
  v_ashrrev_i32 v221, 31, v220
  s_and_b32 s11, s4, 15
  v_mfma_f32_16x16x32_bf16 v[72:75], v[40:43], a[212:215], v[72:75]
  ds_read_b64_tr_b16 v[58:59], v14 offset:14336
  buffer_load_dwordx4 v3, s[52:55], s88 offen offset:2048 lds
  ds_read_b128 a[228:231], v24 offset:18432
  ds_read_b128 a[244:247], v25 offset:18432
  v_mfma_f32_16x16x32_bf16 v[80:83], v[32:35], a[200:203], v[80:83]
  ds_read_b64_tr_b16 v[60:61], v17 offset:12288
  buffer_load_dwordx4 v4, s[52:55], s88 offen offset:3072 lds
  v_mfma_f32_16x16x32_bf16 v[80:83], v[40:43], a[216:219], v[80:83]
  ds_read_b128 a[232:235], v24 offset:20480
  ds_read_b128 a[248:251], v25 offset:20480
  v_mfma_f32_16x16x32_bf16 v[88:91], v[32:35], a[204:207], v[88:91]
  ds_read_b64_tr_b16 v[62:63], v17 offset:14336
  s_lshl_b32 s11, s11, 2
  v_mfma_f32_16x16x32_bf16 v[88:91], v[40:43], a[220:223], v[88:91]
  ds_read_b128 a[236:239], v24 offset:22528
  ds_read_b128 a[252:255], v25 offset:22528
  v_mfma_f32_16x16x32_bf16 v[68:71], v[36:39], a[192:195], v[68:71]
  s_add_u32 s11, s11, s3
  s_mul_i32 s12, s11, 5184
  v_mfma_f32_16x16x32_bf16 v[68:71], v[44:47], a[208:211], v[68:71]
  s_mul_i32 s10, s5, 331776
  s_add_u32 s12, s12, s10
  v_mfma_f32_16x16x32_bf16 v[76:79], v[36:39], a[196:199], v[76:79]
  v_min_u32 v252, 10, v0
  v_lshlrev_b32 v252, 7, v252
  v_mfma_f32_16x16x32_bf16 v[76:79], v[44:47], a[212:215], v[76:79]
  v_add_u32 v252, s12, v252
  v_mfma_f32_16x16x32_bf16 v[84:87], v[36:39], a[200:203], v[84:87]
  v_mfma_f32_16x16x32_bf16 v[84:87], v[44:47], a[216:219], v[84:87]
  v_mfma_f32_16x16x32_bf16 v[92:95], v[36:39], a[204:207], v[92:95]
  v_mfma_f32_16x16x32_bf16 v[92:95], v[44:47], a[220:223], v[92:95]
  s_waitcnt vmcnt(8) lgkmcnt(0)
  s_barrier
  v_mfma_f32_16x16x32_bf16 v[64:67], v[48:51], a[224:227], v[64:67]
  ds_read_b64_tr_b16 v[32:33], v13 offset:49152
  v_mfma_f32_16x16x32_bf16 v[64:67], v[56:59], a[240:243], v[64:67]
  ds_read_b64_tr_b16 v[34:35], v13 offset:51200
  v_readlane_b32 s88, v23, 7
  v_mfma_f32_16x16x32_bf16 v[72:75], v[48:51], a[228:231], v[72:75]
  ds_read_b64_tr_b16 v[36:37], v16 offset:49152
  v_mfma_f32_16x16x32_bf16 v[72:75], v[56:59], a[244:247], v[72:75]
  ds_read_b64_tr_b16 v[38:39], v16 offset:51200
  ds_read_b128 v[172:175], v24 offset:32768
  ds_read_b128 v[188:191], v25 offset:32768
  v_mfma_f32_16x16x32_bf16 v[80:83], v[48:51], a[232:235], v[80:83]
  s_add_u32 m0, s9, 114688
  v_mfma_f32_16x16x32_bf16 v[80:83], v[56:59], a[248:251], v[80:83]
  ds_read_b64_tr_b16 v[40:41], v13 offset:53248
  buffer_load_dwordx4 v1, s[52:55], s88 offen lds
  v_mfma_f32_16x16x32_bf16 v[88:91], v[48:51], a[236:239], v[88:91]
  ds_read_b64_tr_b16 v[42:43], v13 offset:55296
  ds_read_b128 v[176:179], v24 offset:34816
  ds_read_b128 v[192:195], v25 offset:34816
  v_mfma_f32_16x16x32_bf16 v[88:91], v[56:59], a[252:255], v[88:91]
  v_mfma_f32_16x16x32_bf16 v[68:71], v[52:55], a[224:227], v[68:71]
  ds_read_b64_tr_b16 v[44:45], v16 offset:53248
  buffer_load_dwordx4 v2, s[52:55], s88 offen offset:1024 lds
  v_mfma_f32_16x16x32_bf16 v[68:71], v[60:63], a[240:243], v[68:71]
  ds_read_b64_tr_b16 v[46:47], v16 offset:55296
  ds_read_b128 v[180:183], v24 offset:36864
  ds_read_b128 v[196:199], v25 offset:36864
  v_mfma_f32_16x16x32_bf16 v[76:79], v[52:55], a[228:231], v[76:79]
  v_mfma_f32_16x16x32_bf16 v[76:79], v[60:63], a[244:247], v[76:79]
  ds_read_b128 v[184:187], v24 offset:38912
  ds_read_b128 v[200:203], v25 offset:38912
  v_mfma_f32_16x16x32_bf16 v[84:87], v[52:55], a[232:235], v[84:87]
  ds_read_b64_tr_b16 v[48:49], v13 offset:57344
  buffer_load_dwordx4 v3, s[52:55], s88 offen offset:2048 lds
  v_mfma_f32_16x16x32_bf16 v[84:87], v[60:63], a[248:251], v[84:87]
  ds_read_b64_tr_b16 v[50:51], v13 offset:59392
  v_mfma_f32_16x16x32_bf16 v[92:95], v[52:55], a[236:239], v[92:95]
  ds_read_b64_tr_b16 v[52:53], v16 offset:57344
  buffer_load_dwordx4 v4, s[52:55], s88 offen offset:3072 lds
  v_readlane_b32 s88, v23, 8
  s_add_u32 m0, s9, 131072
  v_mfma_f32_16x16x32_bf16 v[92:95], v[60:63], a[252:255], v[92:95]
  s_waitcnt lgkmcnt(3)
  v_mfma_f32_16x16x32_bf16 v[64:67], v[32:35], v[172:175], v[64:67]
  ds_read_b64_tr_b16 v[54:55], v16 offset:59392
  v_mfma_f32_16x16x32_bf16 v[64:67], v[40:43], v[188:191], v[64:67]
  ds_read_b64_tr_b16 v[56:57], v13 offset:61440
  buffer_load_dwordx4 v1, s[52:55], s88 offen lds
  v_mfma_f32_16x16x32_bf16 v[72:75], v[32:35], v[176:179], v[72:75]
  v_mfma_f32_16x16x32_bf16 v[72:75], v[40:43], v[192:195], v[72:75]
  ds_read_b64_tr_b16 v[58:59], v13 offset:63488
  v_mfma_f32_16x16x32_bf16 v[80:83], v[32:35], v[180:183], v[80:83]
  ds_read_b64_tr_b16 v[60:61], v16 offset:61440
  buffer_load_dwordx4 v2, s[52:55], s88 offen offset:1024 lds
  v_mfma_f32_16x16x32_bf16 v[80:83], v[40:43], v[196:199], v[80:83]
  v_mfma_f32_16x16x32_bf16 v[88:91], v[32:35], v[184:187], v[88:91]
  ds_read_b64_tr_b16 v[62:63], v16 offset:63488
  v_mfma_f32_16x16x32_bf16 v[88:91], v[40:43], v[200:203], v[88:91]
  v_mfma_f32_16x16x32_bf16 v[68:71], v[36:39], v[172:175], v[68:71]
  v_mfma_f32_16x16x32_bf16 v[68:71], v[44:47], v[188:191], v[68:71]
  v_mfma_f32_16x16x32_bf16 v[76:79], v[36:39], v[176:179], v[76:79]
  v_mfma_f32_16x16x32_bf16 v[76:79], v[44:47], v[192:195], v[76:79]
  v_mfma_f32_16x16x32_bf16 v[84:87], v[36:39], v[180:183], v[84:87]
  v_mfma_f32_16x16x32_bf16 v[84:87], v[44:47], v[196:199], v[84:87]
  v_mfma_f32_16x16x32_bf16 v[92:95], v[36:39], v[184:187], v[92:95]
  v_mfma_f32_16x16x32_bf16 v[92:95], v[44:47], v[200:203], v[92:95]
  s_waitcnt vmcnt(10) lgkmcnt(0)
  s_barrier
  v_mfma_f32_16x16x32_bf16 v[128:131], v[48:51], a[0:3], 0
  ds_read_b64_tr_b16 v[32:33], v14 offset:16384
  v_mfma_f32_16x16x32_bf16 v[128:131], v[56:59], a[16:19], v[128:131]
  ds_read_b64_tr_b16 v[34:35], v14 offset:18432
  v_mfma_f32_16x16x32_bf16 v[136:139], v[48:51], a[4:7], 0
  ds_read_b64_tr_b16 v[36:37], v14 offset:20480
  v_mfma_f32_16x16x32_bf16 v[136:139], v[56:59], a[20:23], v[136:139]
  ds_read_b64_tr_b16 v[38:39], v14 offset:22528
  v_mul_f32 v160, v64, v64
  v_mfma_f32_16x16x32_bf16 v[144:147], v[48:51], a[8:11], 0
  v_fmaak_f32 v160, v160, v20, 0xc0135761
  v_mul_f32 v161, v65, v65
  v_mfma_f32_16x16x32_bf16 v[144:147], v[56:59], a[24:27], v[144:147]
  ds_read_b64_tr_b16 v[40:41], v14 offset:24576
  buffer_load_dwordx4 v3, s[52:55], s88 offen offset:2048 lds
  v_mfma_f32_16x16x32_bf16 v[152:155], v[48:51], a[12:15], 0
  ds_read_b64_tr_b16 v[42:43], v14 offset:26624
  v_mul_f32 v160, v160, v64
  v_mfma_f32_16x16x32_bf16 v[152:155], v[56:59], a[28:31], v[152:155]
  v_exp_f32 v160, v160
  v_mfma_f32_16x16x32_bf16 v[132:135], v[52:55], a[0:3], 0
  ds_read_b64_tr_b16 v[44:45], v14 offset:28672
  buffer_load_dwordx4 v4, s[52:55], s88 offen offset:3072 lds
  v_readlane_b32 s88, v23, 9
  v_mfma_f32_16x16x32_bf16 v[132:135], v[60:63], a[16:19], v[132:135]
PAD1:
  s_cbranch_execz PAD5
  ds_read_b64_tr_b16 v[46:47], v14 offset:30720
  v_add_f32 v160, 1.0, v160
  v_mfma_f32_16x16x32_bf16 v[140:143], v[52:55], a[4:7], 0
  s_add_u32 m0, s9, 16384
  v_rcp_f32 v160, v160
  v_mfma_f32_16x16x32_bf16 v[140:143], v[60:63], a[20:23], v[140:143]
  v_mul_f32 v64, v160, v64
  v_fmaak_f32 v161, v161, v20, 0xc0135761
  v_mfma_f32_16x16x32_bf16 v[148:151], v[52:55], a[8:11], 0
  ds_read_b64_tr_b16 v[48:49], v17 offset:16384
  buffer_load_dwordx4 v1, s[48:51], s88 offen lds
  v_mfma_f32_16x16x32_bf16 v[148:151], v[60:63], a[24:27], v[148:151]
  ds_read_b64_tr_b16 v[50:51], v17 offset:18432
  v_mul_f32 v161, v161, v65
  v_mfma_f32_16x16x32_bf16 v[156:159], v[52:55], a[12:15], 0
  ds_read_b64_tr_b16 v[52:53], v17 offset:20480
  buffer_load_dwordx4 v2, s[48:51], s88 offen offset:1024 lds
  v_mfma_f32_16x16x32_bf16 v[156:159], v[60:63], a[28:31], v[156:159]
  s_waitcnt lgkmcnt(3)
  v_exp_f32 v161, v161
  v_mfma_f32_16x16x32_bf16 v[128:131], v[32:35], a[32:35], v[128:131]
  ds_read_b64_tr_b16 v[54:55], v17 offset:22528
  v_add_f32 v161, 1.0, v161
  v_mfma_f32_16x16x32_bf16 v[128:131], v[36:39], a[48:51], v[128:131]
  ds_read_b64_tr_b16 v[56:57], v17 offset:24576
  buffer_load_dwordx4 v3, s[48:51], s88 offen offset:2048 lds
  v_mfma_f32_16x16x32_bf16 v[128:131], v[40:43], a[64:67], v[128:131]
  v_rcp_f32 v161, v161
  v_mfma_f32_16x16x32_bf16 v[128:131], v[44:47], a[80:83], v[128:131]
  ds_read_b64_tr_b16 v[58:59], v17 offset:26624
  v_mul_f32 v65, v161, v65
  v_mfma_f32_16x16x32_bf16 v[136:139], v[32:35], a[36:39], v[136:139]
  ds_read_b64_tr_b16 v[60:61], v17 offset:28672
  buffer_load_dwordx4 v4, s[48:51], s88 offen offset:3072 lds
  v_mfma_f32_16x16x32_bf16 v[136:139], v[36:39], a[52:55], v[136:139]
  v_mul_f32 v162, v66, v66
  v_mul_f32 v163, v67, v67
  v_mfma_f32_16x16x32_bf16 v[136:139], v[40:43], a[68:71], v[136:139]
  ds_read_b64_tr_b16 v[62:63], v17 offset:30720
  v_fmaak_f32 v162, v162, v20, 0xc0135761
  v_mfma_f32_16x16x32_bf16 v[136:139], v[44:47], a[84:87], v[136:139]
  v_mul_f32 v162, v162, v66
  v_fmaak_f32 v163, v163, v20, 0xc0135761
  v_mfma_f32_16x16x32_bf16 v[144:147], v[32:35], a[40:43], v[144:147]
  v_exp_f32 v162, v162
  v_mfma_f32_16x16x32_bf16 v[144:147], v[36:39], a[56:59], v[144:147]
  v_add_f32 v162, 1.0, v162
  v_mul_f32 v163, v163, v67
  v_mfma_f32_16x16x32_bf16 v[144:147], v[40:43], a[72:75], v[144:147]
  v_rcp_f32 v162, v162
  v_mfma_f32_16x16x32_bf16 v[144:147], v[44:47], a[88:91], v[144:147]
  v_exp_f32 v163, v163
  v_mfma_f32_16x16x32_bf16 v[152:155], v[32:35], a[44:47], v[152:155]
  v_mul_f32 v66, v162, v66
  v_add_f32 v163, 1.0, v163
  v_mfma_f32_16x16x32_bf16 v[152:155], v[36:39], a[60:63], v[152:155]
  v_rcp_f32 v163, v163
  v_mfma_f32_16x16x32_bf16 v[152:155], v[40:43], a[76:79], v[152:155]
  v_mul_f32 v67, v163, v67
  v_mul_f32 v164, v68, v68
  v_mfma_f32_16x16x32_bf16 v[152:155], v[44:47], a[92:95], v[152:155]
  s_waitcnt vmcnt(8) lgkmcnt(0)
  s_barrier
  v_mfma_f32_16x16x32_bf16 v[132:135], v[48:51], a[32:35], v[132:135]
  ds_read_b64_tr_b16 v[32:33], v14 offset:32768
  v_fmaak_f32 v164, v164, v20, 0xc0135761
  v_mfma_f32_16x16x32_bf16 v[132:135], v[52:55], a[48:51], v[132:135]
  ds_read_b64_tr_b16 v[34:35], v14 offset:34816
  v_readlane_b32 s88, v23, 10
  v_mfma_f32_16x16x32_bf16 v[132:135], v[56:59], a[64:67], v[132:135]
  ds_read_b64_tr_b16 v[36:37], v14 offset:36864
  v_mul_f32 v164, v164, v68
  v_mfma_f32_16x16x32_bf16 v[132:135], v[60:63], a[80:83], v[132:135]
  ds_read_b64_tr_b16 v[38:39], v14 offset:38912
  v_mul_f32 v165, v69, v69
  v_mfma_f32_16x16x32_bf16 v[140:143], v[48:51], a[36:39], v[140:143]
  s_add_u32 m0, s9, 65536
  v_exp_f32 v164, v164
  v_mfma_f32_16x16x32_bf16 v[140:143], v[52:55], a[52:55], v[140:143]
  ds_read_b64_tr_b16 v[40:41], v14 offset:40960
  buffer_load_dwordx4 v1, s[48:51], s88 offen lds
  v_mfma_f32_16x16x32_bf16 v[140:143], v[56:59], a[68:71], v[140:143]
  ds_read_b64_tr_b16 v[42:43], v14 offset:43008
  v_add_f32 v164, 1.0, v164
  v_mfma_f32_16x16x32_bf16 v[140:143], v[60:63], a[84:87], v[140:143]
  v_rcp_f32 v164, v164
  v_mfma_f32_16x16x32_bf16 v[148:151], v[48:51], a[40:43], v[148:151]
  ds_read_b64_tr_b16 v[44:45], v14 offset:45056
  v_mul_f32 v68, v164, v68
  v_mfma_f32_16x16x32_bf16 v[148:151], v[52:55], a[56:59], v[148:151]
  ds_read_b64_tr_b16 v[46:47], v14 offset:47104
  buffer_load_dwordx4 v2, s[48:51], s88 offen offset:1024 lds
  v_mfma_f32_16x16x32_bf16 v[148:151], v[56:59], a[72:75], v[148:151]
  v_fmaak_f32 v165, v165, v20, 0xc0135761
  v_mul_f32 v166, v70, v70
  v_mfma_f32_16x16x32_bf16 v[148:151], v[60:63], a[88:91], v[148:151]
  v_mul_f32 v165, v165, v69
  v_fmaak_f32 v166, v166, v20, 0xc0135761
  v_mfma_f32_16x16x32_bf16 v[156:159], v[48:51], a[44:47], v[156:159]
  ds_read_b64_tr_b16 v[48:49], v17 offset:32768
  v_mul_f32 v166, v166, v70
  v_mfma_f32_16x16x32_bf16 v[156:159], v[52:55], a[60:63], v[156:159]
  ds_read_b64_tr_b16 v[50:51], v17 offset:34816
  v_mul_f32 v167, v71, v71
  v_mfma_f32_16x16x32_bf16 v[156:159], v[56:59], a[76:79], v[156:159]
  ds_read_b64_tr_b16 v[52:53], v17 offset:36864
  buffer_load_dwordx4 v3, s[48:51], s88 offen offset:2048 lds
  v_mfma_f32_16x16x32_bf16 v[156:159], v[60:63], a[92:95], v[156:159]
  s_waitcnt lgkmcnt(3)
  v_exp_f32 v165, v165
  v_mfma_f32_16x16x32_bf16 v[128:131], v[32:35], a[96:99], v[128:131]
  ds_read_b64_tr_b16 v[54:55], v17 offset:38912
  v_add_f32 v165, 1.0, v165
  v_mfma_f32_16x16x32_bf16 v[128:131], v[36:39], a[112:115], v[128:131]
  ds_read_b64_tr_b16 v[56:57], v17 offset:40960
  v_fmaak_f32 v167, v167, v20, 0xc0135761
  v_mfma_f32_16x16x32_bf16 v[128:131], v[40:43], a[128:131], v[128:131]
  v_rcp_f32 v165, v165
  v_mfma_f32_16x16x32_bf16 v[128:131], v[44:47], a[144:147], v[128:131]
  ds_read_b64_tr_b16 v[58:59], v17 offset:43008
  buffer_load_dwordx4 v4, s[48:51], s88 offen offset:3072 lds
  v_mfma_f32_16x16x32_bf16 v[136:139], v[32:35], a[100:103], v[136:139]
  ds_read_b64_tr_b16 v[60:61], v17 offset:45056
  v_mul_f32 v69, v165, v69
  v_mfma_f32_16x16x32_bf16 v[136:139], v[36:39], a[116:119], v[136:139]
  v_exp_f32 v166, v166
  v_mfma_f32_16x16x32_bf16 v[136:139], v[40:43], a[132:135], v[136:139]
  ds_read_b64_tr_b16 v[62:63], v17 offset:47104
  v_add_f32 v166, 1.0, v166
  v_mfma_f32_16x16x32_bf16 v[136:139], v[44:47], a[148:151], v[136:139]
  v_rcp_f32 v166, v166
  v_mfma_f32_16x16x32_bf16 v[144:147], v[32:35], a[104:107], v[144:147]
  v_mul_f32 v70, v166, v70
  v_mul_f32 v167, v167, v71
  v_mfma_f32_16x16x32_bf16 v[144:147], v[36:39], a[120:123], v[144:147]
  v_exp_f32 v167, v167
  v_mfma_f32_16x16x32_bf16 v[144:147], v[40:43], a[136:139], v[144:147]
  v_add_f32 v167, 1.0, v167
  v_mul_f32 v168, v72, v72
  v_mfma_f32_16x16x32_bf16 v[144:147], v[44:47], a[152:155], v[144:147]
  v_rcp_f32 v167, v167
  v_mfma_f32_16x16x32_bf16 v[152:155], v[32:35], a[108:111], v[152:155]
  v_mul_f32 v71, v167, v71
  v_fmaak_f32 v168, v168, v20, 0xc0135761
  v_mfma_f32_16x16x32_bf16 v[152:155], v[36:39], a[124:127], v[152:155]
  v_mul_f32 v168, v168, v72
  v_mul_f32 v169, v73, v73
  v_mfma_f32_16x16x32_bf16 v[152:155], v[40:43], a[140:143], v[152:155]
  v_exp_f32 v168, v168
  v_mfma_f32_16x16x32_bf16 v[152:155], v[44:47], a[156:159], v[152:155]
  s_waitcnt lgkmcnt(0)
  v_add_f32 v168, 1.0, v168
  v_fmaak_f32 v169, v169, v20, 0xc0135761
  v_mfma_f32_16x16x32_bf16 v[132:135], v[48:51], a[96:99], v[132:135]
  ds_read_b64_tr_b16 v[32:33], v14 offset:49152
  v_mul_f32 v169, v169, v73
  v_mfma_f32_16x16x32_bf16 v[132:135], v[52:55], a[112:115], v[132:135]
  ds_read_b64_tr_b16 v[34:35], v14 offset:51200
  v_readlane_b32 s88, v23, 11
  v_mfma_f32_16x16x32_bf16 v[132:135], v[56:59], a[128:131], v[132:135]
  ds_read_b64_tr_b16 v[36:37], v14 offset:53248
  v_mul_f32 v170, v74, v74
  v_mfma_f32_16x16x32_bf16 v[132:135], v[60:63], a[144:147], v[132:135]
  ds_read_b64_tr_b16 v[38:39], v14 offset:55296
  v_fmaak_f32 v170, v170, v20, 0xc0135761
  v_mfma_f32_16x16x32_bf16 v[140:143], v[48:51], a[100:103], v[140:143]
  s_add_u32 m0, s9, 147456
  v_rcp_f32 v168, v168
  v_mfma_f32_16x16x32_bf16 v[140:143], v[52:55], a[116:119], v[140:143]
  ds_read_b64_tr_b16 v[40:41], v14 offset:57344
  buffer_load_dwordx4 v1, s[48:51], s88 offen lds
  v_mfma_f32_16x16x32_bf16 v[140:143], v[56:59], a[132:135], v[140:143]
  ds_read_b64_tr_b16 v[42:43], v14 offset:59392
  v_mul_f32 v72, v168, v72
  v_mfma_f32_16x16x32_bf16 v[140:143], v[60:63], a[148:151], v[140:143]
  v_exp_f32 v169, v169
  v_mfma_f32_16x16x32_bf16 v[148:151], v[48:51], a[104:107], v[148:151]
  ds_read_b64_tr_b16 v[44:45], v14 offset:61440
  v_add_f32 v169, 1.0, v169
  v_mfma_f32_16x16x32_bf16 v[148:151], v[52:55], a[120:123], v[148:151]
  ds_read_b64_tr_b16 v[46:47], v14 offset:63488
  buffer_load_dwordx4 v2, s[48:51], s88 offen offset:1024 lds
  v_mfma_f32_16x16x32_bf16 v[148:151], v[56:59], a[136:139], v[148:151]
  v_rcp_f32 v169, v169
  v_mfma_f32_16x16x32_bf16 v[148:151], v[60:63], a[152:155], v[148:151]
  v_mul_f32 v73, v169, v73
  v_mul_f32 v170, v170, v74
  v_mfma_f32_16x16x32_bf16 v[156:159], v[48:51], a[108:111], v[156:159]
  ds_read_b64_tr_b16 v[48:49], v17 offset:49152
  v_mul_f32 v171, v75, v75
  v_mfma_f32_16x16x32_bf16 v[156:159], v[52:55], a[124:127], v[156:159]
  ds_read_b64_tr_b16 v[50:51], v17 offset:51200
  v_fmaak_f32 v171, v171, v20, 0xc0135761
  v_mfma_f32_16x16x32_bf16 v[156:159], v[56:59], a[140:143], v[156:159]
  ds_read_b64_tr_b16 v[52:53], v17 offset:53248
  buffer_load_dwordx4 v3, s[48:51], s88 offen offset:2048 lds
  v_mfma_f32_16x16x32_bf16 v[156:159], v[60:63], a[156:159], v[156:159]
  s_waitcnt lgkmcnt(3)
  v_exp_f32 v170, v170
  v_mfma_f32_16x16x32_bf16 v[128:131], v[32:35], a[160:163], v[128:131]
  ds_read_b64_tr_b16 v[54:55], v17 offset:55296
  v_add_f32 v170, 1.0, v170
  v_mfma_f32_16x16x32_bf16 v[128:131], v[36:39], a[176:179], v[128:131]
  ds_read_b64_tr_b16 v[56:57], v17 offset:57344
  v_mul_f32 v171, v171, v75
  v_mfma_f32_16x16x32_bf16 v[128:131], v[40:43], a[192:195], v[128:131]
  v_rcp_f32 v170, v170
  v_mfma_f32_16x16x32_bf16 v[128:131], v[44:47], a[208:211], v[128:131]
  ds_read_b64_tr_b16 v[58:59], v17 offset:59392
  buffer_load_dwordx4 v4, s[48:51], s88 offen offset:3072 lds
  v_mfma_f32_16x16x32_bf16 v[136:139], v[32:35], a[164:167], v[136:139]
  ds_read_b64_tr_b16 v[60:61], v17 offset:61440
  v_mul_f32 v74, v170, v74
  v_mfma_f32_16x16x32_bf16 v[136:139], v[36:39], a[180:183], v[136:139]
  v_exp_f32 v171, v171
  v_mfma_f32_16x16x32_bf16 v[136:139], v[40:43], a[196:199], v[136:139]
  ds_read_b64_tr_b16 v[62:63], v17 offset:63488
  v_add_f32 v171, 1.0, v171
  v_mfma_f32_16x16x32_bf16 v[136:139], v[44:47], a[212:215], v[136:139]
  v_rcp_f32 v171, v171
  v_mfma_f32_16x16x32_bf16 v[144:147], v[32:35], a[168:171], v[144:147]
  v_mul_f32 v75, v171, v75
  v_mul_f32 v160, v76, v76
  v_mfma_f32_16x16x32_bf16 v[144:147], v[36:39], a[184:187], v[144:147]
  v_fmaak_f32 v160, v160, v20, 0xc0135761
  v_mul_f32 v161, v77, v77
  v_mfma_f32_16x16x32_bf16 v[144:147], v[40:43], a[200:203], v[144:147]
  v_mul_f32 v160, v160, v76
  v_fmaak_f32 v161, v161, v20, 0xc0135761
  v_mfma_f32_16x16x32_bf16 v[144:147], v[44:47], a[216:219], v[144:147]
  v_exp_f32 v160, v160
  v_mfma_f32_16x16x32_bf16 v[152:155], v[32:35], a[172:175], v[152:155]
  v_add_f32 v160, 1.0, v160
  v_mul_f32 v161, v161, v77
  v_mfma_f32_16x16x32_bf16 v[152:155], v[36:39], a[188:191], v[152:155]
  v_rcp_f32 v160, v160
  v_mfma_f32_16x16x32_bf16 v[152:155], v[40:43], a[204:207], v[152:155]
  v_exp_f32 v161, v161
  v_mfma_f32_16x16x32_bf16 v[152:155], v[44:47], a[220:223], v[152:155]
  s_waitcnt vmcnt(8) lgkmcnt(0)
  s_barrier
  v_mfma_f32_16x16x32_bf16 v[132:135], v[48:51], a[160:163], v[132:135]
  ds_read_b64_tr_b16 v[32:33], v15 offset:0
  v_mul_f32 v76, v160, v76
  v_mfma_f32_16x16x32_bf16 v[132:135], v[52:55], a[176:179], v[132:135]
  ds_read_b64_tr_b16 v[34:35], v15 offset:2048
  v_readlane_b32 s88, v23, 12
  v_mfma_f32_16x16x32_bf16 v[132:135], v[56:59], a[192:195], v[132:135]
  ds_read_b64_tr_b16 v[36:37], v15 offset:4096
  v_add_f32 v161, 1.0, v161
  v_mfma_f32_16x16x32_bf16 v[132:135], v[60:63], a[208:211], v[132:135]
  ds_read_b64_tr_b16 v[38:39], v15 offset:6144
  v_mul_f32 v162, v78, v78
  v_mfma_f32_16x16x32_bf16 v[140:143], v[48:51], a[164:167], v[140:143]
  s_add_u32 m0, s9, 32768
  v_rcp_f32 v161, v161
  v_mfma_f32_16x16x32_bf16 v[140:143], v[52:55], a[180:183], v[140:143]
  ds_read_b64_tr_b16 v[40:41], v15 offset:8192
  buffer_load_dwordx4 v1, s[48:51], s88 offen lds
  v_mfma_f32_16x16x32_bf16 v[140:143], v[56:59], a[196:199], v[140:143]
  ds_read_b64_tr_b16 v[42:43], v15 offset:10240
  v_mul_f32 v77, v161, v77
  v_mfma_f32_16x16x32_bf16 v[140:143], v[60:63], a[212:215], v[140:143]
  v_fmaak_f32 v162, v162, v20, 0xc0135761
  v_mul_f32 v163, v79, v79
  v_mfma_f32_16x16x32_bf16 v[148:151], v[48:51], a[168:171], v[148:151]
  ds_read_b64_tr_b16 v[44:45], v15 offset:12288
  v_mul_f32 v162, v162, v78
  v_mfma_f32_16x16x32_bf16 v[148:151], v[52:55], a[184:187], v[148:151]
  ds_read_b64_tr_b16 v[46:47], v15 offset:14336
  buffer_load_dwordx4 v2, s[48:51], s88 offen offset:1024 lds
  v_mfma_f32_16x16x32_bf16 v[148:151], v[56:59], a[200:203], v[148:151]
  v_exp_f32 v162, v162
  v_mfma_f32_16x16x32_bf16 v[148:151], v[60:63], a[216:219], v[148:151]
  v_add_f32 v162, 1.0, v162
  v_fmaak_f32 v163, v163, v20, 0xc0135761
  v_mfma_f32_16x16x32_bf16 v[156:159], v[48:51], a[172:175], v[156:159]
  ds_read_b64_tr_b16 v[48:49], v18 offset:0
  v_mul_f32 v163, v163, v79
  v_mfma_f32_16x16x32_bf16 v[156:159], v[52:55], a[188:191], v[156:159]
  ds_read_b64_tr_b16 v[50:51], v18 offset:2048
  v_mul_f32 v164, v80, v80
  v_mfma_f32_16x16x32_bf16 v[156:159], v[56:59], a[204:207], v[156:159]
  ds_read_b64_tr_b16 v[52:53], v18 offset:4096
  buffer_load_dwordx4 v3, s[48:51], s88 offen offset:2048 lds
  v_mfma_f32_16x16x32_bf16 v[156:159], v[60:63], a[220:223], v[156:159]
  s_waitcnt lgkmcnt(3)
  v_rcp_f32 v162, v162
  v_mfma_f32_16x16x32_bf16 v[128:131], v[32:35], a[224:227], v[128:131]
  ds_read_b64_tr_b16 v[54:55], v18 offset:6144
  v_mul_f32 v78, v162, v78
  v_mfma_f32_16x16x32_bf16 v[128:131], v[36:39], a[240:243], v[128:131]
  ds_read_b64_tr_b16 v[56:57], v18 offset:8192
  v_fmaak_f32 v164, v164, v20, 0xc0135761
  v_mfma_f32_16x16x32_bf16 v[128:131], v[40:43], v[172:175], v[128:131]
  v_exp_f32 v163, v163
  v_mfma_f32_16x16x32_bf16 v[128:131], v[44:47], v[188:191], v[128:131]
  ds_read_b64_tr_b16 v[58:59], v18 offset:10240
  buffer_load_dwordx4 v4, s[48:51], s88 offen offset:3072 lds
  v_mfma_f32_16x16x32_bf16 v[136:139], v[32:35], a[228:231], v[136:139]
  ds_read_b64_tr_b16 v[60:61], v18 offset:12288
  v_add_f32 v163, 1.0, v163
  v_mfma_f32_16x16x32_bf16 v[136:139], v[36:39], a[244:247], v[136:139]
  v_rcp_f32 v163, v163
  v_mfma_f32_16x16x32_bf16 v[136:139], v[40:43], v[176:179], v[136:139]
  ds_read_b64_tr_b16 v[62:63], v18 offset:14336
  v_mul_f32 v79, v163, v79
  v_mfma_f32_16x16x32_bf16 v[136:139], v[44:47], v[192:195], v[136:139]
  v_mul_f32 v164, v164, v80
  v_mul_f32 v165, v81, v81
  v_mfma_f32_16x16x32_bf16 v[144:147], v[32:35], a[232:235], v[144:147]
  v_exp_f32 v164, v164
  v_mfma_f32_16x16x32_bf16 v[144:147], v[36:39], a[248:251], v[144:147]
  v_add_f32 v164, 1.0, v164
  v_fmaak_f32 v165, v165, v20, 0xc0135761
  v_mfma_f32_16x16x32_bf16 v[144:147], v[40:43], v[180:183], v[144:147]
  v_rcp_f32 v164, v164
  v_mfma_f32_16x16x32_bf16 v[144:147], v[44:47], v[196:199], v[144:147]
  v_mul_f32 v80, v164, v80
  v_mul_f32 v165, v165, v81
  v_mfma_f32_16x16x32_bf16 v[152:155], v[32:35], a[236:239], v[152:155]
  v_exp_f32 v165, v165
  v_mfma_f32_16x16x32_bf16 v[152:155], v[36:39], a[252:255], v[152:155]
  v_add_f32 v165, 1.0, v165
  v_mul_f32 v166, v82, v82
  v_mfma_f32_16x16x32_bf16 v[152:155], v[40:43], v[184:187], v[152:155]
  v_rcp_f32 v165, v165
  v_mfma_f32_16x16x32_bf16 v[152:155], v[44:47], v[200:203], v[152:155]
  s_waitcnt lgkmcnt(0)
  v_mul_f32 v81, v165, v81
  v_fmaak_f32 v166, v166, v20, 0xc0135761
  v_mfma_f32_16x16x32_bf16 v[132:135], v[48:51], a[224:227], v[132:135]
  ds_read_b64_tr_b16 v[32:33], v13 offset:16384
  v_mul_f32 v166, v166, v82
  v_mfma_f32_16x16x32_bf16 v[132:135], v[52:55], a[240:243], v[132:135]
  ds_read_b64_tr_b16 v[34:35], v13 offset:18432
  v_readlane_b32 s88, v23, 13
  v_mfma_f32_16x16x32_bf16 v[132:135], v[56:59], v[172:175], v[132:135]
  ds_read_b64_tr_b16 v[36:37], v13 offset:20480
  v_mul_f32 v167, v83, v83
  v_mfma_f32_16x16x32_bf16 v[132:135], v[60:63], v[188:191], v[132:135]
  ds_read_b64_tr_b16 v[38:39], v13 offset:22528
  v_fmaak_f32 v167, v167, v20, 0xc0135761
  v_mfma_f32_16x16x32_bf16 v[140:143], v[48:51], a[228:231], v[140:143]
  s_add_u32 m0, s9, 49152
  v_exp_f32 v166, v166
  v_mfma_f32_16x16x32_bf16 v[140:143], v[52:55], a[244:247], v[140:143]
  ds_read_b64_tr_b16 v[40:41], v13 offset:24576
  buffer_load_dwordx4 v1, s[56:59], s88 offen lds
  v_mfma_f32_16x16x32_bf16 v[140:143], v[56:59], v[176:179], v[140:143]
  ds_read_b64_tr_b16 v[42:43], v13 offset:26624
  v_add_f32 v166, 1.0, v166
  v_mfma_f32_16x16x32_bf16 v[140:143], v[60:63], v[192:195], v[140:143]
  v_rcp_f32 v166, v166
  v_mfma_f32_16x16x32_bf16 v[148:151], v[48:51], a[232:235], v[148:151]
  ds_read_b64_tr_b16 v[44:45], v13 offset:28672
  v_mul_f32 v82, v166, v82
  v_mfma_f32_16x16x32_bf16 v[148:151], v[52:55], a[248:251], v[148:151]
  ds_read_b64_tr_b16 v[46:47], v13 offset:30720
  buffer_load_dwordx4 v2, s[56:59], s88 offen offset:1024 lds
  v_mfma_f32_16x16x32_bf16 v[148:151], v[56:59], v[180:183], v[148:151]
  v_mul_f32 v167, v167, v83
  v_mul_f32 v168, v84, v84
  v_mfma_f32_16x16x32_bf16 v[148:151], v[60:63], v[196:199], v[148:151]
  v_exp_f32 v167, v167
  v_mfma_f32_16x16x32_bf16 v[156:159], v[48:51], a[236:239], v[156:159]
  ds_read_b64_tr_b16 v[48:49], v16 offset:16384
  v_add_f32 v167, 1.0, v167
  v_mfma_f32_16x16x32_bf16 v[156:159], v[52:55], a[252:255], v[156:159]
  ds_read_b64_tr_b16 v[50:51], v16 offset:18432
  v_fmaak_f32 v168, v168, v20, 0xc0135761
  v_mfma_f32_16x16x32_bf16 v[156:159], v[56:59], v[184:187], v[156:159]
  ds_read_b64_tr_b16 v[52:53], v16 offset:20480
  buffer_load_dwordx4 v3, s[56:59], s88 offen offset:2048 lds
  v_mfma_f32_16x16x32_bf16 v[156:159], v[60:63], v[200:203], v[156:159]
  s_waitcnt lgkmcnt(3)
  v_rcp_f32 v167, v167
  v_mfma_f32_16x16x32_bf16 v[96:99], v[32:35], a[0:3], 0
  ds_read_b64_tr_b16 v[54:55], v16 offset:22528
  v_mul_f32 v83, v167, v83
  v_mfma_f32_16x16x32_bf16 v[96:99], v[36:39], a[16:19], v[96:99]
  ds_read_b64_tr_b16 v[56:57], v16 offset:24576
  v_mul_f32 v168, v168, v84
  v_mfma_f32_16x16x32_bf16 v[96:99], v[40:43], a[32:35], v[96:99]
  v_exp_f32 v168, v168
  v_mfma_f32_16x16x32_bf16 v[96:99], v[44:47], a[48:51], v[96:99]
  ds_read_b64_tr_b16 v[58:59], v16 offset:26624
  buffer_load_dwordx4 v4, s[56:59], s88 offen offset:3072 lds
  v_mfma_f32_16x16x32_bf16 v[104:107], v[32:35], a[4:7], 0
  ds_read_b64_tr_b16 v[60:61], v16 offset:28672
  v_mul_f32 v64, v64, v128
  v_mfma_f32_16x16x32_bf16 v[104:107], v[36:39], a[20:23], v[104:107]
  v_mul_f32 v65, v65, v129
  v_mul_f32 v66, v66, v130
  v_mfma_f32_16x16x32_bf16 v[104:107], v[40:43], a[36:39], v[104:107]
  ds_read_b64_tr_b16 v[62:63], v16 offset:30720
  v_cvt_pk_bf16_f32 v64, v64, v65
  v_mfma_f32_16x16x32_bf16 v[104:107], v[44:47], a[52:55], v[104:107]
  v_mul_f32 v67, v67, v131
  v_mul_f32 v68, v68, v132
  v_mfma_f32_16x16x32_bf16 v[112:115], v[32:35], a[8:11], 0
  v_cvt_pk_bf16_f32 v65, v66, v67
  v_mul_f32 v69, v69, v133
  v_mfma_f32_16x16x32_bf16 v[112:115], v[36:39], a[24:27], v[112:115]
  v_cvt_pk_bf16_f32 v66, v68, v69
  v_mul_f32 v70, v70, v134
  v_mfma_f32_16x16x32_bf16 v[112:115], v[40:43], a[40:43], v[112:115]
  v_mul_f32 v71, v71, v135
  v_mul_f32 v72, v72, v136
  v_mfma_f32_16x16x32_bf16 v[112:115], v[44:47], a[56:59], v[112:115]
  v_cvt_pk_bf16_f32 v67, v70, v71
  v_mul_f32 v73, v73, v137
  v_mfma_f32_16x16x32_bf16 v[120:123], v[32:35], a[12:15], 0
  v_cvt_pk_bf16_f32 v72, v72, v73
  v_mul_f32 v74, v74, v138
  v_mfma_f32_16x16x32_bf16 v[120:123], v[36:39], a[28:31], v[120:123]
  v_mul_f32 v75, v75, v139
  v_mul_f32 v76, v76, v140
  v_mfma_f32_16x16x32_bf16 v[120:123], v[40:43], a[44:47], v[120:123]
  v_cvt_pk_bf16_f32 v73, v74, v75
  v_mul_f32 v77, v77, v141
  v_mfma_f32_16x16x32_bf16 v[120:123], v[44:47], a[60:63], v[120:123]
  s_waitcnt vmcnt(8) lgkmcnt(0)
  s_barrier
  v_mfma_f32_16x16x32_bf16 v[100:103], v[48:51], a[0:3], 0
  ds_read_b64_tr_b16 v[32:33], v14 offset:0
  v_cvt_pk_bf16_f32 v74, v76, v77
  v_mfma_f32_16x16x32_bf16 v[100:103], v[52:55], a[16:19], v[100:103]
  ds_read_b64_tr_b16 v[34:35], v14 offset:2048
  v_readlane_b32 s88, v23, 14
  v_mfma_f32_16x16x32_bf16 v[100:103], v[56:59], a[32:35], v[100:103]
  ds_read_b64_tr_b16 v[36:37], v14 offset:4096
  v_mul_f32 v78, v78, v142
  v_mfma_f32_16x16x32_bf16 v[100:103], v[60:63], a[48:51], v[100:103]
  ds_read_b64_tr_b16 v[38:39], v14 offset:6144
  v_mul_f32 v79, v79, v143
  v_mfma_f32_16x16x32_bf16 v[108:111], v[48:51], a[4:7], 0
  s_add_u32 m0, s9, 81920
  ds_write_b128 v236, v[64:67] offset:0
  v_mfma_f32_16x16x32_bf16 v[108:111], v[52:55], a[20:23], v[108:111]
  ds_read_b64_tr_b16 v[40:41], v14 offset:8192
  buffer_load_dwordx4 v1, s[52:55], s88 offen lds
  v_mfma_f32_16x16x32_bf16 v[108:111], v[56:59], a[36:39], v[108:111]
  ds_read_b64_tr_b16 v[42:43], v14 offset:10240
  v_cvt_pk_bf16_f32 v75, v78, v79
  v_mfma_f32_16x16x32_bf16 v[108:111], v[60:63], a[52:55], v[108:111]
  ds_write_b128 v236, v[72:75] offset:1024
  v_mfma_f32_16x16x32_bf16 v[116:119], v[48:51], a[8:11], 0
  ds_read_b64_tr_b16 v[44:45], v14 offset:12288
  v_mul_f32 v80, v80, v144
  v_mfma_f32_16x16x32_bf16 v[116:119], v[52:55], a[24:27], v[116:119]
  ds_read_b64_tr_b16 v[46:47], v14 offset:14336
  buffer_load_dwordx4 v2, s[52:55], s88 offen offset:1024 lds
  v_mfma_f32_16x16x32_bf16 v[116:119], v[56:59], a[40:43], v[116:119]
  v_mul_f32 v81, v81, v145
  v_mul_f32 v82, v82, v146
  v_mfma_f32_16x16x32_bf16 v[116:119], v[60:63], a[56:59], v[116:119]
  v_cvt_pk_bf16_f32 v80, v80, v81
  v_add_f32 v168, 1.0, v168
  v_mfma_f32_16x16x32_bf16 v[124:127], v[48:51], a[12:15], 0
  ds_read_b64_tr_b16 v[48:49], v17 offset:0
  v_mul_f32 v83, v83, v147
  v_mfma_f32_16x16x32_bf16 v[124:127], v[52:55], a[28:31], v[124:127]
  ds_read_b64_tr_b16 v[50:51], v17 offset:2048
  v_cvt_pk_bf16_f32 v81, v82, v83
  v_mfma_f32_16x16x32_bf16 v[124:127], v[56:59], a[44:47], v[124:127]
  ds_read_b64_tr_b16 v[52:53], v17 offset:4096
  buffer_load_dwordx4 v3, s[52:55], s88 offen offset:2048 lds
  v_mfma_f32_16x16x32_bf16 v[124:127], v[60:63], a[60:63], v[124:127]
  s_waitcnt lgkmcnt(3)
  v_rcp_f32 v168, v168
  v_mfma_f32_16x16x32_bf16 v[96:99], v[32:35], a[64:67], v[96:99]
  ds_read_b64_tr_b16 v[54:55], v17 offset:6144
  v_mul_f32 v84, v168, v84
  v_mfma_f32_16x16x32_bf16 v[96:99], v[36:39], a[80:83], v[96:99]
  ds_read_b64_tr_b16 v[56:57], v17 offset:8192
  v_mul_f32 v169, v85, v85
  v_mfma_f32_16x16x32_bf16 v[96:99], v[40:43], a[96:99], v[96:99]
  v_fmaak_f32 v169, v169, v20, 0xc0135761
  v_mul_f32 v84, v84, v148
  v_mfma_f32_16x16x32_bf16 v[96:99], v[44:47], a[112:115], v[96:99]
  ds_read_b64_tr_b16 v[58:59], v17 offset:10240
  buffer_load_dwordx4 v4, s[52:55], s88 offen offset:3072 lds
  v_mfma_f32_16x16x32_bf16 v[104:107], v[32:35], a[68:71], v[104:107]
  ds_read_b64_tr_b16 v[60:61], v17 offset:12288
  v_mul_f32 v169, v169, v85
  v_mfma_f32_16x16x32_bf16 v[104:107], v[36:39], a[84:87], v[104:107]
  v_exp_f32 v169, v169
  v_mfma_f32_16x16x32_bf16 v[104:107], v[40:43], a[100:103], v[104:107]
  ds_read_b64_tr_b16 v[62:63], v17 offset:14336
  v_add_f32 v169, 1.0, v169
  v_mfma_f32_16x16x32_bf16 v[104:107], v[44:47], a[116:119], v[104:107]
  v_rcp_f32 v169, v169
  v_mfma_f32_16x16x32_bf16 v[112:115], v[32:35], a[72:75], v[112:115]
  v_mul_f32 v85, v169, v85
  v_mul_f32 v170, v86, v86
  v_mfma_f32_16x16x32_bf16 v[112:115], v[36:39], a[88:91], v[112:115]
  v_fmaak_f32 v170, v170, v20, 0xc0135761
  v_mul_f32 v85, v85, v149
  v_mfma_f32_16x16x32_bf16 v[112:115], v[40:43], a[104:107], v[112:115]
  v_cvt_pk_bf16_f32 v82, v84, v85
  v_mul_f32 v170, v170, v86
  v_mfma_f32_16x16x32_bf16 v[112:115], v[44:47], a[120:123], v[112:115]
  v_exp_f32 v170, v170
  v_mfma_f32_16x16x32_bf16 v[120:123], v[32:35], a[76:79], v[120:123]
  v_add_f32 v170, 1.0, v170
  v_mul_f32 v171, v87, v87
  v_mfma_f32_16x16x32_bf16 v[120:123], v[36:39], a[92:95], v[120:123]
  v_rcp_f32 v170, v170
  v_mfma_f32_16x16x32_bf16 v[120:123], v[40:43], a[108:111], v[120:123]
  v_mul_f32 v86, v170, v86
  v_fmaak_f32 v171, v171, v20, 0xc0135761
  v_mfma_f32_16x16x32_bf16 v[120:123], v[44:47], a[124:127], v[120:123]
  s_waitcnt lgkmcnt(0)
  v_mul_f32 v171, v171, v87
  v_mul_f32 v86, v86, v150
  v_mfma_f32_16x16x32_bf16 v[100:103], v[48:51], a[64:67], v[100:103]
  ds_read_b64_tr_b16 v[32:33], v15 offset:16384
  v_mul_f32 v160, v88, v88
  v_mfma_f32_16x16x32_bf16 v[100:103], v[52:55], a[80:83], v[100:103]
  ds_read_b64_tr_b16 v[34:35], v15 offset:18432
  v_readlane_b32 s88, v23, 15
  v_mfma_f32_16x16x32_bf16 v[100:103], v[56:59], a[96:99], v[100:103]
  ds_read_b64_tr_b16 v[36:37], v15 offset:20480
  v_fmaak_f32 v160, v160, v20, 0xc0135761
  v_mfma_f32_16x16x32_bf16 v[100:103], v[60:63], a[112:115], v[100:103]
  ds_read_b64_tr_b16 v[38:39], v15 offset:22528
  v_mul_f32 v160, v160, v88
  v_mfma_f32_16x16x32_bf16 v[108:111], v[48:51], a[68:71], v[108:111]
  s_add_u32 m0, s9, 98304
  v_exp_f32 v171, v171
  v_mfma_f32_16x16x32_bf16 v[108:111], v[52:55], a[84:87], v[108:111]
  ds_read_b64_tr_b16 v[40:41], v15 offset:24576
  buffer_load_dwordx4 v1, s[52:55], s88 offen lds
  v_mfma_f32_16x16x32_bf16 v[108:111], v[56:59], a[100:103], v[108:111]
  ds_read_b64_tr_b16 v[42:43], v15 offset:26624
  v_add_f32 v171, 1.0, v171
  v_mfma_f32_16x16x32_bf16 v[108:111], v[60:63], a[116:119], v[108:111]
  v_rcp_f32 v171, v171
  v_mfma_f32_16x16x32_bf16 v[116:119], v[48:51], a[72:75], v[116:119]
  ds_read_b64_tr_b16 v[44:45], v15 offset:28672
  v_mul_f32 v87, v171, v87
  v_mfma_f32_16x16x32_bf16 v[116:119], v[52:55], a[88:91], v[116:119]
  ds_read_b64_tr_b16 v[46:47], v15 offset:30720
  buffer_load_dwordx4 v2, s[52:55], s88 offen offset:1024 lds
  v_mfma_f32_16x16x32_bf16 v[116:119], v[56:59], a[104:107], v[116:119]
  v_exp_f32 v160, v160
  v_mfma_f32_16x16x32_bf16 v[116:119], v[60:63], a[120:123], v[116:119]
  v_add_f32 v160, 1.0, v160
  v_mul_f32 v87, v87, v151
  v_mfma_f32_16x16x32_bf16 v[124:127], v[48:51], a[76:79], v[124:127]
  ds_read_b64_tr_b16 v[48:49], v18 offset:16384
  v_cvt_pk_bf16_f32 v83, v86, v87
  v_mfma_f32_16x16x32_bf16 v[124:127], v[52:55], a[92:95], v[124:127]
  ds_read_b64_tr_b16 v[50:51], v18 offset:18432
  v_mul_f32 v161, v89, v89
  v_mfma_f32_16x16x32_bf16 v[124:127], v[56:59], a[108:111], v[124:127]
  ds_read_b64_tr_b16 v[52:53], v18 offset:20480
  buffer_load_dwordx4 v3, s[52:55], s88 offen offset:2048 lds
  v_mfma_f32_16x16x32_bf16 v[124:127], v[60:63], a[124:127], v[124:127]
  s_waitcnt lgkmcnt(3)
  ds_write_b128 v236, v[80:83] offset:2048
  v_mfma_f32_16x16x32_bf16 v[96:99], v[32:35], a[128:131], v[96:99]
  ds_read_b64_tr_b16 v[54:55], v18 offset:22528
  v_fmaak_f32 v161, v161, v20, 0xc0135761
  v_mfma_f32_16x16x32_bf16 v[96:99], v[36:39], a[144:147], v[96:99]
  ds_read_b64_tr_b16 v[56:57], v18 offset:24576
  v_mul_f32 v161, v161, v89
  v_mfma_f32_16x16x32_bf16 v[96:99], v[40:43], a[160:163], v[96:99]
  v_rcp_f32 v160, v160
  v_mfma_f32_16x16x32_bf16 v[96:99], v[44:47], a[176:179], v[96:99]
  ds_read_b64_tr_b16 v[58:59], v18 offset:26624
  buffer_load_dwordx4 v4, s[52:55], s88 offen offset:3072 lds
  v_mfma_f32_16x16x32_bf16 v[104:107], v[32:35], a[132:135], v[104:107]
  ds_read_b64_tr_b16 v[60:61], v18 offset:28672
  v_mul_f32 v88, v160, v88
  v_mfma_f32_16x16x32_bf16 v[104:107], v[36:39], a[148:151], v[104:107]
  v_exp_f32 v161, v161
  v_mfma_f32_16x16x32_bf16 v[104:107], v[40:43], a[164:167], v[104:107]
  ds_read_b64_tr_b16 v[62:63], v18 offset:30720
  v_add_f32 v161, 1.0, v161
  v_mfma_f32_16x16x32_bf16 v[104:107], v[44:47], a[180:183], v[104:107]
  v_rcp_f32 v161, v161
  v_mfma_f32_16x16x32_bf16 v[112:115], v[32:35], a[136:139], v[112:115]
  v_mul_f32 v89, v161, v89
  v_mul_f32 v88, v88, v152
  v_mfma_f32_16x16x32_bf16 v[112:115], v[36:39], a[152:155], v[112:115]
  v_mul_f32 v162, v90, v90
  v_mul_f32 v89, v89, v153
  v_mfma_f32_16x16x32_bf16 v[112:115], v[40:43], a[168:171], v[112:115]
  v_cvt_pk_bf16_f32 v88, v88, v89
  v_fmaak_f32 v162, v162, v20, 0xc0135761
  v_mfma_f32_16x16x32_bf16 v[112:115], v[44:47], a[184:187], v[112:115]
  v_mul_f32 v162, v162, v90
  v_mul_f32 v163, v91, v91
  v_mfma_f32_16x16x32_bf16 v[120:123], v[32:35], a[140:143], v[120:123]
  v_exp_f32 v162, v162
  v_mfma_f32_16x16x32_bf16 v[120:123], v[36:39], a[156:159], v[120:123]
  v_add_f32 v162, 1.0, v162
  v_fmaak_f32 v163, v163, v20, 0xc0135761
  v_mfma_f32_16x16x32_bf16 v[120:123], v[40:43], a[172:175], v[120:123]
  v_rcp_f32 v162, v162
  v_mfma_f32_16x16x32_bf16 v[120:123], v[44:47], a[188:191], v[120:123]
  s_waitcnt vmcnt(8) lgkmcnt(0)
  s_barrier
  v_mfma_f32_16x16x32_bf16 v[100:103], v[48:51], a[128:131], v[100:103]
  ds_read_b64_tr_b16 v[32:33], v13 offset:32768
  v_mul_f32 v90, v162, v90
  v_mfma_f32_16x16x32_bf16 v[100:103], v[52:55], a[144:147], v[100:103]
  ds_read_b64_tr_b16 v[34:35], v13 offset:34816
  v_readlane_b32 s88, v23, 16
  v_mfma_f32_16x16x32_bf16 v[100:103], v[56:59], a[160:163], v[100:103]
PAD2:
  s_cbranch_execz PAD6
  ds_read_b64_tr_b16 v[36:37], v13 offset:36864
  v_mul_f32 v163, v163, v91
  v_mfma_f32_16x16x32_bf16 v[100:103], v[60:63], a[176:179], v[100:103]
  ds_read_b64_tr_b16 v[38:39], v13 offset:38912
  v_mul_f32 v90, v90, v154
  v_mfma_f32_16x16x32_bf16 v[108:111], v[48:51], a[132:135], v[108:111]
  s_add_u32 m0, s9, 114688
  v_exp_f32 v163, v163
  v_mfma_f32_16x16x32_bf16 v[108:111], v[52:55], a[148:151], v[108:111]
  ds_read_b64_tr_b16 v[40:41], v13 offset:40960
  buffer_load_dwordx4 v1, s[52:55], s88 offen lds
  v_mfma_f32_16x16x32_bf16 v[108:111], v[56:59], a[164:167], v[108:111]
  ds_read_b64_tr_b16 v[42:43], v13 offset:43008
  v_add_f32 v163, 1.0, v163
  v_mfma_f32_16x16x32_bf16 v[108:111], v[60:63], a[180:183], v[108:111]
  v_rcp_f32 v163, v163
  v_mfma_f32_16x16x32_bf16 v[116:119], v[48:51], a[136:139], v[116:119]
  ds_read_b64_tr_b16 v[44:45], v13 offset:45056
  v_mul_f32 v91, v163, v91
  v_mfma_f32_16x16x32_bf16 v[116:119], v[52:55], a[152:155], v[116:119]
  ds_read_b64_tr_b16 v[46:47], v13 offset:47104
  buffer_load_dwordx4 v2, s[52:55], s88 offen offset:1024 lds
  v_mfma_f32_16x16x32_bf16 v[116:119], v[56:59], a[168:171], v[116:119]
  v_mul_f32 v164, v92, v92
  v_mul_f32 v91, v91, v155
  v_mfma_f32_16x16x32_bf16 v[116:119], v[60:63], a[184:187], v[116:119]
  v_cvt_pk_bf16_f32 v89, v90, v91
  v_fmaak_f32 v164, v164, v20, 0xc0135761
  v_mfma_f32_16x16x32_bf16 v[124:127], v[48:51], a[140:143], v[124:127]
  ds_read_b64_tr_b16 v[48:49], v16 offset:32768
  v_mul_f32 v164, v164, v92
  v_mfma_f32_16x16x32_bf16 v[124:127], v[52:55], a[156:159], v[124:127]
  ds_read_b64_tr_b16 v[50:51], v16 offset:34816
  v_mul_f32 v165, v93, v93
  v_mfma_f32_16x16x32_bf16 v[124:127], v[56:59], a[172:175], v[124:127]
  ds_read_b64_tr_b16 v[52:53], v16 offset:36864
  buffer_load_dwordx4 v3, s[52:55], s88 offen offset:2048 lds
  v_mfma_f32_16x16x32_bf16 v[124:127], v[60:63], a[188:191], v[124:127]
  s_waitcnt lgkmcnt(3)
  v_exp_f32 v164, v164
  v_mfma_f32_16x16x32_bf16 v[96:99], v[32:35], a[192:195], v[96:99]
  ds_read_b64_tr_b16 v[54:55], v16 offset:38912
  v_add_f32 v164, 1.0, v164
  v_mfma_f32_16x16x32_bf16 v[96:99], v[36:39], a[208:211], v[96:99]
  ds_read_b64_tr_b16 v[56:57], v16 offset:40960
  v_fmaak_f32 v165, v165, v20, 0xc0135761
  v_mfma_f32_16x16x32_bf16 v[96:99], v[40:43], a[224:227], v[96:99]
  v_rcp_f32 v164, v164
  v_mfma_f32_16x16x32_bf16 v[96:99], v[44:47], a[240:243], v[96:99]
  ds_read_b64_tr_b16 v[58:59], v16 offset:43008
  buffer_load_dwordx4 v4, s[52:55], s88 offen offset:3072 lds
  v_mfma_f32_16x16x32_bf16 v[104:107], v[32:35], a[196:199], v[104:107]
  ds_read_b64_tr_b16 v[60:61], v16 offset:45056
  v_mul_f32 v92, v164, v92
  v_mfma_f32_16x16x32_bf16 v[104:107], v[36:39], a[212:215], v[104:107]
  v_mul_f32 v165, v165, v93
  v_mul_f32 v92, v92, v156
  v_mfma_f32_16x16x32_bf16 v[104:107], v[40:43], a[228:231], v[104:107]
  ds_read_b64_tr_b16 v[62:63], v16 offset:47104
  v_mul_f32 v166, v94, v94
  v_mfma_f32_16x16x32_bf16 v[104:107], v[44:47], a[244:247], v[104:107]
  v_exp_f32 v165, v165
  v_mfma_f32_16x16x32_bf16 v[112:115], v[32:35], a[200:203], v[112:115]
  v_add_f32 v165, 1.0, v165
  v_fmaak_f32 v166, v166, v20, 0xc0135761
  v_mfma_f32_16x16x32_bf16 v[112:115], v[36:39], a[216:219], v[112:115]
  v_rcp_f32 v165, v165
  v_mfma_f32_16x16x32_bf16 v[112:115], v[40:43], a[232:235], v[112:115]
  v_mul_f32 v93, v165, v93
  v_mul_f32 v166, v166, v94
  v_mfma_f32_16x16x32_bf16 v[112:115], v[44:47], a[248:251], v[112:115]
  v_exp_f32 v166, v166
  v_mfma_f32_16x16x32_bf16 v[120:123], v[32:35], a[204:207], v[120:123]
  v_add_f32 v166, 1.0, v166
  v_mul_f32 v93, v93, v157
  v_mfma_f32_16x16x32_bf16 v[120:123], v[36:39], a[220:223], v[120:123]
  v_mul_f32 v167, v95, v95
  v_cvt_pk_bf16_f32 v90, v92, v93
  v_mfma_f32_16x16x32_bf16 v[120:123], v[40:43], a[236:239], v[120:123]
  v_rcp_f32 v166, v166
  v_mfma_f32_16x16x32_bf16 v[120:123], v[44:47], a[252:255], v[120:123]
  s_waitcnt lgkmcnt(0)
  v_fmaak_f32 v167, v167, v20, 0xc0135761
  v_mul_f32 v94, v166, v94
  v_mfma_f32_16x16x32_bf16 v[100:103], v[48:51], a[192:195], v[100:103]
  ds_read_b64_tr_b16 v[32:33], v13 offset:49152
  v_mul_f32 v167, v167, v95
  v_mfma_f32_16x16x32_bf16 v[100:103], v[52:55], a[208:211], v[100:103]
  ds_read_b64_tr_b16 v[34:35], v13 offset:51200
  v_readlane_b32 s88, v23, 17
  v_mfma_f32_16x16x32_bf16 v[100:103], v[56:59], a[224:227], v[100:103]
  ds_read_b64_tr_b16 v[36:37], v16 offset:49152
  v_mul_f32 v94, v94, v158
  v_mfma_f32_16x16x32_bf16 v[100:103], v[60:63], a[240:243], v[100:103]
  ds_read_b64_tr_b16 v[38:39], v16 offset:51200
  v_mfma_f32_16x16x32_bf16 v[108:111], v[48:51], a[196:199], v[108:111]
  s_add_u32 m0, s9, 16384
  v_exp_f32 v167, v167
  v_mfma_f32_16x16x32_bf16 v[108:111], v[52:55], a[212:215], v[108:111]
  ds_read_b64_tr_b16 v[40:41], v13 offset:53248
  buffer_load_dwordx4 v1, s[52:55], s88 offen lds
  v_mfma_f32_16x16x32_bf16 v[108:111], v[56:59], a[228:231], v[108:111]
  ds_read_b64_tr_b16 v[42:43], v13 offset:55296
  v_add_f32 v167, 1.0, v167
  v_mfma_f32_16x16x32_bf16 v[108:111], v[60:63], a[244:247], v[108:111]
  v_rcp_f32 v167, v167
  v_mfma_f32_16x16x32_bf16 v[116:119], v[48:51], a[200:203], v[116:119]
  ds_read_b64_tr_b16 v[44:45], v16 offset:53248
  v_mul_f32 v95, v167, v95
  v_mfma_f32_16x16x32_bf16 v[116:119], v[52:55], a[216:219], v[116:119]
  ds_read_b64_tr_b16 v[46:47], v16 offset:55296
  buffer_load_dwordx4 v2, s[52:55], s88 offen offset:1024 lds
  v_mfma_f32_16x16x32_bf16 v[116:119], v[56:59], a[232:235], v[116:119]
  v_mul_f32 v95, v95, v159
  v_mfma_f32_16x16x32_bf16 v[116:119], v[60:63], a[248:251], v[116:119]
  v_cvt_pk_bf16_f32 v91, v94, v95
  v_mfma_f32_16x16x32_bf16 v[124:127], v[48:51], a[204:207], v[124:127]
  ds_read_b64_tr_b16 v[48:49], v13 offset:57344
  v_mfma_f32_16x16x32_bf16 v[124:127], v[52:55], a[220:223], v[124:127]
  ds_read_b64_tr_b16 v[50:51], v13 offset:59392
  v_mfma_f32_16x16x32_bf16 v[124:127], v[56:59], a[236:239], v[124:127]
  ds_read_b64_tr_b16 v[52:53], v16 offset:57344
  buffer_load_dwordx4 v3, s[52:55], s88 offen offset:2048 lds
  v_mfma_f32_16x16x32_bf16 v[124:127], v[60:63], a[252:255], v[124:127]
  s_waitcnt lgkmcnt(3)
  ds_write_b128 v236, v[88:91] offset:3072
  v_mfma_f32_16x16x32_bf16 v[96:99], v[32:35], v[172:175], v[96:99]
  ds_read_b64_tr_b16 v[54:55], v16 offset:59392
  v_mfma_f32_16x16x32_bf16 v[96:99], v[40:43], v[188:191], v[96:99]
  ds_read_b64_tr_b16 v[56:57], v13 offset:61440
  v_mfma_f32_16x16x32_bf16 v[104:107], v[32:35], v[176:179], v[104:107]
  v_mfma_f32_16x16x32_bf16 v[104:107], v[40:43], v[192:195], v[104:107]
  ds_read_b64_tr_b16 v[58:59], v13 offset:63488
  buffer_load_dwordx4 v4, s[52:55], s88 offen offset:3072 lds
  v_mfma_f32_16x16x32_bf16 v[112:115], v[32:35], v[180:183], v[112:115]
  ds_read_b64_tr_b16 v[60:61], v16 offset:61440
  v_mfma_f32_16x16x32_bf16 v[112:115], v[40:43], v[196:199], v[112:115]
  v_mfma_f32_16x16x32_bf16 v[120:123], v[32:35], v[184:187], v[120:123]
  ds_read_b64_tr_b16 v[62:63], v16 offset:63488
  v_mfma_f32_16x16x32_bf16 v[120:123], v[40:43], v[200:203], v[120:123]
  v_mfma_f32_16x16x32_bf16 v[100:103], v[36:39], v[172:175], v[100:103]
  v_mfma_f32_16x16x32_bf16 v[100:103], v[44:47], v[188:191], v[100:103]
  v_mfma_f32_16x16x32_bf16 v[108:111], v[36:39], v[176:179], v[108:111]
  v_mfma_f32_16x16x32_bf16 v[108:111], v[44:47], v[192:195], v[108:111]
  v_mfma_f32_16x16x32_bf16 v[116:119], v[36:39], v[180:183], v[116:119]
  v_mfma_f32_16x16x32_bf16 v[116:119], v[44:47], v[196:199], v[116:119]
  v_mfma_f32_16x16x32_bf16 v[124:127], v[36:39], v[184:187], v[124:127]
  v_mfma_f32_16x16x32_bf16 v[124:127], v[44:47], v[200:203], v[124:127]
  s_waitcnt vmcnt(8) lgkmcnt(0)
  s_barrier
  v_mfma_f32_16x16x32_bf16 v[128:131], v[48:51], a[0:3], 0
  ds_read_b64_tr_b16 v[32:33], v14 offset:16384
  v_readlane_b32 s88, v23, 18
  v_mfma_f32_16x16x32_bf16 v[128:131], v[56:59], a[16:19], v[128:131]
  ds_read_b64_tr_b16 v[34:35], v14 offset:18432
  v_mfma_f32_16x16x32_bf16 v[136:139], v[48:51], a[4:7], 0
  ds_read_b64_tr_b16 v[36:37], v14 offset:20480
  v_mfma_f32_16x16x32_bf16 v[136:139], v[56:59], a[20:23], v[136:139]
  ds_read_b64_tr_b16 v[38:39], v14 offset:22528
  v_mul_f32 v168, v96, v96
  v_mul_f32 v169, v97, v97
  v_mfma_f32_16x16x32_bf16 v[144:147], v[48:51], a[8:11], 0
  s_add_u32 m0, s9, 131072
  v_mad_u64_u32 v[214:215], s[98:99], v211, s88, v[204:205]
  v_fmaak_f32 v168, v168, v20, 0xc0135761
  v_fmaak_f32 v169, v169, v20, 0xc0135761
  v_mfma_f32_16x16x32_bf16 v[144:147], v[56:59], a[24:27], v[144:147]
  ds_read_b64_tr_b16 v[40:41], v14 offset:24576
  global_load_lds_dwordx4 v[214:215], off
  v_mul_f32 v168, v168, v96
  v_mfma_f32_16x16x32_bf16 v[152:155], v[48:51], a[12:15], 0
  ds_read_b64_tr_b16 v[42:43], v14 offset:26624
  v_lshl_add_u64 v[216:217], v[214:215], 0, s[100:101]
  v_mul_f32 v169, v169, v97
  v_mfma_f32_16x16x32_bf16 v[152:155], v[56:59], a[28:31], v[152:155]
  v_exp_f32 v168, v168
  v_mul_f32 v170, v98, v98
  v_mfma_f32_16x16x32_bf16 v[132:135], v[52:55], a[0:3], 0
  ds_read_b64_tr_b16 v[44:45], v14 offset:28672
  v_exp_f32 v169, v169
  v_mfma_f32_16x16x32_bf16 v[132:135], v[60:63], a[16:19], v[132:135]
  ds_read_b64_tr_b16 v[46:47], v14 offset:30720
  global_load_lds_dwordx4 v[216:217], off offset:1024
  v_add_f32 v168, 1.0, v168
  v_mfma_f32_16x16x32_bf16 v[140:143], v[52:55], a[4:7], 0
  s_add_u32 s88, s88, 4
  v_rcp_f32 v168, v168
  v_add_f32 v169, 1.0, v169
  v_mfma_f32_16x16x32_bf16 v[140:143], v[60:63], a[20:23], v[140:143]
  s_add_u32 m0, s9, 133120
  v_mad_u64_u32 v[214:215], s[98:99], v211, s88, v[204:205]
  v_rcp_f32 v169, v169
  v_mfma_f32_16x16x32_bf16 v[148:151], v[52:55], a[8:11], 0
  ds_read_b64_tr_b16 v[48:49], v17 offset:16384
  v_mul_f32 v96, v168, v96
  v_mul_f32 v97, v169, v97
  v_mfma_f32_16x16x32_bf16 v[148:151], v[60:63], a[24:27], v[148:151]
  ds_read_b64_tr_b16 v[50:51], v17 offset:18432
  v_fmaak_f32 v170, v170, v20, 0xc0135761
  v_mul_f32 v171, v99, v99
  v_mfma_f32_16x16x32_bf16 v[156:159], v[52:55], a[12:15], 0
  ds_read_b64_tr_b16 v[52:53], v17 offset:20480
  global_load_lds_dwordx4 v[214:215], off
  v_mul_f32 v170, v170, v98
  v_mfma_f32_16x16x32_bf16 v[156:159], v[60:63], a[28:31], v[156:159]
  s_waitcnt lgkmcnt(3)
  v_exp_f32 v170, v170
  v_fmaak_f32 v171, v171, v20, 0xc0135761
  v_mfma_f32_16x16x32_bf16 v[128:131], v[32:35], a[32:35], v[128:131]
  ds_read_b64_tr_b16 v[54:55], v17 offset:22528
  v_lshl_add_u64 v[216:217], v[214:215], 0, s[100:101]
  v_add_f32 v170, 1.0, v170
  v_mfma_f32_16x16x32_bf16 v[128:131], v[36:39], a[48:51], v[128:131]
  ds_read_b64_tr_b16 v[56:57], v17 offset:24576
  v_rcp_f32 v170, v170
  v_mfma_f32_16x16x32_bf16 v[128:131], v[40:43], a[64:67], v[128:131]
  v_mul_f32 v98, v170, v98
  v_mul_f32 v171, v171, v99
  v_mul_f32 v160, v100, v100
  v_mfma_f32_16x16x32_bf16 v[128:131], v[44:47], a[80:83], v[128:131]
  ds_read_b64_tr_b16 v[58:59], v17 offset:26624
  global_load_lds_dwordx4 v[216:217], off offset:1024
  v_fmaak_f32 v160, v160, v20, 0xc0135761
  v_mfma_f32_16x16x32_bf16 v[136:139], v[32:35], a[36:39], v[136:139]
  ds_read_b64_tr_b16 v[60:61], v17 offset:28672
  v_exp_f32 v171, v171
  v_mfma_f32_16x16x32_bf16 v[136:139], v[36:39], a[52:55], v[136:139]
  v_add_f32 v171, 1.0, v171
  v_mul_f32 v160, v160, v100
  v_mul_f32 v161, v101, v101
  v_mfma_f32_16x16x32_bf16 v[136:139], v[40:43], a[68:71], v[136:139]
  ds_read_b64_tr_b16 v[62:63], v17 offset:30720
  v_rcp_f32 v171, v171
  v_mfma_f32_16x16x32_bf16 v[136:139], v[44:47], a[84:87], v[136:139]
  v_exp_f32 v160, v160
  v_mul_f32 v99, v171, v99
  v_mfma_f32_16x16x32_bf16 v[144:147], v[32:35], a[40:43], v[144:147]
  v_add_f32 v160, 1.0, v160
  v_fmaak_f32 v161, v161, v20, 0xc0135761
  v_mfma_f32_16x16x32_bf16 v[144:147], v[36:39], a[56:59], v[144:147]
  v_rcp_f32 v160, v160
  v_mfma_f32_16x16x32_bf16 v[144:147], v[40:43], a[72:75], v[144:147]
  v_mul_f32 v100, v160, v100
  v_mul_f32 v161, v161, v101
  v_mfma_f32_16x16x32_bf16 v[144:147], v[44:47], a[88:91], v[144:147]
  v_exp_f32 v161, v161
  v_mfma_f32_16x16x32_bf16 v[152:155], v[32:35], a[44:47], v[152:155]
  v_add_f32 v161, 1.0, v161
  v_mul_f32 v162, v102, v102
  v_mfma_f32_16x16x32_bf16 v[152:155], v[36:39], a[60:63], v[152:155]
  v_rcp_f32 v161, v161
  v_mfma_f32_16x16x32_bf16 v[152:155], v[40:43], a[76:79], v[152:155]
  v_mul_f32 v101, v161, v101
  v_fmaak_f32 v162, v162, v20, 0xc0135761
  v_mfma_f32_16x16x32_bf16 v[152:155], v[44:47], a[92:95], v[152:155]
  s_waitcnt lgkmcnt(0)
  v_mul_f32 v162, v162, v102
  v_mul_f32 v163, v103, v103
  v_mfma_f32_16x16x32_bf16 v[132:135], v[48:51], a[32:35], v[132:135]
  ds_read_b64_tr_b16 v[32:33], v14 offset:32768
  v_readlane_b32 s88, v23, 19
  v_mfma_f32_16x16x32_bf16 v[132:135], v[52:55], a[48:51], v[132:135]
  ds_read_b64_tr_b16 v[34:35], v14 offset:34816
  v_fmaak_f32 v163, v163, v20, 0xc0135761
  v_mfma_f32_16x16x32_bf16 v[132:135], v[56:59], a[64:67], v[132:135]
  ds_read_b64_tr_b16 v[36:37], v14 offset:36864
  v_mul_f32 v163, v163, v103
  v_mfma_f32_16x16x32_bf16 v[132:135], v[60:63], a[80:83], v[132:135]
  ds_read_b64_tr_b16 v[38:39], v14 offset:38912
  v_mul_f32 v164, v104, v104
  v_mfma_f32_16x16x32_bf16 v[140:143], v[48:51], a[36:39], v[140:143]
  s_add_u32 m0, s9, 65536
  v_mad_u64_u32 v[214:215], s[98:99], v211, s88, v[204:205]
  v_fmaak_f32 v164, v164, v20, 0xc0135761
  v_mfma_f32_16x16x32_bf16 v[140:143], v[52:55], a[52:55], v[140:143]
  ds_read_b64_tr_b16 v[40:41], v14 offset:40960
  global_load_lds_dwordx4 v[214:215], off
  v_mfma_f32_16x16x32_bf16 v[140:143], v[56:59], a[68:71], v[140:143]
  ds_read_b64_tr_b16 v[42:43], v14 offset:43008
  v_lshl_add_u64 v[216:217], v[214:215], 0, s[100:101]
  v_mfma_f32_16x16x32_bf16 v[140:143], v[60:63], a[84:87], v[140:143]
  v_exp_f32 v162, v162
  v_mfma_f32_16x16x32_bf16 v[148:151], v[48:51], a[40:43], v[148:151]
  ds_read_b64_tr_b16 v[44:45], v14 offset:45056
  v_add_f32 v162, 1.0, v162
  v_mfma_f32_16x16x32_bf16 v[148:151], v[52:55], a[56:59], v[148:151]
  ds_read_b64_tr_b16 v[46:47], v14 offset:47104
  global_load_lds_dwordx4 v[216:217], off offset:1024
  v_mfma_f32_16x16x32_bf16 v[148:151], v[56:59], a[72:75], v[148:151]
  s_add_u32 s88, s88, 4
  v_rcp_f32 v162, v162
  v_mfma_f32_16x16x32_bf16 v[148:151], v[60:63], a[88:91], v[148:151]
  s_add_u32 m0, s9, 67584
  v_mad_u64_u32 v[214:215], s[98:99], v211, s88, v[204:205]
  v_mul_f32 v102, v162, v102
  v_mfma_f32_16x16x32_bf16 v[156:159], v[48:51], a[44:47], v[156:159]
  ds_read_b64_tr_b16 v[48:49], v17 offset:32768
  v_mul_f32 v164, v164, v104
  v_mfma_f32_16x16x32_bf16 v[156:159], v[52:55], a[60:63], v[156:159]
  ds_read_b64_tr_b16 v[50:51], v17 offset:34816
  v_mul_f32 v165, v105, v105
  v_mfma_f32_16x16x32_bf16 v[156:159], v[56:59], a[76:79], v[156:159]
  ds_read_b64_tr_b16 v[52:53], v17 offset:36864
  global_load_lds_dwordx4 v[214:215], off
  v_mfma_f32_16x16x32_bf16 v[156:159], v[60:63], a[92:95], v[156:159]
  s_waitcnt lgkmcnt(3)
  v_exp_f32 v163, v163
  v_mfma_f32_16x16x32_bf16 v[128:131], v[32:35], a[96:99], v[128:131]
  ds_read_b64_tr_b16 v[54:55], v17 offset:38912
  v_lshl_add_u64 v[216:217], v[214:215], 0, s[100:101]
  v_mfma_f32_16x16x32_bf16 v[128:131], v[36:39], a[112:115], v[128:131]
  ds_read_b64_tr_b16 v[56:57], v17 offset:40960
  v_add_f32 v163, 1.0, v163
  v_mfma_f32_16x16x32_bf16 v[128:131], v[40:43], a[128:131], v[128:131]
  v_rcp_f32 v163, v163
  v_mfma_f32_16x16x32_bf16 v[128:131], v[44:47], a[144:147], v[128:131]
  ds_read_b64_tr_b16 v[58:59], v17 offset:43008
  global_load_lds_dwordx4 v[216:217], off offset:1024
  v_mfma_f32_16x16x32_bf16 v[136:139], v[32:35], a[100:103], v[136:139]
  ds_read_b64_tr_b16 v[60:61], v17 offset:45056
  v_mul_f32 v103, v163, v103
  v_mfma_f32_16x16x32_bf16 v[136:139], v[36:39], a[116:119], v[136:139]
  v_exp_f32 v164, v164
  v_mfma_f32_16x16x32_bf16 v[136:139], v[40:43], a[132:135], v[136:139]
  ds_read_b64_tr_b16 v[62:63], v17 offset:47104
  v_add_f32 v164, 1.0, v164
  v_mfma_f32_16x16x32_bf16 v[136:139], v[44:47], a[148:151], v[136:139]
  v_rcp_f32 v164, v164
  v_mfma_f32_16x16x32_bf16 v[144:147], v[32:35], a[104:107], v[144:147]
  v_mul_f32 v104, v164, v104
  v_fmaak_f32 v165, v165, v20, 0xc0135761
  v_mfma_f32_16x16x32_bf16 v[144:147], v[36:39], a[120:123], v[144:147]
  v_mul_f32 v165, v165, v105
  v_mul_f32 v166, v106, v106
  v_mfma_f32_16x16x32_bf16 v[144:147], v[40:43], a[136:139], v[144:147]
  v_exp_f32 v165, v165
  v_mfma_f32_16x16x32_bf16 v[144:147], v[44:47], a[152:155], v[144:147]
  v_add_f32 v165, 1.0, v165
  v_fmaak_f32 v166, v166, v20, 0xc0135761
  v_mfma_f32_16x16x32_bf16 v[152:155], v[32:35], a[108:111], v[152:155]
  v_rcp_f32 v165, v165
  v_mfma_f32_16x16x32_bf16 v[152:155], v[36:39], a[124:127], v[152:155]
  v_mul_f32 v105, v165, v105
  v_mul_f32 v166, v166, v106
  v_mfma_f32_16x16x32_bf16 v[152:155], v[40:43], a[140:143], v[152:155]
  v_exp_f32 v166, v166
  v_mfma_f32_16x16x32_bf16 v[152:155], v[44:47], a[156:159], v[152:155]
  s_waitcnt vmcnt(8) lgkmcnt(0)
  s_barrier
  v_mfma_f32_16x16x32_bf16 v[132:135], v[48:51], a[96:99], v[132:135]
  ds_read_b64_tr_b16 v[32:33], v14 offset:49152
  v_readlane_b32 s88, v23, 20
  v_mfma_f32_16x16x32_bf16 v[132:135], v[52:55], a[112:115], v[132:135]
  ds_read_b64_tr_b16 v[34:35], v14 offset:51200
  v_add_f32 v166, 1.0, v166
  v_mfma_f32_16x16x32_bf16 v[132:135], v[56:59], a[128:131], v[132:135]
  ds_read_b64_tr_b16 v[36:37], v14 offset:53248
  v_mul_f32 v167, v107, v107
  v_mfma_f32_16x16x32_bf16 v[132:135], v[60:63], a[144:147], v[132:135]
  ds_read_b64_tr_b16 v[38:39], v14 offset:55296
  v_fmaak_f32 v167, v167, v20, 0xc0135761
  v_mfma_f32_16x16x32_bf16 v[140:143], v[48:51], a[100:103], v[140:143]
  s_add_u32 m0, s9, 147456
  v_mad_u64_u32 v[214:215], s[98:99], v211, s88, v[204:205]
  v_mul_f32 v167, v167, v107
  v_mfma_f32_16x16x32_bf16 v[140:143], v[52:55], a[116:119], v[140:143]
  ds_read_b64_tr_b16 v[40:41], v14 offset:57344
  global_load_lds_dwordx4 v[214:215], off
  v_mfma_f32_16x16x32_bf16 v[140:143], v[56:59], a[132:135], v[140:143]
  ds_read_b64_tr_b16 v[42:43], v14 offset:59392
  v_lshl_add_u64 v[216:217], v[214:215], 0, s[100:101]
  v_mfma_f32_16x16x32_bf16 v[140:143], v[60:63], a[148:151], v[140:143]
  v_rcp_f32 v166, v166
  v_mfma_f32_16x16x32_bf16 v[148:151], v[48:51], a[104:107], v[148:151]
  ds_read_b64_tr_b16 v[44:45], v14 offset:61440
  v_mul_f32 v106, v166, v106
  v_mfma_f32_16x16x32_bf16 v[148:151], v[52:55], a[120:123], v[148:151]
  ds_read_b64_tr_b16 v[46:47], v14 offset:63488
  global_load_lds_dwordx4 v[216:217], off offset:1024
  v_mfma_f32_16x16x32_bf16 v[148:151], v[56:59], a[136:139], v[148:151]
  s_add_u32 s88, s88, 4
  v_exp_f32 v167, v167
  v_mfma_f32_16x16x32_bf16 v[148:151], v[60:63], a[152:155], v[148:151]
  s_add_u32 m0, s9, 149504
  v_mad_u64_u32 v[214:215], s[98:99], v211, s88, v[204:205]
  v_add_f32 v167, 1.0, v167
  v_mfma_f32_16x16x32_bf16 v[156:159], v[48:51], a[108:111], v[156:159]
  ds_read_b64_tr_b16 v[48:49], v17 offset:49152
  v_mul_f32 v168, v108, v108
  v_mfma_f32_16x16x32_bf16 v[156:159], v[52:55], a[124:127], v[156:159]
  ds_read_b64_tr_b16 v[50:51], v17 offset:51200
  v_fmaak_f32 v168, v168, v20, 0xc0135761
  v_mfma_f32_16x16x32_bf16 v[156:159], v[56:59], a[140:143], v[156:159]
  ds_read_b64_tr_b16 v[52:53], v17 offset:53248
  global_load_lds_dwordx4 v[214:215], off
  v_mfma_f32_16x16x32_bf16 v[156:159], v[60:63], a[156:159], v[156:159]
  s_waitcnt lgkmcnt(3)
  v_rcp_f32 v167, v167
  v_mfma_f32_16x16x32_bf16 v[128:131], v[32:35], a[160:163], v[128:131]
  ds_read_b64_tr_b16 v[54:55], v17 offset:55296
  v_lshl_add_u64 v[216:217], v[214:215], 0, s[100:101]
  v_mfma_f32_16x16x32_bf16 v[128:131], v[36:39], a[176:179], v[128:131]
  ds_read_b64_tr_b16 v[56:57], v17 offset:57344
  v_mul_f32 v107, v167, v107
  v_mfma_f32_16x16x32_bf16 v[128:131], v[40:43], a[192:195], v[128:131]
  v_mul_f32 v168, v168, v108
  v_mul_f32 v169, v109, v109
  v_mfma_f32_16x16x32_bf16 v[128:131], v[44:47], a[208:211], v[128:131]
  ds_read_b64_tr_b16 v[58:59], v17 offset:59392
  global_load_lds_dwordx4 v[216:217], off offset:1024
  v_mfma_f32_16x16x32_bf16 v[136:139], v[32:35], a[164:167], v[136:139]
  ds_read_b64_tr_b16 v[60:61], v17 offset:61440
  v_fmaak_f32 v169, v169, v20, 0xc0135761
  v_mfma_f32_16x16x32_bf16 v[136:139], v[36:39], a[180:183], v[136:139]
  v_exp_f32 v168, v168
  v_mfma_f32_16x16x32_bf16 v[136:139], v[40:43], a[196:199], v[136:139]
  ds_read_b64_tr_b16 v[62:63], v17 offset:63488
  v_add_f32 v168, 1.0, v168
  v_mfma_f32_16x16x32_bf16 v[136:139], v[44:47], a[212:215], v[136:139]
  v_rcp_f32 v168, v168
  v_mfma_f32_16x16x32_bf16 v[144:147], v[32:35], a[168:171], v[144:147]
  v_mul_f32 v108, v168, v108
  v_mul_f32 v169, v169, v109
  v_mfma_f32_16x16x32_bf16 v[144:147], v[36:39], a[184:187], v[144:147]
  v_exp_f32 v169, v169
  v_mfma_f32_16x16x32_bf16 v[144:147], v[40:43], a[200:203], v[144:147]
  v_add_f32 v169, 1.0, v169
  v_mul_f32 v170, v110, v110
  v_mfma_f32_16x16x32_bf16 v[144:147], v[44:47], a[216:219], v[144:147]
  v_rcp_f32 v169, v169
  v_mfma_f32_16x16x32_bf16 v[152:155], v[32:35], a[172:175], v[152:155]
  v_mul_f32 v109, v169, v109
  v_fmaak_f32 v170, v170, v20, 0xc0135761
  v_mfma_f32_16x16x32_bf16 v[152:155], v[36:39], a[188:191], v[152:155]
  v_mul_f32 v170, v170, v110
  v_mul_f32 v171, v111, v111
  v_mfma_f32_16x16x32_bf16 v[152:155], v[40:43], a[204:207], v[152:155]
  v_exp_f32 v170, v170
  v_mfma_f32_16x16x32_bf16 v[152:155], v[44:47], a[220:223], v[152:155]
  s_waitcnt lgkmcnt(0)
  v_add_f32 v170, 1.0, v170
  v_fmaak_f32 v171, v171, v20, 0xc0135761
  v_mfma_f32_16x16x32_bf16 v[132:135], v[48:51], a[160:163], v[132:135]
  ds_read_b64_tr_b16 v[32:33], v13 offset:16384
  v_readlane_b32 s88, v23, 21
  v_mfma_f32_16x16x32_bf16 v[132:135], v[52:55], a[176:179], v[132:135]
  ds_read_b64_tr_b16 v[34:35], v13 offset:18432
  v_mul_f32 v171, v171, v111
  v_mfma_f32_16x16x32_bf16 v[132:135], v[56:59], a[192:195], v[132:135]
  ds_read_b64_tr_b16 v[36:37], v13 offset:20480
  v_mul_f32 v160, v112, v112
  v_mfma_f32_16x16x32_bf16 v[132:135], v[60:63], a[208:211], v[132:135]
  ds_read_b64_tr_b16 v[38:39], v13 offset:22528
  v_fmaak_f32 v160, v160, v20, 0xc0135761
  v_mfma_f32_16x16x32_bf16 v[140:143], v[48:51], a[164:167], v[140:143]
  s_add_u32 m0, s9, 32768
  v_mad_u64_u32 v[214:215], s[98:99], v211, s88, v[204:205]
  v_mul_f32 v160, v160, v112
  v_mfma_f32_16x16x32_bf16 v[140:143], v[52:55], a[180:183], v[140:143]
  ds_read_b64_tr_b16 v[40:41], v13 offset:24576
  global_load_lds_dwordx4 v[214:215], off
  v_mfma_f32_16x16x32_bf16 v[140:143], v[56:59], a[196:199], v[140:143]
  ds_read_b64_tr_b16 v[42:43], v13 offset:26624
  v_lshl_add_u64 v[216:217], v[214:215], 0, s[100:101]
  v_mfma_f32_16x16x32_bf16 v[140:143], v[60:63], a[212:215], v[140:143]
  v_rcp_f32 v170, v170
  v_mfma_f32_16x16x32_bf16 v[148:151], v[48:51], a[168:171], v[148:151]
  ds_read_b64_tr_b16 v[44:45], v13 offset:28672
  v_mul_f32 v110, v170, v110
  v_mfma_f32_16x16x32_bf16 v[148:151], v[52:55], a[184:187], v[148:151]
  ds_read_b64_tr_b16 v[46:47], v13 offset:30720
  global_load_lds_dwordx4 v[216:217], off offset:1024
  v_mfma_f32_16x16x32_bf16 v[148:151], v[56:59], a[200:203], v[148:151]
  s_add_u32 s88, s88, 4
  v_exp_f32 v171, v171
  v_mfma_f32_16x16x32_bf16 v[148:151], v[60:63], a[216:219], v[148:151]
  s_add_u32 m0, s9, 34816
  v_mad_u64_u32 v[214:215], s[98:99], v211, s88, v[204:205]
  v_add_f32 v171, 1.0, v171
  v_mfma_f32_16x16x32_bf16 v[156:159], v[48:51], a[172:175], v[156:159]
  ds_read_b64_tr_b16 v[48:49], v16 offset:16384
  v_mul_f32 v161, v113, v113
  v_mfma_f32_16x16x32_bf16 v[156:159], v[52:55], a[188:191], v[156:159]
  ds_read_b64_tr_b16 v[50:51], v16 offset:18432
  v_fmaak_f32 v161, v161, v20, 0xc0135761
  v_mfma_f32_16x16x32_bf16 v[156:159], v[56:59], a[204:207], v[156:159]
  ds_read_b64_tr_b16 v[52:53], v16 offset:20480
  global_load_lds_dwordx4 v[214:215], off
  v_mfma_f32_16x16x32_bf16 v[156:159], v[60:63], a[220:223], v[156:159]
  s_waitcnt lgkmcnt(3)
  v_rcp_f32 v171, v171
  v_mfma_f32_16x16x32_bf16 v[128:131], v[32:35], a[224:227], v[128:131]
  ds_read_b64_tr_b16 v[54:55], v16 offset:22528
  v_lshl_add_u64 v[216:217], v[214:215], 0, s[100:101]
  v_mfma_f32_16x16x32_bf16 v[128:131], v[36:39], a[240:243], v[128:131]
  ds_read_b64_tr_b16 v[56:57], v16 offset:24576
  v_mul_f32 v111, v171, v111
  v_mfma_f32_16x16x32_bf16 v[128:131], v[40:43], v[172:175], v[128:131]
  v_exp_f32 v160, v160
  v_mfma_f32_16x16x32_bf16 v[128:131], v[44:47], v[188:191], v[128:131]
  ds_read_b64_tr_b16 v[58:59], v16 offset:26624
  global_load_lds_dwordx4 v[216:217], off offset:1024
  v_mfma_f32_16x16x32_bf16 v[136:139], v[32:35], a[228:231], v[136:139]
  ds_read_b64_tr_b16 v[60:61], v16 offset:28672
  v_add_f32 v160, 1.0, v160
  v_mfma_f32_16x16x32_bf16 v[136:139], v[36:39], a[244:247], v[136:139]
  v_rcp_f32 v160, v160
  v_mfma_f32_16x16x32_bf16 v[136:139], v[40:43], v[176:179], v[136:139]
  ds_read_b64_tr_b16 v[62:63], v16 offset:30720
  v_mul_f32 v112, v160, v112
  v_mfma_f32_16x16x32_bf16 v[136:139], v[44:47], v[192:195], v[136:139]
  v_mul_f32 v161, v161, v113
  v_mul_f32 v162, v114, v114
  v_mfma_f32_16x16x32_bf16 v[144:147], v[32:35], a[232:235], v[144:147]
  v_exp_f32 v161, v161
  v_mfma_f32_16x16x32_bf16 v[144:147], v[36:39], a[248:251], v[144:147]
  v_add_f32 v161, 1.0, v161
  v_fmaak_f32 v162, v162, v20, 0xc0135761
  v_mfma_f32_16x16x32_bf16 v[144:147], v[40:43], v[180:183], v[144:147]
  v_rcp_f32 v161, v161
  v_mfma_f32_16x16x32_bf16 v[144:147], v[44:47], v[196:199], v[144:147]
  v_mul_f32 v113, v161, v113
  v_mul_f32 v162, v162, v114
  v_mfma_f32_16x16x32_bf16 v[152:155], v[32:35], a[236:239], v[152:155]
  v_exp_f32 v162, v162
  v_mfma_f32_16x16x32_bf16 v[152:155], v[36:39], a[252:255], v[152:155]
  v_add_f32 v162, 1.0, v162
  v_mul_f32 v163, v115, v115
  v_mfma_f32_16x16x32_bf16 v[152:155], v[40:43], v[184:187], v[152:155]
  v_rcp_f32 v162, v162
  v_mfma_f32_16x16x32_bf16 v[152:155], v[44:47], v[200:203], v[152:155]
  s_waitcnt vmcnt(8) lgkmcnt(0)
  s_barrier
  v_mfma_f32_16x16x32_bf16 v[132:135], v[48:51], a[224:227], v[132:135]
  ds_read_b64_tr_b16 v[32:33], v15 offset:0
  v_readlane_b32 s88, v23, 22
  v_mfma_f32_16x16x32_bf16 v[132:135], v[52:55], a[240:243], v[132:135]
  ds_read_b64_tr_b16 v[34:35], v15 offset:2048
  v_mul_f32 v114, v162, v114
  v_mfma_f32_16x16x32_bf16 v[132:135], v[56:59], v[172:175], v[132:135]
  ds_read_b64_tr_b16 v[36:37], v15 offset:4096
  v_fmaak_f32 v163, v163, v20, 0xc0135761
  v_mfma_f32_16x16x32_bf16 v[132:135], v[60:63], v[188:191], v[132:135]
  ds_read_b64_tr_b16 v[38:39], v15 offset:6144
  v_mul_f32 v163, v163, v115
  v_mfma_f32_16x16x32_bf16 v[140:143], v[48:51], a[228:231], v[140:143]
  s_add_u32 m0, s9, 49152
  v_mad_u64_u32 v[214:215], s[98:99], v210, s88, v[208:209]
  v_mul_f32 v164, v116, v116
  v_mfma_f32_16x16x32_bf16 v[140:143], v[52:55], a[244:247], v[140:143]
  ds_read_b64_tr_b16 v[40:41], v15 offset:8192
  global_load_lds_dwordx4 v[214:215], off
  v_mfma_f32_16x16x32_bf16 v[140:143], v[56:59], v[176:179], v[140:143]
  ds_read_b64_tr_b16 v[42:43], v15 offset:10240
  v_lshl_add_u64 v[216:217], v[214:215], 0, v[220:221]
  v_mfma_f32_16x16x32_bf16 v[140:143], v[60:63], v[192:195], v[140:143]
  v_exp_f32 v163, v163
  v_mfma_f32_16x16x32_bf16 v[148:151], v[48:51], a[232:235], v[148:151]
  ds_read_b64_tr_b16 v[44:45], v15 offset:12288
  v_add_f32 v163, 1.0, v163
  v_mfma_f32_16x16x32_bf16 v[148:151], v[52:55], a[248:251], v[148:151]
  ds_read_b64_tr_b16 v[46:47], v15 offset:14336
  global_load_lds_dwordx4 v[216:217], off offset:1024
  v_mfma_f32_16x16x32_bf16 v[148:151], v[56:59], v[180:183], v[148:151]
  s_add_u32 s88, s88, 4
  v_rcp_f32 v163, v163
  v_mfma_f32_16x16x32_bf16 v[148:151], v[60:63], v[196:199], v[148:151]
  s_add_u32 m0, s9, 51200
  v_mad_u64_u32 v[214:215], s[98:99], v210, s88, v[208:209]
  v_mul_f32 v115, v163, v115
  v_mfma_f32_16x16x32_bf16 v[156:159], v[48:51], a[236:239], v[156:159]
  ds_read_b64_tr_b16 v[48:49], v18 offset:0
  v_fmaak_f32 v164, v164, v20, 0xc0135761
  v_mfma_f32_16x16x32_bf16 v[156:159], v[52:55], a[252:255], v[156:159]
  ds_read_b64_tr_b16 v[50:51], v18 offset:2048
  v_mul_f32 v164, v164, v116
  v_mfma_f32_16x16x32_bf16 v[156:159], v[56:59], v[184:187], v[156:159]
  ds_read_b64_tr_b16 v[52:53], v18 offset:4096
  global_load_lds_dwordx4 v[214:215], off
  v_mfma_f32_16x16x32_bf16 v[156:159], v[60:63], v[200:203], v[156:159]
  s_waitcnt lgkmcnt(3)
  v_exp_f32 v164, v164
  v_mfma_f32_16x16x32_bf16 v[64:67], v[32:35], a[0:3], 0
  ds_read_b64_tr_b16 v[54:55], v18 offset:6144
  v_lshl_add_u64 v[216:217], v[214:215], 0, v[220:221]
  v_mfma_f32_16x16x32_bf16 v[64:67], v[36:39], a[16:19], v[64:67]
  ds_read_b64_tr_b16 v[56:57], v18 offset:8192
  v_add_f32 v164, 1.0, v164
  v_mfma_f32_16x16x32_bf16 v[64:67], v[40:43], a[32:35], v[64:67]
  v_rcp_f32 v164, v164
  v_mfma_f32_16x16x32_bf16 v[64:67], v[44:47], a[48:51], v[64:67]
  ds_read_b64_tr_b16 v[58:59], v18 offset:10240
  global_load_lds_dwordx4 v[216:217], off offset:1024
  v_mfma_f32_16x16x32_bf16 v[72:75], v[32:35], a[4:7], 0
  ds_read_b64_tr_b16 v[60:61], v18 offset:12288
  v_mul_f32 v96, v96, v128
  v_mfma_f32_16x16x32_bf16 v[72:75], v[36:39], a[20:23], v[72:75]
  v_mul_f32 v97, v97, v129
  v_mul_f32 v98, v98, v130
  v_mfma_f32_16x16x32_bf16 v[72:75], v[40:43], a[36:39], v[72:75]
  ds_read_b64_tr_b16 v[62:63], v18 offset:14336
  v_cvt_pk_bf16_f32 v96, v96, v97
  v_mfma_f32_16x16x32_bf16 v[72:75], v[44:47], a[52:55], v[72:75]
PAD3:
  s_cbranch_execz PAD7
  v_mul_f32 v99, v99, v131
  v_mul_f32 v100, v100, v132
  v_mfma_f32_16x16x32_bf16 v[80:83], v[32:35], a[8:11], 0
  v_cvt_pk_bf16_f32 v97, v98, v99
  v_mul_f32 v101, v101, v133
  v_mfma_f32_16x16x32_bf16 v[80:83], v[36:39], a[24:27], v[80:83]
  v_cvt_pk_bf16_f32 v98, v100, v101
  v_mul_f32 v102, v102, v134
  v_mfma_f32_16x16x32_bf16 v[80:83], v[40:43], a[40:43], v[80:83]
  v_mul_f32 v103, v103, v135
  v_mul_f32 v104, v104, v136
  v_mfma_f32_16x16x32_bf16 v[80:83], v[44:47], a[56:59], v[80:83]
  v_cvt_pk_bf16_f32 v99, v102, v103
  v_mul_f32 v105, v105, v137
  v_mfma_f32_16x16x32_bf16 v[88:91], v[32:35], a[12:15], 0
  ds_write_b128 v236, v[96:99] offset:16384
  v_mfma_f32_16x16x32_bf16 v[88:91], v[36:39], a[28:31], v[88:91]
  v_cvt_pk_bf16_f32 v104, v104, v105
  v_mul_f32 v106, v106, v138
  v_mfma_f32_16x16x32_bf16 v[88:91], v[40:43], a[44:47], v[88:91]
  v_mul_f32 v107, v107, v139
  v_mul_f32 v108, v108, v140
  v_mfma_f32_16x16x32_bf16 v[88:91], v[44:47], a[60:63], v[88:91]
  s_waitcnt lgkmcnt(1)
  v_cvt_pk_bf16_f32 v105, v106, v107
  v_mul_f32 v109, v109, v141
  v_mfma_f32_16x16x32_bf16 v[68:71], v[48:51], a[0:3], 0
  ds_read_b64_tr_b16 v[32:33], v14 offset:0
  v_readlane_b32 s88, v23, 23
  v_mfma_f32_16x16x32_bf16 v[68:71], v[52:55], a[16:19], v[68:71]
  ds_read_b64_tr_b16 v[34:35], v14 offset:2048
  v_cvt_pk_bf16_f32 v106, v108, v109
  v_mfma_f32_16x16x32_bf16 v[68:71], v[56:59], a[32:35], v[68:71]
  ds_read_b64_tr_b16 v[36:37], v14 offset:4096
  v_mul_f32 v110, v110, v142
  v_mfma_f32_16x16x32_bf16 v[68:71], v[60:63], a[48:51], v[68:71]
  ds_read_b64_tr_b16 v[38:39], v14 offset:6144
  v_mul_f32 v111, v111, v143
  v_mfma_f32_16x16x32_bf16 v[76:79], v[48:51], a[4:7], 0
  s_add_u32 m0, s9, 81920
  v_mad_u64_u32 v[214:215], s[98:99], v212, s88, v[206:207]
  v_cvt_pk_bf16_f32 v107, v110, v111
  v_mfma_f32_16x16x32_bf16 v[76:79], v[52:55], a[20:23], v[76:79]
  ds_read_b64_tr_b16 v[40:41], v14 offset:8192
  global_load_lds_dwordx4 v[214:215], off
  v_mfma_f32_16x16x32_bf16 v[76:79], v[56:59], a[36:39], v[76:79]
  ds_read_b64_tr_b16 v[42:43], v14 offset:10240
  v_lshl_add_u64 v[216:217], v[214:215], 0, v[218:219]
  v_mfma_f32_16x16x32_bf16 v[76:79], v[60:63], a[52:55], v[76:79]
  ds_write_b128 v236, v[104:107] offset:17408
  v_mfma_f32_16x16x32_bf16 v[84:87], v[48:51], a[8:11], 0
  ds_read_b64_tr_b16 v[44:45], v14 offset:12288
  v_mul_f32 v112, v112, v144
  v_mul_f32 v113, v113, v145
  v_mfma_f32_16x16x32_bf16 v[84:87], v[52:55], a[24:27], v[84:87]
  ds_read_b64_tr_b16 v[46:47], v14 offset:14336
  global_load_lds_dwordx4 v[216:217], off offset:1024
  v_mfma_f32_16x16x32_bf16 v[84:87], v[56:59], a[40:43], v[84:87]
  s_add_u32 s88, s88, 4
  v_cvt_pk_bf16_f32 v112, v112, v113
  v_mul_f32 v114, v114, v146
  v_mfma_f32_16x16x32_bf16 v[84:87], v[60:63], a[56:59], v[84:87]
  s_add_u32 m0, s9, 83968
  v_mad_u64_u32 v[214:215], s[98:99], v212, s88, v[206:207]
  v_mul_f32 v116, v164, v116
  v_mfma_f32_16x16x32_bf16 v[92:95], v[48:51], a[12:15], 0
  ds_read_b64_tr_b16 v[48:49], v17 offset:0
  v_mul_f32 v115, v115, v147
  v_mfma_f32_16x16x32_bf16 v[92:95], v[52:55], a[28:31], v[92:95]
  ds_read_b64_tr_b16 v[50:51], v17 offset:2048
  v_cvt_pk_bf16_f32 v113, v114, v115
  v_mfma_f32_16x16x32_bf16 v[92:95], v[56:59], a[44:47], v[92:95]
  ds_read_b64_tr_b16 v[52:53], v17 offset:4096
  global_load_lds_dwordx4 v[214:215], off
  v_mfma_f32_16x16x32_bf16 v[92:95], v[60:63], a[60:63], v[92:95]
  s_waitcnt lgkmcnt(3)
  v_mul_f32 v165, v117, v117
  v_mul_f32 v116, v116, v148
  v_mfma_f32_16x16x32_bf16 v[64:67], v[32:35], a[64:67], v[64:67]
  ds_read_b64_tr_b16 v[54:55], v17 offset:6144
  v_lshl_add_u64 v[216:217], v[214:215], 0, v[218:219]
  v_mfma_f32_16x16x32_bf16 v[64:67], v[36:39], a[80:83], v[64:67]
  ds_read_b64_tr_b16 v[56:57], v17 offset:8192
  v_fmaak_f32 v165, v165, v20, 0xc0135761
  v_mfma_f32_16x16x32_bf16 v[64:67], v[40:43], a[96:99], v[64:67]
  v_mul_f32 v165, v165, v117
  v_mul_f32 v166, v118, v118
  v_mfma_f32_16x16x32_bf16 v[64:67], v[44:47], a[112:115], v[64:67]
  ds_read_b64_tr_b16 v[58:59], v17 offset:10240
  global_load_lds_dwordx4 v[216:217], off offset:1024
  v_mfma_f32_16x16x32_bf16 v[72:75], v[32:35], a[68:71], v[72:75]
  ds_read_b64_tr_b16 v[60:61], v17 offset:12288
  v_fmaak_f32 v166, v166, v20, 0xc0135761
  v_mfma_f32_16x16x32_bf16 v[72:75], v[36:39], a[84:87], v[72:75]
  v_exp_f32 v165, v165
  v_mfma_f32_16x16x32_bf16 v[72:75], v[40:43], a[100:103], v[72:75]
  ds_read_b64_tr_b16 v[62:63], v17 offset:14336
  v_add_f32 v165, 1.0, v165
  v_mfma_f32_16x16x32_bf16 v[72:75], v[44:47], a[116:119], v[72:75]
  v_rcp_f32 v165, v165
  v_mfma_f32_16x16x32_bf16 v[80:83], v[32:35], a[72:75], v[80:83]
  v_mul_f32 v117, v165, v117
  v_mul_f32 v166, v166, v118
  v_mfma_f32_16x16x32_bf16 v[80:83], v[36:39], a[88:91], v[80:83]
  v_exp_f32 v166, v166
  v_mfma_f32_16x16x32_bf16 v[80:83], v[40:43], a[104:107], v[80:83]
  v_add_f32 v166, 1.0, v166
  v_mul_f32 v117, v117, v149
  v_mfma_f32_16x16x32_bf16 v[80:83], v[44:47], a[120:123], v[80:83]
  v_rcp_f32 v166, v166
  v_mfma_f32_16x16x32_bf16 v[88:91], v[32:35], a[76:79], v[88:91]
  v_cvt_pk_bf16_f32 v114, v116, v117
  v_mul_f32 v118, v166, v118
  v_mfma_f32_16x16x32_bf16 v[88:91], v[36:39], a[92:95], v[88:91]
  v_mul_f32 v167, v119, v119
  v_mul_f32 v118, v118, v150
  v_mfma_f32_16x16x32_bf16 v[88:91], v[40:43], a[108:111], v[88:91]
  v_fmaak_f32 v167, v167, v20, 0xc0135761
  v_mul_f32 v168, v120, v120
  v_mfma_f32_16x16x32_bf16 v[88:91], v[44:47], a[124:127], v[88:91]
  s_waitcnt vmcnt(8) lgkmcnt(0)
  s_barrier
  v_mfma_f32_16x16x32_bf16 v[68:71], v[48:51], a[64:67], v[68:71]
  ds_read_b64_tr_b16 v[32:33], v15 offset:16384
  v_readlane_b32 s88, v23, 24
  v_mfma_f32_16x16x32_bf16 v[68:71], v[52:55], a[80:83], v[68:71]
  ds_read_b64_tr_b16 v[34:35], v15 offset:18432
  v_mul_f32 v167, v167, v119
  v_mfma_f32_16x16x32_bf16 v[68:71], v[56:59], a[96:99], v[68:71]
  ds_read_b64_tr_b16 v[36:37], v15 offset:20480
  v_fmaak_f32 v168, v168, v20, 0xc0135761
  v_mfma_f32_16x16x32_bf16 v[68:71], v[60:63], a[112:115], v[68:71]
  ds_read_b64_tr_b16 v[38:39], v15 offset:22528
  v_mul_f32 v168, v168, v120
  v_mfma_f32_16x16x32_bf16 v[76:79], v[48:51], a[68:71], v[76:79]
  s_add_u32 m0, s9, 98304
  v_mad_u64_u32 v[214:215], s[98:99], v212, s88, v[206:207]
  v_mul_f32 v169, v121, v121
  v_mfma_f32_16x16x32_bf16 v[76:79], v[52:55], a[84:87], v[76:79]
  ds_read_b64_tr_b16 v[40:41], v15 offset:24576
  global_load_lds_dwordx4 v[214:215], off
  v_mfma_f32_16x16x32_bf16 v[76:79], v[56:59], a[100:103], v[76:79]
  ds_read_b64_tr_b16 v[42:43], v15 offset:26624
  v_lshl_add_u64 v[216:217], v[214:215], 0, v[218:219]
  v_mfma_f32_16x16x32_bf16 v[76:79], v[60:63], a[116:119], v[76:79]
  v_exp_f32 v167, v167
  v_mfma_f32_16x16x32_bf16 v[84:87], v[48:51], a[72:75], v[84:87]
  ds_read_b64_tr_b16 v[44:45], v15 offset:28672
  v_add_f32 v167, 1.0, v167
  v_mfma_f32_16x16x32_bf16 v[84:87], v[52:55], a[88:91], v[84:87]
  ds_read_b64_tr_b16 v[46:47], v15 offset:30720
  global_load_lds_dwordx4 v[216:217], off offset:1024
  v_mfma_f32_16x16x32_bf16 v[84:87], v[56:59], a[104:107], v[84:87]
  s_add_u32 s88, s88, 4
  v_rcp_f32 v167, v167
  v_mfma_f32_16x16x32_bf16 v[84:87], v[60:63], a[120:123], v[84:87]
  s_add_u32 m0, s9, 100352
  v_mad_u64_u32 v[214:215], s[98:99], v212, s88, v[206:207]
  v_mul_f32 v119, v167, v119
  v_mfma_f32_16x16x32_bf16 v[92:95], v[48:51], a[76:79], v[92:95]
  ds_read_b64_tr_b16 v[48:49], v18 offset:16384
  v_mul_f32 v119, v119, v151
  v_mfma_f32_16x16x32_bf16 v[92:95], v[52:55], a[92:95], v[92:95]
  ds_read_b64_tr_b16 v[50:51], v18 offset:18432
  v_cvt_pk_bf16_f32 v115, v118, v119
  v_mfma_f32_16x16x32_bf16 v[92:95], v[56:59], a[108:111], v[92:95]
  ds_read_b64_tr_b16 v[52:53], v18 offset:20480
  global_load_lds_dwordx4 v[214:215], off
  v_mfma_f32_16x16x32_bf16 v[92:95], v[60:63], a[124:127], v[92:95]
  s_waitcnt lgkmcnt(3)
  ds_write_b128 v236, v[112:115] offset:18432
  v_mfma_f32_16x16x32_bf16 v[64:67], v[32:35], a[128:131], v[64:67]
  ds_read_b64_tr_b16 v[54:55], v18 offset:22528
  v_lshl_add_u64 v[216:217], v[214:215], 0, v[218:219]
  v_fmaak_f32 v169, v169, v20, 0xc0135761
  v_mfma_f32_16x16x32_bf16 v[64:67], v[36:39], a[144:147], v[64:67]
  ds_read_b64_tr_b16 v[56:57], v18 offset:24576
  v_mul_f32 v169, v169, v121
  v_mfma_f32_16x16x32_bf16 v[64:67], v[40:43], a[160:163], v[64:67]
  v_exp_f32 v168, v168
  v_mfma_f32_16x16x32_bf16 v[64:67], v[44:47], a[176:179], v[64:67]
  ds_read_b64_tr_b16 v[58:59], v18 offset:26624
  global_load_lds_dwordx4 v[216:217], off offset:1024
  v_mfma_f32_16x16x32_bf16 v[72:75], v[32:35], a[132:135], v[72:75]
  ds_read_b64_tr_b16 v[60:61], v18 offset:28672
  v_add_f32 v168, 1.0, v168
  v_mfma_f32_16x16x32_bf16 v[72:75], v[36:39], a[148:151], v[72:75]
  v_rcp_f32 v168, v168
  v_mfma_f32_16x16x32_bf16 v[72:75], v[40:43], a[164:167], v[72:75]
  ds_read_b64_tr_b16 v[62:63], v18 offset:30720
  v_mul_f32 v120, v168, v120
  v_mfma_f32_16x16x32_bf16 v[72:75], v[44:47], a[180:183], v[72:75]
  v_exp_f32 v169, v169
  v_mfma_f32_16x16x32_bf16 v[80:83], v[32:35], a[136:139], v[80:83]
  v_add_f32 v169, 1.0, v169
  v_mul_f32 v120, v120, v152
  v_mfma_f32_16x16x32_bf16 v[80:83], v[36:39], a[152:155], v[80:83]
  v_rcp_f32 v169, v169
  v_mfma_f32_16x16x32_bf16 v[80:83], v[40:43], a[168:171], v[80:83]
  v_mul_f32 v121, v169, v121
  v_mul_f32 v170, v122, v122
  v_mfma_f32_16x16x32_bf16 v[80:83], v[44:47], a[184:187], v[80:83]
  v_fmaak_f32 v170, v170, v20, 0xc0135761
  v_mul_f32 v121, v121, v153
  v_mfma_f32_16x16x32_bf16 v[88:91], v[32:35], a[140:143], v[88:91]
  v_cvt_pk_bf16_f32 v120, v120, v121
  v_mul_f32 v170, v170, v122
  v_mfma_f32_16x16x32_bf16 v[88:91], v[36:39], a[156:159], v[88:91]
  v_exp_f32 v170, v170
  v_mul_f32 v171, v123, v123
  v_mfma_f32_16x16x32_bf16 v[88:91], v[40:43], a[172:175], v[88:91]
  v_add_f32 v170, 1.0, v170
  v_fmaak_f32 v171, v171, v20, 0xc0135761
  v_mfma_f32_16x16x32_bf16 v[88:91], v[44:47], a[188:191], v[88:91]
  s_waitcnt lgkmcnt(0)
  v_rcp_f32 v170, v170
  v_mfma_f32_16x16x32_bf16 v[68:71], v[48:51], a[128:131], v[68:71]
  ds_read_b64_tr_b16 v[32:33], v13 offset:32768
  v_readlane_b32 s88, v23, 25
  v_mfma_f32_16x16x32_bf16 v[68:71], v[52:55], a[144:147], v[68:71]
  ds_read_b64_tr_b16 v[34:35], v13 offset:34816
  v_mul_f32 v122, v170, v122
  v_mfma_f32_16x16x32_bf16 v[68:71], v[56:59], a[160:163], v[68:71]
  ds_read_b64_tr_b16 v[36:37], v13 offset:36864
  v_mul_f32 v171, v171, v123
  v_mfma_f32_16x16x32_bf16 v[68:71], v[60:63], a[176:179], v[68:71]
  ds_read_b64_tr_b16 v[38:39], v13 offset:38912
  v_mul_f32 v122, v122, v154
  v_mfma_f32_16x16x32_bf16 v[76:79], v[48:51], a[132:135], v[76:79]
  s_add_u32 m0, s9, 114688
  v_mad_u64_u32 v[214:215], s[98:99], v212, s88, v[206:207]
  v_mul_f32 v160, v124, v124
  v_mfma_f32_16x16x32_bf16 v[76:79], v[52:55], a[148:151], v[76:79]
  ds_read_b64_tr_b16 v[40:41], v13 offset:40960
  global_load_lds_dwordx4 v[214:215], off
  v_mfma_f32_16x16x32_bf16 v[76:79], v[56:59], a[164:167], v[76:79]
  ds_read_b64_tr_b16 v[42:43], v13 offset:43008
  v_lshl_add_u64 v[216:217], v[214:215], 0, v[218:219]
  v_mfma_f32_16x16x32_bf16 v[76:79], v[60:63], a[180:183], v[76:79]
  v_exp_f32 v171, v171
  v_mfma_f32_16x16x32_bf16 v[84:87], v[48:51], a[136:139], v[84:87]
  ds_read_b64_tr_b16 v[44:45], v13 offset:45056
  v_add_f32 v171, 1.0, v171
  v_mfma_f32_16x16x32_bf16 v[84:87], v[52:55], a[152:155], v[84:87]
  ds_read_b64_tr_b16 v[46:47], v13 offset:47104
  global_load_lds_dwordx4 v[216:217], off offset:1024
  v_mfma_f32_16x16x32_bf16 v[84:87], v[56:59], a[168:171], v[84:87]
  s_add_u32 s88, s88, 4
  v_rcp_f32 v171, v171
  v_mfma_f32_16x16x32_bf16 v[84:87], v[60:63], a[184:187], v[84:87]
  s_add_u32 m0, s9, 116736
  v_mad_u64_u32 v[214:215], s[98:99], v212, s88, v[206:207]
  v_mul_f32 v123, v171, v123
  v_mfma_f32_16x16x32_bf16 v[92:95], v[48:51], a[140:143], v[92:95]
  ds_read_b64_tr_b16 v[48:49], v16 offset:32768
  v_fmaak_f32 v160, v160, v20, 0xc0135761
  v_mfma_f32_16x16x32_bf16 v[92:95], v[52:55], a[156:159], v[92:95]
  ds_read_b64_tr_b16 v[50:51], v16 offset:34816
  v_mul_f32 v160, v160, v124
  v_mfma_f32_16x16x32_bf16 v[92:95], v[56:59], a[172:175], v[92:95]
  ds_read_b64_tr_b16 v[52:53], v16 offset:36864
  global_load_lds_dwordx4 v[214:215], off
  v_mfma_f32_16x16x32_bf16 v[92:95], v[60:63], a[188:191], v[92:95]
  s_waitcnt lgkmcnt(3)
  v_exp_f32 v160, v160
  v_mfma_f32_16x16x32_bf16 v[64:67], v[32:35], a[192:195], v[64:67]
  ds_read_b64_tr_b16 v[54:55], v16 offset:38912
  v_lshl_add_u64 v[216:217], v[214:215], 0, v[218:219]
  v_mfma_f32_16x16x32_bf16 v[64:67], v[36:39], a[208:211], v[64:67]
  ds_read_b64_tr_b16 v[56:57], v16 offset:40960
  v_add_f32 v160, 1.0, v160
  v_mfma_f32_16x16x32_bf16 v[64:67], v[40:43], a[224:227], v[64:67]
  v_rcp_f32 v160, v160
  v_mfma_f32_16x16x32_bf16 v[64:67], v[44:47], a[240:243], v[64:67]
  ds_read_b64_tr_b16 v[58:59], v16 offset:43008
  global_load_lds_dwordx4 v[216:217], off offset:1024
  v_mfma_f32_16x16x32_bf16 v[72:75], v[32:35], a[196:199], v[72:75]
  ds_read_b64_tr_b16 v[60:61], v16 offset:45056
  v_mul_f32 v124, v160, v124
  v_mfma_f32_16x16x32_bf16 v[72:75], v[36:39], a[212:215], v[72:75]
  v_mul_f32 v123, v123, v155
  v_mul_f32 v161, v125, v125
  v_mfma_f32_16x16x32_bf16 v[72:75], v[40:43], a[228:231], v[72:75]
  ds_read_b64_tr_b16 v[62:63], v16 offset:47104
  v_cvt_pk_bf16_f32 v121, v122, v123
  v_mfma_f32_16x16x32_bf16 v[72:75], v[44:47], a[244:247], v[72:75]
  v_fmaak_f32 v161, v161, v20, 0xc0135761
  v_mul_f32 v124, v124, v156
  v_mul_f32 v162, v126, v126
  v_mfma_f32_16x16x32_bf16 v[80:83], v[32:35], a[200:203], v[80:83]
  v_mul_f32 v161, v161, v125
  v_fmaak_f32 v162, v162, v20, 0xc0135761
  v_mul_f32 v163, v127, v127
  v_mfma_f32_16x16x32_bf16 v[80:83], v[36:39], a[216:219], v[80:83]
  v_exp_f32 v161, v161
  v_mfma_f32_16x16x32_bf16 v[80:83], v[40:43], a[232:235], v[80:83]
  v_add_f32 v161, 1.0, v161
  v_mul_f32 v162, v162, v126
  v_mfma_f32_16x16x32_bf16 v[80:83], v[44:47], a[248:251], v[80:83]
  v_rcp_f32 v161, v161
  v_mfma_f32_16x16x32_bf16 v[88:91], v[32:35], a[204:207], v[88:91]
  v_exp_f32 v162, v162
  v_mfma_f32_16x16x32_bf16 v[88:91], v[36:39], a[220:223], v[88:91]
  v_mul_f32 v125, v161, v125
  v_add_f32 v162, 1.0, v162
  v_mfma_f32_16x16x32_bf16 v[88:91], v[40:43], a[236:239], v[88:91]
  v_rcp_f32 v162, v162
  v_mul_f32 v125, v125, v157
  v_mfma_f32_16x16x32_bf16 v[88:91], v[44:47], a[252:255], v[88:91]
  s_waitcnt vmcnt(8) lgkmcnt(0)
  s_barrier
  v_mfma_f32_16x16x32_bf16 v[68:71], v[48:51], a[192:195], v[68:71]
  ds_read_b64_tr_b16 v[32:33], v13 offset:49152
  v_readlane_b32 s88, v23, 26
  v_fmaak_f32 v163, v163, v20, 0xc0135761
  v_mfma_f32_16x16x32_bf16 v[68:71], v[52:55], a[208:211], v[68:71]
  ds_read_b64_tr_b16 v[34:35], v13 offset:51200
  v_mul_f32 v163, v163, v127
  v_mfma_f32_16x16x32_bf16 v[68:71], v[56:59], a[224:227], v[68:71]
  ds_read_b64_tr_b16 v[36:37], v16 offset:49152
  v_cvt_pk_bf16_f32 v122, v124, v125
  v_mfma_f32_16x16x32_bf16 v[68:71], v[60:63], a[240:243], v[68:71]
  ds_read_b64_tr_b16 v[38:39], v16 offset:51200
  v_exp_f32 v163, v163
  v_mfma_f32_16x16x32_bf16 v[76:79], v[48:51], a[196:199], v[76:79]
  s_add_u32 m0, s9, 131072
  v_mad_u64_u32 v[214:215], s[98:99], v212, s88, v[206:207]
  v_mul_f32 v126, v162, v126
  v_mfma_f32_16x16x32_bf16 v[76:79], v[52:55], a[212:215], v[76:79]
  ds_read_b64_tr_b16 v[40:41], v13 offset:53248
  global_load_lds_dwordx4 v[214:215], off
  v_add_f32 v163, 1.0, v163
  v_mfma_f32_16x16x32_bf16 v[76:79], v[56:59], a[228:231], v[76:79]
  ds_read_b64_tr_b16 v[42:43], v13 offset:55296
  v_lshl_add_u64 v[216:217], v[214:215], 0, v[218:219]
  v_mfma_f32_16x16x32_bf16 v[76:79], v[60:63], a[244:247], v[76:79]
  v_rcp_f32 v163, v163
  v_mfma_f32_16x16x32_bf16 v[84:87], v[48:51], a[200:203], v[84:87]
  ds_read_b64_tr_b16 v[44:45], v16 offset:53248
  v_mul_f32 v127, v163, v127
  v_mfma_f32_16x16x32_bf16 v[84:87], v[52:55], a[216:219], v[84:87]
  ds_read_b64_tr_b16 v[46:47], v16 offset:55296
  global_load_lds_dwordx4 v[216:217], off offset:1024
  v_mfma_f32_16x16x32_bf16 v[84:87], v[56:59], a[232:235], v[84:87]
  s_add_u32 s88, s88, 4
  v_mul_f32 v126, v126, v158
  v_mul_f32 v127, v127, v159
  v_mfma_f32_16x16x32_bf16 v[84:87], v[60:63], a[248:251], v[84:87]
  s_add_u32 m0, s9, 133120
  v_mad_u64_u32 v[214:215], s[98:99], v212, s88, v[206:207]
  v_cvt_pk_bf16_f32 v123, v126, v127
  v_mfma_f32_16x16x32_bf16 v[92:95], v[48:51], a[204:207], v[92:95]
  ds_read_b64_tr_b16 v[48:49], v13 offset:57344
  v_mfma_f32_16x16x32_bf16 v[92:95], v[52:55], a[220:223], v[92:95]
  ds_read_b64_tr_b16 v[50:51], v13 offset:59392
  v_mfma_f32_16x16x32_bf16 v[92:95], v[56:59], a[236:239], v[92:95]
  ds_read_b64_tr_b16 v[52:53], v16 offset:57344
  global_load_lds_dwordx4 v[214:215], off
  v_mfma_f32_16x16x32_bf16 v[92:95], v[60:63], a[252:255], v[92:95]
  s_waitcnt lgkmcnt(3)
  ds_write_b128 v236, v[120:123] offset:19456
  v_mfma_f32_16x16x32_bf16 v[64:67], v[32:35], v[172:175], v[64:67]
  ds_read_b64_tr_b16 v[54:55], v16 offset:59392
  v_lshl_add_u64 v[216:217], v[214:215], 0, v[218:219]
  v_mfma_f32_16x16x32_bf16 v[64:67], v[40:43], v[188:191], v[64:67]
  ds_read_b64_tr_b16 v[56:57], v13 offset:61440
  v_mfma_f32_16x16x32_bf16 v[72:75], v[32:35], v[176:179], v[72:75]
  v_mfma_f32_16x16x32_bf16 v[72:75], v[40:43], v[192:195], v[72:75]
  ds_read_b64_tr_b16 v[58:59], v13 offset:63488
  global_load_lds_dwordx4 v[216:217], off offset:1024
  v_mfma_f32_16x16x32_bf16 v[80:83], v[32:35], v[180:183], v[80:83]
  ds_read_b64_tr_b16 v[60:61], v16 offset:61440
  v_mfma_f32_16x16x32_bf16 v[80:83], v[40:43], v[196:199], v[80:83]
  v_mfma_f32_16x16x32_bf16 v[88:91], v[32:35], v[184:187], v[88:91]
  ds_read_b64_tr_b16 v[62:63], v16 offset:63488
  v_mfma_f32_16x16x32_bf16 v[88:91], v[40:43], v[200:203], v[88:91]
  v_mfma_f32_16x16x32_bf16 v[68:71], v[36:39], v[172:175], v[68:71]
  v_mfma_f32_16x16x32_bf16 v[68:71], v[44:47], v[188:191], v[68:71]
  v_mfma_f32_16x16x32_bf16 v[76:79], v[36:39], v[176:179], v[76:79]
  v_mfma_f32_16x16x32_bf16 v[76:79], v[44:47], v[192:195], v[76:79]
  v_mfma_f32_16x16x32_bf16 v[84:87], v[36:39], v[180:183], v[84:87]
  v_mfma_f32_16x16x32_bf16 v[84:87], v[44:47], v[196:199], v[84:87]
  v_mfma_f32_16x16x32_bf16 v[92:95], v[36:39], v[184:187], v[92:95]
  v_mfma_f32_16x16x32_bf16 v[92:95], v[44:47], v[200:203], v[92:95]
  s_waitcnt lgkmcnt(0)
  v_mfma_f32_16x16x32_bf16 v[128:131], v[48:51], a[0:3], 0
  ds_read_b64_tr_b16 v[32:33], v14 offset:16384
  v_mfma_f32_16x16x32_bf16 v[128:131], v[56:59], a[16:19], v[128:131]
  ds_read_b64_tr_b16 v[34:35], v14 offset:18432
  v_readlane_b32 s88, v23, 27
  v_mfma_f32_16x16x32_bf16 v[136:139], v[48:51], a[4:7], 0
  ds_read_b64_tr_b16 v[36:37], v14 offset:20480
  v_mfma_f32_16x16x32_bf16 v[136:139], v[56:59], a[20:23], v[136:139]
  ds_read_b64_tr_b16 v[38:39], v14 offset:22528
  v_mfma_f32_16x16x32_bf16 v[144:147], v[48:51], a[8:11], 0
  s_add_u32 m0, s9, 32768
  v_mfma_f32_16x16x32_bf16 v[144:147], v[56:59], a[24:27], v[144:147]
  ds_read_b64_tr_b16 v[40:41], v14 offset:24576
  buffer_load_dwordx4 v1, s[48:51], s88 offen lds
  s_cmp_ge_u32 s3, 2
  s_cbranch_scc1 F_xw1
  ds_write_b128 v224, v[80:83] offset:0
  ds_write_b128 v224, v[84:87] offset:1024
  ds_write_b128 v224, v[88:91] offset:2048
  ds_write_b128 v224, v[92:95] offset:3072
  s_branch F_xw2
F_xw1:
  ds_write_b128 v224, v[64:67] offset:0
  ds_write_b128 v224, v[68:71] offset:1024
  ds_write_b128 v224, v[72:75] offset:2048
  ds_write_b128 v224, v[76:79] offset:3072
F_xw2:
  v_mfma_f32_16x16x32_bf16 v[152:155], v[48:51], a[12:15], 0
  ds_read_b64_tr_b16 v[42:43], v14 offset:26624
  v_mfma_f32_16x16x32_bf16 v[152:155], v[56:59], a[28:31], v[152:155]
  v_mfma_f32_16x16x32_bf16 v[132:135], v[52:55], a[0:3], 0
  ds_read_b64_tr_b16 v[44:45], v14 offset:28672
  buffer_load_ushort v228, v226, s[68:71], s80 offen
  v_mfma_f32_16x16x32_bf16 v[132:135], v[60:63], a[16:19], v[132:135]
  ds_read_b64_tr_b16 v[46:47], v14 offset:30720
  buffer_load_dwordx4 v2, s[48:51], s88 offen offset:1024 lds
  v_mfma_f32_16x16x32_bf16 v[140:143], v[52:55], a[4:7], 0
  v_mfma_f32_16x16x32_bf16 v[140:143], v[60:63], a[20:23], v[140:143]
  buffer_load_ushort v229, v226, s[68:71], s81 offen
  v_mfma_f32_16x16x32_bf16 v[148:151], v[52:55], a[8:11], 0
  ds_read_b64_tr_b16 v[48:49], v17 offset:16384
  v_mfma_f32_16x16x32_bf16 v[148:151], v[60:63], a[24:27], v[148:151]
  ds_read_b64_tr_b16 v[50:51], v17 offset:18432
  v_mfma_f32_16x16x32_bf16 v[156:159], v[52:55], a[12:15], 0
  ds_read_b64_tr_b16 v[52:53], v17 offset:20480
  buffer_load_dwordx4 v3, s[48:51], s88 offen offset:2048 lds
  v_mfma_f32_16x16x32_bf16 v[156:159], v[60:63], a[28:31], v[156:159]
  s_waitcnt lgkmcnt(3)
  buffer_load_ushort v230, v226, s[68:71], s82 offen
  v_mfma_f32_16x16x32_bf16 v[128:131], v[32:35], a[32:35], v[128:131]
  ds_read_b64_tr_b16 v[54:55], v17 offset:22528
  v_mfma_f32_16x16x32_bf16 v[128:131], v[36:39], a[48:51], v[128:131]
  ds_read_b64_tr_b16 v[56:57], v17 offset:24576
  buffer_load_ushort v231, v226, s[68:71], s83 offen
  v_mfma_f32_16x16x32_bf16 v[128:131], v[40:43], a[64:67], v[128:131]
  v_mfma_f32_16x16x32_bf16 v[128:131], v[44:47], a[80:83], v[128:131]
  ds_read_b64_tr_b16 v[58:59], v17 offset:26624
  buffer_load_dwordx4 v4, s[48:51], s88 offen offset:3072 lds
  v_mfma_f32_16x16x32_bf16 v[136:139], v[32:35], a[36:39], v[136:139]
  ds_read_b64_tr_b16 v[60:61], v17 offset:28672
  buffer_load_ushort v232, v226, s[68:71], s84 offen
  v_mfma_f32_16x16x32_bf16 v[136:139], v[36:39], a[52:55], v[136:139]
  v_mfma_f32_16x16x32_bf16 v[136:139], v[40:43], a[68:71], v[136:139]
  ds_read_b64_tr_b16 v[62:63], v17 offset:30720
  v_mfma_f32_16x16x32_bf16 v[136:139], v[44:47], a[84:87], v[136:139]
  buffer_load_ushort v233, v226, s[68:71], s85 offen
  v_mfma_f32_16x16x32_bf16 v[144:147], v[32:35], a[40:43], v[144:147]
  v_mfma_f32_16x16x32_bf16 v[144:147], v[36:39], a[56:59], v[144:147]
  v_mfma_f32_16x16x32_bf16 v[144:147], v[40:43], a[72:75], v[144:147]
  buffer_load_ushort v234, v226, s[68:71], s86 offen
  v_mfma_f32_16x16x32_bf16 v[144:147], v[44:47], a[88:91], v[144:147]
  v_mfma_f32_16x16x32_bf16 v[152:155], v[32:35], a[44:47], v[152:155]
  v_mfma_f32_16x16x32_bf16 v[152:155], v[36:39], a[60:63], v[152:155]
  buffer_load_ushort v235, v226, s[68:71], s87 offen
  v_mfma_f32_16x16x32_bf16 v[152:155], v[40:43], a[76:79], v[152:155]
  v_mfma_f32_16x16x32_bf16 v[152:155], v[44:47], a[92:95], v[152:155]
  s_waitcnt vmcnt(16) lgkmcnt(0)
  s_barrier
  v_mfma_f32_16x16x32_bf16 v[132:135], v[48:51], a[32:35], v[132:135]
  ds_read_b64_tr_b16 v[32:33], v14 offset:32768
  v_cmp_eq_u32 vcc, 0, v0
  v_mfma_f32_16x16x32_bf16 v[132:135], v[52:55], a[48:51], v[132:135]
  ds_read_b64_tr_b16 v[34:35], v14 offset:34816
  v_readlane_b32 s88, v23, 28
  v_mfma_f32_16x16x32_bf16 v[132:135], v[56:59], a[64:67], v[132:135]
  ds_read_b64_tr_b16 v[36:37], v14 offset:36864
  v_mov_b32 v245, 1073741824
  v_mfma_f32_16x16x32_bf16 v[132:135], v[60:63], a[80:83], v[132:135]
  ds_read_b64_tr_b16 v[38:39], v14 offset:38912
  s_cmp_ge_u32 s3, 2
  s_cbranch_scc1 F_xr1
  ds_read_b128 v[80:83], v225 offset:0
  ds_read_b128 v[84:87], v225 offset:1024
  ds_read_b128 v[88:91], v225 offset:2048
  ds_read_b128 v[92:95], v225 offset:3072
  s_branch F_xr2
F_xr1:
  ds_read_b128 v[64:67], v225 offset:0
  ds_read_b128 v[68:71], v225 offset:1024
  ds_read_b128 v[72:75], v225 offset:2048
  ds_read_b128 v[76:79], v225 offset:3072
F_xr2:
  v_mfma_f32_16x16x32_bf16 v[140:143], v[48:51], a[36:39], v[140:143]
  s_add_u32 m0, s9, 147456
  v_mov_b32 v241, 0
  v_cndmask_b32_e64 v245, v245, 0, vcc
  v_mfma_f32_16x16x32_bf16 v[140:143], v[52:55], a[52:55], v[140:143]
  ds_read_b64_tr_b16 v[40:41], v14 offset:40960
  buffer_load_dwordx4 v1, s[48:51], s88 offen lds
  v_mfma_f32_16x16x32_bf16 v[140:143], v[56:59], a[68:71], v[140:143]
  ds_read_b64_tr_b16 v[42:43], v14 offset:43008
  s_lshl_b32 s10, s4, 6
  v_mfma_f32_16x16x32_bf16 v[140:143], v[60:63], a[84:87], v[140:143]
  s_lshl_b32 s11, s5, 2
  s_add_u32 s10, s10, s11
  v_mfma_f32_16x16x32_bf16 v[148:151], v[48:51], a[40:43], v[148:151]
  ds_read_b64_tr_b16 v[44:45], v14 offset:45056
  s_add_u32 s10, s10, 45875200
  v_mfma_f32_16x16x32_bf16 v[148:151], v[52:55], a[56:59], v[148:151]
  ds_read_b64_tr_b16 v[46:47], v14 offset:47104
  buffer_load_dwordx4 v2, s[48:51], s88 offen offset:1024 lds
  v_mfma_f32_16x16x32_bf16 v[148:151], v[56:59], a[72:75], v[148:151]
  s_waitcnt lgkmcnt(7)
  v_mul_f32 v164, v64, v64
  v_mul_f32 v165, v65, v65
  v_mfma_f32_16x16x32_bf16 v[148:151], v[60:63], a[88:91], v[148:151]
  v_fmaak_f32 v164, v164, v20, 0xc0135761
  v_fmaak_f32 v165, v165, v20, 0xc0135761
  v_mfma_f32_16x16x32_bf16 v[156:159], v[48:51], a[44:47], v[156:159]
  ds_read_b64_tr_b16 v[48:49], v17 offset:32768
  v_mul_f32 v164, v164, v64
  v_mfma_f32_16x16x32_bf16 v[156:159], v[52:55], a[60:63], v[156:159]
  ds_read_b64_tr_b16 v[50:51], v17 offset:34816
  v_mul_f32 v165, v165, v65
  v_mfma_f32_16x16x32_bf16 v[156:159], v[56:59], a[76:79], v[156:159]
  ds_read_b64_tr_b16 v[52:53], v17 offset:36864
  buffer_load_dwordx4 v3, s[48:51], s88 offen offset:2048 lds
  v_mfma_f32_16x16x32_bf16 v[156:159], v[60:63], a[92:95], v[156:159]
  s_waitcnt lgkmcnt(3)
  v_exp_f32 v164, v164
  v_mfma_f32_16x16x32_bf16 v[128:131], v[32:35], a[96:99], v[128:131]
  ds_read_b64_tr_b16 v[54:55], v17 offset:38912
  v_add_f32 v164, 1.0, v164
  v_mfma_f32_16x16x32_bf16 v[128:131], v[36:39], a[112:115], v[128:131]
  ds_read_b64_tr_b16 v[56:57], v17 offset:40960
  v_mul_f32 v166, v66, v66
  v_mfma_f32_16x16x32_bf16 v[128:131], v[40:43], a[128:131], v[128:131]
  v_rcp_f32 v164, v164
  v_mfma_f32_16x16x32_bf16 v[128:131], v[44:47], a[144:147], v[128:131]
  ds_read_b64_tr_b16 v[58:59], v17 offset:43008
  buffer_load_dwordx4 v4, s[48:51], s88 offen offset:3072 lds
  v_mfma_f32_16x16x32_bf16 v[136:139], v[32:35], a[100:103], v[136:139]
  ds_read_b64_tr_b16 v[60:61], v17 offset:45056
  v_mul_f32 v64, v164, v64
  v_mfma_f32_16x16x32_bf16 v[136:139], v[36:39], a[116:119], v[136:139]
  v_exp_f32 v165, v165
  v_mfma_f32_16x16x32_bf16 v[136:139], v[40:43], a[132:135], v[136:139]
  ds_read_b64_tr_b16 v[62:63], v17 offset:47104
  v_add_f32 v165, 1.0, v165
  v_mfma_f32_16x16x32_bf16 v[136:139], v[44:47], a[148:151], v[136:139]
  v_rcp_f32 v165, v165
  v_mfma_f32_16x16x32_bf16 v[144:147], v[32:35], a[104:107], v[144:147]
  v_mul_f32 v65, v165, v65
  v_mul_f32 v64, v64, v80
  v_mfma_f32_16x16x32_bf16 v[144:147], v[36:39], a[120:123], v[144:147]
  v_mul_f32 v65, v65, v81
  v_fmaak_f32 v166, v166, v20, 0xc0135761
  v_mfma_f32_16x16x32_bf16 v[144:147], v[40:43], a[136:139], v[144:147]
  v_cvt_pk_bf16_f32 v64, v64, v65
  v_mul_f32 v166, v166, v66
  v_mfma_f32_16x16x32_bf16 v[144:147], v[44:47], a[152:155], v[144:147]
  v_exp_f32 v166, v166
  v_mfma_f32_16x16x32_bf16 v[152:155], v[32:35], a[108:111], v[152:155]
  v_add_f32 v166, 1.0, v166
  v_mul_f32 v167, v67, v67
  v_mfma_f32_16x16x32_bf16 v[152:155], v[36:39], a[124:127], v[152:155]
  v_rcp_f32 v166, v166
  v_mfma_f32_16x16x32_bf16 v[152:155], v[40:43], a[140:143], v[152:155]
  v_mul_f32 v66, v166, v66
  v_fmaak_f32 v167, v167, v20, 0xc0135761
  v_mfma_f32_16x16x32_bf16 v[152:155], v[44:47], a[156:159], v[152:155]
  s_waitcnt lgkmcnt(0)
  v_mul_f32 v167, v167, v67
  v_mul_f32 v66, v66, v82
  v_mfma_f32_16x16x32_bf16 v[132:135], v[48:51], a[96:99], v[132:135]
  ds_read_b64_tr_b16 v[32:33], v14 offset:49152
  s_lshl_b32 s11, s3, 28
  v_mfma_f32_16x16x32_bf16 v[132:135], v[52:55], a[112:115], v[132:135]
  ds_read_b64_tr_b16 v[34:35], v14 offset:51200
  v_readlane_b32 s88, v23, 29
  v_mfma_f32_16x16x32_bf16 v[132:135], v[56:59], a[128:131], v[132:135]
  ds_read_b64_tr_b16 v[36:37], v14 offset:53248
  s_add_u32 s10, s10, s11
  v_mfma_f32_16x16x32_bf16 v[132:135], v[60:63], a[144:147], v[132:135]
  ds_read_b64_tr_b16 v[38:39], v14 offset:55296
  v_add_u32 v244, s10, v245
  v_mfma_f32_16x16x32_bf16 v[140:143], v[48:51], a[100:103], v[140:143]
  s_add_u32 m0, s9, 49152
  v_exp_f32 v167, v167
  v_mfma_f32_16x16x32_bf16 v[140:143], v[52:55], a[116:119], v[140:143]
  ds_read_b64_tr_b16 v[40:41], v14 offset:57344
  buffer_load_dwordx4 v1, s[48:51], s88 offen lds
  v_mfma_f32_16x16x32_bf16 v[140:143], v[56:59], a[132:135], v[140:143]
  ds_read_b64_tr_b16 v[42:43], v14 offset:59392
  v_add_f32 v167, 1.0, v167
  v_mfma_f32_16x16x32_bf16 v[140:143], v[60:63], a[148:151], v[140:143]
  v_rcp_f32 v167, v167
  v_mfma_f32_16x16x32_bf16 v[148:151], v[48:51], a[104:107], v[148:151]
  ds_read_b64_tr_b16 v[44:45], v14 offset:61440
  v_mul_f32 v67, v167, v67
  v_mfma_f32_16x16x32_bf16 v[148:151], v[52:55], a[120:123], v[148:151]
PAD4:
  s_cbranch_execz PAD8
  ds_read_b64_tr_b16 v[46:47], v14 offset:63488
  buffer_load_dwordx4 v2, s[48:51], s88 offen offset:1024 lds
  v_mfma_f32_16x16x32_bf16 v[148:151], v[56:59], a[136:139], v[148:151]
  s_and_b32 s10, s2, 3
  s_lshl_b32 s10, s10, 6
  v_mfma_f32_16x16x32_bf16 v[148:151], v[60:63], a[152:155], v[148:151]
  s_lshl_b32 s11, s3, 12
  s_add_u32 s10, s10, s11
  v_mfma_f32_16x16x32_bf16 v[156:159], v[48:51], a[108:111], v[156:159]
  ds_read_b64_tr_b16 v[48:49], v17 offset:49152
  v_lshlrev_b32 v249, 6, v0
  v_mfma_f32_16x16x32_bf16 v[156:159], v[52:55], a[124:127], v[156:159]
  ds_read_b64_tr_b16 v[50:51], v17 offset:51200
  v_lshlrev_b32 v238, 8, v0
  v_mfma_f32_16x16x32_bf16 v[156:159], v[56:59], a[140:143], v[156:159]
  ds_read_b64_tr_b16 v[52:53], v17 offset:53248
  buffer_load_dwordx4 v3, s[48:51], s88 offen offset:2048 lds
  v_mfma_f32_16x16x32_bf16 v[156:159], v[60:63], a[156:159], v[156:159]
  s_waitcnt lgkmcnt(3)
  v_add_u32 v238, s10, v238
  v_mov_b32 v239, 1
  v_mfma_f32_16x16x32_bf16 v[128:131], v[32:35], a[160:163], v[128:131]
  ds_read_b64_tr_b16 v[54:55], v17 offset:55296
  buffer_store_dword v241, v244, s[64:67], 0 offen sc1
  v_mfma_f32_16x16x32_bf16 v[128:131], v[36:39], a[176:179], v[128:131]
  ds_read_b64_tr_b16 v[56:57], v17 offset:57344
  s_lshr_b32 s6, s2, 4
  v_mfma_f32_16x16x32_bf16 v[128:131], v[40:43], a[192:195], v[128:131]
  s_lshl_b32 s6, s6, 3
  s_and_b32 s10, s2, 7
  v_mfma_f32_16x16x32_bf16 v[128:131], v[44:47], a[208:211], v[128:131]
  ds_read_b64_tr_b16 v[58:59], v17 offset:59392
  buffer_load_dwordx4 v4, s[48:51], s88 offen offset:3072 lds
  v_mfma_f32_16x16x32_bf16 v[136:139], v[32:35], a[164:167], v[136:139]
  ds_read_b64_tr_b16 v[60:61], v17 offset:61440
  s_add_u32 s6, s6, s10
  v_mfma_f32_16x16x32_bf16 v[136:139], v[36:39], a[180:183], v[136:139]
  s_bfe_u32 s7, s2, 0x10003
  s_lshl_b32 s84, s6, 1
  v_mfma_f32_16x16x32_bf16 v[136:139], v[40:43], a[196:199], v[136:139]
  ds_read_b64_tr_b16 v[62:63], v17 offset:63488
  s_mov_b32 s68, s38
  v_mfma_f32_16x16x32_bf16 v[136:139], v[44:47], a[212:215], v[136:139]
  v_mul_f32 v67, v67, v83
  s_add_u32 s84, s84, s7
  v_mfma_f32_16x16x32_bf16 v[144:147], v[32:35], a[168:171], v[144:147]
  v_cvt_pk_bf16_f32 v65, v66, v67
  s_mul_i32 s83, s84, 9216
  v_mfma_f32_16x16x32_bf16 v[144:147], v[36:39], a[184:187], v[144:147]
  s_add_u32 s83, s83, 41156608
  s_and_b32 s69, s39, 0xffff
  v_mfma_f32_16x16x32_bf16 v[144:147], v[40:43], a[200:203], v[144:147]
  v_mul_f32 v168, v68, v68
  s_xor_b32 s84, s84, 1
  v_mfma_f32_16x16x32_bf16 v[144:147], v[44:47], a[216:219], v[144:147]
  v_fmaak_f32 v168, v168, v20, 0xc0135761
  s_mul_i32 s84, s84, 9216
  v_mfma_f32_16x16x32_bf16 v[152:155], v[32:35], a[172:175], v[152:155]
  v_mul_f32 v168, v168, v68
  s_add_u32 s84, s84, 41156608
  v_mfma_f32_16x16x32_bf16 v[152:155], v[36:39], a[188:191], v[152:155]
  v_exp_f32 v168, v168
  v_mfma_f32_16x16x32_bf16 v[152:155], v[40:43], a[204:207], v[152:155]
  v_add_f32 v168, 1.0, v168
  s_mov_b32 s70, 256
  v_mfma_f32_16x16x32_bf16 v[152:155], v[44:47], a[220:223], v[152:155]
  s_waitcnt vmcnt(13) lgkmcnt(0)
  s_barrier
  v_mfma_f32_16x16x32_bf16 v[132:135], v[48:51], a[160:163], v[132:135]
  ds_read_b64_tr_b16 v[32:33], v15 offset:0
  s_mul_i32 s96, s3, 2304
  v_mfma_f32_16x16x32_bf16 v[132:135], v[52:55], a[176:179], v[132:135]
  ds_read_b64_tr_b16 v[34:35], v15 offset:2048
  v_readlane_b32 s88, v23, 30
  v_mfma_f32_16x16x32_bf16 v[132:135], v[56:59], a[192:195], v[132:135]
  ds_read_b64_tr_b16 v[36:37], v15 offset:4096
  s_add_u32 s96, s96, s83
  v_mfma_f32_16x16x32_bf16 v[132:135], v[60:63], a[208:211], v[132:135]
  ds_read_b64_tr_b16 v[38:39], v15 offset:6144
  v_readfirstlane_b32 s97, v244
  v_mfma_f32_16x16x32_bf16 v[140:143], v[48:51], a[164:167], v[140:143]
  s_add_u32 m0, s9, 81920
  v_rcp_f32 v168, v168
  v_mfma_f32_16x16x32_bf16 v[140:143], v[52:55], a[180:183], v[140:143]
  ds_read_b64_tr_b16 v[40:41], v15 offset:8192
  buffer_load_dwordx4 v1, s[48:51], s88 offen lds
  v_mfma_f32_16x16x32_bf16 v[140:143], v[56:59], a[196:199], v[140:143]
  ds_read_b64_tr_b16 v[42:43], v15 offset:10240
  v_mul_f32 v68, v168, v68
  v_mfma_f32_16x16x32_bf16 v[140:143], v[60:63], a[212:215], v[140:143]
  s_mov_b32 s71, 0x20000
  v_mul_f32 v169, v69, v69
  v_mfma_f32_16x16x32_bf16 v[148:151], v[48:51], a[168:171], v[148:151]
  ds_read_b64_tr_b16 v[44:45], v15 offset:12288
  v_fmaak_f32 v169, v169, v20, 0xc0135761
  v_mfma_f32_16x16x32_bf16 v[148:151], v[52:55], a[184:187], v[148:151]
  ds_read_b64_tr_b16 v[46:47], v15 offset:14336
  buffer_load_dwordx4 v2, s[48:51], s88 offen offset:1024 lds
  v_mfma_f32_16x16x32_bf16 v[148:151], v[56:59], a[200:203], v[148:151]
  v_mul_f32 v169, v169, v69
  v_mul_f32 v68, v68, v84
  v_mfma_f32_16x16x32_bf16 v[148:151], v[60:63], a[216:219], v[148:151]
  v_exp_f32 v169, v169
  v_mfma_f32_16x16x32_bf16 v[156:159], v[48:51], a[172:175], v[156:159]
  ds_read_b64_tr_b16 v[48:49], v18 offset:0
  v_add_f32 v169, 1.0, v169
  v_mfma_f32_16x16x32_bf16 v[156:159], v[52:55], a[188:191], v[156:159]
  ds_read_b64_tr_b16 v[50:51], v18 offset:2048
  v_mul_f32 v170, v70, v70
  v_mfma_f32_16x16x32_bf16 v[156:159], v[56:59], a[204:207], v[156:159]
  ds_read_b64_tr_b16 v[52:53], v18 offset:4096
  buffer_load_dwordx4 v3, s[48:51], s88 offen offset:2048 lds
  v_mfma_f32_16x16x32_bf16 v[156:159], v[60:63], a[220:223], v[156:159]
  s_waitcnt lgkmcnt(3)
  v_rcp_f32 v169, v169
  v_mfma_f32_16x16x32_bf16 v[128:131], v[32:35], a[224:227], v[128:131]
  ds_read_b64_tr_b16 v[54:55], v18 offset:6144
  v_mul_f32 v69, v169, v69
  v_mfma_f32_16x16x32_bf16 v[128:131], v[36:39], a[240:243], v[128:131]
  ds_read_b64_tr_b16 v[56:57], v18 offset:8192
  v_mul_f32 v69, v69, v85
  v_mfma_f32_16x16x32_bf16 v[128:131], v[40:43], v[172:175], v[128:131]
  v_cvt_pk_bf16_f32 v66, v68, v69
  v_fmaak_f32 v170, v170, v20, 0xc0135761
  v_mfma_f32_16x16x32_bf16 v[128:131], v[44:47], v[188:191], v[128:131]
  ds_read_b64_tr_b16 v[58:59], v18 offset:10240
  buffer_load_dwordx4 v4, s[48:51], s88 offen offset:3072 lds
  v_mfma_f32_16x16x32_bf16 v[136:139], v[32:35], a[228:231], v[136:139]
  ds_read_b64_tr_b16 v[60:61], v18 offset:12288
  v_mul_f32 v170, v170, v70
  v_mfma_f32_16x16x32_bf16 v[136:139], v[36:39], a[244:247], v[136:139]
  v_exp_f32 v170, v170
  v_mfma_f32_16x16x32_bf16 v[136:139], v[40:43], v[176:179], v[136:139]
  ds_read_b64_tr_b16 v[62:63], v18 offset:14336
  v_add_f32 v170, 1.0, v170
  v_mfma_f32_16x16x32_bf16 v[136:139], v[44:47], v[192:195], v[136:139]
  v_rcp_f32 v170, v170
  v_mfma_f32_16x16x32_bf16 v[144:147], v[32:35], a[232:235], v[144:147]
  v_mul_f32 v70, v170, v70
  v_mul_f32 v171, v71, v71
  v_mfma_f32_16x16x32_bf16 v[144:147], v[36:39], a[248:251], v[144:147]
  v_fmaak_f32 v171, v171, v20, 0xc0135761
  v_mul_f32 v70, v70, v86
  v_mfma_f32_16x16x32_bf16 v[144:147], v[40:43], v[180:183], v[144:147]
  v_mul_f32 v171, v171, v71
  v_mul_f32 v160, v72, v72
  v_mfma_f32_16x16x32_bf16 v[144:147], v[44:47], v[196:199], v[144:147]
  v_exp_f32 v171, v171
  v_mfma_f32_16x16x32_bf16 v[152:155], v[32:35], a[236:239], v[152:155]
  v_add_f32 v171, 1.0, v171
  v_fmaak_f32 v160, v160, v20, 0xc0135761
  v_mfma_f32_16x16x32_bf16 v[152:155], v[36:39], a[252:255], v[152:155]
  v_rcp_f32 v171, v171
  v_mfma_f32_16x16x32_bf16 v[152:155], v[40:43], v[184:187], v[152:155]
  v_mul_f32 v71, v171, v71
  v_mul_f32 v160, v160, v72
  v_mfma_f32_16x16x32_bf16 v[152:155], v[44:47], v[200:203], v[152:155]
  s_waitcnt lgkmcnt(0)
  v_exp_f32 v160, v160
  v_mfma_f32_16x16x32_bf16 v[132:135], v[48:51], a[224:227], v[132:135]
  ds_read_b64_tr_b16 v[32:33], v13 offset:32768
  v_add_f32 v160, 1.0, v160
  v_mfma_f32_16x16x32_bf16 v[132:135], v[52:55], a[240:243], v[132:135]
  ds_read_b64_tr_b16 v[34:35], v13 offset:34816
  v_readlane_b32 s88, v23, 31
  v_mfma_f32_16x16x32_bf16 v[132:135], v[56:59], v[172:175], v[132:135]
  ds_read_b64_tr_b16 v[36:37], v13 offset:36864
  v_mul_f32 v71, v71, v87
  v_mfma_f32_16x16x32_bf16 v[132:135], v[60:63], v[188:191], v[132:135]
  ds_read_b64_tr_b16 v[38:39], v13 offset:38912
  v_cvt_pk_bf16_f32 v67, v70, v71
  v_mfma_f32_16x16x32_bf16 v[140:143], v[48:51], a[228:231], v[140:143]
  s_add_u32 m0, s9, 98304
  ds_write_b128 v223, v[64:67] offset:0
  v_mfma_f32_16x16x32_bf16 v[140:143], v[52:55], a[244:247], v[140:143]
  ds_read_b64_tr_b16 v[40:41], v13 offset:40960
  buffer_load_dwordx4 v1, s[56:59], s88 offen lds
  v_mfma_f32_16x16x32_bf16 v[140:143], v[56:59], v[176:179], v[140:143]
  ds_read_b64_tr_b16 v[42:43], v13 offset:43008
  v_mul_f32 v161, v73, v73
  v_mfma_f32_16x16x32_bf16 v[140:143], v[60:63], v[192:195], v[140:143]
  v_rcp_f32 v160, v160
  v_mfma_f32_16x16x32_bf16 v[148:151], v[48:51], a[232:235], v[148:151]
  ds_read_b64_tr_b16 v[44:45], v13 offset:45056
  v_mul_f32 v72, v160, v72
  v_mfma_f32_16x16x32_bf16 v[148:151], v[52:55], a[248:251], v[148:151]
  ds_read_b64_tr_b16 v[46:47], v13 offset:47104
  buffer_load_dwordx4 v2, s[56:59], s88 offen offset:1024 lds
  v_mfma_f32_16x16x32_bf16 v[148:151], v[56:59], v[180:183], v[148:151]
  v_mul_f32 v72, v72, v88
  v_fmaak_f32 v161, v161, v20, 0xc0135761
  v_mfma_f32_16x16x32_bf16 v[148:151], v[60:63], v[196:199], v[148:151]
  v_mul_f32 v161, v161, v73
  v_mul_f32 v162, v74, v74
  v_mfma_f32_16x16x32_bf16 v[156:159], v[48:51], a[236:239], v[156:159]
  ds_read_b64_tr_b16 v[48:49], v16 offset:32768
  v_fmaak_f32 v162, v162, v20, 0xc0135761
  v_mfma_f32_16x16x32_bf16 v[156:159], v[52:55], a[252:255], v[156:159]
  ds_read_b64_tr_b16 v[50:51], v16 offset:34816
  v_mul_f32 v162, v162, v74
  v_mfma_f32_16x16x32_bf16 v[156:159], v[56:59], v[184:187], v[156:159]
  ds_read_b64_tr_b16 v[52:53], v16 offset:36864
  buffer_load_dwordx4 v3, s[56:59], s88 offen offset:2048 lds
  v_mfma_f32_16x16x32_bf16 v[156:159], v[60:63], v[200:203], v[156:159]
  s_waitcnt lgkmcnt(3)
  v_exp_f32 v161, v161
  v_mfma_f32_16x16x32_bf16 v[96:99], v[32:35], a[0:3], 0
  ds_read_b64_tr_b16 v[54:55], v16 offset:38912
  v_add_f32 v161, 1.0, v161
  v_mfma_f32_16x16x32_bf16 v[96:99], v[36:39], a[16:19], v[96:99]
  ds_read_b64_tr_b16 v[56:57], v16 offset:40960
  v_mul_f32 v163, v75, v75
  v_mfma_f32_16x16x32_bf16 v[96:99], v[40:43], a[32:35], v[96:99]
  v_rcp_f32 v161, v161
  v_mfma_f32_16x16x32_bf16 v[96:99], v[44:47], a[48:51], v[96:99]
  ds_read_b64_tr_b16 v[58:59], v16 offset:43008
  buffer_load_dwordx4 v4, s[56:59], s88 offen offset:3072 lds
  v_mfma_f32_16x16x32_bf16 v[104:107], v[32:35], a[4:7], 0
  ds_read_b64_tr_b16 v[60:61], v16 offset:45056
  v_mul_f32 v73, v161, v73
  v_mfma_f32_16x16x32_bf16 v[104:107], v[36:39], a[20:23], v[104:107]
  v_exp_f32 v162, v162
  v_mfma_f32_16x16x32_bf16 v[104:107], v[40:43], a[36:39], v[104:107]
  ds_read_b64_tr_b16 v[62:63], v16 offset:47104
  v_add_f32 v162, 1.0, v162
  v_mfma_f32_16x16x32_bf16 v[104:107], v[44:47], a[52:55], v[104:107]
  v_rcp_f32 v162, v162
  v_mfma_f32_16x16x32_bf16 v[112:115], v[32:35], a[8:11], 0
  v_mul_f32 v74, v162, v74
  v_mul_f32 v73, v73, v89
  v_mfma_f32_16x16x32_bf16 v[112:115], v[36:39], a[24:27], v[112:115]
  v_cvt_pk_bf16_f32 v72, v72, v73
  v_mul_f32 v74, v74, v90
  v_mfma_f32_16x16x32_bf16 v[112:115], v[40:43], a[40:43], v[112:115]
  v_fmaak_f32 v163, v163, v20, 0xc0135761
  v_mul_f32 v164, v76, v76
  v_mfma_f32_16x16x32_bf16 v[112:115], v[44:47], a[56:59], v[112:115]
  v_mul_f32 v163, v163, v75
  v_fmaak_f32 v164, v164, v20, 0xc0135761
  v_mfma_f32_16x16x32_bf16 v[120:123], v[32:35], a[12:15], 0
  v_exp_f32 v163, v163
  v_mfma_f32_16x16x32_bf16 v[120:123], v[36:39], a[28:31], v[120:123]
  v_add_f32 v163, 1.0, v163
  v_mul_f32 v164, v164, v76
  v_mfma_f32_16x16x32_bf16 v[120:123], v[40:43], a[44:47], v[120:123]
  v_rcp_f32 v163, v163
  v_mfma_f32_16x16x32_bf16 v[120:123], v[44:47], a[60:63], v[120:123]
  s_waitcnt vmcnt(8) lgkmcnt(0)
  s_barrier
  v_mfma_f32_16x16x32_bf16 v[100:103], v[48:51], a[0:3], 0
  ds_read_b64_tr_b16 v[32:33], v15 offset:16384
  v_mul_f32 v75, v163, v75
  v_mfma_f32_16x16x32_bf16 v[100:103], v[52:55], a[16:19], v[100:103]
  ds_read_b64_tr_b16 v[34:35], v15 offset:18432
  v_readlane_b32 s88, v23, 32
  v_mfma_f32_16x16x32_bf16 v[100:103], v[56:59], a[32:35], v[100:103]
  ds_read_b64_tr_b16 v[36:37], v15 offset:20480
  v_mul_f32 v75, v75, v91
  v_mfma_f32_16x16x32_bf16 v[100:103], v[60:63], a[48:51], v[100:103]
  ds_read_b64_tr_b16 v[38:39], v15 offset:22528
  v_cvt_pk_bf16_f32 v73, v74, v75
  v_mfma_f32_16x16x32_bf16 v[108:111], v[48:51], a[4:7], 0
  s_add_u32 m0, s9, 114688
  v_exp_f32 v164, v164
  v_mfma_f32_16x16x32_bf16 v[108:111], v[52:55], a[20:23], v[108:111]
  ds_read_b64_tr_b16 v[40:41], v15 offset:24576
  buffer_load_dwordx4 v1, s[52:55], s88 offen lds
  v_mfma_f32_16x16x32_bf16 v[108:111], v[56:59], a[36:39], v[108:111]
  ds_read_b64_tr_b16 v[42:43], v15 offset:26624
  v_add_f32 v164, 1.0, v164
  v_mfma_f32_16x16x32_bf16 v[108:111], v[60:63], a[52:55], v[108:111]
  v_rcp_f32 v164, v164
  v_mfma_f32_16x16x32_bf16 v[116:119], v[48:51], a[8:11], 0
  ds_read_b64_tr_b16 v[44:45], v15 offset:28672
  v_mul_f32 v76, v164, v76
  v_mfma_f32_16x16x32_bf16 v[116:119], v[52:55], a[24:27], v[116:119]
  ds_read_b64_tr_b16 v[46:47], v15 offset:30720
  buffer_load_dwordx4 v2, s[52:55], s88 offen offset:1024 lds
  v_mfma_f32_16x16x32_bf16 v[116:119], v[56:59], a[40:43], v[116:119]
  v_lshl_or_b32 v228, v229, 16, v228
  v_lshl_or_b32 v229, v231, 16, v230
  v_mfma_f32_16x16x32_bf16 v[116:119], v[60:63], a[56:59], v[116:119]
  v_mul_f32 v76, v76, v92
  v_lshl_or_b32 v230, v233, 16, v232
  v_mfma_f32_16x16x32_bf16 v[124:127], v[48:51], a[12:15], 0
  ds_read_b64_tr_b16 v[48:49], v18 offset:16384
  v_lshl_or_b32 v231, v235, 16, v234
  v_mfma_f32_16x16x32_bf16 v[124:127], v[52:55], a[28:31], v[124:127]
  ds_read_b64_tr_b16 v[50:51], v18 offset:18432
  buffer_store_dwordx4 v[228:231], v227, s[64:67], s79 offen sc1
  v_mfma_f32_16x16x32_bf16 v[124:127], v[56:59], a[44:47], v[124:127]
  ds_read_b64_tr_b16 v[52:53], v18 offset:20480
  buffer_load_dwordx4 v3, s[52:55], s88 offen offset:2048 lds
  v_mfma_f32_16x16x32_bf16 v[124:127], v[60:63], a[60:63], v[124:127]
  s_waitcnt lgkmcnt(3)
  v_and_b32 v216, 31, v0
  v_lshrrev_b32 v217, 5, v0
  v_mfma_f32_16x16x32_bf16 v[96:99], v[32:35], a[64:67], v[96:99]
  ds_read_b64_tr_b16 v[54:55], v18 offset:22528
  v_lshlrev_b32 v214, 4, v217
  v_mfma_f32_16x16x32_bf16 v[96:99], v[36:39], a[80:83], v[96:99]
  ds_read_b64_tr_b16 v[56:57], v18 offset:24576
  v_mul_f32 v165, v77, v77
  v_mfma_f32_16x16x32_bf16 v[96:99], v[40:43], a[96:99], v[96:99]
  v_fmaak_f32 v165, v165, v20, 0xc0135761
  v_lshl_add_u32 v214, v216, 5, v214
  v_mfma_f32_16x16x32_bf16 v[96:99], v[44:47], a[112:115], v[96:99]
  ds_read_b64_tr_b16 v[58:59], v18 offset:26624
  buffer_load_dwordx4 v4, s[52:55], s88 offen offset:3072 lds
  v_mfma_f32_16x16x32_bf16 v[104:107], v[32:35], a[68:71], v[104:107]
  ds_read_b64_tr_b16 v[60:61], v18 offset:28672
  v_mul_f32 v165, v165, v77
  v_mfma_f32_16x16x32_bf16 v[104:107], v[36:39], a[84:87], v[104:107]
  v_exp_f32 v165, v165
  v_mfma_f32_16x16x32_bf16 v[104:107], v[40:43], a[100:103], v[104:107]
  ds_read_b64_tr_b16 v[62:63], v18 offset:30720
  v_add_f32 v165, 1.0, v165
  v_mfma_f32_16x16x32_bf16 v[104:107], v[44:47], a[116:119], v[104:107]
  v_rcp_f32 v165, v165
  v_mfma_f32_16x16x32_bf16 v[112:115], v[32:35], a[72:75], v[112:115]
  v_mul_f32 v77, v165, v77
  v_lshlrev_b32 v215, 2, v0
  v_mfma_f32_16x16x32_bf16 v[112:115], v[36:39], a[88:91], v[112:115]
  v_mul_f32 v128, s92, v128
  v_mul_f32 v129, s92, v129
  v_mfma_f32_16x16x32_bf16 v[112:115], v[40:43], a[104:107], v[112:115]
  v_mul_f32 v130, s92, v130
  v_mul_f32 v131, s92, v131
  v_mfma_f32_16x16x32_bf16 v[112:115], v[44:47], a[120:123], v[112:115]
  v_mul_f32 v216, s92, v134
  v_mul_f32 v217, s92, v135
  v_mfma_f32_16x16x32_bf16 v[120:123], v[32:35], a[76:79], v[120:123]
  v_cvt_pk_bf16_f32 v128, v128, v129
  v_cvt_pk_bf16_f32 v129, v130, v131
  v_mfma_f32_16x16x32_bf16 v[120:123], v[36:39], a[92:95], v[120:123]
  v_cvt_pk_bf16_f32 v218, v216, v217
  v_mul_f32 v136, s92, v136
  v_mfma_f32_16x16x32_bf16 v[120:123], v[40:43], a[108:111], v[120:123]
  v_mul_f32 v137, s92, v137
  v_mul_f32 v138, s92, v138
  v_mfma_f32_16x16x32_bf16 v[120:123], v[44:47], a[124:127], v[120:123]
  s_waitcnt lgkmcnt(0)
  v_mul_f32 v139, s92, v139
  v_mul_f32 v216, s92, v142
  v_mfma_f32_16x16x32_bf16 v[100:103], v[48:51], a[64:67], v[100:103]
  ds_read_b64_tr_b16 v[32:33], v13 offset:49152
  v_mul_f32 v217, s92, v143
  v_mfma_f32_16x16x32_bf16 v[100:103], v[52:55], a[80:83], v[100:103]
  ds_read_b64_tr_b16 v[34:35], v13 offset:51200
  v_readlane_b32 s88, v23, 33
  v_mfma_f32_16x16x32_bf16 v[100:103], v[56:59], a[96:99], v[100:103]
  ds_read_b64_tr_b16 v[36:37], v13 offset:53248
  v_cvt_pk_bf16_f32 v130, v136, v137
  v_mfma_f32_16x16x32_bf16 v[100:103], v[60:63], a[112:115], v[100:103]
  ds_read_b64_tr_b16 v[38:39], v13 offset:55296
  v_cvt_pk_bf16_f32 v131, v138, v139
  v_mfma_f32_16x16x32_bf16 v[108:111], v[48:51], a[68:71], v[108:111]
  s_add_u32 m0, s9, 32768
  v_cvt_pk_bf16_f32 v219, v216, v217
  v_mul_f32 v144, s92, v144
  v_mfma_f32_16x16x32_bf16 v[108:111], v[52:55], a[84:87], v[108:111]
  ds_read_b64_tr_b16 v[40:41], v13 offset:57344
  buffer_load_dwordx4 v1, s[52:55], s88 offen lds
  v_mfma_f32_16x16x32_bf16 v[108:111], v[56:59], a[100:103], v[108:111]
  ds_read_b64_tr_b16 v[42:43], v13 offset:59392
  v_mul_f32 v145, s92, v145
  v_mfma_f32_16x16x32_bf16 v[108:111], v[60:63], a[116:119], v[108:111]
  v_mul_f32 v146, s92, v146
  v_mul_f32 v147, s92, v147
  v_mfma_f32_16x16x32_bf16 v[116:119], v[48:51], a[72:75], v[116:119]
  ds_read_b64_tr_b16 v[44:45], v13 offset:61440
  v_mul_f32 v216, s92, v150
  v_mfma_f32_16x16x32_bf16 v[116:119], v[52:55], a[88:91], v[116:119]
  ds_read_b64_tr_b16 v[46:47], v13 offset:63488
  buffer_load_dwordx4 v2, s[52:55], s88 offen offset:1024 lds
  v_mfma_f32_16x16x32_bf16 v[116:119], v[56:59], a[104:107], v[116:119]
  v_mul_f32 v217, s92, v151
  v_cvt_pk_bf16_f32 v144, v144, v145
  v_mfma_f32_16x16x32_bf16 v[116:119], v[60:63], a[120:123], v[116:119]
  v_cvt_pk_bf16_f32 v145, v146, v147
  v_cvt_pk_bf16_f32 v220, v216, v217
  v_mfma_f32_16x16x32_bf16 v[124:127], v[48:51], a[76:79], v[124:127]
  ds_read_b64_tr_b16 v[48:49], v16 offset:49152
  v_mul_f32 v152, s92, v152
  v_mfma_f32_16x16x32_bf16 v[124:127], v[52:55], a[92:95], v[124:127]
  ds_read_b64_tr_b16 v[50:51], v16 offset:51200
  v_mul_f32 v153, s92, v153
  v_mfma_f32_16x16x32_bf16 v[124:127], v[56:59], a[108:111], v[124:127]
  ds_read_b64_tr_b16 v[52:53], v16 offset:53248
  buffer_load_dwordx4 v3, s[52:55], s88 offen offset:2048 lds
  v_mfma_f32_16x16x32_bf16 v[124:127], v[60:63], a[124:127], v[124:127]
  s_waitcnt lgkmcnt(3)
  v_mul_f32 v154, s92, v154
  v_mul_f32 v155, s92, v155
  v_mfma_f32_16x16x32_bf16 v[96:99], v[32:35], a[128:131], v[96:99]
  ds_read_b64_tr_b16 v[54:55], v16 offset:55296
  v_mul_f32 v216, s92, v158
  v_mfma_f32_16x16x32_bf16 v[96:99], v[36:39], a[144:147], v[96:99]
  ds_read_b64_tr_b16 v[56:57], v16 offset:57344
  v_mul_f32 v217, s92, v159
  v_mfma_f32_16x16x32_bf16 v[96:99], v[40:43], a[160:163], v[96:99]
  v_cvt_pk_bf16_f32 v146, v152, v153
  v_mul_f32 v166, v78, v78
  v_mfma_f32_16x16x32_bf16 v[96:99], v[44:47], a[176:179], v[96:99]
  ds_read_b64_tr_b16 v[58:59], v16 offset:59392
  buffer_load_dwordx4 v4, s[52:55], s88 offen offset:3072 lds
  v_mfma_f32_16x16x32_bf16 v[104:107], v[32:35], a[132:135], v[104:107]
  ds_read_b64_tr_b16 v[60:61], v16 offset:61440
  v_fmaak_f32 v166, v166, v20, 0xc0135761
  v_mfma_f32_16x16x32_bf16 v[104:107], v[36:39], a[148:151], v[104:107]
  v_mul_f32 v166, v166, v78
  v_mul_f32 v77, v77, v93
  v_mfma_f32_16x16x32_bf16 v[104:107], v[40:43], a[164:167], v[104:107]
  ds_read_b64_tr_b16 v[62:63], v16 offset:63488
  v_cvt_pk_bf16_f32 v74, v76, v77
  v_mfma_f32_16x16x32_bf16 v[104:107], v[44:47], a[180:183], v[104:107]
  v_exp_f32 v166, v166
  v_mfma_f32_16x16x32_bf16 v[112:115], v[32:35], a[136:139], v[112:115]
  v_add_f32 v166, 1.0, v166
  v_cvt_pk_bf16_f32 v147, v154, v155
  v_mfma_f32_16x16x32_bf16 v[112:115], v[36:39], a[152:155], v[112:115]
  v_rcp_f32 v166, v166
  v_mfma_f32_16x16x32_bf16 v[112:115], v[40:43], a[168:171], v[112:115]
  v_mul_f32 v78, v166, v78
  v_cvt_pk_bf16_f32 v221, v216, v217
  v_mfma_f32_16x16x32_bf16 v[112:115], v[44:47], a[184:187], v[112:115]
  v_permlane16_swap_b32 v128, v130
  v_permlane16_swap_b32 v129, v131
  v_mfma_f32_16x16x32_bf16 v[120:123], v[32:35], a[140:143], v[120:123]
  v_permlane16_swap_b32 v218, v219
  v_permlane16_swap_b32 v144, v146
  v_mfma_f32_16x16x32_bf16 v[120:123], v[36:39], a[156:159], v[120:123]
  v_permlane16_swap_b32 v145, v147
  v_permlane16_swap_b32 v220, v221
  v_mfma_f32_16x16x32_bf16 v[120:123], v[40:43], a[172:175], v[120:123]
  buffer_store_dwordx4 v[128:131], v214, s[64:67], s75 offen sc1
  buffer_store_dwordx4 v[144:147], v214, s[64:67], s75 offen offset:1024 sc1
  v_mfma_f32_16x16x32_bf16 v[120:123], v[44:47], a[188:191], v[120:123]
  s_waitcnt vmcnt(11) lgkmcnt(0)
  s_barrier
  v_mfma_f32_16x16x32_bf16 v[100:103], v[48:51], a[128:131], v[100:103]
  ds_read_b64_tr_b16 v[32:33], v14 offset:16384
  v_permlane32_swap_b32 v219, v221
  v_mfma_f32_16x16x32_bf16 v[100:103], v[52:55], a[144:147], v[100:103]
  ds_read_b64_tr_b16 v[34:35], v14 offset:18432
  v_readlane_b32 s88, v23, 34
  v_mfma_f32_16x16x32_bf16 v[100:103], v[56:59], a[160:163], v[100:103]
  ds_read_b64_tr_b16 v[36:37], v14 offset:20480
  buffer_store_dword v219, v215, s[64:67], s76 offen sc1
  v_mfma_f32_16x16x32_bf16 v[100:103], v[60:63], a[176:179], v[100:103]
  ds_read_b64_tr_b16 v[38:39], v14 offset:22528
  v_mul_f32 v167, v79, v79
  v_mfma_f32_16x16x32_bf16 v[108:111], v[48:51], a[132:135], v[108:111]
  s_add_u32 m0, s9, 131072
  s_cmp_ge_u32 s14, 7
  s_cbranch_scc1 F_kv_end
  s_cmp_lg_u32 s14, 6
  s_cbranch_scc1 F_kv_kv
  v_permlane16_swap_b32 v140, v132
  v_permlane16_swap_b32 v156, v148
  v_xor_b32 v216, 64, v215
  s_add_u32 s10, s76, 4964352
  v_permlane32_swap_b32 v140, v156
  buffer_store_dword v156, v216, s[64:67], s10 offen sc1
  s_branch F_kv_end
F_kv_kv:
  v_cvt_pk_bf16_f32 v132, v132, v133
  v_cvt_pk_bf16_f32 v133, v134, v135
  v_cvt_pk_bf16_f32 v134, v140, v141
  v_cvt_pk_bf16_f32 v135, v142, v143
  v_cvt_pk_bf16_f32 v148, v148, v149
  v_cvt_pk_bf16_f32 v149, v150, v151
  v_cvt_pk_bf16_f32 v150, v156, v157
  v_cvt_pk_bf16_f32 v151, v158, v159
  v_lshrrev_b32 v217, 5, v0
  v_permlane16_swap_b32 v132, v134
  v_permlane16_swap_b32 v133, v135
  v_permlane16_swap_b32 v148, v150
  v_permlane16_swap_b32 v149, v151
  v_and_b32 v216, 0x1f0, v21
  v_permlane32_swap_b32 v132, v148
  v_permlane32_swap_b32 v133, v149
  v_permlane32_swap_b32 v134, v150
  v_permlane32_swap_b32 v135, v151
  s_cmp_ge_u32 s14, 3
  s_cbranch_scc1 F_kv_v
  s_cmp_eq_u32 s14, 2
  s_cbranch_scc1 F_kv_kx
  v_mul_u32_u24 v217, 2240, v217
  v_add_u32 v216, v216, v217
  s_lshl_b32 s10, s14, 9
  s_add_u32 s10, s10, s77
  buffer_store_dwordx4 v[148:151], v216, s[64:67], s10 offen sc1
  s_branch F_kv_end
F_kv_kx:
  v_lshl_add_u32 v216, v217, 2, v216
  buffer_store_dword v151, v216, s[64:67], s78 offen sc1
  s_branch F_kv_end
F_kv_v:
  s_lshr_b32 s10, s9, 2
  s_add_u32 s10, s10, 73728
  v_add_u32 v216, s10, v21
  ds_write_b128 v216, v[148:151]
  v_and_b32 v216, 48, v0
  v_lshlrev_b32 v216, 4, v216
  v_add_u32 v216, s10, v216
  v_and_b32 v218, 12, v0
  v_lshl_add_u32 v216, v218, 2, v216
  v_and_b32 v218, 2, v0
  v_lshl_add_u32 v216, v218, 5, v216
  v_and_b32 v218, 1, v0
  v_lshl_add_u32 v216, v218, 3, v216
  s_waitcnt lgkmcnt(0)
  ds_read_b64_tr_b16 v[132:133], v216
  ds_read_b64_tr_b16 v[134:135], v216 offset:128
  v_mul_u32_u24 v217, 2240, v217
  v_bfe_u32 v218, v0, 3, 2
  v_mul_u32_u24 v218, 304, v218
  v_and_b32 v216, 0x70, v21
  v_add3_u32 v217, v217, v218, v216
  s_sub_u32 s10, s14, 3
  s_lshl_b32 s10, s10, 7
  s_min_u32 s10, s10, 160
  s_add_u32 s10, s10, s77
  s_waitcnt lgkmcnt(0)
  s_cmp_lg_u32 s14, 5
  s_cbranch_scc1 F_kv_vs
  v_cmp_eq_u32 vcc, 0x50, v216
  v_mov_b32 v218, 0x3f803f80
  v_add_u32 v220, 48, v217
  v_cndmask_b32 v132, v132, v218, vcc
  v_cndmask_b32 v133, v133, v218, vcc
  v_cndmask_b32 v134, v134, v218, vcc
  v_cndmask_b32 v135, v135, v218, vcc
  v_cndmask_b32 v217, v217, v220, vcc
  v_cmp_gt_u32 vcc, 0x50, v216
  v_mov_b32 v218, 1073741824
  s_nop 0
  v_cndmask_b32 v217, v217, v218, vcc
F_kv_vs:
  buffer_store_dwordx4 v[132:135], v217, s[64:67], s10 offen offset:1024 sc1
F_kv_end:
  v_mfma_f32_16x16x32_bf16 v[108:111], v[52:55], a[148:151], v[108:111]
  ds_read_b64_tr_b16 v[40:41], v14 offset:24576
  buffer_load_dwordx4 v1, s[52:55], s88 offen lds
  v_mfma_f32_16x16x32_bf16 v[108:111], v[56:59], a[164:167], v[108:111]
  ds_read_b64_tr_b16 v[42:43], v14 offset:26624
  v_fmaak_f32 v167, v167, v20, 0xc0135761
  v_mfma_f32_16x16x32_bf16 v[108:111], v[60:63], a[180:183], v[108:111]
  v_mul_f32 v167, v167, v79
  v_mul_f32 v78, v78, v94
  v_mfma_f32_16x16x32_bf16 v[116:119], v[48:51], a[136:139], v[116:119]
  ds_read_b64_tr_b16 v[44:45], v14 offset:28672
  s_add_u32 s86, s9, 37748736
  v_mfma_f32_16x16x32_bf16 v[116:119], v[52:55], a[152:155], v[116:119]
  ds_read_b64_tr_b16 v[46:47], v14 offset:30720
  buffer_load_dwordx4 v2, s[52:55], s88 offen offset:1024 lds
  v_mfma_f32_16x16x32_bf16 v[116:119], v[56:59], a[168:171], v[116:119]
  v_exp_f32 v167, v167
  v_mfma_f32_16x16x32_bf16 v[116:119], v[60:63], a[184:187], v[116:119]
  v_add_f32 v167, 1.0, v167
  s_mul_i32 s10, s7, 9
  v_mfma_f32_16x16x32_bf16 v[124:127], v[48:51], a[140:143], v[124:127]
  ds_read_b64_tr_b16 v[48:49], v17 offset:16384
  s_lshl_b32 s11, s3, 1
  v_mfma_f32_16x16x32_bf16 v[124:127], v[52:55], a[156:159], v[124:127]
  ds_read_b64_tr_b16 v[50:51], v17 offset:18432
  s_add_u32 s11, s11, s10
  v_mfma_f32_16x16x32_bf16 v[124:127], v[56:59], a[172:175], v[124:127]
  ds_read_b64_tr_b16 v[52:53], v17 offset:20480
  buffer_load_dwordx4 v3, s[52:55], s88 offen offset:2048 lds
  v_mfma_f32_16x16x32_bf16 v[124:127], v[60:63], a[188:191], v[124:127]
  s_waitcnt lgkmcnt(3)
  v_rcp_f32 v167, v167
  v_mfma_f32_16x16x32_bf16 v[96:99], v[32:35], a[192:195], v[96:99]
  ds_read_b64_tr_b16 v[54:55], v17 offset:22528
  v_mul_f32 v79, v167, v79
  v_mfma_f32_16x16x32_bf16 v[96:99], v[36:39], a[208:211], v[96:99]
  ds_read_b64_tr_b16 v[56:57], v17 offset:24576
  v_mul_f32 v79, v79, v95
  v_mfma_f32_16x16x32_bf16 v[96:99], v[40:43], a[224:227], v[96:99]
  v_cvt_pk_bf16_f32 v75, v78, v79
  s_lshr_b32 s80, s6, 3
  v_mfma_f32_16x16x32_bf16 v[96:99], v[44:47], a[240:243], v[96:99]
  ds_read_b64_tr_b16 v[58:59], v17 offset:26624
  buffer_load_dwordx4 v4, s[52:55], s88 offen offset:3072 lds
  v_mfma_f32_16x16x32_bf16 v[104:107], v[32:35], a[196:199], v[104:107]
  ds_read_b64_tr_b16 v[60:61], v17 offset:28672
  s_mul_i32 s80, s80, 2359296
  v_mfma_f32_16x16x32_bf16 v[104:107], v[36:39], a[212:215], v[104:107]
  ds_write_b128 v223, v[72:75] offset:1024
  v_mfma_f32_16x16x32_bf16 v[104:107], v[40:43], a[228:231], v[104:107]
  ds_read_b64_tr_b16 v[62:63], v17 offset:30720
  s_lshl_b32 s12, s11, 13
  v_mfma_f32_16x16x32_bf16 v[104:107], v[44:47], a[244:247], v[104:107]
  s_add_u32 s80, s80, s12
  s_and_b32 s12, s6, 7
  v_mfma_f32_16x16x32_bf16 v[112:115], v[32:35], a[200:203], v[112:115]
  s_lshl_b32 s12, s12, 10
  s_add_u32 s80, s80, s12
  v_mfma_f32_16x16x32_bf16 v[112:115], v[36:39], a[216:219], v[112:115]
  s_lshl_b32 s10, s7, 4
  s_lshl_b32 s11, s3, 2
  v_mfma_f32_16x16x32_bf16 v[112:115], v[40:43], a[232:235], v[112:115]
  s_add_u32 s10, s10, s11
  s_lshl_b32 s10, s10, 11
  v_mfma_f32_16x16x32_bf16 v[112:115], v[44:47], a[248:251], v[112:115]
  s_lshl_b32 s11, s6, 4
  s_add_u32 s10, s10, s11
  v_mfma_f32_16x16x32_bf16 v[120:123], v[32:35], a[204:207], v[120:123]
  v_bfe_u32 v240, v0, 4, 1
  v_and_b32 v251, 15, v0
  v_mfma_f32_16x16x32_bf16 v[120:123], v[36:39], a[220:223], v[120:123]
  v_lshl_add_u32 v240, v240, 11, v251
  v_lshrrev_b32 v242, 5, v0
  v_mfma_f32_16x16x32_bf16 v[120:123], v[40:43], a[236:239], v[120:123]
  v_lshlrev_b32 v241, 5, v240
  v_lshl_add_u32 v241, v242, 4, v241
  v_mfma_f32_16x16x32_bf16 v[120:123], v[44:47], a[252:255], v[120:123]
  s_waitcnt lgkmcnt(0)
  v_lshlrev_b32 v240, 2, v240
  v_lshlrev_b32 v251, 2, v251
  v_mfma_f32_16x16x32_bf16 v[100:103], v[48:51], a[192:195], v[100:103]
  ds_read_b64_tr_b16 v[32:33], v14 offset:32768
  s_lshl_b32 s16, s10, 5
  v_mfma_f32_16x16x32_bf16 v[100:103], v[52:55], a[208:211], v[100:103]
  ds_read_b64_tr_b16 v[34:35], v14 offset:34816
  v_readlane_b32 s88, v23, 35
  v_mfma_f32_16x16x32_bf16 v[100:103], v[56:59], a[224:227], v[100:103]
PAD5:
  s_cbranch_execz PAD9
  ds_read_b64_tr_b16 v[36:37], v17 offset:32768
  s_add_u32 s16, s16, 38797312
  v_mfma_f32_16x16x32_bf16 v[100:103], v[60:63], a[240:243], v[100:103]
  ds_read_b64_tr_b16 v[38:39], v17 offset:34816
  s_add_u32 s17, s16, 131072
  v_mfma_f32_16x16x32_bf16 v[108:111], v[48:51], a[196:199], v[108:111]
  s_add_u32 m0, s9, 49152
  s_lshl_b32 s18, s10, 2
  s_add_u32 s18, s18, 40894464
  v_mfma_f32_16x16x32_bf16 v[108:111], v[52:55], a[212:215], v[108:111]
  ds_read_b64_tr_b16 v[40:41], v14 offset:36864
  buffer_load_dwordx4 v1, s[52:55], s88 offen lds
  v_mfma_f32_16x16x32_bf16 v[108:111], v[56:59], a[228:231], v[108:111]
  ds_read_b64_tr_b16 v[42:43], v14 offset:38912
  s_add_u32 s19, s18, 16384
  v_mfma_f32_16x16x32_bf16 v[108:111], v[60:63], a[244:247], v[108:111]
  s_lshl_b32 s20, s6, 6
  s_add_u32 s20, s20, 45907968
  v_mfma_f32_16x16x32_bf16 v[116:119], v[48:51], a[200:203], v[116:119]
  ds_read_b64_tr_b16 v[44:45], v17 offset:36864
  v_mfma_f32_16x16x32_bf16 v[116:119], v[52:55], a[216:219], v[116:119]
  ds_read_b64_tr_b16 v[46:47], v17 offset:38912
  buffer_load_dwordx4 v2, s[52:55], s88 offen offset:1024 lds
  v_mfma_f32_16x16x32_bf16 v[116:119], v[56:59], a[232:235], v[116:119]
  v_mfma_f32_16x16x32_bf16 v[116:119], v[60:63], a[248:251], v[116:119]
  v_mfma_f32_16x16x32_bf16 v[124:127], v[48:51], a[204:207], v[124:127]
  ds_read_b64_tr_b16 v[48:49], v14 offset:40960
  v_mfma_f32_16x16x32_bf16 v[124:127], v[52:55], a[220:223], v[124:127]
  ds_read_b64_tr_b16 v[50:51], v14 offset:43008
  v_mfma_f32_16x16x32_bf16 v[124:127], v[56:59], a[236:239], v[124:127]
  ds_read_b64_tr_b16 v[52:53], v17 offset:40960
  buffer_load_dwordx4 v3, s[52:55], s88 offen offset:2048 lds
  v_mfma_f32_16x16x32_bf16 v[124:127], v[60:63], a[252:255], v[124:127]
  s_waitcnt lgkmcnt(3)
  v_mfma_f32_16x16x32_bf16 v[96:99], v[32:35], v[172:175], v[96:99]
  ds_read_b64_tr_b16 v[54:55], v17 offset:43008
  v_mfma_f32_16x16x32_bf16 v[96:99], v[40:43], v[188:191], v[96:99]
  ds_read_b64_tr_b16 v[56:57], v14 offset:45056
  v_mfma_f32_16x16x32_bf16 v[104:107], v[32:35], v[176:179], v[104:107]
  v_mfma_f32_16x16x32_bf16 v[104:107], v[40:43], v[192:195], v[104:107]
  ds_read_b64_tr_b16 v[58:59], v14 offset:47104
  buffer_load_dwordx4 v4, s[52:55], s88 offen offset:3072 lds
  v_mfma_f32_16x16x32_bf16 v[112:115], v[32:35], v[180:183], v[112:115]
  ds_read_b64_tr_b16 v[60:61], v17 offset:45056
  v_mfma_f32_16x16x32_bf16 v[112:115], v[40:43], v[196:199], v[112:115]
  v_mfma_f32_16x16x32_bf16 v[120:123], v[32:35], v[184:187], v[120:123]
  ds_read_b64_tr_b16 v[62:63], v17 offset:47104
  v_mfma_f32_16x16x32_bf16 v[120:123], v[40:43], v[200:203], v[120:123]
  v_mfma_f32_16x16x32_bf16 v[100:103], v[36:39], v[172:175], v[100:103]
  buffer_load_dword v253, v252, s[60:63], 0 offen
  v_mfma_f32_16x16x32_bf16 v[100:103], v[44:47], v[188:191], v[100:103]
  v_mfma_f32_16x16x32_bf16 v[108:111], v[36:39], v[176:179], v[108:111]
  v_mfma_f32_16x16x32_bf16 v[108:111], v[44:47], v[192:195], v[108:111]
  v_mfma_f32_16x16x32_bf16 v[116:119], v[36:39], v[180:183], v[116:119]
  v_mfma_f32_16x16x32_bf16 v[116:119], v[44:47], v[196:199], v[116:119]
  v_mfma_f32_16x16x32_bf16 v[124:127], v[36:39], v[184:187], v[124:127]
  v_mfma_f32_16x16x32_bf16 v[124:127], v[44:47], v[200:203], v[124:127]
  s_waitcnt vmcnt(12) lgkmcnt(0)
  s_barrier
  v_mfma_f32_16x16x32_bf16 v[128:131], v[48:51], a[0:3], 0
  ds_read_b64_tr_b16 v[32:33], v14 offset:49152
  v_mfma_f32_16x16x32_bf16 v[128:131], v[56:59], a[16:19], v[128:131]
  ds_read_b64_tr_b16 v[34:35], v14 offset:51200
  v_readlane_b32 s88, v23, 36
  v_mfma_f32_16x16x32_bf16 v[136:139], v[48:51], a[4:7], 0
  ds_read_b64_tr_b16 v[36:37], v14 offset:53248
  v_mfma_f32_16x16x32_bf16 v[136:139], v[56:59], a[20:23], v[136:139]
  ds_read_b64_tr_b16 v[38:39], v14 offset:55296
  v_mul_f32 v168, v96, v96
  v_mfma_f32_16x16x32_bf16 v[144:147], v[48:51], a[8:11], 0
  s_add_u32 m0, s9, 147456
  v_fmaak_f32 v168, v168, v20, 0xc0135761
  v_mul_f32 v169, v97, v97
  v_mfma_f32_16x16x32_bf16 v[144:147], v[56:59], a[24:27], v[144:147]
  ds_read_b64_tr_b16 v[40:41], v14 offset:57344
  buffer_load_dwordx4 v1, s[48:51], s88 offen lds
  v_mfma_f32_16x16x32_bf16 v[152:155], v[48:51], a[12:15], 0
  ds_read_b64_tr_b16 v[42:43], v14 offset:59392
  v_mul_f32 v168, v168, v96
  v_mfma_f32_16x16x32_bf16 v[152:155], v[56:59], a[28:31], v[152:155]
  v_exp_f32 v168, v168
  v_mfma_f32_16x16x32_bf16 v[132:135], v[52:55], a[0:3], 0
  ds_read_b64_tr_b16 v[44:45], v14 offset:61440
  v_add_f32 v168, 1.0, v168
  v_mfma_f32_16x16x32_bf16 v[132:135], v[60:63], a[16:19], v[132:135]
  ds_read_b64_tr_b16 v[46:47], v14 offset:63488
  buffer_load_dwordx4 v2, s[48:51], s88 offen offset:1024 lds
  v_mfma_f32_16x16x32_bf16 v[140:143], v[52:55], a[4:7], 0
  v_rcp_f32 v168, v168
  v_mfma_f32_16x16x32_bf16 v[140:143], v[60:63], a[20:23], v[140:143]
  v_mul_f32 v96, v168, v96
  v_fmaak_f32 v169, v169, v20, 0xc0135761
  v_mfma_f32_16x16x32_bf16 v[148:151], v[52:55], a[8:11], 0
  ds_read_b64_tr_b16 v[48:49], v17 offset:49152
  v_mul_f32 v169, v169, v97
  v_mfma_f32_16x16x32_bf16 v[148:151], v[60:63], a[24:27], v[148:151]
  ds_read_b64_tr_b16 v[50:51], v17 offset:51200
  v_mul_f32 v170, v98, v98
  v_mfma_f32_16x16x32_bf16 v[156:159], v[52:55], a[12:15], 0
  ds_read_b64_tr_b16 v[52:53], v17 offset:53248
  buffer_load_dwordx4 v3, s[48:51], s88 offen offset:2048 lds
  v_mfma_f32_16x16x32_bf16 v[156:159], v[60:63], a[28:31], v[156:159]
  s_waitcnt lgkmcnt(3)
  v_exp_f32 v169, v169
  v_mfma_f32_16x16x32_bf16 v[128:131], v[32:35], a[32:35], v[128:131]
  ds_read_b64_tr_b16 v[54:55], v17 offset:55296
  v_add_f32 v169, 1.0, v169
  v_mfma_f32_16x16x32_bf16 v[128:131], v[36:39], a[48:51], v[128:131]
  ds_read_b64_tr_b16 v[56:57], v17 offset:57344
  v_fmaak_f32 v170, v170, v20, 0xc0135761
  v_mfma_f32_16x16x32_bf16 v[128:131], v[40:43], a[64:67], v[128:131]
  v_rcp_f32 v169, v169
  v_mfma_f32_16x16x32_bf16 v[128:131], v[44:47], a[80:83], v[128:131]
  ds_read_b64_tr_b16 v[58:59], v17 offset:59392
  buffer_load_dwordx4 v4, s[48:51], s88 offen offset:3072 lds
  v_mfma_f32_16x16x32_bf16 v[136:139], v[32:35], a[36:39], v[136:139]
  ds_read_b64_tr_b16 v[60:61], v17 offset:61440
  v_mul_f32 v97, v169, v97
  v_mfma_f32_16x16x32_bf16 v[136:139], v[36:39], a[52:55], v[136:139]
  v_mul_f32 v170, v170, v98
  v_mul_f32 v171, v99, v99
  v_mfma_f32_16x16x32_bf16 v[136:139], v[40:43], a[68:71], v[136:139]
  ds_read_b64_tr_b16 v[62:63], v17 offset:63488
  v_fmaak_f32 v171, v171, v20, 0xc0135761
  v_mfma_f32_16x16x32_bf16 v[136:139], v[44:47], a[84:87], v[136:139]
  v_exp_f32 v170, v170
  v_mfma_f32_16x16x32_bf16 v[144:147], v[32:35], a[40:43], v[144:147]
  v_add_f32 v170, 1.0, v170
  v_mul_f32 v171, v171, v99
  v_mfma_f32_16x16x32_bf16 v[144:147], v[36:39], a[56:59], v[144:147]
  v_rcp_f32 v170, v170
  v_mfma_f32_16x16x32_bf16 v[144:147], v[40:43], a[72:75], v[144:147]
  v_exp_f32 v171, v171
  v_mfma_f32_16x16x32_bf16 v[144:147], v[44:47], a[88:91], v[144:147]
  v_mul_f32 v98, v170, v98
  v_add_f32 v171, 1.0, v171
  v_mfma_f32_16x16x32_bf16 v[152:155], v[32:35], a[44:47], v[152:155]
  v_rcp_f32 v171, v171
  v_mfma_f32_16x16x32_bf16 v[152:155], v[36:39], a[60:63], v[152:155]
  v_mul_f32 v99, v171, v99
  v_mul_f32 v160, v100, v100
  v_mfma_f32_16x16x32_bf16 v[152:155], v[40:43], a[76:79], v[152:155]
  v_fmaak_f32 v160, v160, v20, 0xc0135761
  v_mul_f32 v161, v101, v101
  v_mfma_f32_16x16x32_bf16 v[152:155], v[44:47], a[92:95], v[152:155]
  s_waitcnt lgkmcnt(0)
  v_mul_f32 v160, v160, v100
  v_fmaak_f32 v161, v161, v20, 0xc0135761
  v_mfma_f32_16x16x32_bf16 v[132:135], v[48:51], a[32:35], v[132:135]
  ds_read_b64_tr_b16 v[32:33], v13 offset:32768
  v_mul_f32 v161, v161, v101
  v_mfma_f32_16x16x32_bf16 v[132:135], v[52:55], a[48:51], v[132:135]
  ds_read_b64_tr_b16 v[34:35], v13 offset:34816
  v_readlane_b32 s88, v23, 37
  v_mfma_f32_16x16x32_bf16 v[132:135], v[56:59], a[64:67], v[132:135]
  ds_read_b64_tr_b16 v[36:37], v13 offset:36864
  v_mul_f32 v162, v102, v102
  v_mfma_f32_16x16x32_bf16 v[132:135], v[60:63], a[80:83], v[132:135]
  ds_read_b64_tr_b16 v[38:39], v13 offset:38912
  v_fmaak_f32 v162, v162, v20, 0xc0135761
  v_mfma_f32_16x16x32_bf16 v[140:143], v[48:51], a[36:39], v[140:143]
  s_add_u32 m0, s9, 81920
  v_exp_f32 v160, v160
  v_mfma_f32_16x16x32_bf16 v[140:143], v[52:55], a[52:55], v[140:143]
  ds_read_b64_tr_b16 v[40:41], v13 offset:40960
  buffer_load_dwordx4 v1, s[48:51], s88 offen lds
  v_mfma_f32_16x16x32_bf16 v[140:143], v[56:59], a[68:71], v[140:143]
  ds_read_b64_tr_b16 v[42:43], v13 offset:43008
  v_add_f32 v160, 1.0, v160
  v_mfma_f32_16x16x32_bf16 v[140:143], v[60:63], a[84:87], v[140:143]
  v_rcp_f32 v160, v160
  v_mfma_f32_16x16x32_bf16 v[148:151], v[48:51], a[40:43], v[148:151]
  ds_read_b64_tr_b16 v[44:45], v13 offset:45056
  v_mul_f32 v100, v160, v100
  v_mfma_f32_16x16x32_bf16 v[148:151], v[52:55], a[56:59], v[148:151]
  ds_read_b64_tr_b16 v[46:47], v13 offset:47104
  buffer_load_dwordx4 v2, s[48:51], s88 offen offset:1024 lds
  v_mfma_f32_16x16x32_bf16 v[148:151], v[56:59], a[72:75], v[148:151]
  v_exp_f32 v161, v161
  v_mfma_f32_16x16x32_bf16 v[148:151], v[60:63], a[88:91], v[148:151]
  v_add_u32 v252, 1408, v252
  v_add_f32 v161, 1.0, v161
  v_mfma_f32_16x16x32_bf16 v[156:159], v[48:51], a[44:47], v[156:159]
  ds_read_b64_tr_b16 v[48:49], v16 offset:32768
  v_mul_f32 v162, v162, v102
  v_mfma_f32_16x16x32_bf16 v[156:159], v[52:55], a[60:63], v[156:159]
  ds_read_b64_tr_b16 v[50:51], v16 offset:34816
  v_mul_f32 v163, v103, v103
  v_mfma_f32_16x16x32_bf16 v[156:159], v[56:59], a[76:79], v[156:159]
  ds_read_b64_tr_b16 v[52:53], v16 offset:36864
  buffer_load_dwordx4 v3, s[48:51], s88 offen offset:2048 lds
  v_mfma_f32_16x16x32_bf16 v[156:159], v[60:63], a[92:95], v[156:159]
  s_waitcnt lgkmcnt(3)
  v_rcp_f32 v161, v161
  v_mfma_f32_16x16x32_bf16 v[128:131], v[32:35], a[96:99], v[128:131]
  ds_read_b64_tr_b16 v[54:55], v16 offset:38912
  v_mul_f32 v101, v161, v101
  v_mfma_f32_16x16x32_bf16 v[128:131], v[36:39], a[112:115], v[128:131]
  ds_read_b64_tr_b16 v[56:57], v16 offset:40960
  v_fmaak_f32 v163, v163, v20, 0xc0135761
  v_mfma_f32_16x16x32_bf16 v[128:131], v[40:43], a[128:131], v[128:131]
  v_exp_f32 v162, v162
  v_mfma_f32_16x16x32_bf16 v[128:131], v[44:47], a[144:147], v[128:131]
  ds_read_b64_tr_b16 v[58:59], v16 offset:43008
  buffer_load_dwordx4 v4, s[48:51], s88 offen offset:3072 lds
  v_mfma_f32_16x16x32_bf16 v[136:139], v[32:35], a[100:103], v[136:139]
  ds_read_b64_tr_b16 v[60:61], v16 offset:45056
  v_add_f32 v162, 1.0, v162
  v_mfma_f32_16x16x32_bf16 v[136:139], v[36:39], a[116:119], v[136:139]
  v_rcp_f32 v162, v162
  v_mfma_f32_16x16x32_bf16 v[136:139], v[40:43], a[132:135], v[136:139]
  ds_read_b64_tr_b16 v[62:63], v16 offset:47104
  v_mul_f32 v102, v162, v102
  v_mfma_f32_16x16x32_bf16 v[136:139], v[44:47], a[148:151], v[136:139]
  buffer_load_dword v253, v252, s[60:63], 0 offen
  v_mfma_f32_16x16x32_bf16 v[144:147], v[32:35], a[104:107], v[144:147]
  v_mul_f32 v163, v163, v103
  v_mul_f32 v164, v104, v104
  v_mfma_f32_16x16x32_bf16 v[144:147], v[36:39], a[120:123], v[144:147]
  v_exp_f32 v163, v163
  v_mfma_f32_16x16x32_bf16 v[144:147], v[40:43], a[136:139], v[144:147]
  v_add_f32 v163, 1.0, v163
  v_fmaak_f32 v164, v164, v20, 0xc0135761
  v_mfma_f32_16x16x32_bf16 v[144:147], v[44:47], a[152:155], v[144:147]
  v_rcp_f32 v163, v163
  v_mfma_f32_16x16x32_bf16 v[152:155], v[32:35], a[108:111], v[152:155]
  v_mul_f32 v103, v163, v103
  v_mul_f32 v164, v164, v104
  v_mfma_f32_16x16x32_bf16 v[152:155], v[36:39], a[124:127], v[152:155]
  v_exp_f32 v164, v164
  v_mfma_f32_16x16x32_bf16 v[152:155], v[40:43], a[140:143], v[152:155]
  v_add_f32 v164, 1.0, v164
  v_mul_f32 v165, v105, v105
  v_mfma_f32_16x16x32_bf16 v[152:155], v[44:47], a[156:159], v[152:155]
  s_waitcnt vmcnt(10) lgkmcnt(0)
  s_barrier
  v_mfma_f32_16x16x32_bf16 v[132:135], v[48:51], a[96:99], v[132:135]
  ds_read_b64_tr_b16 v[32:33], v15 offset:0
  v_fmaak_f32 v165, v165, v20, 0xc0135761
  v_mfma_f32_16x16x32_bf16 v[132:135], v[52:55], a[112:115], v[132:135]
  ds_read_b64_tr_b16 v[34:35], v15 offset:2048
  v_readlane_b32 s88, v23, 38
  v_mfma_f32_16x16x32_bf16 v[132:135], v[56:59], a[128:131], v[132:135]
  ds_read_b64_tr_b16 v[36:37], v15 offset:4096
  v_mul_f32 v165, v165, v105
  v_mfma_f32_16x16x32_bf16 v[132:135], v[60:63], a[144:147], v[132:135]
  ds_read_b64_tr_b16 v[38:39], v15 offset:6144
  buffer_atomic_add v239, v238, s[68:71], 0 offen sc1
  v_mfma_f32_16x16x32_bf16 v[140:143], v[48:51], a[100:103], v[140:143]
  s_add_u32 m0, s9, 98304
  v_rcp_f32 v164, v164
  v_mfma_f32_16x16x32_bf16 v[140:143], v[52:55], a[116:119], v[140:143]
  ds_read_b64_tr_b16 v[40:41], v15 offset:8192
  buffer_load_dwordx4 v1, s[48:51], s88 offen lds
  v_mfma_f32_16x16x32_bf16 v[140:143], v[56:59], a[132:135], v[140:143]
  ds_read_b64_tr_b16 v[42:43], v15 offset:10240
  v_mul_f32 v104, v164, v104
  v_mfma_f32_16x16x32_bf16 v[140:143], v[60:63], a[148:151], v[140:143]
  v_exp_f32 v165, v165
  v_mfma_f32_16x16x32_bf16 v[148:151], v[48:51], a[104:107], v[148:151]
  ds_read_b64_tr_b16 v[44:45], v15 offset:12288
  v_add_f32 v165, 1.0, v165
  v_mfma_f32_16x16x32_bf16 v[148:151], v[52:55], a[120:123], v[148:151]
  ds_read_b64_tr_b16 v[46:47], v15 offset:14336
  buffer_load_dwordx4 v2, s[48:51], s88 offen offset:1024 lds
  v_mfma_f32_16x16x32_bf16 v[148:151], v[56:59], a[136:139], v[148:151]
  v_rcp_f32 v165, v165
  v_mfma_f32_16x16x32_bf16 v[148:151], v[60:63], a[152:155], v[148:151]
  v_mul_f32 v105, v165, v105
  v_mul_f32 v166, v106, v106
  v_mfma_f32_16x16x32_bf16 v[156:159], v[48:51], a[108:111], v[156:159]
  ds_read_b64_tr_b16 v[48:49], v18 offset:0
  v_fmaak_f32 v166, v166, v20, 0xc0135761
  v_mfma_f32_16x16x32_bf16 v[156:159], v[52:55], a[124:127], v[156:159]
  ds_read_b64_tr_b16 v[50:51], v18 offset:2048
  v_mul_f32 v166, v166, v106
  v_mfma_f32_16x16x32_bf16 v[156:159], v[56:59], a[140:143], v[156:159]
  ds_read_b64_tr_b16 v[52:53], v18 offset:4096
  buffer_load_dwordx4 v3, s[48:51], s88 offen offset:2048 lds
  v_mfma_f32_16x16x32_bf16 v[156:159], v[60:63], a[156:159], v[156:159]
  s_waitcnt lgkmcnt(3)
  v_exp_f32 v166, v166
  v_mfma_f32_16x16x32_bf16 v[128:131], v[32:35], a[160:163], v[128:131]
  ds_read_b64_tr_b16 v[54:55], v18 offset:6144
  v_add_f32 v166, 1.0, v166
  v_mfma_f32_16x16x32_bf16 v[128:131], v[36:39], a[176:179], v[128:131]
  ds_read_b64_tr_b16 v[56:57], v18 offset:8192
  v_mul_f32 v167, v107, v107
  v_mfma_f32_16x16x32_bf16 v[128:131], v[40:43], a[192:195], v[128:131]
  v_rcp_f32 v166, v166
  v_mfma_f32_16x16x32_bf16 v[128:131], v[44:47], a[208:211], v[128:131]
  ds_read_b64_tr_b16 v[58:59], v18 offset:10240
  buffer_load_dwordx4 v4, s[48:51], s88 offen offset:3072 lds
  v_mfma_f32_16x16x32_bf16 v[136:139], v[32:35], a[164:167], v[136:139]
  ds_read_b64_tr_b16 v[60:61], v18 offset:12288
  v_mul_f32 v106, v166, v106
  v_mfma_f32_16x16x32_bf16 v[136:139], v[36:39], a[180:183], v[136:139]
  v_fmaak_f32 v167, v167, v20, 0xc0135761
  v_mul_f32 v168, v108, v108
  v_mfma_f32_16x16x32_bf16 v[136:139], v[40:43], a[196:199], v[136:139]
  ds_read_b64_tr_b16 v[62:63], v18 offset:14336
  v_mul_f32 v167, v167, v107
  v_mfma_f32_16x16x32_bf16 v[136:139], v[44:47], a[212:215], v[136:139]
  v_exp_f32 v167, v167
  v_mfma_f32_16x16x32_bf16 v[144:147], v[32:35], a[168:171], v[144:147]
  v_add_f32 v167, 1.0, v167
  v_fmaak_f32 v168, v168, v20, 0xc0135761
  v_mfma_f32_16x16x32_bf16 v[144:147], v[36:39], a[184:187], v[144:147]
  v_rcp_f32 v167, v167
  v_mfma_f32_16x16x32_bf16 v[144:147], v[40:43], a[200:203], v[144:147]
  v_mul_f32 v107, v167, v107
  v_mul_f32 v168, v168, v108
  v_mfma_f32_16x16x32_bf16 v[144:147], v[44:47], a[216:219], v[144:147]
  v_exp_f32 v168, v168
  v_mfma_f32_16x16x32_bf16 v[152:155], v[32:35], a[172:175], v[152:155]
  v_add_f32 v168, 1.0, v168
  v_mul_f32 v169, v109, v109
  v_mfma_f32_16x16x32_bf16 v[152:155], v[36:39], a[188:191], v[152:155]
  v_rcp_f32 v168, v168
  v_mfma_f32_16x16x32_bf16 v[152:155], v[40:43], a[204:207], v[152:155]
  v_mul_f32 v108, v168, v108
  v_fmaak_f32 v169, v169, v20, 0xc0135761
  v_mfma_f32_16x16x32_bf16 v[152:155], v[44:47], a[220:223], v[152:155]
  s_waitcnt lgkmcnt(0)
  v_mul_f32 v169, v169, v109
  v_mul_f32 v170, v110, v110
  v_mfma_f32_16x16x32_bf16 v[132:135], v[48:51], a[160:163], v[132:135]
  ds_read_b64_tr_b16 v[32:33], v13 offset:49152
  v_fmaak_f32 v170, v170, v20, 0xc0135761
  v_mfma_f32_16x16x32_bf16 v[132:135], v[52:55], a[176:179], v[132:135]
  ds_read_b64_tr_b16 v[34:35], v13 offset:51200
  v_readlane_b32 s88, v23, 39
  v_mfma_f32_16x16x32_bf16 v[132:135], v[56:59], a[192:195], v[132:135]
  ds_read_b64_tr_b16 v[36:37], v13 offset:53248
  v_mul_f32 v170, v170, v110
  v_mfma_f32_16x16x32_bf16 v[132:135], v[60:63], a[208:211], v[132:135]
  ds_read_b64_tr_b16 v[38:39], v13 offset:55296
  v_mul_f32 v171, v111, v111
  v_mfma_f32_16x16x32_bf16 v[140:143], v[48:51], a[164:167], v[140:143]
  s_add_u32 m0, s9, 114688
  v_exp_f32 v169, v169
  v_mfma_f32_16x16x32_bf16 v[140:143], v[52:55], a[180:183], v[140:143]
  ds_read_b64_tr_b16 v[40:41], v13 offset:57344
  buffer_load_dwordx4 v1, s[48:51], s88 offen lds
  v_mfma_f32_16x16x32_bf16 v[140:143], v[56:59], a[196:199], v[140:143]
  ds_read_b64_tr_b16 v[42:43], v13 offset:59392
  v_add_f32 v169, 1.0, v169
  v_mfma_f32_16x16x32_bf16 v[140:143], v[60:63], a[212:215], v[140:143]
  v_rcp_f32 v169, v169
  v_mfma_f32_16x16x32_bf16 v[148:151], v[48:51], a[168:171], v[148:151]
  ds_read_b64_tr_b16 v[44:45], v13 offset:61440
  v_add_u32 v252, 1408, v252
  v_mfma_f32_16x16x32_bf16 v[148:151], v[52:55], a[184:187], v[148:151]
  ds_read_b64_tr_b16 v[46:47], v13 offset:63488
  buffer_load_dwordx4 v2, s[48:51], s88 offen offset:1024 lds
  v_mfma_f32_16x16x32_bf16 v[148:151], v[56:59], a[200:203], v[148:151]
  v_exp_f32 v170, v170
  v_mfma_f32_16x16x32_bf16 v[148:151], v[60:63], a[216:219], v[148:151]
  v_mul_f32 v109, v169, v109
  v_add_f32 v170, 1.0, v170
  v_mfma_f32_16x16x32_bf16 v[156:159], v[48:51], a[172:175], v[156:159]
  ds_read_b64_tr_b16 v[48:49], v16 offset:49152
  v_fmaak_f32 v171, v171, v20, 0xc0135761
  v_mfma_f32_16x16x32_bf16 v[156:159], v[52:55], a[188:191], v[156:159]
  ds_read_b64_tr_b16 v[50:51], v16 offset:51200
  v_mul_f32 v171, v171, v111
  v_mfma_f32_16x16x32_bf16 v[156:159], v[56:59], a[204:207], v[156:159]
  ds_read_b64_tr_b16 v[52:53], v16 offset:53248
  buffer_load_dwordx4 v3, s[48:51], s88 offen offset:2048 lds
  v_mfma_f32_16x16x32_bf16 v[156:159], v[60:63], a[220:223], v[156:159]
  s_waitcnt lgkmcnt(3)
  v_rcp_f32 v170, v170
  v_mfma_f32_16x16x32_bf16 v[128:131], v[32:35], a[224:227], v[128:131]
  ds_read_b64_tr_b16 v[54:55], v16 offset:55296
  v_mul_f32 v110, v170, v110
  v_mfma_f32_16x16x32_bf16 v[128:131], v[36:39], a[240:243], v[128:131]
  ds_read_b64_tr_b16 v[56:57], v16 offset:57344
  v_mul_f32 v160, v112, v112
  v_mfma_f32_16x16x32_bf16 v[128:131], v[40:43], v[172:175], v[128:131]
  v_exp_f32 v171, v171
  v_mfma_f32_16x16x32_bf16 v[128:131], v[44:47], v[188:191], v[128:131]
  ds_read_b64_tr_b16 v[58:59], v16 offset:59392
  buffer_load_dwordx4 v4, s[48:51], s88 offen offset:3072 lds
  v_mfma_f32_16x16x32_bf16 v[136:139], v[32:35], a[228:231], v[136:139]
  ds_read_b64_tr_b16 v[60:61], v16 offset:61440
  v_add_f32 v171, 1.0, v171
  v_mfma_f32_16x16x32_bf16 v[136:139], v[36:39], a[244:247], v[136:139]
  v_rcp_f32 v171, v171
  v_mfma_f32_16x16x32_bf16 v[136:139], v[40:43], v[176:179], v[136:139]
  ds_read_b64_tr_b16 v[62:63], v16 offset:63488
  v_mul_f32 v111, v171, v111
  v_mfma_f32_16x16x32_bf16 v[136:139], v[44:47], v[192:195], v[136:139]
  buffer_load_dword v253, v252, s[60:63], 0 offen
  v_mfma_f32_16x16x32_bf16 v[144:147], v[32:35], a[232:235], v[144:147]
  v_fmaak_f32 v160, v160, v20, 0xc0135761
  v_mul_f32 v161, v113, v113
  v_mfma_f32_16x16x32_bf16 v[144:147], v[36:39], a[248:251], v[144:147]
  v_mul_f32 v160, v160, v112
  v_fmaak_f32 v161, v161, v20, 0xc0135761
  v_mfma_f32_16x16x32_bf16 v[144:147], v[40:43], v[180:183], v[144:147]
  v_exp_f32 v160, v160
  v_mfma_f32_16x16x32_bf16 v[144:147], v[44:47], v[196:199], v[144:147]
  v_add_f32 v160, 1.0, v160
  v_mul_f32 v161, v161, v113
  v_mfma_f32_16x16x32_bf16 v[152:155], v[32:35], a[236:239], v[152:155]
  v_rcp_f32 v160, v160
  v_mfma_f32_16x16x32_bf16 v[152:155], v[36:39], a[252:255], v[152:155]
  v_exp_f32 v161, v161
  v_mfma_f32_16x16x32_bf16 v[152:155], v[40:43], v[184:187], v[152:155]
  v_mul_f32 v112, v160, v112
  v_add_f32 v161, 1.0, v161
  v_mfma_f32_16x16x32_bf16 v[152:155], v[44:47], v[200:203], v[152:155]
  s_waitcnt vmcnt(11) lgkmcnt(0)
  s_barrier
  v_mfma_f32_16x16x32_bf16 v[132:135], v[48:51], a[224:227], v[132:135]
  ds_read_b64_tr_b16 v[32:33], v15 offset:16384
  v_mul_f32 v162, v114, v114
  v_mfma_f32_16x16x32_bf16 v[132:135], v[52:55], a[240:243], v[132:135]
  ds_read_b64_tr_b16 v[34:35], v15 offset:18432
  v_readlane_b32 s88, v23, 40
  v_mfma_f32_16x16x32_bf16 v[132:135], v[56:59], v[172:175], v[132:135]
  ds_read_b64_tr_b16 v[36:37], v15 offset:20480
  v_fmaak_f32 v162, v162, v20, 0xc0135761
  v_mfma_f32_16x16x32_bf16 v[132:135], v[60:63], v[188:191], v[132:135]
  ds_read_b64_tr_b16 v[38:39], v15 offset:22528
  v_mul_f32 v162, v162, v114
  v_mfma_f32_16x16x32_bf16 v[140:143], v[48:51], a[228:231], v[140:143]
  s_add_u32 m0, s9, 49152
  v_rcp_f32 v161, v161
  v_mfma_f32_16x16x32_bf16 v[140:143], v[52:55], a[244:247], v[140:143]
  ds_read_b64_tr_b16 v[40:41], v15 offset:24576
  buffer_load_dwordx4 v1, s[56:59], s88 offen lds
  v_mfma_f32_16x16x32_bf16 v[140:143], v[56:59], v[176:179], v[140:143]
  ds_read_b64_tr_b16 v[42:43], v15 offset:26624
  v_mul_f32 v113, v161, v113
  v_mfma_f32_16x16x32_bf16 v[140:143], v[60:63], v[192:195], v[140:143]
  v_exp_f32 v162, v162
  v_mfma_f32_16x16x32_bf16 v[148:151], v[48:51], a[232:235], v[148:151]
  ds_read_b64_tr_b16 v[44:45], v15 offset:28672
  v_add_f32 v162, 1.0, v162
  v_mfma_f32_16x16x32_bf16 v[148:151], v[52:55], a[248:251], v[148:151]
  ds_read_b64_tr_b16 v[46:47], v15 offset:30720
  buffer_load_dwordx4 v2, s[56:59], s88 offen offset:1024 lds
  v_mfma_f32_16x16x32_bf16 v[148:151], v[56:59], v[180:183], v[148:151]
  v_rcp_f32 v162, v162
  v_mfma_f32_16x16x32_bf16 v[148:151], v[60:63], v[196:199], v[148:151]
  v_mul_f32 v114, v162, v114
  v_mul_f32 v163, v115, v115
  v_mfma_f32_16x16x32_bf16 v[156:159], v[48:51], a[236:239], v[156:159]
  ds_read_b64_tr_b16 v[48:49], v18 offset:16384
  v_fmaak_f32 v163, v163, v20, 0xc0135761
  v_mfma_f32_16x16x32_bf16 v[156:159], v[52:55], a[252:255], v[156:159]
  ds_read_b64_tr_b16 v[50:51], v18 offset:18432
  v_mul_f32 v163, v163, v115
  v_mfma_f32_16x16x32_bf16 v[156:159], v[56:59], v[184:187], v[156:159]
  ds_read_b64_tr_b16 v[52:53], v18 offset:20480
  buffer_load_dwordx4 v3, s[56:59], s88 offen offset:2048 lds
  v_mfma_f32_16x16x32_bf16 v[156:159], v[60:63], v[200:203], v[156:159]
  s_waitcnt lgkmcnt(3)
  v_exp_f32 v163, v163
  v_mfma_f32_16x16x32_bf16 v[64:67], v[32:35], a[0:3], 0
  ds_read_b64_tr_b16 v[54:55], v18 offset:22528
  v_add_f32 v163, 1.0, v163
  v_mfma_f32_16x16x32_bf16 v[64:67], v[36:39], a[16:19], v[64:67]
  ds_read_b64_tr_b16 v[56:57], v18 offset:24576
  v_mul_f32 v164, v116, v116
  v_mfma_f32_16x16x32_bf16 v[64:67], v[40:43], a[32:35], v[64:67]
  v_rcp_f32 v163, v163
  v_mfma_f32_16x16x32_bf16 v[64:67], v[44:47], a[48:51], v[64:67]
  ds_read_b64_tr_b16 v[58:59], v18 offset:26624
  buffer_load_dwordx4 v4, s[56:59], s88 offen offset:3072 lds
  v_mfma_f32_16x16x32_bf16 v[72:75], v[32:35], a[4:7], 0
  ds_read_b64_tr_b16 v[60:61], v18 offset:28672
  v_mul_f32 v96, v96, v128
  v_mfma_f32_16x16x32_bf16 v[72:75], v[36:39], a[20:23], v[72:75]
  v_mul_f32 v97, v97, v129
  v_mul_f32 v98, v98, v130
  v_mfma_f32_16x16x32_bf16 v[72:75], v[40:43], a[36:39], v[72:75]
  ds_read_b64_tr_b16 v[62:63], v18 offset:30720
  v_cvt_pk_bf16_f32 v96, v96, v97
  v_mfma_f32_16x16x32_bf16 v[72:75], v[44:47], a[52:55], v[72:75]
  v_mul_f32 v99, v99, v131
  v_mul_f32 v100, v100, v132
  v_mfma_f32_16x16x32_bf16 v[80:83], v[32:35], a[8:11], 0
  v_cvt_pk_bf16_f32 v97, v98, v99
  v_mul_f32 v101, v101, v133
  v_mfma_f32_16x16x32_bf16 v[80:83], v[36:39], a[24:27], v[80:83]
  v_cvt_pk_bf16_f32 v98, v100, v101
  v_mul_f32 v102, v102, v134
  v_mfma_f32_16x16x32_bf16 v[80:83], v[40:43], a[40:43], v[80:83]
  v_mul_f32 v103, v103, v135
  v_mul_f32 v104, v104, v136
  v_mfma_f32_16x16x32_bf16 v[80:83], v[44:47], a[56:59], v[80:83]
  v_cvt_pk_bf16_f32 v99, v102, v103
  v_mul_f32 v105, v105, v137
  v_mfma_f32_16x16x32_bf16 v[88:91], v[32:35], a[12:15], 0
  ds_write_b128 v236, v[96:99] offset:32768
  v_mfma_f32_16x16x32_bf16 v[88:91], v[36:39], a[28:31], v[88:91]
  v_cvt_pk_bf16_f32 v104, v104, v105
  v_mul_f32 v106, v106, v138
  v_mfma_f32_16x16x32_bf16 v[88:91], v[40:43], a[44:47], v[88:91]
  v_mul_f32 v107, v107, v139
  v_mul_f32 v108, v108, v140
  v_mfma_f32_16x16x32_bf16 v[88:91], v[44:47], a[60:63], v[88:91]
  s_waitcnt lgkmcnt(1)
  v_cvt_pk_bf16_f32 v105, v106, v107
  v_mul_f32 v109, v109, v141
  v_mfma_f32_16x16x32_bf16 v[68:71], v[48:51], a[0:3], 0
  ds_read_b64_tr_b16 v[32:33], v14 offset:16384
  v_cvt_pk_bf16_f32 v106, v108, v109
  v_mfma_f32_16x16x32_bf16 v[68:71], v[52:55], a[16:19], v[68:71]
  ds_read_b64_tr_b16 v[34:35], v14 offset:18432
  v_readlane_b32 s88, v23, 41
  v_mfma_f32_16x16x32_bf16 v[68:71], v[56:59], a[32:35], v[68:71]
  ds_read_b64_tr_b16 v[36:37], v14 offset:20480
  v_mul_f32 v110, v110, v142
  v_mfma_f32_16x16x32_bf16 v[68:71], v[60:63], a[48:51], v[68:71]
  ds_read_b64_tr_b16 v[38:39], v14 offset:22528
  v_mul_f32 v111, v111, v143
  v_mfma_f32_16x16x32_bf16 v[76:79], v[48:51], a[4:7], 0
  s_add_u32 m0, s9, 131072
  v_cvt_pk_bf16_f32 v107, v110, v111
  v_mul_f32 v112, v112, v144
  v_mfma_f32_16x16x32_bf16 v[76:79], v[52:55], a[20:23], v[76:79]
  ds_read_b64_tr_b16 v[40:41], v14 offset:24576
  buffer_load_dwordx4 v1, s[52:55], s88 offen lds
  v_mfma_f32_16x16x32_bf16 v[76:79], v[56:59], a[36:39], v[76:79]
  ds_read_b64_tr_b16 v[42:43], v14 offset:26624
  v_mul_f32 v113, v113, v145
  v_mfma_f32_16x16x32_bf16 v[76:79], v[60:63], a[52:55], v[76:79]
  v_add_u32 v252, 1408, v252
  v_cvt_pk_bf16_f32 v112, v112, v113
  v_mfma_f32_16x16x32_bf16 v[84:87], v[48:51], a[8:11], 0
  ds_read_b64_tr_b16 v[44:45], v14 offset:28672
  v_mul_f32 v115, v163, v115
  v_mfma_f32_16x16x32_bf16 v[84:87], v[52:55], a[24:27], v[84:87]
  ds_read_b64_tr_b16 v[46:47], v14 offset:30720
  buffer_load_dwordx4 v2, s[52:55], s88 offen offset:1024 lds
  v_mfma_f32_16x16x32_bf16 v[84:87], v[56:59], a[40:43], v[84:87]
  ds_write_b128 v236, v[104:107] offset:33792
  v_mfma_f32_16x16x32_bf16 v[84:87], v[60:63], a[56:59], v[84:87]
  v_mul_f32 v114, v114, v146
  v_fmaak_f32 v164, v164, v20, 0xc0135761
  v_mfma_f32_16x16x32_bf16 v[92:95], v[48:51], a[12:15], 0
  ds_read_b64_tr_b16 v[48:49], v17 offset:16384
  v_mul_f32 v164, v164, v116
  v_mfma_f32_16x16x32_bf16 v[92:95], v[52:55], a[28:31], v[92:95]
  ds_read_b64_tr_b16 v[50:51], v17 offset:18432
  v_mul_f32 v115, v115, v147
  v_mfma_f32_16x16x32_bf16 v[92:95], v[56:59], a[44:47], v[92:95]
  ds_read_b64_tr_b16 v[52:53], v17 offset:20480
  buffer_load_dwordx4 v3, s[52:55], s88 offen offset:2048 lds
  v_mfma_f32_16x16x32_bf16 v[92:95], v[60:63], a[60:63], v[92:95]
  s_waitcnt lgkmcnt(4)
  v_exp_f32 v164, v164
  v_mfma_f32_16x16x32_bf16 v[64:67], v[32:35], a[64:67], v[64:67]
  ds_read_b64_tr_b16 v[54:55], v17 offset:22528
  v_cvt_pk_bf16_f32 v113, v114, v115
  v_mfma_f32_16x16x32_bf16 v[64:67], v[36:39], a[80:83], v[64:67]
  ds_read_b64_tr_b16 v[56:57], v17 offset:24576
  v_add_f32 v164, 1.0, v164
  v_mfma_f32_16x16x32_bf16 v[64:67], v[40:43], a[96:99], v[64:67]
  v_rcp_f32 v164, v164
  v_mfma_f32_16x16x32_bf16 v[64:67], v[44:47], a[112:115], v[64:67]
  ds_read_b64_tr_b16 v[58:59], v17 offset:26624
  buffer_load_dwordx4 v4, s[52:55], s88 offen offset:3072 lds
  v_mfma_f32_16x16x32_bf16 v[72:75], v[32:35], a[68:71], v[72:75]
  ds_read_b64_tr_b16 v[60:61], v17 offset:28672
  v_mul_f32 v116, v164, v116
  v_mfma_f32_16x16x32_bf16 v[72:75], v[36:39], a[84:87], v[72:75]
  buffer_load_dword v253, v252, s[60:63], 0 offen
  v_mfma_f32_16x16x32_bf16 v[72:75], v[40:43], a[100:103], v[72:75]
  ds_read_b64_tr_b16 v[62:63], v17 offset:30720
  v_mul_f32 v165, v117, v117
  v_mfma_f32_16x16x32_bf16 v[72:75], v[44:47], a[116:119], v[72:75]
  v_fmaak_f32 v165, v165, v20, 0xc0135761
  v_mul_f32 v116, v116, v148
  v_mfma_f32_16x16x32_bf16 v[80:83], v[32:35], a[72:75], v[80:83]
  v_mul_f32 v165, v165, v117
  v_mul_f32 v166, v118, v118
  v_mfma_f32_16x16x32_bf16 v[80:83], v[36:39], a[88:91], v[80:83]
  v_exp_f32 v165, v165
  v_mfma_f32_16x16x32_bf16 v[80:83], v[40:43], a[104:107], v[80:83]
  v_add_f32 v165, 1.0, v165
  v_fmaak_f32 v166, v166, v20, 0xc0135761
  v_mfma_f32_16x16x32_bf16 v[80:83], v[44:47], a[120:123], v[80:83]
  v_rcp_f32 v165, v165
  v_mfma_f32_16x16x32_bf16 v[88:91], v[32:35], a[76:79], v[88:91]
  v_mul_f32 v117, v165, v117
  v_mul_f32 v166, v166, v118
  v_mfma_f32_16x16x32_bf16 v[88:91], v[36:39], a[92:95], v[88:91]
  v_exp_f32 v166, v166
  v_mfma_f32_16x16x32_bf16 v[88:91], v[40:43], a[108:111], v[88:91]
  v_add_f32 v166, 1.0, v166
  v_mul_f32 v117, v117, v149
  v_mfma_f32_16x16x32_bf16 v[88:91], v[44:47], a[124:127], v[88:91]
  s_waitcnt vmcnt(10) lgkmcnt(0)
  s_barrier
  v_mfma_f32_16x16x32_bf16 v[68:71], v[48:51], a[64:67], v[68:71]
  ds_read_b64_tr_b16 v[32:33], v14 offset:32768
  v_cvt_pk_bf16_f32 v114, v116, v117
  v_mfma_f32_16x16x32_bf16 v[68:71], v[52:55], a[80:83], v[68:71]
PAD6:
  s_cbranch_execz PAD10
  ds_read_b64_tr_b16 v[34:35], v14 offset:34816
  v_readlane_b32 s88, v23, 42
  v_mfma_f32_16x16x32_bf16 v[68:71], v[56:59], a[96:99], v[68:71]
  ds_read_b64_tr_b16 v[36:37], v14 offset:36864
  v_mul_f32 v167, v119, v119
  v_mfma_f32_16x16x32_bf16 v[68:71], v[60:63], a[112:115], v[68:71]
  ds_read_b64_tr_b16 v[38:39], v14 offset:38912
  v_fmaak_f32 v167, v167, v20, 0xc0135761
  v_mfma_f32_16x16x32_bf16 v[76:79], v[48:51], a[68:71], v[76:79]
  s_add_u32 m0, s9, 81920
  v_rcp_f32 v166, v166
  v_mfma_f32_16x16x32_bf16 v[76:79], v[52:55], a[84:87], v[76:79]
  ds_read_b64_tr_b16 v[40:41], v14 offset:40960
  buffer_load_dwordx4 v1, s[52:55], s88 offen lds
  v_mfma_f32_16x16x32_bf16 v[76:79], v[56:59], a[100:103], v[76:79]
  ds_read_b64_tr_b16 v[42:43], v14 offset:43008
  v_mul_f32 v118, v166, v118
  v_mfma_f32_16x16x32_bf16 v[76:79], v[60:63], a[116:119], v[76:79]
  v_mul_f32 v167, v167, v119
  v_mul_f32 v118, v118, v150
  v_mfma_f32_16x16x32_bf16 v[84:87], v[48:51], a[72:75], v[84:87]
  ds_read_b64_tr_b16 v[44:45], v14 offset:45056
  v_mul_f32 v168, v120, v120
  v_mfma_f32_16x16x32_bf16 v[84:87], v[52:55], a[88:91], v[84:87]
  ds_read_b64_tr_b16 v[46:47], v14 offset:47104
  buffer_load_dwordx4 v2, s[52:55], s88 offen offset:1024 lds
  v_mfma_f32_16x16x32_bf16 v[84:87], v[56:59], a[104:107], v[84:87]
  v_exp_f32 v167, v167
  v_mfma_f32_16x16x32_bf16 v[84:87], v[60:63], a[120:123], v[84:87]
  v_add_f32 v167, 1.0, v167
  v_fmaak_f32 v168, v168, v20, 0xc0135761
  v_mfma_f32_16x16x32_bf16 v[92:95], v[48:51], a[76:79], v[92:95]
  ds_read_b64_tr_b16 v[48:49], v17 offset:32768
  v_mul_f32 v168, v168, v120
  v_mfma_f32_16x16x32_bf16 v[92:95], v[52:55], a[92:95], v[92:95]
  ds_read_b64_tr_b16 v[50:51], v17 offset:34816
  v_mul_f32 v169, v121, v121
  v_mfma_f32_16x16x32_bf16 v[92:95], v[56:59], a[108:111], v[92:95]
  ds_read_b64_tr_b16 v[52:53], v17 offset:36864
  buffer_load_dwordx4 v3, s[52:55], s88 offen offset:2048 lds
  v_mfma_f32_16x16x32_bf16 v[92:95], v[60:63], a[124:127], v[92:95]
  s_waitcnt lgkmcnt(3)
  v_rcp_f32 v167, v167
  v_mfma_f32_16x16x32_bf16 v[64:67], v[32:35], a[128:131], v[64:67]
  ds_read_b64_tr_b16 v[54:55], v17 offset:38912
  v_mul_f32 v119, v167, v119
  v_mfma_f32_16x16x32_bf16 v[64:67], v[36:39], a[144:147], v[64:67]
  ds_read_b64_tr_b16 v[56:57], v17 offset:40960
  v_mul_f32 v119, v119, v151
  v_mfma_f32_16x16x32_bf16 v[64:67], v[40:43], a[160:163], v[64:67]
  v_exp_f32 v168, v168
  v_mfma_f32_16x16x32_bf16 v[64:67], v[44:47], a[176:179], v[64:67]
  ds_read_b64_tr_b16 v[58:59], v17 offset:43008
  buffer_load_dwordx4 v4, s[52:55], s88 offen offset:3072 lds
  v_mfma_f32_16x16x32_bf16 v[72:75], v[32:35], a[132:135], v[72:75]
  ds_read_b64_tr_b16 v[60:61], v17 offset:45056
  v_cvt_pk_bf16_f32 v115, v118, v119
  v_mfma_f32_16x16x32_bf16 v[72:75], v[36:39], a[148:151], v[72:75]
  ds_write_b128 v236, v[112:115] offset:34816
  v_mfma_f32_16x16x32_bf16 v[72:75], v[40:43], a[164:167], v[72:75]
  ds_read_b64_tr_b16 v[62:63], v17 offset:47104
  v_add_f32 v168, 1.0, v168
  v_mfma_f32_16x16x32_bf16 v[72:75], v[44:47], a[180:183], v[72:75]
  v_rcp_f32 v168, v168
  v_mfma_f32_16x16x32_bf16 v[80:83], v[32:35], a[136:139], v[80:83]
  v_mul_f32 v120, v168, v120
  v_fmaak_f32 v169, v169, v20, 0xc0135761
  v_mfma_f32_16x16x32_bf16 v[80:83], v[36:39], a[152:155], v[80:83]
  v_mul_f32 v169, v169, v121
  v_mul_f32 v120, v120, v152
  v_mfma_f32_16x16x32_bf16 v[80:83], v[40:43], a[168:171], v[80:83]
  v_exp_f32 v169, v169
  v_mfma_f32_16x16x32_bf16 v[80:83], v[44:47], a[184:187], v[80:83]
  v_add_f32 v169, 1.0, v169
  v_mul_f32 v170, v122, v122
  v_mfma_f32_16x16x32_bf16 v[88:91], v[32:35], a[140:143], v[88:91]
  v_rcp_f32 v169, v169
  v_mfma_f32_16x16x32_bf16 v[88:91], v[36:39], a[156:159], v[88:91]
  v_mul_f32 v121, v169, v121
  v_fmaak_f32 v170, v170, v20, 0xc0135761
  v_mfma_f32_16x16x32_bf16 v[88:91], v[40:43], a[172:175], v[88:91]
  v_mul_f32 v170, v170, v122
  v_mul_f32 v121, v121, v153
  v_mfma_f32_16x16x32_bf16 v[88:91], v[44:47], a[188:191], v[88:91]
  s_waitcnt lgkmcnt(0)
  v_exp_f32 v170, v170
  v_mfma_f32_16x16x32_bf16 v[68:71], v[48:51], a[128:131], v[68:71]
  ds_read_b64_tr_b16 v[32:33], v14 offset:49152
  v_cvt_pk_bf16_f32 v120, v120, v121
  v_mfma_f32_16x16x32_bf16 v[68:71], v[52:55], a[144:147], v[68:71]
  ds_read_b64_tr_b16 v[34:35], v14 offset:51200
  v_readlane_b32 s88, v23, 43
  v_mfma_f32_16x16x32_bf16 v[68:71], v[56:59], a[160:163], v[68:71]
  ds_read_b64_tr_b16 v[36:37], v14 offset:53248
  v_add_f32 v170, 1.0, v170
  v_mfma_f32_16x16x32_bf16 v[68:71], v[60:63], a[176:179], v[68:71]
  ds_read_b64_tr_b16 v[38:39], v14 offset:55296
  v_mul_f32 v171, v123, v123
  v_mfma_f32_16x16x32_bf16 v[76:79], v[48:51], a[132:135], v[76:79]
  s_add_u32 m0, s9, 147456
  v_rcp_f32 v170, v170
  v_mfma_f32_16x16x32_bf16 v[76:79], v[52:55], a[148:151], v[76:79]
  ds_read_b64_tr_b16 v[40:41], v14 offset:57344
  buffer_load_dwordx4 v1, s[52:55], s88 offen lds
  v_mfma_f32_16x16x32_bf16 v[76:79], v[56:59], a[164:167], v[76:79]
  ds_read_b64_tr_b16 v[42:43], v14 offset:59392
  v_mul_f32 v122, v170, v122
  v_mfma_f32_16x16x32_bf16 v[76:79], v[60:63], a[180:183], v[76:79]
  v_fmaak_f32 v171, v171, v20, 0xc0135761
  v_mul_f32 v122, v122, v154
  v_mfma_f32_16x16x32_bf16 v[84:87], v[48:51], a[136:139], v[84:87]
  ds_read_b64_tr_b16 v[44:45], v14 offset:61440
  v_mul_f32 v171, v171, v123
  v_mfma_f32_16x16x32_bf16 v[84:87], v[52:55], a[152:155], v[84:87]
  ds_read_b64_tr_b16 v[46:47], v14 offset:63488
  buffer_load_dwordx4 v2, s[52:55], s88 offen offset:1024 lds
  v_mfma_f32_16x16x32_bf16 v[84:87], v[56:59], a[168:171], v[84:87]
  v_exp_f32 v171, v171
  v_mfma_f32_16x16x32_bf16 v[84:87], v[60:63], a[184:187], v[84:87]
  v_add_f32 v171, 1.0, v171
  v_mul_f32 v160, v124, v124
  v_mfma_f32_16x16x32_bf16 v[92:95], v[48:51], a[140:143], v[92:95]
  ds_read_b64_tr_b16 v[48:49], v17 offset:49152
  v_fmaak_f32 v160, v160, v20, 0xc0135761
  v_mfma_f32_16x16x32_bf16 v[92:95], v[52:55], a[156:159], v[92:95]
  ds_read_b64_tr_b16 v[50:51], v17 offset:51200
  v_mul_f32 v160, v160, v124
  v_mfma_f32_16x16x32_bf16 v[92:95], v[56:59], a[172:175], v[92:95]
  ds_read_b64_tr_b16 v[52:53], v17 offset:53248
  buffer_load_dwordx4 v3, s[52:55], s88 offen offset:2048 lds
  v_mfma_f32_16x16x32_bf16 v[92:95], v[60:63], a[188:191], v[92:95]
  s_waitcnt lgkmcnt(3)
  v_rcp_f32 v171, v171
  v_mfma_f32_16x16x32_bf16 v[64:67], v[32:35], a[192:195], v[64:67]
  ds_read_b64_tr_b16 v[54:55], v17 offset:55296
  v_mul_f32 v123, v171, v123
  v_mfma_f32_16x16x32_bf16 v[64:67], v[36:39], a[208:211], v[64:67]
  ds_read_b64_tr_b16 v[56:57], v17 offset:57344
  v_mul_f32 v123, v123, v155
  v_mfma_f32_16x16x32_bf16 v[64:67], v[40:43], a[224:227], v[64:67]
  v_exp_f32 v160, v160
  v_mfma_f32_16x16x32_bf16 v[64:67], v[44:47], a[240:243], v[64:67]
  ds_read_b64_tr_b16 v[58:59], v17 offset:59392
  buffer_load_dwordx4 v4, s[52:55], s88 offen offset:3072 lds
  v_mfma_f32_16x16x32_bf16 v[72:75], v[32:35], a[196:199], v[72:75]
  ds_read_b64_tr_b16 v[60:61], v17 offset:61440
  v_cvt_pk_bf16_f32 v121, v122, v123
  v_mfma_f32_16x16x32_bf16 v[72:75], v[36:39], a[212:215], v[72:75]
  v_add_f32 v160, 1.0, v160
  v_mul_f32 v161, v125, v125
  v_mfma_f32_16x16x32_bf16 v[72:75], v[40:43], a[228:231], v[72:75]
  ds_read_b64_tr_b16 v[62:63], v17 offset:63488
  v_fmaak_f32 v161, v161, v20, 0xc0135761
  v_mfma_f32_16x16x32_bf16 v[72:75], v[44:47], a[244:247], v[72:75]
  v_rcp_f32 v160, v160
  v_mfma_f32_16x16x32_bf16 v[80:83], v[32:35], a[200:203], v[80:83]
  v_mul_f32 v124, v160, v124
  v_mul_f32 v161, v161, v125
  v_mfma_f32_16x16x32_bf16 v[80:83], v[36:39], a[216:219], v[80:83]
  v_exp_f32 v161, v161
  v_mul_f32 v124, v124, v156
  v_mfma_f32_16x16x32_bf16 v[80:83], v[40:43], a[232:235], v[80:83]
  v_add_f32 v161, 1.0, v161
  v_mul_f32 v162, v126, v126
  v_mul_f32 v163, v127, v127
  v_mfma_f32_16x16x32_bf16 v[80:83], v[44:47], a[248:251], v[80:83]
  v_rcp_f32 v161, v161
  v_mfma_f32_16x16x32_bf16 v[88:91], v[32:35], a[204:207], v[88:91]
  v_mul_f32 v125, v161, v125
  v_fmaak_f32 v162, v162, v20, 0xc0135761
  v_mfma_f32_16x16x32_bf16 v[88:91], v[36:39], a[220:223], v[88:91]
  v_mul_f32 v162, v162, v126
  v_mul_f32 v125, v125, v157
  v_fmaak_f32 v163, v163, v20, 0xc0135761
  v_mfma_f32_16x16x32_bf16 v[88:91], v[40:43], a[236:239], v[88:91]
  v_exp_f32 v162, v162
  v_cvt_pk_bf16_f32 v122, v124, v125
  v_mfma_f32_16x16x32_bf16 v[88:91], v[44:47], a[252:255], v[88:91]
  s_waitcnt vmcnt(9) lgkmcnt(0)
  s_barrier
  v_mfma_f32_16x16x32_bf16 v[68:71], v[48:51], a[192:195], v[68:71]
  ds_read_b64_tr_b16 v[32:33], v13 offset:49152
  v_add_f32 v162, 1.0, v162
  v_mul_f32 v163, v163, v127
  v_mfma_f32_16x16x32_bf16 v[68:71], v[52:55], a[208:211], v[68:71]
  ds_read_b64_tr_b16 v[34:35], v13 offset:51200
  v_readlane_b32 s88, v23, 44
  v_mfma_f32_16x16x32_bf16 v[68:71], v[56:59], a[224:227], v[68:71]
  ds_read_b64_tr_b16 v[36:37], v16 offset:49152
  v_mfma_f32_16x16x32_bf16 v[68:71], v[60:63], a[240:243], v[68:71]
  ds_read_b64_tr_b16 v[38:39], v16 offset:51200
  v_exp_f32 v163, v163
  v_mfma_f32_16x16x32_bf16 v[76:79], v[48:51], a[196:199], v[76:79]
  s_add_u32 m0, s9, 98304
  v_rcp_f32 v162, v162
  v_mfma_f32_16x16x32_bf16 v[76:79], v[52:55], a[212:215], v[76:79]
  ds_read_b64_tr_b16 v[40:41], v13 offset:53248
  buffer_load_dwordx4 v1, s[52:55], s88 offen lds
  v_mfma_f32_16x16x32_bf16 v[76:79], v[56:59], a[228:231], v[76:79]
  ds_read_b64_tr_b16 v[42:43], v13 offset:55296
  v_add_f32 v163, 1.0, v163
  v_mfma_f32_16x16x32_bf16 v[76:79], v[60:63], a[244:247], v[76:79]
  v_rcp_f32 v163, v163
  v_mfma_f32_16x16x32_bf16 v[84:87], v[48:51], a[200:203], v[84:87]
  ds_read_b64_tr_b16 v[44:45], v16 offset:53248
  v_mul_f32 v126, v162, v126
  v_mfma_f32_16x16x32_bf16 v[84:87], v[52:55], a[216:219], v[84:87]
  ds_read_b64_tr_b16 v[46:47], v16 offset:55296
  buffer_load_dwordx4 v2, s[52:55], s88 offen offset:1024 lds
  v_mfma_f32_16x16x32_bf16 v[84:87], v[56:59], a[232:235], v[84:87]
  v_mul_f32 v127, v163, v127
  v_mul_f32 v126, v126, v158
  v_mfma_f32_16x16x32_bf16 v[84:87], v[60:63], a[248:251], v[84:87]
  v_mul_f32 v127, v127, v159
  v_mfma_f32_16x16x32_bf16 v[92:95], v[48:51], a[204:207], v[92:95]
  ds_read_b64_tr_b16 v[48:49], v13 offset:57344
  v_cvt_pk_bf16_f32 v123, v126, v127
  v_mfma_f32_16x16x32_bf16 v[92:95], v[52:55], a[220:223], v[92:95]
  ds_read_b64_tr_b16 v[50:51], v13 offset:59392
  v_mfma_f32_16x16x32_bf16 v[92:95], v[56:59], a[236:239], v[92:95]
  ds_read_b64_tr_b16 v[52:53], v16 offset:57344
  buffer_load_dwordx4 v3, s[52:55], s88 offen offset:2048 lds
  v_mfma_f32_16x16x32_bf16 v[92:95], v[60:63], a[252:255], v[92:95]
  s_waitcnt lgkmcnt(3)
  ds_write_b128 v236, v[120:123] offset:35840
  v_mfma_f32_16x16x32_bf16 v[64:67], v[32:35], v[172:175], v[64:67]
  ds_read_b64_tr_b16 v[54:55], v16 offset:59392
  v_mfma_f32_16x16x32_bf16 v[64:67], v[40:43], v[188:191], v[64:67]
  ds_read_b64_tr_b16 v[56:57], v13 offset:61440
  v_mfma_f32_16x16x32_bf16 v[72:75], v[32:35], v[176:179], v[72:75]
  v_mfma_f32_16x16x32_bf16 v[72:75], v[40:43], v[192:195], v[72:75]
  ds_read_b64_tr_b16 v[58:59], v13 offset:63488
  buffer_load_dwordx4 v4, s[52:55], s88 offen offset:3072 lds
  v_mfma_f32_16x16x32_bf16 v[80:83], v[32:35], v[180:183], v[80:83]
  ds_read_b64_tr_b16 v[60:61], v16 offset:61440
  v_mfma_f32_16x16x32_bf16 v[80:83], v[40:43], v[196:199], v[80:83]
  v_mfma_f32_16x16x32_bf16 v[88:91], v[32:35], v[184:187], v[88:91]
  ds_read_b64_tr_b16 v[62:63], v16 offset:63488
  v_mfma_f32_16x16x32_bf16 v[88:91], v[40:43], v[200:203], v[88:91]
  v_mfma_f32_16x16x32_bf16 v[68:71], v[36:39], v[172:175], v[68:71]
  v_mfma_f32_16x16x32_bf16 v[68:71], v[44:47], v[188:191], v[68:71]
  v_mfma_f32_16x16x32_bf16 v[76:79], v[36:39], v[176:179], v[76:79]
  v_mfma_f32_16x16x32_bf16 v[76:79], v[44:47], v[192:195], v[76:79]
  v_mfma_f32_16x16x32_bf16 v[84:87], v[36:39], v[180:183], v[84:87]
  v_mfma_f32_16x16x32_bf16 v[84:87], v[44:47], v[196:199], v[84:87]
  v_mfma_f32_16x16x32_bf16 v[92:95], v[36:39], v[184:187], v[92:95]
  v_mfma_f32_16x16x32_bf16 v[92:95], v[44:47], v[200:203], v[92:95]
  s_waitcnt lgkmcnt(0)
  v_mfma_f32_16x16x32_bf16 v[128:131], v[48:51], a[0:3], 0
  ds_read_b64_tr_b16 v[32:33], v15 offset:0
  v_mfma_f32_16x16x32_bf16 v[128:131], v[56:59], a[16:19], v[128:131]
  ds_read_b64_tr_b16 v[34:35], v15 offset:2048
  v_readlane_b32 s88, v22, 0
  v_mfma_f32_16x16x32_bf16 v[136:139], v[48:51], a[4:7], 0
  ds_read_b64_tr_b16 v[36:37], v15 offset:4096
  v_mfma_f32_16x16x32_bf16 v[136:139], v[56:59], a[20:23], v[136:139]
  ds_read_b64_tr_b16 v[38:39], v15 offset:6144
  v_mul_f32 v164, v64, v64
  v_mul_f32 v165, v65, v65
  v_mfma_f32_16x16x32_bf16 v[144:147], v[48:51], a[8:11], 0
  s_add_u32 m0, s9, 114688
  v_fmaak_f32 v164, v164, v20, 0xc0135761
  v_fmaak_f32 v165, v165, v20, 0xc0135761
  v_mul_f32 v166, v66, v66
  v_mfma_f32_16x16x32_bf16 v[144:147], v[56:59], a[24:27], v[144:147]
  ds_read_b64_tr_b16 v[40:41], v15 offset:8192
  buffer_load_dwordx4 v5, s[60:63], s88 offen lds
  v_mul_f32 v164, v164, v64
  v_mfma_f32_16x16x32_bf16 v[152:155], v[48:51], a[12:15], 0
  ds_read_b64_tr_b16 v[42:43], v15 offset:10240
  v_exp_f32 v164, v164
  v_mfma_f32_16x16x32_bf16 v[152:155], v[56:59], a[28:31], v[152:155]
  v_add_f32 v164, 1.0, v164
  v_mul_f32 v165, v165, v65
  v_fmaak_f32 v166, v166, v20, 0xc0135761
  v_mfma_f32_16x16x32_bf16 v[132:135], v[52:55], a[0:3], 0
  ds_read_b64_tr_b16 v[44:45], v15 offset:12288
  v_rcp_f32 v164, v164
  v_mfma_f32_16x16x32_bf16 v[132:135], v[60:63], a[16:19], v[132:135]
  ds_read_b64_tr_b16 v[46:47], v15 offset:14336
  buffer_load_dwordx4 v6, s[60:63], s88 offen offset:1024 lds
  v_mul_f32 v64, v164, v64
  v_mfma_f32_16x16x32_bf16 v[140:143], v[52:55], a[4:7], 0
  v_exp_f32 v165, v165
  v_mul_f32 v166, v166, v66
  v_mfma_f32_16x16x32_bf16 v[140:143], v[60:63], a[20:23], v[140:143]
  v_exp_f32 v166, v166
  v_add_f32 v165, 1.0, v165
  v_mfma_f32_16x16x32_bf16 v[148:151], v[52:55], a[8:11], 0
  ds_read_b64_tr_b16 v[48:49], v18 offset:0
  v_rcp_f32 v165, v165
  v_mfma_f32_16x16x32_bf16 v[148:151], v[60:63], a[24:27], v[148:151]
  ds_read_b64_tr_b16 v[50:51], v18 offset:2048
  v_mul_f32 v65, v165, v65
  v_add_f32 v166, 1.0, v166
  v_mfma_f32_16x16x32_bf16 v[156:159], v[52:55], a[12:15], 0
  ds_read_b64_tr_b16 v[52:53], v18 offset:4096
  buffer_load_dwordx4 v7, s[60:63], s88 offen offset:2048 lds
  v_mul_f32 v167, v67, v67
  v_mfma_f32_16x16x32_bf16 v[156:159], v[60:63], a[28:31], v[156:159]
  s_waitcnt lgkmcnt(3)
  v_rcp_f32 v166, v166
  v_fmaak_f32 v167, v167, v20, 0xc0135761
  v_mfma_f32_16x16x32_bf16 v[128:131], v[32:35], a[32:35], v[128:131]
  ds_read_b64_tr_b16 v[54:55], v18 offset:6144
  v_mul_f32 v66, v166, v66
  v_mul_f32 v167, v167, v67
  v_mfma_f32_16x16x32_bf16 v[128:131], v[36:39], a[48:51], v[128:131]
  ds_read_b64_tr_b16 v[56:57], v18 offset:8192
  v_exp_f32 v167, v167
  v_mfma_f32_16x16x32_bf16 v[128:131], v[40:43], a[64:67], v[128:131]
  v_add_f32 v167, 1.0, v167
  v_mul_f32 v168, v68, v68
  v_mul_f32 v169, v69, v69
  v_mfma_f32_16x16x32_bf16 v[128:131], v[44:47], a[80:83], v[128:131]
  ds_read_b64_tr_b16 v[58:59], v18 offset:10240
  buffer_load_dwordx4 v8, s[60:63], s88 offen offset:3072 lds
  v_mfma_f32_16x16x32_bf16 v[136:139], v[32:35], a[36:39], v[136:139]
  ds_read_b64_tr_b16 v[60:61], v18 offset:12288
  v_fmaak_f32 v168, v168, v20, 0xc0135761
  v_mfma_f32_16x16x32_bf16 v[136:139], v[36:39], a[52:55], v[136:139]
  v_rcp_f32 v167, v167
  v_mfma_f32_16x16x32_bf16 v[136:139], v[40:43], a[68:71], v[136:139]
  ds_read_b64_tr_b16 v[62:63], v18 offset:14336
  v_mul_f32 v67, v167, v67
  v_mfma_f32_16x16x32_bf16 v[136:139], v[44:47], a[84:87], v[136:139]
  v_mul_f32 v168, v168, v68
  v_fmaak_f32 v169, v169, v20, 0xc0135761
  v_mfma_f32_16x16x32_bf16 v[144:147], v[32:35], a[40:43], v[144:147]
  v_exp_f32 v168, v168
  v_mfma_f32_16x16x32_bf16 v[144:147], v[36:39], a[56:59], v[144:147]
  v_add_f32 v168, 1.0, v168
  v_mul_f32 v169, v169, v69
  v_mfma_f32_16x16x32_bf16 v[144:147], v[40:43], a[72:75], v[144:147]
  v_rcp_f32 v168, v168
  v_mfma_f32_16x16x32_bf16 v[144:147], v[44:47], a[88:91], v[144:147]
  v_exp_f32 v169, v169
  v_mfma_f32_16x16x32_bf16 v[152:155], v[32:35], a[44:47], v[152:155]
  v_mul_f32 v68, v168, v68
  v_add_f32 v169, 1.0, v169
  v_mfma_f32_16x16x32_bf16 v[152:155], v[36:39], a[60:63], v[152:155]
  v_rcp_f32 v169, v169
  v_mfma_f32_16x16x32_bf16 v[152:155], v[40:43], a[76:79], v[152:155]
  v_mul_f32 v69, v169, v69
  v_mul_f32 v170, v70, v70
  v_mfma_f32_16x16x32_bf16 v[152:155], v[44:47], a[92:95], v[152:155]
  s_waitcnt vmcnt(8) lgkmcnt(0)
  s_barrier
  v_mfma_f32_16x16x32_bf16 v[132:135], v[48:51], a[32:35], v[132:135]
  ds_read_b64_tr_b16 v[32:33], v14 offset:16384
  v_fmaak_f32 v170, v170, v20, 0xc0135761
  v_mfma_f32_16x16x32_bf16 v[132:135], v[52:55], a[48:51], v[132:135]
  ds_read_b64_tr_b16 v[34:35], v14 offset:18432
  v_readlane_b32 s88, v22, 1
  v_mfma_f32_16x16x32_bf16 v[132:135], v[56:59], a[64:67], v[132:135]
  ds_read_b64_tr_b16 v[36:37], v14 offset:20480
  v_mul_f32 v170, v170, v70
  v_mfma_f32_16x16x32_bf16 v[132:135], v[60:63], a[80:83], v[132:135]
  ds_read_b64_tr_b16 v[38:39], v14 offset:22528
  v_mul_f32 v171, v71, v71
  v_mfma_f32_16x16x32_bf16 v[140:143], v[48:51], a[36:39], v[140:143]
  s_add_u32 m0, s9, 131072
  v_exp_f32 v170, v170
  v_mfma_f32_16x16x32_bf16 v[140:143], v[52:55], a[52:55], v[140:143]
  ds_read_b64_tr_b16 v[40:41], v14 offset:24576
  buffer_load_dwordx4 v5, s[60:63], s88 offen lds
  v_mfma_f32_16x16x32_bf16 v[140:143], v[56:59], a[68:71], v[140:143]
  ds_read_b64_tr_b16 v[42:43], v14 offset:26624
  v_add_f32 v170, 1.0, v170
  v_mfma_f32_16x16x32_bf16 v[140:143], v[60:63], a[84:87], v[140:143]
  v_rcp_f32 v170, v170
  v_mfma_f32_16x16x32_bf16 v[148:151], v[48:51], a[40:43], v[148:151]
  ds_read_b64_tr_b16 v[44:45], v14 offset:28672
  v_mul_f32 v70, v170, v70
  v_mfma_f32_16x16x32_bf16 v[148:151], v[52:55], a[56:59], v[148:151]
  ds_read_b64_tr_b16 v[46:47], v14 offset:30720
  buffer_load_dwordx4 v6, s[60:63], s88 offen offset:1024 lds
  v_mfma_f32_16x16x32_bf16 v[148:151], v[56:59], a[72:75], v[148:151]
  v_fmaak_f32 v171, v171, v20, 0xc0135761
  v_mul_f32 v160, v72, v72
  v_mfma_f32_16x16x32_bf16 v[148:151], v[60:63], a[88:91], v[148:151]
  v_mul_f32 v171, v171, v71
  v_fmaak_f32 v160, v160, v20, 0xc0135761
  v_mfma_f32_16x16x32_bf16 v[156:159], v[48:51], a[44:47], v[156:159]
  ds_read_b64_tr_b16 v[48:49], v17 offset:16384
  v_mul_f32 v160, v160, v72
  v_mfma_f32_16x16x32_bf16 v[156:159], v[52:55], a[60:63], v[156:159]
  ds_read_b64_tr_b16 v[50:51], v17 offset:18432
  v_mul_f32 v161, v73, v73
  v_mfma_f32_16x16x32_bf16 v[156:159], v[56:59], a[76:79], v[156:159]
  ds_read_b64_tr_b16 v[52:53], v17 offset:20480
  buffer_load_dwordx4 v7, s[60:63], s88 offen offset:2048 lds
  v_mfma_f32_16x16x32_bf16 v[156:159], v[60:63], a[92:95], v[156:159]
  s_waitcnt lgkmcnt(3)
  v_exp_f32 v171, v171
  v_mfma_f32_16x16x32_bf16 v[128:131], v[32:35], a[96:99], v[128:131]
  ds_read_b64_tr_b16 v[54:55], v17 offset:22528
  v_add_f32 v171, 1.0, v171
  v_mfma_f32_16x16x32_bf16 v[128:131], v[36:39], a[112:115], v[128:131]
  ds_read_b64_tr_b16 v[56:57], v17 offset:24576
  v_fmaak_f32 v161, v161, v20, 0xc0135761
  v_mfma_f32_16x16x32_bf16 v[128:131], v[40:43], a[128:131], v[128:131]
  v_rcp_f32 v171, v171
  v_mfma_f32_16x16x32_bf16 v[128:131], v[44:47], a[144:147], v[128:131]
  ds_read_b64_tr_b16 v[58:59], v17 offset:26624
  buffer_load_dwordx4 v8, s[60:63], s88 offen offset:3072 lds
  v_mfma_f32_16x16x32_bf16 v[136:139], v[32:35], a[100:103], v[136:139]
  ds_read_b64_tr_b16 v[60:61], v17 offset:28672
  v_mul_f32 v71, v171, v71
  v_mfma_f32_16x16x32_bf16 v[136:139], v[36:39], a[116:119], v[136:139]
  v_exp_f32 v160, v160
  v_mfma_f32_16x16x32_bf16 v[136:139], v[40:43], a[132:135], v[136:139]
  ds_read_b64_tr_b16 v[62:63], v17 offset:30720
  v_add_f32 v160, 1.0, v160
  v_mfma_f32_16x16x32_bf16 v[136:139], v[44:47], a[148:151], v[136:139]
  v_rcp_f32 v160, v160
  v_mfma_f32_16x16x32_bf16 v[144:147], v[32:35], a[104:107], v[144:147]
  v_mul_f32 v72, v160, v72
  v_mul_f32 v161, v161, v73
  v_mfma_f32_16x16x32_bf16 v[144:147], v[36:39], a[120:123], v[144:147]
  v_exp_f32 v161, v161
  v_mfma_f32_16x16x32_bf16 v[144:147], v[40:43], a[136:139], v[144:147]
  v_add_f32 v161, 1.0, v161
  v_mul_f32 v162, v74, v74
  v_mfma_f32_16x16x32_bf16 v[144:147], v[44:47], a[152:155], v[144:147]
  v_rcp_f32 v161, v161
  v_mfma_f32_16x16x32_bf16 v[152:155], v[32:35], a[108:111], v[152:155]
  v_mul_f32 v73, v161, v73
  v_fmaak_f32 v162, v162, v20, 0xc0135761
  v_mfma_f32_16x16x32_bf16 v[152:155], v[36:39], a[124:127], v[152:155]
  v_mul_f32 v162, v162, v74
  v_mul_f32 v163, v75, v75
  v_mfma_f32_16x16x32_bf16 v[152:155], v[40:43], a[140:143], v[152:155]
  v_exp_f32 v162, v162
  v_mfma_f32_16x16x32_bf16 v[152:155], v[44:47], a[156:159], v[152:155]
  s_waitcnt lgkmcnt(0)
  v_add_f32 v162, 1.0, v162
  v_fmaak_f32 v163, v163, v20, 0xc0135761
  v_mfma_f32_16x16x32_bf16 v[132:135], v[48:51], a[96:99], v[132:135]
  ds_read_b64_tr_b16 v[32:33], v15 offset:16384
  v_mul_f32 v163, v163, v75
  v_mfma_f32_16x16x32_bf16 v[132:135], v[52:55], a[112:115], v[132:135]
  ds_read_b64_tr_b16 v[34:35], v15 offset:18432
  v_mul_f32 v164, v76, v76
  v_mfma_f32_16x16x32_bf16 v[132:135], v[56:59], a[128:131], v[132:135]
  ds_read_b64_tr_b16 v[36:37], v15 offset:20480
  v_fmaak_f32 v164, v164, v20, 0xc0135761
  v_mfma_f32_16x16x32_bf16 v[132:135], v[60:63], a[144:147], v[132:135]
  ds_read_b64_tr_b16 v[38:39], v15 offset:22528
  v_mul_f32 v164, v164, v76
  v_mfma_f32_16x16x32_bf16 v[140:143], v[48:51], a[100:103], v[140:143]
  v_rcp_f32 v162, v162
  v_mfma_f32_16x16x32_bf16 v[140:143], v[52:55], a[116:119], v[140:143]
  ds_read_b64_tr_b16 v[40:41], v15 offset:24576
  v_mul_f32 v74, v162, v74
  v_mfma_f32_16x16x32_bf16 v[140:143], v[56:59], a[132:135], v[140:143]
  ds_read_b64_tr_b16 v[42:43], v15 offset:26624
  v_mul_f32 v165, v77, v77
  v_mfma_f32_16x16x32_bf16 v[140:143], v[60:63], a[148:151], v[140:143]
  v_exp_f32 v163, v163
  v_mfma_f32_16x16x32_bf16 v[148:151], v[48:51], a[104:107], v[148:151]
  ds_read_b64_tr_b16 v[44:45], v15 offset:28672
  v_add_f32 v163, 1.0, v163
  v_mfma_f32_16x16x32_bf16 v[148:151], v[52:55], a[120:123], v[148:151]
  ds_read_b64_tr_b16 v[46:47], v15 offset:30720
  v_fmaak_f32 v165, v165, v20, 0xc0135761
  v_mfma_f32_16x16x32_bf16 v[148:151], v[56:59], a[136:139], v[148:151]
  v_rcp_f32 v163, v163
  v_mfma_f32_16x16x32_bf16 v[148:151], v[60:63], a[152:155], v[148:151]
  v_exp_f32 v164, v164
  v_mfma_f32_16x16x32_bf16 v[156:159], v[48:51], a[108:111], v[156:159]
  ds_read_b64_tr_b16 v[48:49], v18 offset:16384
  v_mul_f32 v75, v163, v75
  v_mfma_f32_16x16x32_bf16 v[156:159], v[52:55], a[124:127], v[156:159]
  ds_read_b64_tr_b16 v[50:51], v18 offset:18432
  v_add_f32 v164, 1.0, v164
  v_mfma_f32_16x16x32_bf16 v[156:159], v[56:59], a[140:143], v[156:159]
  ds_read_b64_tr_b16 v[52:53], v18 offset:20480
  v_mul_f32 v165, v165, v77
  v_mfma_f32_16x16x32_bf16 v[156:159], v[60:63], a[156:159], v[156:159]
  s_waitcnt lgkmcnt(3)
  v_rcp_f32 v164, v164
  v_mfma_f32_16x16x32_bf16 v[128:131], v[32:35], a[160:163], v[128:131]
  ds_read_b64_tr_b16 v[54:55], v18 offset:22528
  v_mul_f32 v76, v164, v76
  v_mfma_f32_16x16x32_bf16 v[128:131], v[36:39], a[176:179], v[128:131]
  ds_read_b64_tr_b16 v[56:57], v18 offset:24576
  v_mul_f32 v166, v78, v78
  v_mfma_f32_16x16x32_bf16 v[128:131], v[40:43], a[192:195], v[128:131]
  v_exp_f32 v165, v165
  v_mfma_f32_16x16x32_bf16 v[128:131], v[44:47], a[208:211], v[128:131]
  ds_read_b64_tr_b16 v[58:59], v18 offset:26624
  v_add_f32 v165, 1.0, v165
  v_mfma_f32_16x16x32_bf16 v[136:139], v[32:35], a[164:167], v[136:139]
  ds_read_b64_tr_b16 v[60:61], v18 offset:28672
  v_fmaak_f32 v166, v166, v20, 0xc0135761
  v_mfma_f32_16x16x32_bf16 v[136:139], v[36:39], a[180:183], v[136:139]
  v_rcp_f32 v165, v165
  v_mfma_f32_16x16x32_bf16 v[136:139], v[40:43], a[196:199], v[136:139]
  ds_read_b64_tr_b16 v[62:63], v18 offset:30720
  v_mul_f32 v77, v165, v77
  v_mfma_f32_16x16x32_bf16 v[136:139], v[44:47], a[212:215], v[136:139]
  v_mul_f32 v166, v166, v78
  ds_read_b128 a[0:3], v19 offset:0
  v_mfma_f32_16x16x32_bf16 v[144:147], v[32:35], a[168:171], v[144:147]
  v_exp_f32 v166, v166
  v_mfma_f32_16x16x32_bf16 v[144:147], v[36:39], a[184:187], v[144:147]
  v_add_f32 v166, 1.0, v166
  ds_read_b128 a[4:7], v19 offset:1024
  v_mfma_f32_16x16x32_bf16 v[144:147], v[40:43], a[200:203], v[144:147]
  v_rcp_f32 v166, v166
  v_mfma_f32_16x16x32_bf16 v[144:147], v[44:47], a[216:219], v[144:147]
  v_mul_f32 v78, v166, v78
  v_mul_f32 v167, v79, v79
  v_mfma_f32_16x16x32_bf16 v[152:155], v[32:35], a[172:175], v[152:155]
  v_fmaak_f32 v167, v167, v20, 0xc0135761
  v_mul_f32 v168, v80, v80
  v_mfma_f32_16x16x32_bf16 v[152:155], v[36:39], a[188:191], v[152:155]
  v_mul_f32 v167, v167, v79
  v_fmaak_f32 v168, v168, v20, 0xc0135761
  v_mfma_f32_16x16x32_bf16 v[152:155], v[40:43], a[204:207], v[152:155]
  v_exp_f32 v167, v167
  v_mfma_f32_16x16x32_bf16 v[152:155], v[44:47], a[220:223], v[152:155]
  s_waitcnt vmcnt(4) lgkmcnt(0)
  s_barrier
  v_mfma_f32_16x16x32_bf16 v[132:135], v[48:51], a[160:163], v[132:135]
  ds_read_b64_tr_b16 v[32:33], v14 offset:32768
  ds_read_b128 a[8:11], v19 offset:2048
  v_mfma_f32_16x16x32_bf16 v[132:135], v[52:55], a[176:179], v[132:135]
  ds_read_b64_tr_b16 v[34:35], v14 offset:34816
  v_readlane_b32 s88, v22, 2
  v_mfma_f32_16x16x32_bf16 v[132:135], v[56:59], a[192:195], v[132:135]
  ds_read_b64_tr_b16 v[36:37], v14 offset:36864
  ds_read_b128 a[12:15], v19 offset:3072
  v_mfma_f32_16x16x32_bf16 v[132:135], v[60:63], a[208:211], v[132:135]
  ds_read_b64_tr_b16 v[38:39], v14 offset:38912
  ds_read_b128 a[16:19], v19 offset:8192
  v_mfma_f32_16x16x32_bf16 v[140:143], v[48:51], a[164:167], v[140:143]
  s_add_u32 m0, s9, 81920
  ds_read_b128 a[20:23], v19 offset:9216
  ds_read_b128 a[24:27], v19 offset:10240
  v_mfma_f32_16x16x32_bf16 v[140:143], v[52:55], a[180:183], v[140:143]
  ds_read_b64_tr_b16 v[40:41], v14 offset:40960
  buffer_load_dwordx4 v5, s[60:63], s88 offen lds
  v_mfma_f32_16x16x32_bf16 v[140:143], v[56:59], a[196:199], v[140:143]
  ds_read_b64_tr_b16 v[42:43], v14 offset:43008
  buffer_load_dwordx4 v6, s[60:63], s88 offen offset:1024 lds
  v_mfma_f32_16x16x32_bf16 v[140:143], v[60:63], a[212:215], v[140:143]
  ds_read_b128 a[28:31], v19 offset:11264
  v_add_f32 v167, 1.0, v167
  v_mfma_f32_16x16x32_bf16 v[148:151], v[48:51], a[168:171], v[148:151]
  ds_read_b64_tr_b16 v[44:45], v14 offset:45056
  ds_read_b128 a[32:35], v19 offset:16384
  v_mfma_f32_16x16x32_bf16 v[148:151], v[52:55], a[184:187], v[148:151]
  ds_read_b64_tr_b16 v[46:47], v14 offset:47104
  buffer_load_dwordx4 v7, s[60:63], s88 offen offset:2048 lds
  v_mfma_f32_16x16x32_bf16 v[148:151], v[56:59], a[200:203], v[148:151]
  v_rcp_f32 v167, v167
  v_mfma_f32_16x16x32_bf16 v[148:151], v[60:63], a[216:219], v[148:151]
  v_mul_f32 v79, v167, v79
  ds_read_b128 a[36:39], v19 offset:17408
  v_mfma_f32_16x16x32_bf16 v[156:159], v[48:51], a[172:175], v[156:159]
  ds_read_b64_tr_b16 v[48:49], v17 offset:32768
  buffer_load_dwordx4 v8, s[60:63], s88 offen offset:3072 lds
  v_readlane_b32 s88, v22, 3
  s_add_u32 m0, s9, 147456
  v_mfma_f32_16x16x32_bf16 v[156:159], v[52:55], a[188:191], v[156:159]
  ds_read_b64_tr_b16 v[50:51], v17 offset:34816
  ds_read_b128 a[40:43], v19 offset:18432
  v_mfma_f32_16x16x32_bf16 v[156:159], v[56:59], a[204:207], v[156:159]
  ds_read_b64_tr_b16 v[52:53], v17 offset:36864
  buffer_load_dwordx4 v5, s[60:63], s88 offen lds
  v_mfma_f32_16x16x32_bf16 v[156:159], v[60:63], a[220:223], v[156:159]
  s_waitcnt lgkmcnt(5)
  ds_read_b128 a[44:47], v19 offset:19456
  ds_read_b128 a[48:51], v19 offset:24576
  v_mfma_f32_16x16x32_bf16 v[128:131], v[32:35], a[224:227], v[128:131]
  ds_read_b64_tr_b16 v[54:55], v17 offset:38912
  buffer_load_dwordx4 v6, s[60:63], s88 offen offset:1024 lds
  v_mfma_f32_16x16x32_bf16 v[128:131], v[36:39], a[240:243], v[128:131]
  ds_read_b64_tr_b16 v[56:57], v17 offset:40960
  ds_read_b128 a[52:55], v19 offset:25600
  v_mfma_f32_16x16x32_bf16 v[128:131], v[40:43], v[172:175], v[128:131]
  ds_read_b128 a[56:59], v19 offset:26624
  ds_read_b128 a[60:63], v19 offset:27648
  v_mfma_f32_16x16x32_bf16 v[128:131], v[44:47], v[188:191], v[128:131]
  ds_read_b64_tr_b16 v[58:59], v17 offset:43008
  buffer_load_dwordx4 v7, s[60:63], s88 offen offset:2048 lds
  v_mfma_f32_16x16x32_bf16 v[136:139], v[32:35], a[228:231], v[136:139]
  ds_read_b64_tr_b16 v[60:61], v17 offset:45056
  buffer_load_dwordx4 v8, s[60:63], s88 offen offset:3072 lds
  v_mfma_f32_16x16x32_bf16 v[136:139], v[36:39], a[244:247], v[136:139]
  v_mul_f32 v168, v168, v80
  v_mul_f32 v169, v81, v81
  v_mfma_f32_16x16x32_bf16 v[136:139], v[40:43], v[176:179], v[136:139]
  ds_read_b64_tr_b16 v[62:63], v17 offset:47104
  v_fmaak_f32 v169, v169, v20, 0xc0135761
  v_mfma_f32_16x16x32_bf16 v[136:139], v[44:47], v[192:195], v[136:139]
  v_exp_f32 v168, v168
  v_mfma_f32_16x16x32_bf16 v[144:147], v[32:35], a[232:235], v[144:147]
PAD7:
  s_cbranch_execz PAD11
  v_add_f32 v168, 1.0, v168
  v_mul_f32 v169, v169, v81
  v_mfma_f32_16x16x32_bf16 v[144:147], v[36:39], a[248:251], v[144:147]
  v_rcp_f32 v168, v168
  v_mfma_f32_16x16x32_bf16 v[144:147], v[40:43], v[180:183], v[144:147]
  v_exp_f32 v169, v169
  v_mfma_f32_16x16x32_bf16 v[144:147], v[44:47], v[196:199], v[144:147]
  v_mul_f32 v80, v168, v80
  v_add_f32 v169, 1.0, v169
  v_mfma_f32_16x16x32_bf16 v[152:155], v[32:35], a[236:239], v[152:155]
  v_rcp_f32 v169, v169
  v_mfma_f32_16x16x32_bf16 v[152:155], v[36:39], a[252:255], v[152:155]
  v_mul_f32 v81, v169, v81
  ds_read_b128 a[64:67], v19 offset:32768
  v_mfma_f32_16x16x32_bf16 v[152:155], v[40:43], v[184:187], v[152:155]
  ds_read_b128 a[68:71], v19 offset:33792
  ds_read_b128 a[72:75], v19 offset:34816
  v_mfma_f32_16x16x32_bf16 v[152:155], v[44:47], v[200:203], v[152:155]
  s_waitcnt lgkmcnt(3)
  ds_read_b128 a[76:79], v19 offset:35840
  ds_read_b128 a[80:83], v19 offset:40960
  v_mfma_f32_16x16x32_bf16 v[132:135], v[48:51], a[224:227], v[132:135]
  ds_read_b64_tr_b16 v[32:33], v14 offset:49152
  ds_read_b128 a[84:87], v19 offset:41984
  v_mfma_f32_16x16x32_bf16 v[132:135], v[52:55], a[240:243], v[132:135]
  ds_read_b64_tr_b16 v[34:35], v14 offset:51200
  ds_read_b128 a[88:91], v19 offset:43008
  v_mfma_f32_16x16x32_bf16 v[132:135], v[56:59], v[172:175], v[132:135]
  ds_read_b64_tr_b16 v[36:37], v14 offset:53248
  ds_read_b128 a[92:95], v19 offset:44032
  v_mfma_f32_16x16x32_bf16 v[132:135], v[60:63], v[188:191], v[132:135]
  ds_read_b64_tr_b16 v[38:39], v14 offset:55296
  ds_read_b128 a[128:131], v237 offset:0
  v_mfma_f32_16x16x32_bf16 v[140:143], v[48:51], a[228:231], v[140:143]
  ds_read_b128 a[132:135], v237 offset:1024
  ds_read_b128 a[136:139], v237 offset:2048
  v_mfma_f32_16x16x32_bf16 v[140:143], v[52:55], a[244:247], v[140:143]
  ds_read_b64_tr_b16 v[40:41], v14 offset:57344
  ds_read_b128 a[140:143], v237 offset:3072
  v_mfma_f32_16x16x32_bf16 v[140:143], v[56:59], v[176:179], v[140:143]
  ds_read_b64_tr_b16 v[42:43], v14 offset:59392
  v_mul_f32 v170, v82, v82
  v_mfma_f32_16x16x32_bf16 v[140:143], v[60:63], v[192:195], v[140:143]
  v_fmaak_f32 v170, v170, v20, 0xc0135761
  v_mul_f32 v171, v83, v83
  v_mfma_f32_16x16x32_bf16 v[148:151], v[48:51], a[232:235], v[148:151]
  ds_read_b64_tr_b16 v[44:45], v14 offset:61440
  v_mul_f32 v170, v170, v82
  v_mfma_f32_16x16x32_bf16 v[148:151], v[52:55], a[248:251], v[148:151]
  ds_read_b64_tr_b16 v[46:47], v14 offset:63488
  v_fmaak_f32 v171, v171, v20, 0xc0135761
  v_mfma_f32_16x16x32_bf16 v[148:151], v[56:59], v[180:183], v[148:151]
  v_exp_f32 v170, v170
  v_mfma_f32_16x16x32_bf16 v[148:151], v[60:63], v[196:199], v[148:151]
  v_add_f32 v170, 1.0, v170
  v_mul_f32 v171, v171, v83
  v_mfma_f32_16x16x32_bf16 v[156:159], v[48:51], a[236:239], v[156:159]
  ds_read_b64_tr_b16 v[48:49], v17 offset:49152
  v_mul_f32 v160, v84, v84
  v_mfma_f32_16x16x32_bf16 v[156:159], v[52:55], a[252:255], v[156:159]
  ds_read_b64_tr_b16 v[50:51], v17 offset:51200
  v_fmaak_f32 v160, v160, v20, 0xc0135761
  v_mfma_f32_16x16x32_bf16 v[156:159], v[56:59], v[184:187], v[156:159]
  ds_read_b64_tr_b16 v[52:53], v17 offset:53248
  v_mul_f32 v160, v160, v84
  v_mfma_f32_16x16x32_bf16 v[156:159], v[60:63], v[200:203], v[156:159]
  s_waitcnt lgkmcnt(3)
  v_rcp_f32 v170, v170
  v_mfma_f32_16x16x32_bf16 v[96:99], v[32:35], a[0:3], 0
  ds_read_b64_tr_b16 v[54:55], v17 offset:55296
  v_mul_f32 v82, v170, v82
  v_mfma_f32_16x16x32_bf16 v[96:99], v[36:39], a[16:19], v[96:99]
  ds_read_b64_tr_b16 v[56:57], v17 offset:57344
  v_mul_f32 v161, v85, v85
  v_mfma_f32_16x16x32_bf16 v[96:99], v[40:43], a[32:35], v[96:99]
  v_exp_f32 v171, v171
  v_mfma_f32_16x16x32_bf16 v[96:99], v[44:47], a[48:51], v[96:99]
  ds_read_b64_tr_b16 v[58:59], v17 offset:59392
  v_mul_f32 v64, v64, v128
  v_mfma_f32_16x16x32_bf16 v[104:107], v[32:35], a[4:7], 0
  ds_read_b64_tr_b16 v[60:61], v17 offset:61440
  v_mul_f32 v65, v65, v129
  v_mfma_f32_16x16x32_bf16 v[104:107], v[36:39], a[20:23], v[104:107]
  v_exp_f32 v160, v160
  v_mfma_f32_16x16x32_bf16 v[104:107], v[40:43], a[36:39], v[104:107]
  ds_read_b64_tr_b16 v[62:63], v17 offset:63488
  v_cvt_pk_bf16_f32 v64, v64, v65
  v_mfma_f32_16x16x32_bf16 v[104:107], v[44:47], a[52:55], v[104:107]
  v_mul_f32 v66, v66, v130
  v_mul_f32 v67, v67, v131
  v_mfma_f32_16x16x32_bf16 v[112:115], v[32:35], a[8:11], 0
  v_cvt_pk_bf16_f32 v65, v66, v67
  v_mul_f32 v68, v68, v132
  v_mfma_f32_16x16x32_bf16 v[112:115], v[36:39], a[24:27], v[112:115]
  v_mul_f32 v69, v69, v133
  v_mul_f32 v70, v70, v134
  v_mfma_f32_16x16x32_bf16 v[112:115], v[40:43], a[40:43], v[112:115]
  v_cvt_pk_bf16_f32 v66, v68, v69
  v_mul_f32 v71, v71, v135
  v_mfma_f32_16x16x32_bf16 v[112:115], v[44:47], a[56:59], v[112:115]
  buffer_load_dword v252, v249, s[68:71], 0 offen sc1
  v_cvt_pk_bf16_f32 v67, v70, v71
  v_mfma_f32_16x16x32_bf16 v[120:123], v[32:35], a[12:15], 0
  v_mul_f32 v72, v72, v136
  v_mul_f32 v73, v73, v137
  v_mfma_f32_16x16x32_bf16 v[120:123], v[36:39], a[28:31], v[120:123]
  v_cvt_pk_bf16_f32 v72, v72, v73
  v_mul_f32 v74, v74, v138
  v_mfma_f32_16x16x32_bf16 v[120:123], v[40:43], a[44:47], v[120:123]
  v_mul_f32 v75, v75, v139
  v_mul_f32 v76, v76, v140
  v_mfma_f32_16x16x32_bf16 v[120:123], v[44:47], a[60:63], v[120:123]
  s_waitcnt vmcnt(5) lgkmcnt(0)
  s_barrier
  v_mfma_f32_16x16x32_bf16 v[100:103], v[48:51], a[0:3], 0
  ds_read_b64_tr_b16 v[32:33], v15 offset:0
  v_cvt_pk_bf16_f32 v73, v74, v75
  v_mfma_f32_16x16x32_bf16 v[100:103], v[52:55], a[16:19], v[100:103]
  ds_read_b64_tr_b16 v[34:35], v15 offset:2048
  v_readlane_b32 s88, v22, 4
  v_mfma_f32_16x16x32_bf16 v[100:103], v[56:59], a[32:35], v[100:103]
  ds_read_b64_tr_b16 v[36:37], v15 offset:4096
  v_mul_f32 v77, v77, v141
  v_mfma_f32_16x16x32_bf16 v[100:103], v[60:63], a[48:51], v[100:103]
  ds_read_b64_tr_b16 v[38:39], v15 offset:6144
  v_cvt_pk_bf16_f32 v74, v76, v77
  v_mfma_f32_16x16x32_bf16 v[108:111], v[48:51], a[4:7], 0
  s_add_u32 m0, s9, 0
  ds_write_b128 v236, v[64:67] offset:49152
  v_mfma_f32_16x16x32_bf16 v[108:111], v[52:55], a[20:23], v[108:111]
  ds_read_b64_tr_b16 v[40:41], v15 offset:8192
  buffer_load_dwordx4 v5, s[60:63], s88 offen lds
  v_mfma_f32_16x16x32_bf16 v[108:111], v[56:59], a[36:39], v[108:111]
  ds_read_b64_tr_b16 v[42:43], v15 offset:10240
  buffer_load_dwordx4 v6, s[60:63], s88 offen offset:1024 lds
  v_mfma_f32_16x16x32_bf16 v[108:111], v[60:63], a[52:55], v[108:111]
  v_mul_f32 v78, v78, v142
  v_mul_f32 v79, v79, v143
  v_mfma_f32_16x16x32_bf16 v[116:119], v[48:51], a[8:11], 0
  ds_read_b64_tr_b16 v[44:45], v15 offset:12288
  v_cvt_pk_bf16_f32 v75, v78, v79
  v_mfma_f32_16x16x32_bf16 v[116:119], v[52:55], a[24:27], v[116:119]
  ds_read_b64_tr_b16 v[46:47], v15 offset:14336
  buffer_load_dwordx4 v7, s[60:63], s88 offen offset:2048 lds
  v_mfma_f32_16x16x32_bf16 v[116:119], v[56:59], a[40:43], v[116:119]
  ds_write_b128 v236, v[72:75] offset:50176
  v_mfma_f32_16x16x32_bf16 v[116:119], v[60:63], a[56:59], v[116:119]
  v_mul_f32 v80, v80, v144
  v_mul_f32 v81, v81, v145
  v_add_f32 v171, 1.0, v171
  v_mfma_f32_16x16x32_bf16 v[124:127], v[48:51], a[12:15], 0
  ds_read_b64_tr_b16 v[48:49], v18 offset:0
  buffer_load_dwordx4 v8, s[60:63], s88 offen offset:3072 lds
  v_readlane_b32 s88, v22, 5
  s_add_u32 m0, s9, 16384
  v_mfma_f32_16x16x32_bf16 v[124:127], v[52:55], a[28:31], v[124:127]
  ds_read_b64_tr_b16 v[50:51], v18 offset:2048
  v_cvt_pk_bf16_f32 v80, v80, v81
  v_mfma_f32_16x16x32_bf16 v[124:127], v[56:59], a[44:47], v[124:127]
  ds_read_b64_tr_b16 v[52:53], v18 offset:4096
  buffer_load_dwordx4 v5, s[60:63], s88 offen lds
  v_mfma_f32_16x16x32_bf16 v[124:127], v[60:63], a[60:63], v[124:127]
  s_waitcnt lgkmcnt(4)
  v_rcp_f32 v171, v171
  v_mfma_f32_16x16x32_bf16 v[96:99], v[32:35], a[64:67], v[96:99]
  ds_read_b64_tr_b16 v[54:55], v18 offset:6144
  buffer_load_dwordx4 v6, s[60:63], s88 offen offset:1024 lds
  v_mfma_f32_16x16x32_bf16 v[96:99], v[36:39], a[80:83], v[96:99]
  ds_read_b64_tr_b16 v[56:57], v18 offset:8192
  v_mul_f32 v83, v171, v83
  v_mfma_f32_16x16x32_bf16 v[96:99], v[40:43], a[128:131], v[96:99]
  v_mul_f32 v82, v82, v146
  v_add_f32 v160, 1.0, v160
  v_mfma_f32_16x16x32_bf16 v[172:175], v[44:47], a[0:3], 0
  ds_read_b64_tr_b16 v[58:59], v18 offset:10240
  buffer_load_dwordx4 v7, s[60:63], s88 offen offset:2048 lds
  v_mfma_f32_16x16x32_bf16 v[104:107], v[32:35], a[68:71], v[104:107]
  ds_read_b64_tr_b16 v[60:61], v18 offset:12288
  buffer_load_dwordx4 v8, s[60:63], s88 offen offset:3072 lds
  v_mfma_f32_16x16x32_bf16 v[104:107], v[36:39], a[84:87], v[104:107]
  v_rcp_f32 v160, v160
  v_mfma_f32_16x16x32_bf16 v[104:107], v[40:43], a[132:135], v[104:107]
  ds_read_b64_tr_b16 v[62:63], v18 offset:14336
  v_mul_f32 v84, v160, v84
  v_mfma_f32_16x16x32_bf16 v[180:183], v[44:47], a[4:7], 0
  v_mul_f32 v83, v83, v147
  v_fmaak_f32 v161, v161, v20, 0xc0135761
  v_mfma_f32_16x16x32_bf16 v[112:115], v[32:35], a[72:75], v[112:115]
  v_cvt_pk_bf16_f32 v81, v82, v83
  v_mul_f32 v161, v161, v85
  v_mfma_f32_16x16x32_bf16 v[112:115], v[36:39], a[88:91], v[112:115]
  v_exp_f32 v161, v161
  v_mfma_f32_16x16x32_bf16 v[112:115], v[40:43], a[136:139], v[112:115]
  v_add_f32 v161, 1.0, v161
  v_mul_f32 v84, v84, v148
  v_mfma_f32_16x16x32_bf16 v[188:191], v[44:47], a[8:11], 0
  v_rcp_f32 v161, v161
  v_mfma_f32_16x16x32_bf16 v[120:123], v[32:35], a[76:79], v[120:123]
  v_mul_f32 v85, v161, v85
  v_mul_f32 v162, v86, v86
  v_mfma_f32_16x16x32_bf16 v[120:123], v[36:39], a[92:95], v[120:123]
  v_fmaak_f32 v162, v162, v20, 0xc0135761
  v_mul_f32 v85, v85, v149
  v_mfma_f32_16x16x32_bf16 v[120:123], v[40:43], a[140:143], v[120:123]
  v_cvt_pk_bf16_f32 v82, v84, v85
  v_mul_f32 v162, v162, v86
  v_mfma_f32_16x16x32_bf16 v[196:199], v[44:47], a[12:15], 0
  s_waitcnt lgkmcnt(0)
  v_exp_f32 v162, v162
  v_mfma_f32_16x16x32_bf16 v[100:103], v[48:51], a[64:67], v[100:103]
  ds_read_b64_tr_b16 v[32:33], v14 offset:16384
  v_add_f32 v162, 1.0, v162
  v_mfma_f32_16x16x32_bf16 v[100:103], v[52:55], a[80:83], v[100:103]
  ds_read_b64_tr_b16 v[34:35], v14 offset:18432
  v_readlane_b32 s88, v22, 6
  v_mfma_f32_16x16x32_bf16 v[100:103], v[56:59], a[128:131], v[100:103]
  ds_read_b64_tr_b16 v[36:37], v14 offset:20480
  v_mul_f32 v163, v87, v87
  v_mfma_f32_16x16x32_bf16 v[176:179], v[60:63], a[0:3], 0
  ds_read_b64_tr_b16 v[38:39], v14 offset:22528
  v_fmaak_f32 v163, v163, v20, 0xc0135761
  v_mfma_f32_16x16x32_bf16 v[108:111], v[48:51], a[68:71], v[108:111]
  s_add_u32 m0, s9, 32768
  v_rcp_f32 v162, v162
  v_mfma_f32_16x16x32_bf16 v[108:111], v[52:55], a[84:87], v[108:111]
  ds_read_b64_tr_b16 v[40:41], v14 offset:24576
  buffer_load_dwordx4 v5, s[60:63], s88 offen lds
  v_mfma_f32_16x16x32_bf16 v[108:111], v[56:59], a[132:135], v[108:111]
  ds_read_b64_tr_b16 v[42:43], v14 offset:26624
  v_mul_f32 v86, v162, v86
  v_mfma_f32_16x16x32_bf16 v[184:187], v[60:63], a[4:7], 0
  v_mul_f32 v163, v163, v87
  v_mul_f32 v86, v86, v150
  v_mfma_f32_16x16x32_bf16 v[116:119], v[48:51], a[72:75], v[116:119]
  ds_read_b64_tr_b16 v[44:45], v14 offset:28672
  buffer_load_dwordx4 v6, s[60:63], s88 offen offset:1024 lds
  v_mfma_f32_16x16x32_bf16 v[116:119], v[52:55], a[88:91], v[116:119]
  ds_read_b64_tr_b16 v[46:47], v14 offset:30720
  v_mul_f32 v164, v88, v88
  v_mfma_f32_16x16x32_bf16 v[116:119], v[56:59], a[136:139], v[116:119]
  v_exp_f32 v163, v163
  v_mfma_f32_16x16x32_bf16 v[192:195], v[60:63], a[8:11], 0
  v_add_f32 v163, 1.0, v163
  v_fmaak_f32 v164, v164, v20, 0xc0135761
  v_mfma_f32_16x16x32_bf16 v[124:127], v[48:51], a[76:79], v[124:127]
  ds_read_b64_tr_b16 v[48:49], v17 offset:16384
  buffer_load_dwordx4 v7, s[60:63], s88 offen offset:2048 lds
  v_mfma_f32_16x16x32_bf16 v[124:127], v[52:55], a[92:95], v[124:127]
  ds_read_b64_tr_b16 v[50:51], v17 offset:18432
  v_mul_f32 v164, v164, v88
  v_mfma_f32_16x16x32_bf16 v[124:127], v[56:59], a[140:143], v[124:127]
  ds_read_b64_tr_b16 v[52:53], v17 offset:20480
  v_mul_f32 v165, v89, v89
  v_mfma_f32_16x16x32_bf16 v[200:203], v[60:63], a[12:15], 0
  s_waitcnt lgkmcnt(3)
  v_rcp_f32 v163, v163
  v_mfma_f32_16x16x32_bf16 v[172:175], v[32:35], a[16:19], v[172:175]
  ds_read_b64_tr_b16 v[54:55], v17 offset:22528
  buffer_load_dwordx4 v8, s[60:63], s88 offen offset:3072 lds
  v_readlane_b32 s88, v22, 7
  v_mfma_f32_16x16x32_bf16 v[172:175], v[36:39], a[32:35], v[172:175]
  ds_read_b64_tr_b16 v[56:57], v17 offset:24576
  v_mul_f32 v87, v163, v87
  v_mfma_f32_16x16x32_bf16 v[172:175], v[40:43], a[48:51], v[172:175]
  s_add_u32 m0, s9, 65536
  v_exp_f32 v164, v164
  v_mfma_f32_16x16x32_bf16 v[172:175], v[44:47], a[64:67], v[172:175]
  ds_read_b64_tr_b16 v[58:59], v17 offset:26624
  buffer_load_dwordx4 v5, s[60:63], s88 offen lds
  v_mfma_f32_16x16x32_bf16 v[180:183], v[32:35], a[20:23], v[180:183]
  ds_read_b64_tr_b16 v[60:61], v17 offset:28672
  v_add_f32 v164, 1.0, v164
  v_mfma_f32_16x16x32_bf16 v[180:183], v[36:39], a[36:39], v[180:183]
  v_rcp_f32 v164, v164
  v_mfma_f32_16x16x32_bf16 v[180:183], v[40:43], a[52:55], v[180:183]
  ds_read_b64_tr_b16 v[62:63], v17 offset:30720
  v_mul_f32 v88, v164, v88
  v_mfma_f32_16x16x32_bf16 v[180:183], v[44:47], a[68:71], v[180:183]
  v_mul_f32 v87, v87, v151
  v_fmaak_f32 v165, v165, v20, 0xc0135761
  v_mfma_f32_16x16x32_bf16 v[188:191], v[32:35], a[24:27], v[188:191]
  v_cvt_pk_bf16_f32 v83, v86, v87
  v_mul_f32 v165, v165, v89
  v_mfma_f32_16x16x32_bf16 v[188:191], v[36:39], a[40:43], v[188:191]
  ds_write_b128 v236, v[80:83] offset:51200
  v_mfma_f32_16x16x32_bf16 v[188:191], v[40:43], a[56:59], v[188:191]
  v_exp_f32 v165, v165
  v_mul_f32 v88, v88, v152
  v_mfma_f32_16x16x32_bf16 v[188:191], v[44:47], a[72:75], v[188:191]
  v_add_f32 v165, 1.0, v165
  v_mul_f32 v166, v90, v90
  v_mfma_f32_16x16x32_bf16 v[196:199], v[32:35], a[28:31], v[196:199]
  v_rcp_f32 v165, v165
  v_mfma_f32_16x16x32_bf16 v[196:199], v[36:39], a[44:47], v[196:199]
  v_mul_f32 v89, v165, v89
  v_fmaak_f32 v166, v166, v20, 0xc0135761
  v_mfma_f32_16x16x32_bf16 v[196:199], v[40:43], a[60:63], v[196:199]
  v_mul_f32 v166, v166, v90
  v_mul_f32 v89, v89, v153
  v_mfma_f32_16x16x32_bf16 v[196:199], v[44:47], a[76:79], v[196:199]
  s_waitcnt vmcnt(9) lgkmcnt(0)
  s_barrier
  v_mfma_f32_16x16x32_bf16 v[176:179], v[48:51], a[16:19], v[176:179]
  ds_read_b64_tr_b16 v[32:33], v15 offset:16384
  v_cvt_pk_bf16_f32 v88, v88, v89
  v_mfma_f32_16x16x32_bf16 v[176:179], v[52:55], a[32:35], v[176:179]
  ds_read_b64_tr_b16 v[34:35], v15 offset:18432
  v_exp_f32 v166, v166
  v_mfma_f32_16x16x32_bf16 v[176:179], v[56:59], a[48:51], v[176:179]
  ds_read_b64_tr_b16 v[36:37], v18 offset:16384
  v_add_f32 v166, 1.0, v166
  v_mfma_f32_16x16x32_bf16 v[176:179], v[60:63], a[64:67], v[176:179]
  ds_read_b64_tr_b16 v[38:39], v18 offset:18432
  v_mul_f32 v167, v91, v91
  v_mfma_f32_16x16x32_bf16 v[184:187], v[48:51], a[20:23], v[184:187]
  v_rcp_f32 v166, v166
  v_mfma_f32_16x16x32_bf16 v[184:187], v[52:55], a[36:39], v[184:187]
  ds_read_b64_tr_b16 v[40:41], v15 offset:20480
  buffer_load_dwordx4 v6, s[60:63], s88 offen offset:1024 lds
  v_mfma_f32_16x16x32_bf16 v[184:187], v[56:59], a[52:55], v[184:187]
  ds_read_b64_tr_b16 v[42:43], v15 offset:22528
  v_mul_f32 v90, v166, v90
  v_mfma_f32_16x16x32_bf16 v[184:187], v[60:63], a[68:71], v[184:187]
  v_fmaak_f32 v167, v167, v20, 0xc0135761
  v_mul_f32 v90, v90, v154
  v_mfma_f32_16x16x32_bf16 v[192:195], v[48:51], a[24:27], v[192:195]
  ds_read_b64_tr_b16 v[44:45], v18 offset:20480
  buffer_load_dwordx4 v7, s[60:63], s88 offen offset:2048 lds
  v_mfma_f32_16x16x32_bf16 v[192:195], v[52:55], a[40:43], v[192:195]
  ds_read_b64_tr_b16 v[46:47], v18 offset:22528
  v_mul_f32 v167, v167, v91
  v_mfma_f32_16x16x32_bf16 v[192:195], v[56:59], a[56:59], v[192:195]
  v_exp_f32 v167, v167
  v_mfma_f32_16x16x32_bf16 v[192:195], v[60:63], a[72:75], v[192:195]
  v_add_f32 v167, 1.0, v167
  v_mul_f32 v168, v92, v92
  v_mfma_f32_16x16x32_bf16 v[200:203], v[48:51], a[28:31], v[200:203]
  ds_read_b64_tr_b16 v[48:49], v15 offset:24576
  buffer_load_dwordx4 v8, s[60:63], s88 offen offset:3072 lds
  v_readlane_b32 s88, v22, 8
  v_mfma_f32_16x16x32_bf16 v[200:203], v[52:55], a[44:47], v[200:203]
  ds_read_b64_tr_b16 v[50:51], v15 offset:26624
  s_add_u32 m0, s9, 98304
  v_mfma_f32_16x16x32_bf16 v[200:203], v[56:59], a[60:63], v[200:203]
  ds_read_b64_tr_b16 v[52:53], v18 offset:24576
  v_fmaak_f32 v168, v168, v20, 0xc0135761
  v_mfma_f32_16x16x32_bf16 v[200:203], v[60:63], a[76:79], v[200:203]
  s_waitcnt lgkmcnt(3)
  v_rcp_f32 v167, v167
  v_mfma_f32_16x16x32_bf16 v[172:175], v[32:35], a[80:83], v[172:175]
  ds_read_b64_tr_b16 v[54:55], v18 offset:26624
  buffer_load_dwordx4 v5, s[60:63], s88 offen lds
  v_mfma_f32_16x16x32_bf16 v[172:175], v[40:43], a[128:131], v[172:175]
  ds_read_b64_tr_b16 v[56:57], v15 offset:28672
  v_mul_f32 v91, v167, v91
  v_mfma_f32_16x16x32_bf16 v[180:183], v[32:35], a[84:87], v[180:183]
  v_mul_f32 v168, v168, v92
  v_mul_f32 v91, v91, v155
  v_mfma_f32_16x16x32_bf16 v[180:183], v[40:43], a[132:135], v[180:183]
  ds_read_b64_tr_b16 v[58:59], v15 offset:30720
  buffer_load_dwordx4 v6, s[60:63], s88 offen offset:1024 lds
  v_mfma_f32_16x16x32_bf16 v[188:191], v[32:35], a[88:91], v[188:191]
  ds_read_b64_tr_b16 v[60:61], v18 offset:28672
  v_cvt_pk_bf16_f32 v89, v90, v91
  v_mfma_f32_16x16x32_bf16 v[188:191], v[40:43], a[136:139], v[188:191]
  v_exp_f32 v168, v168
  v_mul_f32 v169, v93, v93
  v_mfma_f32_16x16x32_bf16 v[196:199], v[32:35], a[92:95], v[196:199]
  ds_read_b64_tr_b16 v[62:63], v18 offset:30720
  v_add_f32 v168, 1.0, v168
  v_mfma_f32_16x16x32_bf16 v[196:199], v[40:43], a[140:143], v[196:199]
  v_rcp_f32 v168, v168
  v_mfma_f32_16x16x32_bf16 v[176:179], v[36:39], a[80:83], v[176:179]
  v_mul_f32 v92, v168, v92
  v_fmaak_f32 v169, v169, v20, 0xc0135761
  v_mfma_f32_16x16x32_bf16 v[176:179], v[44:47], a[128:131], v[176:179]
  v_mul_f32 v169, v169, v93
  v_mul_f32 v92, v92, v156
  v_mul_f32 v170, v94, v94
  v_mfma_f32_16x16x32_bf16 v[184:187], v[36:39], a[84:87], v[184:187]
  v_exp_f32 v169, v169
  v_fmaak_f32 v170, v170, v20, 0xc0135761
  v_mfma_f32_16x16x32_bf16 v[184:187], v[44:47], a[132:135], v[184:187]
  v_add_f32 v169, 1.0, v169
  v_mul_f32 v170, v170, v94
  v_mfma_f32_16x16x32_bf16 v[192:195], v[36:39], a[88:91], v[192:195]
  v_rcp_f32 v169, v169
  v_mfma_f32_16x16x32_bf16 v[192:195], v[44:47], a[136:139], v[192:195]
  v_cmp_le_u32 vcc, 64, v252
  s_nop 0
  s_cmp_eq_u32 vcc_lo, 15
  s_cbranch_scc0 PK_spin
PK_go:
  v_mfma_f32_16x16x32_bf16 v[200:203], v[36:39], a[92:95], v[200:203]
  v_mul_f32 v171, v95, v95
  v_mul_f32 v93, v169, v93
  v_mfma_f32_16x16x32_bf16 v[200:203], v[44:47], a[140:143], v[200:203]
  s_waitcnt lgkmcnt(0)
  v_fmaak_f32 v171, v171, v20, 0xc0135761
  v_exp_f32 v170, v170
  v_mfma_f32_16x16x32_bf16 v[204:207], v[48:51], a[0:3], 0
  ds_read_b64_tr_b16 v[32:33], v13 offset:0
  v_add_f32 v170, 1.0, v170
  v_mfma_f32_16x16x32_bf16 v[204:207], v[56:59], a[16:19], v[204:207]
  ds_read_b64_tr_b16 v[34:35], v13 offset:2048
  v_mul_f32 v171, v171, v95
  v_mfma_f32_16x16x32_bf16 v[212:215], v[48:51], a[4:7], 0
  ds_read_b64_tr_b16 v[36:37], v13 offset:4096
  v_mul_f32 v93, v93, v157
  v_mfma_f32_16x16x32_bf16 v[212:215], v[56:59], a[20:23], v[212:215]
  ds_read_b64_tr_b16 v[38:39], v13 offset:6144
  v_exp_f32 v171, v171
  v_mfma_f32_16x16x32_bf16 v[220:223], v[48:51], a[8:11], 0
  v_rcp_f32 v170, v170
  v_mfma_f32_16x16x32_bf16 v[220:223], v[56:59], a[24:27], v[220:223]
  ds_read_b64_tr_b16 v[40:41], v13 offset:8192
  buffer_load_dwordx4 v7, s[60:63], s88 offen offset:2048 lds
  v_mfma_f32_16x16x32_bf16 v[228:231], v[48:51], a[12:15], 0
  ds_read_b64_tr_b16 v[42:43], v13 offset:10240
  v_add_f32 v171, 1.0, v171
  v_mfma_f32_16x16x32_bf16 v[228:231], v[56:59], a[28:31], v[228:231]
  v_rcp_f32 v171, v171
  v_mfma_f32_16x16x32_bf16 v[208:211], v[52:55], a[0:3], 0
  ds_read_b64_tr_b16 v[44:45], v13 offset:12288
  buffer_load_dwordx4 v8, s[60:63], s88 offen offset:3072 lds
  v_readlane_b32 s88, v22, 9
  v_mfma_f32_16x16x32_bf16 v[208:211], v[60:63], a[16:19], v[208:211]
  ds_read_b64_tr_b16 v[46:47], v13 offset:14336
  v_mul_f32 v94, v170, v94
  v_mfma_f32_16x16x32_bf16 v[216:219], v[52:55], a[4:7], 0
  s_add_u32 m0, s9, 114688
  v_mul_f32 v95, v171, v95
  v_cvt_pk_bf16_f32 v90, v92, v93
  v_mfma_f32_16x16x32_bf16 v[216:219], v[60:63], a[20:23], v[216:219]
  v_mul_f32 v94, v94, v158
  v_mul_f32 v95, v95, v159
  v_mfma_f32_16x16x32_bf16 v[224:227], v[52:55], a[8:11], 0
  ds_read_b64_tr_b16 v[48:49], v16 offset:0
  buffer_load_dwordx4 v5, s[60:63], s88 offen lds
  v_mfma_f32_16x16x32_bf16 v[224:227], v[60:63], a[24:27], v[224:227]
  ds_read_b64_tr_b16 v[50:51], v16 offset:2048
  v_cvt_pk_bf16_f32 v91, v94, v95
  v_mfma_f32_16x16x32_bf16 v[232:235], v[52:55], a[12:15], 0
  ds_read_b64_tr_b16 v[52:53], v16 offset:4096
  v_mfma_f32_16x16x32_bf16 v[232:235], v[60:63], a[28:31], v[232:235]
  s_waitcnt lgkmcnt(3)
  ds_write_b128 v236, v[88:91] offset:52224
  v_mfma_f32_16x16x32_bf16 v[204:207], v[32:35], a[32:35], v[204:207]
  ds_read_b64_tr_b16 v[54:55], v16 offset:6144
  buffer_load_dwordx4 v6, s[60:63], s88 offen offset:1024 lds
  v_mfma_f32_16x16x32_bf16 v[204:207], v[36:39], a[48:51], v[204:207]
  ds_read_b64_tr_b16 v[56:57], v16 offset:8192
  v_mfma_f32_16x16x32_bf16 v[204:207], v[40:43], a[64:67], v[204:207]
  v_mfma_f32_16x16x32_bf16 v[204:207], v[44:47], a[80:83], v[204:207]
  ds_read_b64_tr_b16 v[58:59], v16 offset:10240
  buffer_load_dwordx4 v7, s[60:63], s88 offen offset:2048 lds
  v_mfma_f32_16x16x32_bf16 v[212:215], v[32:35], a[36:39], v[212:215]
  ds_read_b64_tr_b16 v[60:61], v16 offset:12288
  v_mfma_f32_16x16x32_bf16 v[212:215], v[36:39], a[52:55], v[212:215]
  v_mfma_f32_16x16x32_bf16 v[212:215], v[40:43], a[68:71], v[212:215]
  ds_read_b64_tr_b16 v[62:63], v16 offset:14336
  v_mfma_f32_16x16x32_bf16 v[212:215], v[44:47], a[84:87], v[212:215]
  v_mfma_f32_16x16x32_bf16 v[220:223], v[32:35], a[40:43], v[220:223]
  v_mfma_f32_16x16x32_bf16 v[220:223], v[36:39], a[56:59], v[220:223]
  v_mfma_f32_16x16x32_bf16 v[220:223], v[40:43], a[72:75], v[220:223]
  v_mfma_f32_16x16x32_bf16 v[220:223], v[44:47], a[88:91], v[220:223]
  v_mfma_f32_16x16x32_bf16 v[228:231], v[32:35], a[44:47], v[228:231]
  buffer_load_dword v242, v240, s[64:67], s18 offen sc1
  v_mfma_f32_16x16x32_bf16 v[228:231], v[36:39], a[60:63], v[228:231]
  v_mfma_f32_16x16x32_bf16 v[228:231], v[40:43], a[76:79], v[228:231]
  v_mfma_f32_16x16x32_bf16 v[228:231], v[44:47], a[92:95], v[228:231]
  s_waitcnt vmcnt(12) lgkmcnt(0)
  s_barrier
  v_mfma_f32_16x16x32_bf16 v[208:211], v[48:51], a[32:35], v[208:211]
  ds_read_b64_tr_b16 v[32:33], v13 offset:16384
  ds_read_b128 a[96:99], v19 offset:49152
  v_mfma_f32_16x16x32_bf16 v[208:211], v[52:55], a[48:51], v[208:211]
  ds_read_b64_tr_b16 v[34:35], v13 offset:18432
  ds_read_b128 a[100:103], v19 offset:50176
  v_mfma_f32_16x16x32_bf16 v[208:211], v[56:59], a[64:67], v[208:211]
  ds_read_b64_tr_b16 v[36:37], v16 offset:16384
  ds_read_b128 a[104:107], v19 offset:51200
  v_mfma_f32_16x16x32_bf16 v[208:211], v[60:63], a[80:83], v[208:211]
  ds_read_b64_tr_b16 v[38:39], v16 offset:18432
  ds_read_b128 a[108:111], v19 offset:52224
  v_mfma_f32_16x16x32_bf16 v[216:219], v[48:51], a[36:39], v[216:219]
  buffer_load_dword v243, v240, s[64:67], s19 offen sc1
  v_mfma_f32_16x16x32_bf16 v[216:219], v[52:55], a[52:55], v[216:219]
  ds_read_b64_tr_b16 v[40:41], v13 offset:20480
  buffer_load_dwordx4 v8, s[60:63], s88 offen offset:3072 lds
  v_readlane_b32 s88, v22, 10
  v_mfma_f32_16x16x32_bf16 v[216:219], v[56:59], a[68:71], v[216:219]
  ds_read_b64_tr_b16 v[42:43], v13 offset:22528
  ds_read_b128 a[112:115], v19 offset:57344
  v_mfma_f32_16x16x32_bf16 v[216:219], v[60:63], a[84:87], v[216:219]
  s_add_u32 m0, s9, 81920
  buffer_load_dword v251, v251, s[64:67], s20 offen sc1
  v_mfma_f32_16x16x32_bf16 v[224:227], v[48:51], a[40:43], v[224:227]
  ds_read_b64_tr_b16 v[44:45], v16 offset:20480
  buffer_load_dwordx4 v5, s[60:63], s88 offen lds
  ds_read_b128 a[116:119], v19 offset:58368
  v_mfma_f32_16x16x32_bf16 v[224:227], v[52:55], a[56:59], v[224:227]
  ds_read_b64_tr_b16 v[46:47], v16 offset:22528
  ds_read_b128 a[120:123], v19 offset:59392
  v_mfma_f32_16x16x32_bf16 v[224:227], v[56:59], a[72:75], v[224:227]
  ds_read_b128 a[124:127], v19 offset:60416
  v_mfma_f32_16x16x32_bf16 v[224:227], v[60:63], a[88:91], v[224:227]
  buffer_load_dwordx4 v[128:131], v241, s[64:67], s16 offen sc1
  v_mfma_f32_16x16x32_bf16 v[232:235], v[48:51], a[44:47], v[232:235]
  ds_read_b64_tr_b16 v[48:49], v13 offset:24576
  buffer_load_dwordx4 v6, s[60:63], s88 offen offset:1024 lds
  v_mfma_f32_16x16x32_bf16 v[232:235], v[52:55], a[60:63], v[232:235]
  ds_read_b64_tr_b16 v[50:51], v13 offset:26624
  v_mfma_f32_16x16x32_bf16 v[232:235], v[56:59], a[76:79], v[232:235]
  ds_read_b64_tr_b16 v[52:53], v16 offset:24576
  v_mfma_f32_16x16x32_bf16 v[232:235], v[60:63], a[92:95], v[232:235]
  s_waitcnt lgkmcnt(5)
  buffer_load_dwordx4 v[132:135], v241, s[64:67], s17 offen sc1
  v_mfma_f32_16x16x32_bf16 v[204:207], v[32:35], a[128:131], v[204:207]
  ds_read_b64_tr_b16 v[54:55], v16 offset:26624
  buffer_load_dwordx4 v7, s[60:63], s88 offen offset:2048 lds
  v_mfma_f32_16x16x32_bf16 v[212:215], v[32:35], a[132:135], v[212:215]
  ds_read_b64_tr_b16 v[56:57], v13 offset:28672
  v_mfma_f32_16x16x32_bf16 v[220:223], v[32:35], a[136:139], v[220:223]
  v_mfma_f32_16x16x32_bf16 v[228:231], v[32:35], a[140:143], v[228:231]
  ds_read_b64_tr_b16 v[58:59], v13 offset:30720
  buffer_load_dwordx4 v8, s[60:63], s88 offen offset:3072 lds
  v_mfma_f32_16x16x32_bf16 v[232:235], v[36:39], a[140:143], v[232:235]
  ds_read_b64_tr_b16 v[60:61], v16 offset:28672
  v_mfma_f32_16x16x32_bf16 v[224:227], v[36:39], a[136:139], v[224:227]
  v_mfma_f32_16x16x32_bf16 v[216:219], v[36:39], a[132:135], v[216:219]
  ds_read_b64_tr_b16 v[62:63], v16 offset:30720
  v_mfma_f32_16x16x32_bf16 v[208:211], v[36:39], a[128:131], v[208:211]
  v_mfma_f32_16x16x32_bf16 v[96:99], v[40:43], a[96:99], v[96:99]
  v_mfma_f32_16x16x32_bf16 v[104:107], v[40:43], a[100:103], v[104:107]
  v_mfma_f32_16x16x32_bf16 v[112:115], v[40:43], a[104:107], v[112:115]
  v_mfma_f32_16x16x32_bf16 v[120:123], v[40:43], a[108:111], v[120:123]
  v_mfma_f32_16x16x32_bf16 v[124:127], v[44:47], a[108:111], v[124:127]
  v_mfma_f32_16x16x32_bf16 v[116:119], v[44:47], a[104:107], v[116:119]
  v_mfma_f32_16x16x32_bf16 v[108:111], v[44:47], a[100:103], v[108:111]
  v_mfma_f32_16x16x32_bf16 v[100:103], v[44:47], a[96:99], v[100:103]
  s_waitcnt lgkmcnt(0)
  v_mfma_f32_16x16x32_bf16 v[96:99], v[48:51], a[112:115], v[96:99]
  ds_read_b64_tr_b16 v[32:33], v13 offset:32768
  v_mfma_f32_16x16x32_bf16 v[104:107], v[48:51], a[116:119], v[104:107]
  ds_read_b64_tr_b16 v[34:35], v13 offset:34816
  v_readlane_b32 s88, v22, 11
  v_mfma_f32_16x16x32_bf16 v[112:115], v[48:51], a[120:123], v[112:115]
  ds_read_b64_tr_b16 v[36:37], v16 offset:32768
  v_mfma_f32_16x16x32_bf16 v[120:123], v[48:51], a[124:127], v[120:123]
  ds_read_b64_tr_b16 v[38:39], v16 offset:34816
  v_mfma_f32_16x16x32_bf16 v[124:127], v[52:55], a[124:127], v[124:127]
  s_add_u32 m0, s9, 131072
  v_mfma_f32_16x16x32_bf16 v[116:119], v[52:55], a[120:123], v[116:119]
  ds_read_b64_tr_b16 v[40:41], v13 offset:36864
  buffer_load_dwordx4 v5, s[60:63], s88 offen lds
  v_mfma_f32_16x16x32_bf16 v[108:111], v[52:55], a[116:119], v[108:111]
  ds_read_b64_tr_b16 v[42:43], v13 offset:38912
  v_mfma_f32_16x16x32_bf16 v[100:103], v[52:55], a[112:115], v[100:103]
  v_mfma_f32_16x16x32_bf16 v[172:175], v[56:59], a[96:99], v[172:175]
  ds_read_b64_tr_b16 v[44:45], v16 offset:36864
  buffer_load_dwordx4 v6, s[60:63], s88 offen offset:1024 lds
  v_mfma_f32_16x16x32_bf16 v[180:183], v[56:59], a[100:103], v[180:183]
  ds_read_b64_tr_b16 v[46:47], v16 offset:38912
  s_add_u32 s91, s74, 0
  v_mfma_f32_16x16x32_bf16 v[188:191], v[56:59], a[104:107], v[188:191]
  v_mfma_f32_16x16x32_bf16 v[196:199], v[56:59], a[108:111], v[196:199]
  v_cvt_pk_bf16_f32 v96, v96, v97
  v_cvt_pk_bf16_f32 v97, v98, v99
  v_mfma_f32_16x16x32_bf16 v[200:203], v[60:63], a[108:111], v[200:203]
  ds_read_b64_tr_b16 v[48:49], v13 offset:40960
  buffer_load_dwordx4 v7, s[60:63], s88 offen offset:2048 lds
  v_mfma_f32_16x16x32_bf16 v[192:195], v[60:63], a[104:107], v[192:195]
  ds_read_b64_tr_b16 v[50:51], v13 offset:43008
  v_cvt_pk_bf16_f32 v98, v100, v101
  v_mfma_f32_16x16x32_bf16 v[184:187], v[60:63], a[100:103], v[184:187]
  ds_read_b64_tr_b16 v[52:53], v16 offset:40960
  v_cvt_pk_bf16_f32 v99, v102, v103
  v_mfma_f32_16x16x32_bf16 v[176:179], v[60:63], a[96:99], v[176:179]
  s_waitcnt lgkmcnt(3)
  v_cvt_pk_bf16_f32 v100, v104, v105
  v_cvt_pk_bf16_f32 v101, v106, v107
  v_mfma_f32_16x16x32_bf16 v[172:175], v[32:35], a[112:115], v[172:175]
  ds_read_b64_tr_b16 v[54:55], v16 offset:43008
  buffer_load_dwordx4 v8, s[60:63], s88 offen offset:3072 lds
  v_readlane_b32 s88, v22, 12
  v_mfma_f32_16x16x32_bf16 v[180:183], v[32:35], a[116:119], v[180:183]
PAD8:
  s_cbranch_execz PAD12
  ds_read_b64_tr_b16 v[56:57], v13 offset:45056
  v_cvt_pk_bf16_f32 v102, v108, v109
  v_mfma_f32_16x16x32_bf16 v[188:191], v[32:35], a[120:123], v[188:191]
  s_add_u32 m0, s9, 0
  buffer_store_dwordx4 v[96:99], v21, s[64:67], s91 offen offset:0 sc1
  v_mfma_f32_16x16x32_bf16 v[196:199], v[32:35], a[124:127], v[196:199]
  ds_read_b64_tr_b16 v[58:59], v13 offset:47104
  buffer_load_dwordx4 v5, s[60:63], s88 offen lds
  v_mfma_f32_16x16x32_bf16 v[200:203], v[36:39], a[124:127], v[200:203]
  ds_read_b64_tr_b16 v[60:61], v16 offset:45056
  v_cvt_pk_bf16_f32 v103, v110, v111
  v_mfma_f32_16x16x32_bf16 v[192:195], v[36:39], a[120:123], v[192:195]
  v_cvt_pk_bf16_f32 v104, v112, v113
  v_cvt_pk_bf16_f32 v105, v114, v115
  v_mfma_f32_16x16x32_bf16 v[184:187], v[36:39], a[116:119], v[184:187]
  ds_read_b64_tr_b16 v[62:63], v16 offset:47104
  v_cvt_pk_bf16_f32 v106, v116, v117
  v_mfma_f32_16x16x32_bf16 v[176:179], v[36:39], a[112:115], v[176:179]
  v_cvt_pk_bf16_f32 v107, v118, v119
  v_cvt_pk_bf16_f32 v108, v120, v121
  v_mfma_f32_16x16x32_bf16 v[204:207], v[40:43], a[96:99], v[204:207]
  v_cvt_pk_bf16_f32 v109, v122, v123
  v_cvt_pk_bf16_f32 v110, v124, v125
  v_mfma_f32_16x16x32_bf16 v[212:215], v[40:43], a[100:103], v[212:215]
  v_cvt_pk_bf16_f32 v111, v126, v127
  v_mfma_f32_16x16x32_bf16 v[220:223], v[40:43], a[104:107], v[220:223]
  v_mfma_f32_16x16x32_bf16 v[228:231], v[40:43], a[108:111], v[228:231]
  v_cvt_pk_bf16_f32 v172, v172, v173
  v_cvt_pk_bf16_f32 v173, v174, v175
  v_mfma_f32_16x16x32_bf16 v[232:235], v[44:47], a[108:111], v[232:235]
  v_cvt_pk_bf16_f32 v174, v176, v177
  v_cvt_pk_bf16_f32 v175, v178, v179
  v_mfma_f32_16x16x32_bf16 v[224:227], v[44:47], a[104:107], v[224:227]
  v_cvt_pk_bf16_f32 v176, v180, v181
  v_cvt_pk_bf16_f32 v177, v182, v183
  v_mfma_f32_16x16x32_bf16 v[216:219], v[44:47], a[100:103], v[216:219]
  v_cvt_pk_bf16_f32 v178, v184, v185
  v_cvt_pk_bf16_f32 v179, v186, v187
  v_mfma_f32_16x16x32_bf16 v[208:211], v[44:47], a[96:99], v[208:211]
  s_waitcnt vmcnt(19) lgkmcnt(0)
  s_barrier
  v_mfma_f32_16x16x32_bf16 v[204:207], v[48:51], a[112:115], v[204:207]
  ds_read_b64_tr_b16 v[32:33], v14 offset:0
  v_cvt_pk_bf16_f32 v180, v188, v189
  v_mfma_f32_16x16x32_bf16 v[212:215], v[48:51], a[116:119], v[212:215]
  ds_read_b64_tr_b16 v[34:35], v14 offset:2048
  v_cvt_pk_bf16_f32 v181, v190, v191
  v_mfma_f32_16x16x32_bf16 v[220:223], v[48:51], a[120:123], v[220:223]
  ds_read_b64_tr_b16 v[36:37], v14 offset:4096
  v_cvt_pk_bf16_f32 v182, v192, v193
  v_mfma_f32_16x16x32_bf16 v[228:231], v[48:51], a[124:127], v[228:231]
  ds_read_b64_tr_b16 v[38:39], v14 offset:6144
  v_cvt_pk_bf16_f32 v183, v194, v195
  v_mfma_f32_16x16x32_bf16 v[232:235], v[52:55], a[124:127], v[232:235]
  v_cvt_pk_bf16_f32 v184, v196, v197
  v_cvt_pk_bf16_f32 v185, v198, v199
  v_mfma_f32_16x16x32_bf16 v[224:227], v[52:55], a[120:123], v[224:227]
  ds_read_b64_tr_b16 v[40:41], v14 offset:8192
  buffer_load_dwordx4 v6, s[60:63], s88 offen offset:1024 lds
  v_mfma_f32_16x16x32_bf16 v[216:219], v[52:55], a[116:119], v[216:219]
  ds_read_b64_tr_b16 v[42:43], v14 offset:10240
  v_cvt_pk_bf16_f32 v186, v200, v201
  v_mfma_f32_16x16x32_bf16 v[208:211], v[52:55], a[112:115], v[208:211]
  buffer_store_dwordx4 v[100:103], v21, s[64:67], s91 offen offset:1024 sc1
  v_mfma_f32_16x16x32_bf16 v[64:67], v[56:59], a[0:3], 0
  ds_read_b64_tr_b16 v[44:45], v14 offset:12288
  buffer_load_dwordx4 v7, s[60:63], s88 offen offset:2048 lds
  v_mfma_f32_16x16x32_bf16 v[72:75], v[56:59], a[4:7], 0
  ds_read_b64_tr_b16 v[46:47], v14 offset:14336
  v_cvt_pk_bf16_f32 v187, v202, v203
  v_mfma_f32_16x16x32_bf16 v[80:83], v[56:59], a[8:11], 0
  v_mfma_f32_16x16x32_bf16 v[88:91], v[56:59], a[12:15], 0
  v_cvt_pk_bf16_f32 v204, v204, v205
  v_cvt_pk_bf16_f32 v205, v206, v207
  v_mfma_f32_16x16x32_bf16 v[92:95], v[60:63], a[12:15], 0
  ds_read_b64_tr_b16 v[48:49], v17 offset:0
  buffer_load_dwordx4 v8, s[60:63], s88 offen offset:3072 lds
  v_readlane_b32 s88, v22, 13
  v_mfma_f32_16x16x32_bf16 v[84:87], v[60:63], a[8:11], 0
  ds_read_b64_tr_b16 v[50:51], v17 offset:2048
  s_add_u32 m0, s9, 147456
  v_mfma_f32_16x16x32_bf16 v[76:79], v[60:63], a[4:7], 0
  ds_read_b64_tr_b16 v[52:53], v17 offset:4096
  v_cvt_pk_bf16_f32 v206, v208, v209
  v_mfma_f32_16x16x32_bf16 v[68:71], v[60:63], a[0:3], 0
  s_waitcnt lgkmcnt(3)
  v_cvt_pk_bf16_f32 v207, v210, v211
  v_cvt_pk_bf16_f32 v208, v212, v213
  v_mfma_f32_16x16x32_bf16 v[64:67], v[32:35], a[16:19], v[64:67]
  ds_read_b64_tr_b16 v[54:55], v17 offset:6144
  buffer_load_dwordx4 v5, s[60:63], s88 offen lds
  v_mfma_f32_16x16x32_bf16 v[64:67], v[36:39], a[32:35], v[64:67]
  ds_read_b64_tr_b16 v[56:57], v17 offset:8192
  v_cvt_pk_bf16_f32 v209, v214, v215
  v_mfma_f32_16x16x32_bf16 v[64:67], v[40:43], a[48:51], v[64:67]
  v_cvt_pk_bf16_f32 v210, v216, v217
  v_cvt_pk_bf16_f32 v211, v218, v219
  v_mfma_f32_16x16x32_bf16 v[64:67], v[44:47], a[64:67], v[64:67]
  ds_read_b64_tr_b16 v[58:59], v17 offset:10240
  buffer_load_dwordx4 v6, s[60:63], s88 offen offset:1024 lds
  v_mfma_f32_16x16x32_bf16 v[72:75], v[32:35], a[20:23], v[72:75]
  ds_read_b64_tr_b16 v[60:61], v17 offset:12288
  v_cvt_pk_bf16_f32 v212, v220, v221
  v_mfma_f32_16x16x32_bf16 v[72:75], v[36:39], a[36:39], v[72:75]
  v_cvt_pk_bf16_f32 v213, v222, v223
  v_cvt_pk_bf16_f32 v214, v224, v225
  v_mfma_f32_16x16x32_bf16 v[72:75], v[40:43], a[52:55], v[72:75]
  ds_read_b64_tr_b16 v[62:63], v17 offset:14336
  v_cvt_pk_bf16_f32 v215, v226, v227
  v_mfma_f32_16x16x32_bf16 v[72:75], v[44:47], a[68:71], v[72:75]
  v_cvt_pk_bf16_f32 v216, v228, v229
  v_cvt_pk_bf16_f32 v217, v230, v231
  v_mfma_f32_16x16x32_bf16 v[80:83], v[32:35], a[24:27], v[80:83]
  v_cvt_pk_bf16_f32 v218, v232, v233
  v_cvt_pk_bf16_f32 v219, v234, v235
  v_mfma_f32_16x16x32_bf16 v[80:83], v[36:39], a[40:43], v[80:83]
  v_mfma_f32_16x16x32_bf16 v[80:83], v[40:43], a[56:59], v[80:83]
  v_mfma_f32_16x16x32_bf16 v[80:83], v[44:47], a[72:75], v[80:83]
  v_mfma_f32_16x16x32_bf16 v[88:91], v[32:35], a[28:31], v[88:91]
  buffer_store_dwordx4 v[104:107], v21, s[64:67], s91 offen offset:2048 sc1
  v_mfma_f32_16x16x32_bf16 v[88:91], v[36:39], a[44:47], v[88:91]
  v_mfma_f32_16x16x32_bf16 v[88:91], v[40:43], a[60:63], v[88:91]
  v_mfma_f32_16x16x32_bf16 v[88:91], v[44:47], a[76:79], v[88:91]
  s_waitcnt lgkmcnt(0)
  v_mfma_f32_16x16x32_bf16 v[68:71], v[48:51], a[16:19], v[68:71]
  ds_read_b64_tr_b16 v[32:33], v14 offset:32768
  v_mfma_f32_16x16x32_bf16 v[68:71], v[52:55], a[32:35], v[68:71]
  ds_read_b64_tr_b16 v[34:35], v14 offset:34816
  v_mfma_f32_16x16x32_bf16 v[68:71], v[56:59], a[48:51], v[68:71]
  ds_read_b64_tr_b16 v[36:37], v14 offset:36864
  v_mfma_f32_16x16x32_bf16 v[68:71], v[60:63], a[64:67], v[68:71]
  ds_read_b64_tr_b16 v[38:39], v14 offset:38912
  v_mfma_f32_16x16x32_bf16 v[76:79], v[48:51], a[20:23], v[76:79]
  v_mfma_f32_16x16x32_bf16 v[76:79], v[52:55], a[36:39], v[76:79]
  ds_read_b64_tr_b16 v[40:41], v14 offset:40960
  buffer_load_dwordx4 v7, s[60:63], s88 offen offset:2048 lds
  v_mfma_f32_16x16x32_bf16 v[76:79], v[56:59], a[52:55], v[76:79]
  ds_read_b64_tr_b16 v[42:43], v14 offset:43008
  v_mfma_f32_16x16x32_bf16 v[76:79], v[60:63], a[68:71], v[76:79]
  v_mfma_f32_16x16x32_bf16 v[84:87], v[48:51], a[24:27], v[84:87]
  ds_read_b64_tr_b16 v[44:45], v14 offset:45056
  buffer_load_dwordx4 v8, s[60:63], s88 offen offset:3072 lds
  v_readlane_b32 s88, v22, 14
  v_mfma_f32_16x16x32_bf16 v[84:87], v[52:55], a[40:43], v[84:87]
  ds_read_b64_tr_b16 v[46:47], v14 offset:47104
  v_mfma_f32_16x16x32_bf16 v[84:87], v[56:59], a[56:59], v[84:87]
  s_add_u32 m0, s9, 32768
  v_mfma_f32_16x16x32_bf16 v[84:87], v[60:63], a[72:75], v[84:87]
  v_mfma_f32_16x16x32_bf16 v[92:95], v[48:51], a[28:31], v[92:95]
  ds_read_b64_tr_b16 v[48:49], v17 offset:32768
  buffer_load_dwordx4 v5, s[60:63], s88 offen lds
  v_mfma_f32_16x16x32_bf16 v[92:95], v[52:55], a[44:47], v[92:95]
  ds_read_b64_tr_b16 v[50:51], v17 offset:34816
  v_mfma_f32_16x16x32_bf16 v[92:95], v[56:59], a[60:63], v[92:95]
  ds_read_b64_tr_b16 v[52:53], v17 offset:36864
  v_mfma_f32_16x16x32_bf16 v[92:95], v[60:63], a[76:79], v[92:95]
  s_waitcnt lgkmcnt(3)
  v_mfma_f32_16x16x32_bf16 v[64:67], v[32:35], a[80:83], v[64:67]
  ds_read_b64_tr_b16 v[54:55], v17 offset:38912
  buffer_load_dwordx4 v6, s[60:63], s88 offen offset:1024 lds
  v_mfma_f32_16x16x32_bf16 v[64:67], v[36:39], a[96:99], v[64:67]
  ds_read_b64_tr_b16 v[56:57], v17 offset:40960
  v_mfma_f32_16x16x32_bf16 v[64:67], v[40:43], a[112:115], v[64:67]
  buffer_store_dwordx4 v[108:111], v21, s[64:67], s91 offen offset:3072 sc1
  v_mfma_f32_16x16x32_bf16 v[64:67], v[44:47], a[128:131], v[64:67]
  ds_read_b64_tr_b16 v[58:59], v17 offset:43008
  buffer_load_dwordx4 v7, s[60:63], s88 offen offset:2048 lds
  v_mfma_f32_16x16x32_bf16 v[72:75], v[32:35], a[84:87], v[72:75]
  ds_read_b64_tr_b16 v[60:61], v17 offset:45056
  s_add_u32 s91, s74, 16384
  v_mfma_f32_16x16x32_bf16 v[72:75], v[36:39], a[100:103], v[72:75]
  s_mov_b32 s52, s36
  v_mfma_f32_16x16x32_bf16 v[72:75], v[40:43], a[116:119], v[72:75]
  ds_read_b64_tr_b16 v[62:63], v17 offset:47104
  s_and_b32 s53, s37, 0xffff
  v_mfma_f32_16x16x32_bf16 v[72:75], v[44:47], a[132:135], v[72:75]
  s_mov_b32 s54, 2359296
  v_mfma_f32_16x16x32_bf16 v[80:83], v[32:35], a[88:91], v[80:83]
  s_mov_b32 s55, 0x20000
  v_mfma_f32_16x16x32_bf16 v[80:83], v[36:39], a[104:107], v[80:83]
  v_and_b32 v236, 1, v0
  v_mfma_f32_16x16x32_bf16 v[80:83], v[40:43], a[120:123], v[80:83]
  v_lshlrev_b32 v236, 4, v236
  v_mfma_f32_16x16x32_bf16 v[80:83], v[44:47], a[136:139], v[80:83]
  v_mov_b32 v237, 0x3f80
  v_mfma_f32_16x16x32_bf16 v[88:91], v[32:35], a[92:95], v[88:91]
  v_lshlrev_b32 v236, v236, v237
  v_mfma_f32_16x16x32_bf16 v[88:91], v[36:39], a[108:111], v[88:91]
  v_bfe_u32 v237, v0, 2, 1
  v_mfma_f32_16x16x32_bf16 v[88:91], v[40:43], a[124:127], v[88:91]
  v_bfe_u32 v238, v0, 4, 1
  v_mfma_f32_16x16x32_bf16 v[88:91], v[44:47], a[140:143], v[88:91]
  s_waitcnt vmcnt(19) lgkmcnt(0)
  s_barrier
  v_mfma_f32_16x16x32_bf16 v[68:71], v[48:51], a[80:83], v[68:71]
  ds_read_b64_tr_b16 v[32:33], v14 offset:49152
  v_cmp_eq_u32 vcc, v237, v238
  v_mfma_f32_16x16x32_bf16 v[68:71], v[52:55], a[96:99], v[68:71]
  ds_read_b64_tr_b16 v[34:35], v14 offset:51200
  v_bfe_u32 v237, v0, 1, 1
  v_mfma_f32_16x16x32_bf16 v[68:71], v[56:59], a[112:115], v[68:71]
  ds_read_b64_tr_b16 v[36:37], v14 offset:53248
  v_cndmask_b32 v236, 0, v236, vcc
  v_mfma_f32_16x16x32_bf16 v[68:71], v[60:63], a[128:131], v[68:71]
  ds_read_b64_tr_b16 v[38:39], v14 offset:55296
  v_bfe_u32 v238, v0, 3, 1
  v_mfma_f32_16x16x32_bf16 v[76:79], v[48:51], a[84:87], v[76:79]
  v_lshl_add_u32 v237, v238, 1, v237
  v_mfma_f32_16x16x32_bf16 v[76:79], v[52:55], a[100:103], v[76:79]
  ds_read_b64_tr_b16 v[40:41], v14 offset:57344
  buffer_load_dwordx4 v8, s[60:63], s88 offen offset:3072 lds
  v_readlane_b32 s88, v22, 15
  v_mfma_f32_16x16x32_bf16 v[76:79], v[56:59], a[116:119], v[76:79]
  ds_read_b64_tr_b16 v[42:43], v14 offset:59392
  v_cmp_eq_u32 vcc, 0, v237
  v_mfma_f32_16x16x32_bf16 v[76:79], v[60:63], a[132:135], v[76:79]
  s_add_u32 m0, s9, 65536
  v_cndmask_b32 v152, 0, v236, vcc
  v_mfma_f32_16x16x32_bf16 v[84:87], v[48:51], a[88:91], v[84:87]
  ds_read_b64_tr_b16 v[44:45], v14 offset:61440
  buffer_load_dwordx4 v5, s[60:63], s88 offen lds
  v_mfma_f32_16x16x32_bf16 v[84:87], v[52:55], a[104:107], v[84:87]
  ds_read_b64_tr_b16 v[46:47], v14 offset:63488
  v_cmp_eq_u32 vcc, 1, v237
  v_mfma_f32_16x16x32_bf16 v[84:87], v[56:59], a[120:123], v[84:87]
  buffer_store_dwordx4 v[172:175], v21, s[64:67], s91 offen offset:0 sc1
  v_mfma_f32_16x16x32_bf16 v[84:87], v[60:63], a[136:139], v[84:87]
  v_cndmask_b32 v153, 0, v236, vcc
  v_mfma_f32_16x16x32_bf16 v[92:95], v[48:51], a[92:95], v[92:95]
  ds_read_b64_tr_b16 v[48:49], v17 offset:49152
  buffer_load_dwordx4 v6, s[60:63], s88 offen offset:1024 lds
  v_mfma_f32_16x16x32_bf16 v[92:95], v[52:55], a[108:111], v[92:95]
  ds_read_b64_tr_b16 v[50:51], v17 offset:51200
  v_cmp_eq_u32 vcc, 2, v237
  v_mfma_f32_16x16x32_bf16 v[92:95], v[56:59], a[124:127], v[92:95]
  ds_read_b64_tr_b16 v[52:53], v17 offset:53248
  v_cndmask_b32 v154, 0, v236, vcc
  v_mfma_f32_16x16x32_bf16 v[92:95], v[60:63], a[140:143], v[92:95]
  s_waitcnt lgkmcnt(3)
  v_cmp_eq_u32 vcc, 3, v237
  v_mfma_f32_16x16x32_bf16 v[96:99], v[32:35], a[0:3], 0
  ds_read_b64_tr_b16 v[54:55], v17 offset:55296
  buffer_load_dwordx4 v7, s[60:63], s88 offen offset:2048 lds
  v_mfma_f32_16x16x32_bf16 v[96:99], v[36:39], a[16:19], v[96:99]
  ds_read_b64_tr_b16 v[56:57], v17 offset:57344
  v_cndmask_b32 v155, 0, v236, vcc
  v_mfma_f32_16x16x32_bf16 v[96:99], v[40:43], a[32:35], v[96:99]
  v_lshrrev_b32 v163, 5, v0
  v_mfma_f32_16x16x32_bf16 v[96:99], v[44:47], a[48:51], v[96:99]
  ds_read_b64_tr_b16 v[58:59], v17 offset:59392
  buffer_load_dwordx4 v8, s[60:63], s88 offen offset:3072 lds
  v_mfma_f32_16x16x32_bf16 v[104:107], v[32:35], a[4:7], 0
  ds_read_b64_tr_b16 v[60:61], v17 offset:61440
  v_cvt_pk_bf16_f32 v188, v64, v65
  v_mfma_f32_16x16x32_bf16 v[104:107], v[36:39], a[20:23], v[104:107]
  v_cvt_pk_bf16_f32 v189, v66, v67
  v_cvt_pk_bf16_f32 v190, v68, v69
  v_mfma_f32_16x16x32_bf16 v[104:107], v[40:43], a[36:39], v[104:107]
  ds_read_b64_tr_b16 v[62:63], v17 offset:63488
  v_cvt_pk_bf16_f32 v191, v70, v71
  v_mfma_f32_16x16x32_bf16 v[104:107], v[44:47], a[52:55], v[104:107]
  v_cvt_pk_bf16_f32 v192, v72, v73
  v_cvt_pk_bf16_f32 v193, v74, v75
  v_mfma_f32_16x16x32_bf16 v[112:115], v[32:35], a[8:11], 0
  v_cvt_pk_bf16_f32 v194, v76, v77
  v_cvt_pk_bf16_f32 v195, v78, v79
  v_mfma_f32_16x16x32_bf16 v[112:115], v[36:39], a[24:27], v[112:115]
  v_cvt_pk_bf16_f32 v196, v80, v81
  v_cvt_pk_bf16_f32 v197, v82, v83
  v_mfma_f32_16x16x32_bf16 v[112:115], v[40:43], a[40:43], v[112:115]
  v_cvt_pk_bf16_f32 v198, v84, v85
  v_cvt_pk_bf16_f32 v199, v86, v87
  v_mfma_f32_16x16x32_bf16 v[112:115], v[44:47], a[56:59], v[112:115]
  v_cvt_pk_bf16_f32 v200, v88, v89
  v_cvt_pk_bf16_f32 v201, v90, v91
  v_mfma_f32_16x16x32_bf16 v[120:123], v[32:35], a[12:15], 0
  v_cvt_pk_bf16_f32 v202, v92, v93
  v_cvt_pk_bf16_f32 v203, v94, v95
  v_mfma_f32_16x16x32_bf16 v[120:123], v[36:39], a[28:31], v[120:123]
  v_mul_u32_u24 v163, 146944, v163
  v_mfma_f32_16x16x32_bf16 v[120:123], v[40:43], a[44:47], v[120:123]
  buffer_store_dwordx4 v[176:179], v21, s[64:67], s91 offen offset:1024 sc1
  v_mfma_f32_16x16x32_bf16 v[120:123], v[44:47], a[60:63], v[120:123]
  s_waitcnt lgkmcnt(0)
  v_add_u32 v163, v163, v21
  v_mfma_f32_16x16x32_bf16 v[100:103], v[48:51], a[0:3], 0
  ds_read_b64_tr_b16 v[32:33], v14 offset:16384
  s_mul_i32 s10, s7, 9
  v_mfma_f32_16x16x32_bf16 v[100:103], v[52:55], a[16:19], v[100:103]
  ds_read_b64_tr_b16 v[34:35], v14 offset:18432
  v_readlane_b32 s88, v22, 16
  v_mfma_f32_16x16x32_bf16 v[100:103], v[56:59], a[32:35], v[100:103]
  ds_read_b64_tr_b16 v[36:37], v14 offset:20480
  s_lshl_b32 s11, s3, 1
  v_mfma_f32_16x16x32_bf16 v[100:103], v[60:63], a[48:51], v[100:103]
  ds_read_b64_tr_b16 v[38:39], v14 offset:22528
  s_add_u32 s11, s11, s10
  v_mfma_f32_16x16x32_bf16 v[108:111], v[48:51], a[4:7], 0
  s_add_u32 m0, s9, 98304
  s_mul_i32 s81, s11, 36864
  v_mfma_f32_16x16x32_bf16 v[108:111], v[52:55], a[20:23], v[108:111]
  ds_read_b64_tr_b16 v[40:41], v14 offset:24576
  buffer_load_dwordx4 v5, s[60:63], s88 offen lds
  v_mfma_f32_16x16x32_bf16 v[108:111], v[56:59], a[36:39], v[108:111]
  ds_read_b64_tr_b16 v[42:43], v14 offset:26624
  s_add_u32 s81, s81, 37912576
  v_mfma_f32_16x16x32_bf16 v[108:111], v[60:63], a[52:55], v[108:111]
  s_add_u32 s10, s10, 8
  v_mfma_f32_16x16x32_bf16 v[116:119], v[48:51], a[8:11], 0
  ds_read_b64_tr_b16 v[44:45], v14 offset:28672
  s_mul_i32 s82, s10, 36864
  v_mfma_f32_16x16x32_bf16 v[116:119], v[52:55], a[24:27], v[116:119]
  ds_read_b64_tr_b16 v[46:47], v14 offset:30720
  buffer_load_dwordx4 v6, s[60:63], s88 offen offset:1024 lds
  v_mfma_f32_16x16x32_bf16 v[116:119], v[56:59], a[40:43], v[116:119]
  s_and_b32 s12, s3, 1
  v_mfma_f32_16x16x32_bf16 v[116:119], v[60:63], a[56:59], v[116:119]
  s_mul_i32 s12, s12, 18432
  v_mfma_f32_16x16x32_bf16 v[124:127], v[48:51], a[12:15], 0
  ds_read_b64_tr_b16 v[48:49], v17 offset:16384
  s_add_u32 s82, s82, s12
  v_mfma_f32_16x16x32_bf16 v[124:127], v[52:55], a[28:31], v[124:127]
  ds_read_b64_tr_b16 v[50:51], v17 offset:18432
  s_add_u32 s82, s82, 37912576
  v_mfma_f32_16x16x32_bf16 v[124:127], v[56:59], a[44:47], v[124:127]
  ds_read_b64_tr_b16 v[52:53], v17 offset:20480
  buffer_load_dwordx4 v7, s[60:63], s88 offen offset:2048 lds
  v_mfma_f32_16x16x32_bf16 v[124:127], v[60:63], a[60:63], v[124:127]
  s_waitcnt lgkmcnt(3)
  s_sub_u32 s10, s10, s11
  v_mfma_f32_16x16x32_bf16 v[96:99], v[32:35], a[64:67], v[96:99]
  ds_read_b64_tr_b16 v[54:55], v17 offset:22528
  s_lshl_b32 s10, s10, 13
  v_mfma_f32_16x16x32_bf16 v[96:99], v[36:39], a[80:83], v[96:99]
  ds_read_b64_tr_b16 v[56:57], v17 offset:24576
  s_and_b32 s12, s72, 294912
  v_mfma_f32_16x16x32_bf16 v[96:99], v[40:43], a[96:99], v[96:99]
  s_add_u32 s10, s10, s12
  v_mfma_f32_16x16x32_bf16 v[96:99], v[44:47], a[112:115], v[96:99]
  ds_read_b64_tr_b16 v[58:59], v17 offset:26624
  buffer_load_dwordx4 v8, s[60:63], s88 offen offset:3072 lds
  v_mfma_f32_16x16x32_bf16 v[104:107], v[32:35], a[68:71], v[104:107]
  ds_read_b64_tr_b16 v[60:61], v17 offset:28672
  s_and_b32 s12, s3, 1
  v_mfma_f32_16x16x32_bf16 v[104:107], v[36:39], a[84:87], v[104:107]
  buffer_store_dwordx4 v[180:183], v21, s[64:67], s91 offen offset:2048 sc1
  v_mfma_f32_16x16x32_bf16 v[104:107], v[40:43], a[100:103], v[104:107]
  ds_read_b64_tr_b16 v[62:63], v17 offset:30720
  s_lshl_b32 s12, s12, 9
  v_mfma_f32_16x16x32_bf16 v[104:107], v[44:47], a[116:119], v[104:107]
  s_add_u32 s10, s10, s12
  v_mfma_f32_16x16x32_bf16 v[112:115], v[32:35], a[72:75], v[112:115]
  v_add_u32 v247, s10, v163
  v_mfma_f32_16x16x32_bf16 v[112:115], v[36:39], a[88:91], v[112:115]
  v_add_u32 v246, 8192, v163
  v_mfma_f32_16x16x32_bf16 v[112:115], v[40:43], a[104:107], v[112:115]
  s_and_b32 s12, s72, 5120
  v_mfma_f32_16x16x32_bf16 v[112:115], v[44:47], a[120:123], v[112:115]
  v_add_u32 v245, s12, v21
  v_mfma_f32_16x16x32_bf16 v[120:123], v[32:35], a[76:79], v[120:123]
  s_andn2_b32 s12, 4096, s72
  v_mfma_f32_16x16x32_bf16 v[120:123], v[36:39], a[92:95], v[120:123]
  v_add_u32 v250, s12, v21
  v_mfma_f32_16x16x32_bf16 v[120:123], v[40:43], a[108:111], v[120:123]
  v_add_u32 v167, 4096, v250
  v_mfma_f32_16x16x32_bf16 v[120:123], v[44:47], a[124:127], v[120:123]
  s_waitcnt vmcnt(21) lgkmcnt(0)
  s_barrier
  v_mfma_f32_16x16x32_bf16 v[100:103], v[48:51], a[64:67], v[100:103]
  ds_read_b64_tr_b16 v[32:33], v15 offset:0
  s_and_b32 s12, s72, 1073741824
  v_mfma_f32_16x16x32_bf16 v[100:103], v[52:55], a[80:83], v[100:103]
  ds_read_b64_tr_b16 v[34:35], v15 offset:2048
  v_readlane_b32 s88, v22, 17
  v_mfma_f32_16x16x32_bf16 v[100:103], v[56:59], a[96:99], v[100:103]
  ds_read_b64_tr_b16 v[36:37], v15 offset:4096
  v_add_u32 v248, s12, v250
  v_mfma_f32_16x16x32_bf16 v[100:103], v[60:63], a[112:115], v[100:103]
  ds_read_b64_tr_b16 v[38:39], v15 offset:6144
  s_getreg_b32 s42, hwreg(HW_REG_XCC_ID, 0, 4)
  v_mfma_f32_16x16x32_bf16 v[108:111], v[48:51], a[68:71], v[108:111]
  s_add_u32 m0, s9, 81920
  s_add_u32 s42, s42, 1
  v_mfma_f32_16x16x32_bf16 v[108:111], v[52:55], a[84:87], v[108:111]
  ds_read_b64_tr_b16 v[40:41], v15 offset:8192
  buffer_load_dwordx4 v5, s[60:63], s88 offen lds
  v_mfma_f32_16x16x32_bf16 v[108:111], v[56:59], a[100:103], v[108:111]
  ds_read_b64_tr_b16 v[42:43], v15 offset:10240
  v_mov_b32 v166, s42
  v_mfma_f32_16x16x32_bf16 v[108:111], v[60:63], a[116:119], v[108:111]
  s_mov_b32 s14, 0x07060302
  v_mfma_f32_16x16x32_bf16 v[116:119], v[48:51], a[72:75], v[116:119]
  ds_read_b64_tr_b16 v[44:45], v15 offset:12288
  buffer_load_dwordx4 v6, s[60:63], s88 offen offset:1024 lds
  v_mfma_f32_16x16x32_bf16 v[116:119], v[52:55], a[88:91], v[116:119]
  ds_read_b64_tr_b16 v[46:47], v15 offset:14336
  s_mul_i32 s8, s7, 9216
  v_mfma_f32_16x16x32_bf16 v[116:119], v[56:59], a[104:107], v[116:119]
  buffer_store_dwordx4 v[184:187], v21, s[64:67], s91 offen offset:3072 sc1
  v_mfma_f32_16x16x32_bf16 v[116:119], v[60:63], a[120:123], v[116:119]
  s_add_u32 s91, s74, 32768
  s_sub_u32 s15, 9216, s8
  v_mfma_f32_16x16x32_bf16 v[124:127], v[48:51], a[76:79], v[124:127]
  ds_read_b64_tr_b16 v[48:49], v18 offset:0
  buffer_load_dwordx4 v7, s[60:63], s88 offen offset:2048 lds
  v_mfma_f32_16x16x32_bf16 v[124:127], v[52:55], a[92:95], v[124:127]
  ds_read_b64_tr_b16 v[50:51], v18 offset:2048
  v_lshlrev_b32 v164, 4, v0
  v_mfma_f32_16x16x32_bf16 v[124:127], v[56:59], a[108:111], v[124:127]
  ds_read_b64_tr_b16 v[52:53], v18 offset:4096
  v_and_b32 v236, 31, v0
  v_mfma_f32_16x16x32_bf16 v[124:127], v[60:63], a[124:127], v[124:127]
  s_waitcnt lgkmcnt(3)
  v_mov_b32 v237, 0x10000
  v_mfma_f32_16x16x32_bf16 v[96:99], v[32:35], a[128:131], v[96:99]
  ds_read_b64_tr_b16 v[54:55], v18 offset:6144
  buffer_load_dwordx4 v8, s[60:63], s88 offen offset:3072 lds
  v_readlane_b32 s88, v22, 18
  v_mfma_f32_16x16x32_bf16 v[64:67], v[36:39], a[0:3], 0
  ds_read_b64_tr_b16 v[56:57], v18 offset:8192
  v_cmp_lt_u32 vcc, 18, v236
  v_mfma_f32_16x16x32_bf16 v[64:67], v[40:43], a[16:19], v[64:67]
  s_add_u32 m0, s9, 114688
  v_lshrrev_b32 v238, 5, v0
  v_mfma_f32_16x16x32_bf16 v[64:67], v[44:47], a[32:35], v[64:67]
  ds_read_b64_tr_b16 v[58:59], v18 offset:10240
  buffer_load_dwordx4 v5, s[60:63], s88 offen lds
  v_mfma_f32_16x16x32_bf16 v[104:107], v[32:35], a[132:135], v[104:107]
  ds_read_b64_tr_b16 v[60:61], v18 offset:12288
  v_mul_u32_u24 v238, 304, v238
  v_mfma_f32_16x16x32_bf16 v[72:75], v[36:39], a[4:7], 0
  v_cndmask_b32 v236, v236, v237, vcc
  v_mfma_f32_16x16x32_bf16 v[72:75], v[40:43], a[20:23], v[72:75]
  ds_read_b64_tr_b16 v[62:63], v18 offset:14336
  v_lshl_add_u32 v165, v236, 4, v238
  v_mfma_f32_16x16x32_bf16 v[72:75], v[44:47], a[36:39], v[72:75]
  s_lshr_b32 s10, s6, 3
  v_mfma_f32_16x16x32_bf16 v[112:115], v[32:35], a[136:139], v[112:115]
  s_lshl_b32 s10, s10, 6
  v_mfma_f32_16x16x32_bf16 v[80:83], v[36:39], a[8:11], 0
  s_add_u32 s10, s10, 45875200
  v_mfma_f32_16x16x32_bf16 v[80:83], v[40:43], a[24:27], v[80:83]
  v_and_b32 v249, 48, v0
  v_mfma_f32_16x16x32_bf16 v[80:83], v[44:47], a[40:43], v[80:83]
  v_lshlrev_b32 v249, 22, v249
  v_mfma_f32_16x16x32_bf16 v[120:123], v[32:35], a[140:143], v[120:123]
  v_lshl_add_u32 v249, v0, 2, v249
  v_mfma_f32_16x16x32_bf16 v[88:91], v[36:39], a[12:15], 0
  v_add_u32 v249, s10, v249
  v_mfma_f32_16x16x32_bf16 v[88:91], v[40:43], a[28:31], v[88:91]
  s_and_b32 s97, s97, 0xfffffff
  v_mfma_f32_16x16x32_bf16 v[88:91], v[44:47], a[44:47], v[88:91]
  s_waitcnt lgkmcnt(0)
  s_xor_b32 s97, s97, 64
  v_mfma_f32_16x16x32_bf16 v[100:103], v[48:51], a[128:131], v[100:103]
  ds_read_b64_tr_b16 v[32:33], v13 offset:0
  v_writelane_b32 v249, s97, 16
  v_mfma_f32_16x16x32_bf16 v[68:71], v[52:55], a[0:3], 0
  ds_read_b64_tr_b16 v[34:35], v13 offset:2048
  v_mfma_f32_16x16x32_bf16 v[68:71], v[56:59], a[16:19], v[68:71]
  ds_read_b64_tr_b16 v[36:37], v13 offset:4096
  v_mfma_f32_16x16x32_bf16 v[68:71], v[60:63], a[32:35], v[68:71]
  ds_read_b64_tr_b16 v[38:39], v13 offset:6144
  v_mfma_f32_16x16x32_bf16 v[108:111], v[48:51], a[132:135], v[108:111]
  buffer_store_dwordx4 v[204:207], v21, s[64:67], s91 offen offset:0 sc1
  v_mfma_f32_16x16x32_bf16 v[76:79], v[52:55], a[4:7], 0
  ds_read_b64_tr_b16 v[40:41], v13 offset:8192
  buffer_load_dwordx4 v6, s[60:63], s88 offen offset:1024 lds
  v_mfma_f32_16x16x32_bf16 v[76:79], v[56:59], a[20:23], v[76:79]
  ds_read_b64_tr_b16 v[42:43], v13 offset:10240
  v_mfma_f32_16x16x32_bf16 v[76:79], v[60:63], a[36:39], v[76:79]
  v_mfma_f32_16x16x32_bf16 v[116:119], v[48:51], a[136:139], v[116:119]
  ds_read_b64_tr_b16 v[44:45], v13 offset:12288
  v_mfma_f32_16x16x32_bf16 v[84:87], v[52:55], a[8:11], 0
  ds_read_b64_tr_b16 v[46:47], v13 offset:14336
  v_mfma_f32_16x16x32_bf16 v[84:87], v[56:59], a[24:27], v[84:87]
  v_mfma_f32_16x16x32_bf16 v[84:87], v[60:63], a[40:43], v[84:87]
  v_mfma_f32_16x16x32_bf16 v[124:127], v[48:51], a[140:143], v[124:127]
  ds_read_b64_tr_b16 v[48:49], v16 offset:0
  buffer_load_dwordx4 v7, s[60:63], s88 offen offset:2048 lds
  v_mfma_f32_16x16x32_bf16 v[92:95], v[52:55], a[12:15], 0
  ds_read_b64_tr_b16 v[50:51], v16 offset:2048
  v_mfma_f32_16x16x32_bf16 v[92:95], v[56:59], a[28:31], v[92:95]
  ds_read_b64_tr_b16 v[52:53], v16 offset:4096
  v_mfma_f32_16x16x32_bf16 v[92:95], v[60:63], a[44:47], v[92:95]
  s_waitcnt lgkmcnt(3)
  v_mfma_f32_16x16x32_bf16 v[64:67], v[32:35], a[48:51], v[64:67]
  ds_read_b64_tr_b16 v[54:55], v16 offset:6144
  v_cvt_pk_bf16_f32 v220, v96, v97
  v_mfma_f32_16x16x32_bf16 v[64:67], v[36:39], a[64:67], v[64:67]
  ds_read_b64_tr_b16 v[56:57], v16 offset:8192
  buffer_load_dwordx4 v8, s[60:63], s88 offen offset:3072 lds
  v_mfma_f32_16x16x32_bf16 v[64:67], v[40:43], a[80:83], v[64:67]
  v_cvt_pk_bf16_f32 v221, v98, v99
  v_cvt_pk_bf16_f32 v222, v100, v101
  v_mfma_f32_16x16x32_bf16 v[64:67], v[44:47], a[96:99], v[64:67]
  ds_read_b64_tr_b16 v[58:59], v16 offset:10240
  v_cvt_pk_bf16_f32 v223, v102, v103
  v_mfma_f32_16x16x32_bf16 v[72:75], v[32:35], a[52:55], v[72:75]
  ds_read_b64_tr_b16 v[60:61], v16 offset:12288
  v_cvt_pk_bf16_f32 v224, v104, v105
  v_mfma_f32_16x16x32_bf16 v[72:75], v[36:39], a[68:71], v[72:75]
  v_cvt_pk_bf16_f32 v225, v106, v107
  v_cvt_pk_bf16_f32 v226, v108, v109
  v_mfma_f32_16x16x32_bf16 v[72:75], v[40:43], a[84:87], v[72:75]
  ds_read_b64_tr_b16 v[62:63], v16 offset:14336
  v_cvt_pk_bf16_f32 v227, v110, v111
  v_mfma_f32_16x16x32_bf16 v[72:75], v[44:47], a[100:103], v[72:75]
  buffer_store_dwordx4 v[208:211], v21, s[64:67], s91 offen offset:1024 sc1
  v_mfma_f32_16x16x32_bf16 v[80:83], v[32:35], a[56:59], v[80:83]
  v_cvt_pk_bf16_f32 v228, v112, v113
  v_cvt_pk_bf16_f32 v229, v114, v115
  v_mfma_f32_16x16x32_bf16 v[80:83], v[36:39], a[72:75], v[80:83]
  v_cvt_pk_bf16_f32 v230, v116, v117
  v_cvt_pk_bf16_f32 v231, v118, v119
  v_mfma_f32_16x16x32_bf16 v[80:83], v[40:43], a[88:91], v[80:83]
  v_cvt_pk_bf16_f32 v232, v120, v121
  v_cvt_pk_bf16_f32 v233, v122, v123
  v_mfma_f32_16x16x32_bf16 v[80:83], v[44:47], a[104:107], v[80:83]
  v_cvt_pk_bf16_f32 v234, v124, v125
  v_cvt_pk_bf16_f32 v235, v126, v127
  v_mfma_f32_16x16x32_bf16 v[88:91], v[32:35], a[60:63], v[88:91]
  v_mfma_f32_16x16x32_bf16 v[88:91], v[36:39], a[76:79], v[88:91]
  v_mfma_f32_16x16x32_bf16 v[88:91], v[40:43], a[92:95], v[88:91]
  v_mfma_f32_16x16x32_bf16 v[88:91], v[44:47], a[108:111], v[88:91]
  s_waitcnt vmcnt(22) lgkmcnt(0)
  s_barrier
  v_mfma_f32_16x16x32_bf16 v[68:71], v[48:51], a[48:51], v[68:71]
  ds_read_b64_tr_b16 v[32:33], v15 offset:16384
  v_mfma_f32_16x16x32_bf16 v[68:71], v[52:55], a[64:67], v[68:71]
  ds_read_b64_tr_b16 v[34:35], v15 offset:18432
  v_readlane_b32 s88, v22, 19
  v_mfma_f32_16x16x32_bf16 v[68:71], v[56:59], a[80:83], v[68:71]
  ds_read_b64_tr_b16 v[36:37], v18 offset:16384
  v_mfma_f32_16x16x32_bf16 v[68:71], v[60:63], a[96:99], v[68:71]
  ds_read_b64_tr_b16 v[38:39], v18 offset:18432
  v_mfma_f32_16x16x32_bf16 v[76:79], v[48:51], a[52:55], v[76:79]
  s_add_u32 m0, s9, 131072
  v_mfma_f32_16x16x32_bf16 v[76:79], v[52:55], a[68:71], v[76:79]
  ds_read_b64_tr_b16 v[40:41], v15 offset:20480
  buffer_load_dwordx4 v5, s[60:63], s88 offen lds
  v_mfma_f32_16x16x32_bf16 v[76:79], v[56:59], a[84:87], v[76:79]
  ds_read_b64_tr_b16 v[42:43], v15 offset:22528
  v_mfma_f32_16x16x32_bf16 v[76:79], v[60:63], a[100:103], v[76:79]
PAD9:
  s_cbranch_execz PAD13
  v_mfma_f32_16x16x32_bf16 v[84:87], v[48:51], a[56:59], v[84:87]
  ds_read_b64_tr_b16 v[44:45], v18 offset:20480
  buffer_load_dwordx4 v6, s[60:63], s88 offen offset:1024 lds
  v_mfma_f32_16x16x32_bf16 v[84:87], v[52:55], a[72:75], v[84:87]
  ds_read_b64_tr_b16 v[46:47], v18 offset:22528
  v_mfma_f32_16x16x32_bf16 v[84:87], v[56:59], a[88:91], v[84:87]
  v_mfma_f32_16x16x32_bf16 v[84:87], v[60:63], a[104:107], v[84:87]
  v_mfma_f32_16x16x32_bf16 v[92:95], v[48:51], a[60:63], v[92:95]
  ds_read_b64_tr_b16 v[48:49], v15 offset:24576
  buffer_load_dwordx4 v7, s[60:63], s88 offen offset:2048 lds
  v_mfma_f32_16x16x32_bf16 v[92:95], v[52:55], a[76:79], v[92:95]
  ds_read_b64_tr_b16 v[50:51], v15 offset:26624
  v_mfma_f32_16x16x32_bf16 v[92:95], v[56:59], a[92:95], v[92:95]
  ds_read_b64_tr_b16 v[52:53], v18 offset:24576
  v_mfma_f32_16x16x32_bf16 v[92:95], v[60:63], a[108:111], v[92:95]
  s_waitcnt lgkmcnt(3)
  buffer_store_dwordx4 v[212:215], v21, s[64:67], s91 offen offset:2048 sc1
  v_mfma_f32_16x16x32_bf16 v[64:67], v[32:35], a[112:115], v[64:67]
  ds_read_b64_tr_b16 v[54:55], v18 offset:26624
  buffer_load_dwordx4 v8, s[60:63], s88 offen offset:3072 lds
  v_mfma_f32_16x16x32_bf16 v[64:67], v[40:43], a[128:131], v[64:67]
  ds_read_b64_tr_b16 v[56:57], v15 offset:28672
  v_mfma_f32_16x16x32_bf16 v[72:75], v[32:35], a[116:119], v[72:75]
  s_add_u32 m0, s9, 0
  s_add_u32 s88, s86, 0
  v_mfma_f32_16x16x32_bf16 v[72:75], v[40:43], a[132:135], v[72:75]
  ds_read_b64_tr_b16 v[58:59], v15 offset:30720
  buffer_load_dwordx4 v21, s[64:67], s88 offen lds
  v_mfma_f32_16x16x32_bf16 v[80:83], v[32:35], a[120:123], v[80:83]
  ds_read_b64_tr_b16 v[60:61], v18 offset:28672
  v_mfma_f32_16x16x32_bf16 v[80:83], v[40:43], a[136:139], v[80:83]
  v_mfma_f32_16x16x32_bf16 v[88:91], v[32:35], a[124:127], v[88:91]
  ds_read_b64_tr_b16 v[62:63], v18 offset:30720
  v_mfma_f32_16x16x32_bf16 v[88:91], v[40:43], a[140:143], v[88:91]
  v_mfma_f32_16x16x32_bf16 v[68:71], v[36:39], a[112:115], v[68:71]
  v_mfma_f32_16x16x32_bf16 v[68:71], v[44:47], a[128:131], v[68:71]
  v_mfma_f32_16x16x32_bf16 v[76:79], v[36:39], a[116:119], v[76:79]
  v_mfma_f32_16x16x32_bf16 v[76:79], v[44:47], a[132:135], v[76:79]
  v_mfma_f32_16x16x32_bf16 v[84:87], v[36:39], a[120:123], v[84:87]
  v_mfma_f32_16x16x32_bf16 v[84:87], v[44:47], a[136:139], v[84:87]
  v_mfma_f32_16x16x32_bf16 v[92:95], v[36:39], a[124:127], v[92:95]
  v_mfma_f32_16x16x32_bf16 v[92:95], v[44:47], a[140:143], v[92:95]
  s_waitcnt lgkmcnt(0)
  v_mfma_f32_16x16x32_bf16 v[96:99], v[48:51], a[0:3], 0
  ds_read_b64_tr_b16 v[32:33], v13 offset:32768
  v_mfma_f32_16x16x32_bf16 v[96:99], v[56:59], a[16:19], v[96:99]
  ds_read_b64_tr_b16 v[34:35], v13 offset:34816
  v_mfma_f32_16x16x32_bf16 v[104:107], v[48:51], a[4:7], 0
  ds_read_b64_tr_b16 v[36:37], v13 offset:36864
  v_mfma_f32_16x16x32_bf16 v[104:107], v[56:59], a[20:23], v[104:107]
  ds_read_b64_tr_b16 v[38:39], v13 offset:38912
  v_cvt_pk_bf16_f32 v172, v64, v65
  v_mfma_f32_16x16x32_bf16 v[112:115], v[48:51], a[8:11], 0
  buffer_store_dwordx4 v[216:219], v21, s[64:67], s91 offen offset:3072 sc1
  v_mfma_f32_16x16x32_bf16 v[112:115], v[56:59], a[24:27], v[112:115]
  ds_read_b64_tr_b16 v[40:41], v13 offset:40960
  buffer_load_dwordx4 v21, s[64:67], s88 offen offset:1024 lds
  v_mfma_f32_16x16x32_bf16 v[120:123], v[48:51], a[12:15], 0
  ds_read_b64_tr_b16 v[42:43], v13 offset:43008
  s_add_u32 s91, s74, 49152
  v_mfma_f32_16x16x32_bf16 v[120:123], v[56:59], a[28:31], v[120:123]
  v_cvt_pk_bf16_f32 v173, v66, v67
  v_cvt_pk_bf16_f32 v174, v68, v69
  v_mfma_f32_16x16x32_bf16 v[100:103], v[52:55], a[0:3], 0
  ds_read_b64_tr_b16 v[44:45], v13 offset:45056
  buffer_load_dwordx4 v21, s[64:67], s88 offen offset:2048 lds
  v_mfma_f32_16x16x32_bf16 v[100:103], v[60:63], a[16:19], v[100:103]
  ds_read_b64_tr_b16 v[46:47], v13 offset:47104
  v_cvt_pk_bf16_f32 v175, v70, v71
  v_mfma_f32_16x16x32_bf16 v[108:111], v[52:55], a[4:7], 0
  v_cvt_pk_bf16_f32 v176, v72, v73
  v_cvt_pk_bf16_f32 v177, v74, v75
  v_mfma_f32_16x16x32_bf16 v[108:111], v[60:63], a[20:23], v[108:111]
  v_cvt_pk_bf16_f32 v178, v76, v77
  v_cvt_pk_bf16_f32 v179, v78, v79
  v_mfma_f32_16x16x32_bf16 v[116:119], v[52:55], a[8:11], 0
  ds_read_b64_tr_b16 v[48:49], v16 offset:32768
  buffer_load_dwordx4 v21, s[64:67], s88 offen offset:3072 lds
  s_add_u32 m0, s9, 16384
  v_mfma_f32_16x16x32_bf16 v[116:119], v[60:63], a[24:27], v[116:119]
  ds_read_b64_tr_b16 v[50:51], v16 offset:34816
  s_add_u32 s88, s86, 16384
  v_mfma_f32_16x16x32_bf16 v[124:127], v[52:55], a[12:15], 0
  ds_read_b64_tr_b16 v[52:53], v16 offset:36864
  v_cvt_pk_bf16_f32 v180, v80, v81
  v_mfma_f32_16x16x32_bf16 v[124:127], v[60:63], a[28:31], v[124:127]
  s_waitcnt lgkmcnt(3)
  v_cvt_pk_bf16_f32 v181, v82, v83
  v_cvt_pk_bf16_f32 v182, v84, v85
  v_mfma_f32_16x16x32_bf16 v[96:99], v[32:35], a[32:35], v[96:99]
  ds_read_b64_tr_b16 v[54:55], v16 offset:38912
  buffer_load_dwordx4 v21, s[64:67], s88 offen lds
  v_mfma_f32_16x16x32_bf16 v[96:99], v[36:39], a[48:51], v[96:99]
  ds_read_b64_tr_b16 v[56:57], v16 offset:40960
  v_cvt_pk_bf16_f32 v183, v86, v87
  v_mfma_f32_16x16x32_bf16 v[96:99], v[40:43], a[64:67], v[96:99]
  v_cvt_pk_bf16_f32 v184, v88, v89
  v_cvt_pk_bf16_f32 v185, v90, v91
  v_mfma_f32_16x16x32_bf16 v[96:99], v[44:47], a[80:83], v[96:99]
  ds_read_b64_tr_b16 v[58:59], v16 offset:43008
  buffer_load_dwordx4 v21, s[64:67], s88 offen offset:1024 lds
  v_mfma_f32_16x16x32_bf16 v[104:107], v[32:35], a[36:39], v[104:107]
  ds_read_b64_tr_b16 v[60:61], v16 offset:45056
  v_cvt_pk_bf16_f32 v186, v92, v93
  v_mfma_f32_16x16x32_bf16 v[104:107], v[36:39], a[52:55], v[104:107]
  v_cvt_pk_bf16_f32 v187, v94, v95
  v_mfma_f32_16x16x32_bf16 v[104:107], v[40:43], a[68:71], v[104:107]
  ds_read_b64_tr_b16 v[62:63], v16 offset:47104
  v_mfma_f32_16x16x32_bf16 v[104:107], v[44:47], a[84:87], v[104:107]
  v_mfma_f32_16x16x32_bf16 v[112:115], v[32:35], a[40:43], v[112:115]
  buffer_store_dwordx4 v[188:191], v21, s[64:67], s91 offen offset:0 sc1
  v_mfma_f32_16x16x32_bf16 v[112:115], v[36:39], a[56:59], v[112:115]
  v_mfma_f32_16x16x32_bf16 v[112:115], v[40:43], a[72:75], v[112:115]
  v_mfma_f32_16x16x32_bf16 v[112:115], v[44:47], a[88:91], v[112:115]
  v_mfma_f32_16x16x32_bf16 v[120:123], v[32:35], a[44:47], v[120:123]
  v_mfma_f32_16x16x32_bf16 v[120:123], v[36:39], a[60:63], v[120:123]
  v_mfma_f32_16x16x32_bf16 v[120:123], v[40:43], a[76:79], v[120:123]
  v_mfma_f32_16x16x32_bf16 v[120:123], v[44:47], a[92:95], v[120:123]
  s_waitcnt vmcnt(25) lgkmcnt(0)
  s_barrier
  v_mfma_f32_16x16x32_bf16 v[100:103], v[48:51], a[32:35], v[100:103]
  ds_read_b64_tr_b16 v[32:33], v14 offset:0
  v_mfma_f32_16x16x32_bf16 v[100:103], v[52:55], a[48:51], v[100:103]
  ds_read_b64_tr_b16 v[34:35], v14 offset:2048
  v_mfma_f32_16x16x32_bf16 v[100:103], v[56:59], a[64:67], v[100:103]
  ds_read_b64_tr_b16 v[36:37], v14 offset:4096
  v_mfma_f32_16x16x32_bf16 v[100:103], v[60:63], a[80:83], v[100:103]
  ds_read_b64_tr_b16 v[38:39], v14 offset:6144
  v_mfma_f32_16x16x32_bf16 v[108:111], v[48:51], a[36:39], v[108:111]
  v_mfma_f32_16x16x32_bf16 v[108:111], v[52:55], a[52:55], v[108:111]
  ds_read_b64_tr_b16 v[40:41], v14 offset:8192
  buffer_load_dwordx4 v21, s[64:67], s88 offen offset:2048 lds
  v_mfma_f32_16x16x32_bf16 v[108:111], v[56:59], a[68:71], v[108:111]
  ds_read_b64_tr_b16 v[42:43], v14 offset:10240
  v_mfma_f32_16x16x32_bf16 v[108:111], v[60:63], a[84:87], v[108:111]
  v_mfma_f32_16x16x32_bf16 v[116:119], v[48:51], a[40:43], v[116:119]
  ds_read_b64_tr_b16 v[44:45], v14 offset:12288
  buffer_load_dwordx4 v21, s[64:67], s88 offen offset:3072 lds
  v_readlane_b32 s88, v22, 20
  v_mfma_f32_16x16x32_bf16 v[116:119], v[52:55], a[56:59], v[116:119]
  ds_read_b64_tr_b16 v[46:47], v14 offset:14336
  v_mfma_f32_16x16x32_bf16 v[116:119], v[56:59], a[72:75], v[116:119]
  s_add_u32 m0, s9, 147456
  v_mfma_f32_16x16x32_bf16 v[116:119], v[60:63], a[88:91], v[116:119]
  v_mfma_f32_16x16x32_bf16 v[124:127], v[48:51], a[44:47], v[124:127]
  ds_read_b64_tr_b16 v[48:49], v17 offset:0
  buffer_load_dwordx4 v5, s[60:63], s88 offen lds
  v_mfma_f32_16x16x32_bf16 v[124:127], v[52:55], a[60:63], v[124:127]
  ds_read_b64_tr_b16 v[50:51], v17 offset:2048
  v_mfma_f32_16x16x32_bf16 v[124:127], v[56:59], a[76:79], v[124:127]
  ds_read_b64_tr_b16 v[52:53], v17 offset:4096
  v_mfma_f32_16x16x32_bf16 v[124:127], v[60:63], a[92:95], v[124:127]
  s_waitcnt lgkmcnt(3)
  buffer_store_dwordx4 v[192:195], v21, s[64:67], s91 offen offset:1024 sc1
  v_mfma_f32_16x16x32_bf16 v[96:99], v[32:35], a[96:99], v[96:99]
  ds_read_b64_tr_b16 v[54:55], v17 offset:6144
  buffer_load_dwordx4 v6, s[60:63], s88 offen offset:1024 lds
  v_mfma_f32_16x16x32_bf16 v[96:99], v[36:39], a[112:115], v[96:99]
  ds_read_b64_tr_b16 v[56:57], v17 offset:8192
  v_mfma_f32_16x16x32_bf16 v[96:99], v[40:43], a[128:131], v[96:99]
  v_mfma_f32_16x16x32_bf16 v[64:67], v[44:47], a[0:3], 0
  ds_read_b64_tr_b16 v[58:59], v17 offset:10240
  buffer_load_dwordx4 v7, s[60:63], s88 offen offset:2048 lds
  v_mfma_f32_16x16x32_bf16 v[104:107], v[32:35], a[100:103], v[104:107]
  ds_read_b64_tr_b16 v[60:61], v17 offset:12288
  v_mfma_f32_16x16x32_bf16 v[104:107], v[36:39], a[116:119], v[104:107]
  v_mfma_f32_16x16x32_bf16 v[104:107], v[40:43], a[132:135], v[104:107]
  ds_read_b64_tr_b16 v[62:63], v17 offset:14336
  v_mfma_f32_16x16x32_bf16 v[72:75], v[44:47], a[4:7], 0
  v_mfma_f32_16x16x32_bf16 v[112:115], v[32:35], a[104:107], v[112:115]
  v_mfma_f32_16x16x32_bf16 v[112:115], v[36:39], a[120:123], v[112:115]
  v_mfma_f32_16x16x32_bf16 v[112:115], v[40:43], a[136:139], v[112:115]
  v_mfma_f32_16x16x32_bf16 v[80:83], v[44:47], a[8:11], 0
  v_mfma_f32_16x16x32_bf16 v[120:123], v[32:35], a[108:111], v[120:123]
  v_mfma_f32_16x16x32_bf16 v[120:123], v[36:39], a[124:127], v[120:123]
  v_mfma_f32_16x16x32_bf16 v[120:123], v[40:43], a[140:143], v[120:123]
  v_mfma_f32_16x16x32_bf16 v[88:91], v[44:47], a[12:15], 0
  s_waitcnt lgkmcnt(0)
  v_mfma_f32_16x16x32_bf16 v[100:103], v[48:51], a[96:99], v[100:103]
  ds_read_b64_tr_b16 v[32:33], v14 offset:32768
  v_mfma_f32_16x16x32_bf16 v[100:103], v[52:55], a[112:115], v[100:103]
  ds_read_b64_tr_b16 v[34:35], v14 offset:34816
  v_mfma_f32_16x16x32_bf16 v[100:103], v[56:59], a[128:131], v[100:103]
  ds_read_b64_tr_b16 v[36:37], v14 offset:36864
  v_mfma_f32_16x16x32_bf16 v[68:71], v[60:63], a[0:3], 0
  ds_read_b64_tr_b16 v[38:39], v14 offset:38912
  v_mfma_f32_16x16x32_bf16 v[108:111], v[48:51], a[100:103], v[108:111]
  buffer_store_dwordx4 v[196:199], v21, s[64:67], s91 offen offset:2048 sc1
  v_mfma_f32_16x16x32_bf16 v[108:111], v[52:55], a[116:119], v[108:111]
  ds_read_b64_tr_b16 v[40:41], v14 offset:40960
  buffer_load_dwordx4 v8, s[60:63], s88 offen offset:3072 lds
  v_mfma_f32_16x16x32_bf16 v[108:111], v[56:59], a[132:135], v[108:111]
  ds_read_b64_tr_b16 v[42:43], v14 offset:43008
  v_mfma_f32_16x16x32_bf16 v[76:79], v[60:63], a[4:7], 0
  s_add_u32 m0, s9, 32768
  s_add_u32 s88, s86, 32768
  v_mfma_f32_16x16x32_bf16 v[116:119], v[48:51], a[104:107], v[116:119]
  ds_read_b64_tr_b16 v[44:45], v14 offset:45056
  buffer_load_dwordx4 v21, s[64:67], s88 offen lds
  v_mfma_f32_16x16x32_bf16 v[116:119], v[52:55], a[120:123], v[116:119]
  ds_read_b64_tr_b16 v[46:47], v14 offset:47104
  v_mfma_f32_16x16x32_bf16 v[116:119], v[56:59], a[136:139], v[116:119]
  v_mfma_f32_16x16x32_bf16 v[84:87], v[60:63], a[8:11], 0
  v_mfma_f32_16x16x32_bf16 v[124:127], v[48:51], a[108:111], v[124:127]
  ds_read_b64_tr_b16 v[48:49], v17 offset:32768
  buffer_load_dwordx4 v21, s[64:67], s88 offen offset:1024 lds
  v_mfma_f32_16x16x32_bf16 v[124:127], v[52:55], a[124:127], v[124:127]
  ds_read_b64_tr_b16 v[50:51], v17 offset:34816
  v_mfma_f32_16x16x32_bf16 v[124:127], v[56:59], a[140:143], v[124:127]
  ds_read_b64_tr_b16 v[52:53], v17 offset:36864
  v_mfma_f32_16x16x32_bf16 v[92:95], v[60:63], a[12:15], 0
  s_waitcnt lgkmcnt(3)
  v_mfma_f32_16x16x32_bf16 v[64:67], v[32:35], a[16:19], v[64:67]
  ds_read_b64_tr_b16 v[54:55], v17 offset:38912
  buffer_load_dwordx4 v21, s[64:67], s88 offen offset:2048 lds
  v_mfma_f32_16x16x32_bf16 v[64:67], v[36:39], a[32:35], v[64:67]
  ds_read_b64_tr_b16 v[56:57], v17 offset:40960
  v_mfma_f32_16x16x32_bf16 v[64:67], v[40:43], a[48:51], v[64:67]
  v_cvt_pk_bf16_f32 v204, v96, v97
  v_cvt_pk_bf16_f32 v205, v98, v99
  v_mfma_f32_16x16x32_bf16 v[64:67], v[44:47], a[64:67], v[64:67]
  ds_read_b64_tr_b16 v[58:59], v17 offset:43008
  buffer_load_dwordx4 v21, s[64:67], s88 offen offset:3072 lds
  v_mfma_f32_16x16x32_bf16 v[72:75], v[32:35], a[20:23], v[72:75]
  ds_read_b64_tr_b16 v[60:61], v17 offset:45056
  v_cvt_pk_bf16_f32 v206, v100, v101
  v_mfma_f32_16x16x32_bf16 v[72:75], v[36:39], a[36:39], v[72:75]
  v_cvt_pk_bf16_f32 v207, v102, v103
  v_cvt_pk_bf16_f32 v208, v104, v105
  v_mfma_f32_16x16x32_bf16 v[72:75], v[40:43], a[52:55], v[72:75]
  ds_read_b64_tr_b16 v[62:63], v17 offset:47104
  v_cvt_pk_bf16_f32 v209, v106, v107
  v_mfma_f32_16x16x32_bf16 v[72:75], v[44:47], a[68:71], v[72:75]
  v_cvt_pk_bf16_f32 v210, v108, v109
  v_cvt_pk_bf16_f32 v211, v110, v111
  v_mfma_f32_16x16x32_bf16 v[80:83], v[32:35], a[24:27], v[80:83]
  v_cvt_pk_bf16_f32 v212, v112, v113
  v_cvt_pk_bf16_f32 v213, v114, v115
  v_mfma_f32_16x16x32_bf16 v[80:83], v[36:39], a[40:43], v[80:83]
  v_cvt_pk_bf16_f32 v214, v116, v117
  v_cvt_pk_bf16_f32 v215, v118, v119
  v_mfma_f32_16x16x32_bf16 v[80:83], v[40:43], a[56:59], v[80:83]
  buffer_store_dwordx4 v[200:203], v21, s[64:67], s91 offen offset:3072 sc1
  v_mfma_f32_16x16x32_bf16 v[80:83], v[44:47], a[72:75], v[80:83]
  s_add_u32 s91, s74, 65536
  v_cvt_pk_bf16_f32 v216, v120, v121
  v_mfma_f32_16x16x32_bf16 v[88:91], v[32:35], a[28:31], v[88:91]
  v_cvt_pk_bf16_f32 v217, v122, v123
  v_cvt_pk_bf16_f32 v218, v124, v125
  v_mfma_f32_16x16x32_bf16 v[88:91], v[36:39], a[44:47], v[88:91]
  v_cvt_pk_bf16_f32 v219, v126, v127
  v_mfma_f32_16x16x32_bf16 v[88:91], v[40:43], a[60:63], v[88:91]
  v_mfma_f32_16x16x32_bf16 v[88:91], v[44:47], a[76:79], v[88:91]
  s_waitcnt vmcnt(27) lgkmcnt(0)
  s_barrier
  v_mfma_f32_16x16x32_bf16 v[68:71], v[48:51], a[16:19], v[68:71]
  ds_read_b64_tr_b16 v[32:33], v14 offset:16384
  v_mfma_f32_16x16x32_bf16 v[68:71], v[52:55], a[32:35], v[68:71]
  ds_read_b64_tr_b16 v[34:35], v14 offset:18432
  v_mfma_f32_16x16x32_bf16 v[68:71], v[56:59], a[48:51], v[68:71]
  ds_read_b64_tr_b16 v[36:37], v14 offset:20480
  v_mfma_f32_16x16x32_bf16 v[68:71], v[60:63], a[64:67], v[68:71]
  ds_read_b64_tr_b16 v[38:39], v14 offset:22528
  v_mfma_f32_16x16x32_bf16 v[76:79], v[48:51], a[20:23], v[76:79]
  s_add_u32 m0, s9, 49152
  s_add_u32 s88, s86, 49152
  v_mfma_f32_16x16x32_bf16 v[76:79], v[52:55], a[36:39], v[76:79]
  ds_read_b64_tr_b16 v[40:41], v14 offset:24576
  buffer_load_dwordx4 v21, s[64:67], s88 offen lds
  v_mfma_f32_16x16x32_bf16 v[76:79], v[56:59], a[52:55], v[76:79]
  ds_read_b64_tr_b16 v[42:43], v14 offset:26624
  v_mfma_f32_16x16x32_bf16 v[76:79], v[60:63], a[68:71], v[76:79]
  v_mfma_f32_16x16x32_bf16 v[84:87], v[48:51], a[24:27], v[84:87]
  ds_read_b64_tr_b16 v[44:45], v14 offset:28672
  buffer_load_dwordx4 v21, s[64:67], s88 offen offset:1024 lds
  v_mfma_f32_16x16x32_bf16 v[84:87], v[52:55], a[40:43], v[84:87]
  ds_read_b64_tr_b16 v[46:47], v14 offset:30720
  v_mfma_f32_16x16x32_bf16 v[84:87], v[56:59], a[56:59], v[84:87]
  v_mfma_f32_16x16x32_bf16 v[84:87], v[60:63], a[72:75], v[84:87]
  v_mfma_f32_16x16x32_bf16 v[92:95], v[48:51], a[28:31], v[92:95]
  ds_read_b64_tr_b16 v[48:49], v17 offset:16384
  buffer_load_dwordx4 v21, s[64:67], s88 offen offset:2048 lds
  v_mfma_f32_16x16x32_bf16 v[92:95], v[52:55], a[44:47], v[92:95]
  ds_read_b64_tr_b16 v[50:51], v17 offset:18432
  v_mfma_f32_16x16x32_bf16 v[92:95], v[56:59], a[60:63], v[92:95]
  ds_read_b64_tr_b16 v[52:53], v17 offset:20480
  v_mfma_f32_16x16x32_bf16 v[92:95], v[60:63], a[76:79], v[92:95]
  s_waitcnt lgkmcnt(3)
  v_mfma_f32_16x16x32_bf16 v[64:67], v[32:35], a[80:83], v[64:67]
  ds_read_b64_tr_b16 v[54:55], v17 offset:22528
  buffer_load_dwordx4 v21, s[64:67], s88 offen offset:3072 lds
  v_mfma_f32_16x16x32_bf16 v[64:67], v[36:39], a[96:99], v[64:67]
  ds_read_b64_tr_b16 v[56:57], v17 offset:24576
  v_mfma_f32_16x16x32_bf16 v[64:67], v[40:43], a[112:115], v[64:67]
  s_add_u32 m0, s9, 65536
  s_add_u32 s88, s86, 65536
  v_mfma_f32_16x16x32_bf16 v[64:67], v[44:47], a[128:131], v[64:67]
  ds_read_b64_tr_b16 v[58:59], v17 offset:26624
  buffer_load_dwordx4 v21, s[64:67], s88 offen lds
  v_mfma_f32_16x16x32_bf16 v[72:75], v[32:35], a[84:87], v[72:75]
  ds_read_b64_tr_b16 v[60:61], v17 offset:28672
  v_mfma_f32_16x16x32_bf16 v[72:75], v[36:39], a[100:103], v[72:75]
  buffer_store_dwordx4 v[220:223], v21, s[64:67], s91 offen offset:0 sc1
  v_mfma_f32_16x16x32_bf16 v[72:75], v[40:43], a[116:119], v[72:75]
  ds_read_b64_tr_b16 v[62:63], v17 offset:30720
  v_mfma_f32_16x16x32_bf16 v[72:75], v[44:47], a[132:135], v[72:75]
  v_mfma_f32_16x16x32_bf16 v[80:83], v[32:35], a[88:91], v[80:83]
  v_mfma_f32_16x16x32_bf16 v[80:83], v[36:39], a[104:107], v[80:83]
  v_mfma_f32_16x16x32_bf16 v[80:83], v[40:43], a[120:123], v[80:83]
  v_mfma_f32_16x16x32_bf16 v[80:83], v[44:47], a[136:139], v[80:83]
  v_mfma_f32_16x16x32_bf16 v[88:91], v[32:35], a[92:95], v[88:91]
  v_mfma_f32_16x16x32_bf16 v[88:91], v[36:39], a[108:111], v[88:91]
  v_mfma_f32_16x16x32_bf16 v[88:91], v[40:43], a[124:127], v[88:91]
  v_mfma_f32_16x16x32_bf16 v[88:91], v[44:47], a[140:143], v[88:91]
  s_waitcnt lgkmcnt(0)
  v_mfma_f32_16x16x32_bf16 v[68:71], v[48:51], a[80:83], v[68:71]
  ds_read_b64_tr_b16 v[32:33], v14 offset:49152
  v_mfma_f32_16x16x32_bf16 v[68:71], v[52:55], a[96:99], v[68:71]
  ds_read_b64_tr_b16 v[34:35], v14 offset:51200
  v_mfma_f32_16x16x32_bf16 v[68:71], v[56:59], a[112:115], v[68:71]
  ds_read_b64_tr_b16 v[36:37], v14 offset:53248
  v_mfma_f32_16x16x32_bf16 v[68:71], v[60:63], a[128:131], v[68:71]
  ds_read_b64_tr_b16 v[38:39], v14 offset:55296
  v_mfma_f32_16x16x32_bf16 v[76:79], v[48:51], a[84:87], v[76:79]
  v_mfma_f32_16x16x32_bf16 v[76:79], v[52:55], a[100:103], v[76:79]
  ds_read_b64_tr_b16 v[40:41], v14 offset:57344
  buffer_load_dwordx4 v21, s[64:67], s88 offen offset:1024 lds
  v_mfma_f32_16x16x32_bf16 v[76:79], v[56:59], a[116:119], v[76:79]
  ds_read_b64_tr_b16 v[42:43], v14 offset:59392
  v_mfma_f32_16x16x32_bf16 v[76:79], v[60:63], a[132:135], v[76:79]
  buffer_store_dwordx4 v[224:227], v21, s[64:67], s91 offen offset:1024 sc1
  v_mfma_f32_16x16x32_bf16 v[84:87], v[48:51], a[88:91], v[84:87]
  ds_read_b64_tr_b16 v[44:45], v14 offset:61440
  v_mfma_f32_16x16x32_bf16 v[84:87], v[52:55], a[104:107], v[84:87]
  ds_read_b64_tr_b16 v[46:47], v14 offset:63488
  v_mfma_f32_16x16x32_bf16 v[84:87], v[56:59], a[120:123], v[84:87]
  v_mfma_f32_16x16x32_bf16 v[84:87], v[60:63], a[136:139], v[84:87]
  v_mfma_f32_16x16x32_bf16 v[92:95], v[48:51], a[92:95], v[92:95]
  ds_read_b64_tr_b16 v[48:49], v17 offset:49152
  buffer_load_dwordx4 v21, s[64:67], s88 offen offset:2048 lds
  v_mfma_f32_16x16x32_bf16 v[92:95], v[52:55], a[108:111], v[92:95]
  ds_read_b64_tr_b16 v[50:51], v17 offset:51200
  v_mfma_f32_16x16x32_bf16 v[92:95], v[56:59], a[124:127], v[92:95]
  ds_read_b64_tr_b16 v[52:53], v17 offset:53248
  v_mfma_f32_16x16x32_bf16 v[92:95], v[60:63], a[140:143], v[92:95]
  s_waitcnt lgkmcnt(3)
  v_mfma_f32_16x16x32_bf16 v[96:99], v[32:35], a[0:3], 0
  ds_read_b64_tr_b16 v[54:55], v17 offset:55296
  v_mfma_f32_16x16x32_bf16 v[96:99], v[36:39], a[16:19], v[96:99]
  ds_read_b64_tr_b16 v[56:57], v17 offset:57344
  buffer_load_dwordx4 v21, s[64:67], s88 offen offset:3072 lds
  v_mfma_f32_16x16x32_bf16 v[96:99], v[40:43], a[32:35], v[96:99]
  v_mfma_f32_16x16x32_bf16 v[96:99], v[44:47], a[48:51], v[96:99]
  ds_read_b64_tr_b16 v[58:59], v17 offset:59392
  v_cvt_pk_bf16_f32 v188, v64, v65
  v_mfma_f32_16x16x32_bf16 v[104:107], v[32:35], a[4:7], 0
  ds_read_b64_tr_b16 v[60:61], v17 offset:61440
  v_cvt_pk_bf16_f32 v189, v66, v67
  v_mfma_f32_16x16x32_bf16 v[104:107], v[36:39], a[20:23], v[104:107]
  v_cvt_pk_bf16_f32 v190, v68, v69
  v_cvt_pk_bf16_f32 v191, v70, v71
  v_mfma_f32_16x16x32_bf16 v[104:107], v[40:43], a[36:39], v[104:107]
  ds_read_b64_tr_b16 v[62:63], v17 offset:63488
  v_cvt_pk_bf16_f32 v192, v72, v73
  v_mfma_f32_16x16x32_bf16 v[104:107], v[44:47], a[52:55], v[104:107]
  v_cvt_pk_bf16_f32 v193, v74, v75
  v_cvt_pk_bf16_f32 v194, v76, v77
  v_mfma_f32_16x16x32_bf16 v[112:115], v[32:35], a[8:11], 0
  v_cvt_pk_bf16_f32 v195, v78, v79
  v_cvt_pk_bf16_f32 v196, v80, v81
  v_mfma_f32_16x16x32_bf16 v[112:115], v[36:39], a[24:27], v[112:115]
  v_cvt_pk_bf16_f32 v197, v82, v83
  v_cvt_pk_bf16_f32 v198, v84, v85
  v_mfma_f32_16x16x32_bf16 v[112:115], v[40:43], a[40:43], v[112:115]
  v_cvt_pk_bf16_f32 v199, v86, v87
  v_cvt_pk_bf16_f32 v200, v88, v89
  v_mfma_f32_16x16x32_bf16 v[112:115], v[44:47], a[56:59], v[112:115]
  v_cvt_pk_bf16_f32 v201, v90, v91
  v_cvt_pk_bf16_f32 v202, v92, v93
  v_mfma_f32_16x16x32_bf16 v[120:123], v[32:35], a[12:15], 0
  buffer_store_dwordx4 v[228:231], v21, s[64:67], s91 offen offset:2048 sc1
  v_mfma_f32_16x16x32_bf16 v[120:123], v[36:39], a[28:31], v[120:123]
  v_cvt_pk_bf16_f32 v203, v94, v95
  v_mfma_f32_16x16x32_bf16 v[120:123], v[40:43], a[44:47], v[120:123]
  v_mfma_f32_16x16x32_bf16 v[120:123], v[44:47], a[60:63], v[120:123]
  s_waitcnt vmcnt(16) lgkmcnt(0)
  s_barrier
  v_mfma_f32_16x16x32_bf16 v[100:103], v[48:51], a[0:3], 0
  ds_read_b64_tr_b16 v[32:33], v15 offset:0
  v_mfma_f32_16x16x32_bf16 v[100:103], v[52:55], a[16:19], v[100:103]
  ds_read_b64_tr_b16 v[34:35], v15 offset:2048
  v_mfma_f32_16x16x32_bf16 v[100:103], v[56:59], a[32:35], v[100:103]
  ds_read_b64_tr_b16 v[36:37], v15 offset:4096
  v_mfma_f32_16x16x32_bf16 v[100:103], v[60:63], a[48:51], v[100:103]
  ds_read_b64_tr_b16 v[38:39], v15 offset:6144
  v_mfma_f32_16x16x32_bf16 v[108:111], v[48:51], a[4:7], 0
  v_mfma_f32_16x16x32_bf16 v[108:111], v[52:55], a[20:23], v[108:111]
  ds_read_b64_tr_b16 v[40:41], v15 offset:8192
  v_mfma_f32_16x16x32_bf16 v[108:111], v[56:59], a[36:39], v[108:111]
  ds_read_b64_tr_b16 v[42:43], v15 offset:10240
  v_mfma_f32_16x16x32_bf16 v[108:111], v[60:63], a[52:55], v[108:111]
  v_mfma_f32_16x16x32_bf16 v[116:119], v[48:51], a[8:11], 0
  ds_read_b64_tr_b16 v[44:45], v15 offset:12288
  v_mfma_f32_16x16x32_bf16 v[116:119], v[52:55], a[24:27], v[116:119]
  ds_read_b64_tr_b16 v[46:47], v15 offset:14336
  v_mfma_f32_16x16x32_bf16 v[116:119], v[56:59], a[40:43], v[116:119]
  v_mfma_f32_16x16x32_bf16 v[116:119], v[60:63], a[56:59], v[116:119]
  v_mfma_f32_16x16x32_bf16 v[124:127], v[48:51], a[12:15], 0
  ds_read_b64_tr_b16 v[48:49], v18 offset:0
  v_mfma_f32_16x16x32_bf16 v[124:127], v[52:55], a[28:31], v[124:127]
  ds_read_b64_tr_b16 v[50:51], v18 offset:2048
  v_mfma_f32_16x16x32_bf16 v[124:127], v[56:59], a[44:47], v[124:127]
  ds_read_b64_tr_b16 v[52:53], v18 offset:4096
  v_mfma_f32_16x16x32_bf16 v[124:127], v[60:63], a[60:63], v[124:127]
  s_waitcnt lgkmcnt(3)
  v_mfma_f32_16x16x32_bf16 v[96:99], v[32:35], a[64:67], v[96:99]
  ds_read_b64_tr_b16 v[54:55], v18 offset:6144
  v_mfma_f32_16x16x32_bf16 v[96:99], v[36:39], a[80:83], v[96:99]
  ds_read_b64_tr_b16 v[56:57], v18 offset:8192
  v_mfma_f32_16x16x32_bf16 v[96:99], v[40:43], a[96:99], v[96:99]
  buffer_store_dwordx4 v[232:235], v21, s[64:67], s91 offen offset:3072 sc1
  v_mfma_f32_16x16x32_bf16 v[96:99], v[44:47], a[112:115], v[96:99]
  ds_read_b64_tr_b16 v[58:59], v18 offset:10240
  v_mfma_f32_16x16x32_bf16 v[104:107], v[32:35], a[68:71], v[104:107]
  ds_read_b64_tr_b16 v[60:61], v18 offset:12288
  v_cmp_gt_u32 vcc, 32, v0
  v_mfma_f32_16x16x32_bf16 v[104:107], v[36:39], a[84:87], v[104:107]
  v_mov_b32 v137, 0
  v_mfma_f32_16x16x32_bf16 v[104:107], v[40:43], a[100:103], v[104:107]
  ds_read_b64_tr_b16 v[62:63], v18 offset:14336
  v_mov_b32 v138, 0
  v_mfma_f32_16x16x32_bf16 v[104:107], v[44:47], a[116:119], v[104:107]
  v_mov_b32 v141, 0
  v_mfma_f32_16x16x32_bf16 v[112:115], v[32:35], a[72:75], v[112:115]
  v_mov_b32 v142, 0
  v_mfma_f32_16x16x32_bf16 v[112:115], v[36:39], a[88:91], v[112:115]
  v_cndmask_b32 v136, 0, v242, vcc
  v_mfma_f32_16x16x32_bf16 v[112:115], v[40:43], a[104:107], v[112:115]
  v_cndmask_b32 v139, 0, v242, vcc
  v_mfma_f32_16x16x32_bf16 v[112:115], v[44:47], a[120:123], v[112:115]
  v_cndmask_b32_e64 v140, v242, 0, vcc
  v_mfma_f32_16x16x32_bf16 v[120:123], v[32:35], a[76:79], v[120:123]
  v_cndmask_b32_e64 v143, v242, 0, vcc
  v_mfma_f32_16x16x32_bf16 v[120:123], v[36:39], a[92:95], v[120:123]
  v_mov_b32 v145, 0
  v_mfma_f32_16x16x32_bf16 v[120:123], v[40:43], a[108:111], v[120:123]
  v_mov_b32 v146, 0
  v_mfma_f32_16x16x32_bf16 v[120:123], v[44:47], a[124:127], v[120:123]
  s_waitcnt lgkmcnt(0)
  v_mov_b32 v149, 0
  v_mfma_f32_16x16x32_bf16 v[100:103], v[48:51], a[64:67], v[100:103]
  ds_read_b64_tr_b16 v[32:33], v15 offset:16384
  v_mov_b32 v150, 0
  v_mfma_f32_16x16x32_bf16 v[100:103], v[52:55], a[80:83], v[100:103]
  ds_read_b64_tr_b16 v[34:35], v15 offset:18432
  v_cndmask_b32 v144, 0, v243, vcc
  v_mfma_f32_16x16x32_bf16 v[100:103], v[56:59], a[96:99], v[100:103]
  ds_read_b64_tr_b16 v[36:37], v18 offset:16384
  v_cndmask_b32 v147, 0, v243, vcc
  v_mfma_f32_16x16x32_bf16 v[100:103], v[60:63], a[112:115], v[100:103]
  ds_read_b64_tr_b16 v[38:39], v18 offset:18432
  v_cndmask_b32_e64 v148, v243, 0, vcc
  v_mfma_f32_16x16x32_bf16 v[108:111], v[48:51], a[68:71], v[108:111]
  v_cndmask_b32_e64 v151, v243, 0, vcc
  v_mfma_f32_16x16x32_bf16 v[108:111], v[52:55], a[84:87], v[108:111]
  v_mul_f32 v251, 0xbfb8aa3b, v251
  v_mfma_f32_16x16x32_bf16 v[108:111], v[56:59], a[100:103], v[108:111]
  v_exp_f32 v251, v251
  v_mfma_f32_16x16x32_bf16 v[108:111], v[60:63], a[116:119], v[108:111]
  v_add_f32 v251, 1.0, v251
  v_mfma_f32_16x16x32_bf16 v[116:119], v[48:51], a[72:75], v[116:119]
  v_rcp_f32 v251, v251
  v_mfma_f32_16x16x32_bf16 v[116:119], v[52:55], a[88:91], v[116:119]
  v_mov_b32 v168, -1
  v_mfma_f32_16x16x32_bf16 v[116:119], v[56:59], a[104:107], v[116:119]
  v_mov_b32 v169, -1
  v_mfma_f32_16x16x32_bf16 v[116:119], v[60:63], a[120:123], v[116:119]
  v_mov_b32 v170, -1
  v_mfma_f32_16x16x32_bf16 v[124:127], v[48:51], a[76:79], v[124:127]
  v_mov_b32 v171, -1
  v_mfma_f32_16x16x32_bf16 v[124:127], v[52:55], a[92:95], v[124:127]
  v_lshlrev_b32 v243, 2, v0
  v_mfma_f32_16x16x32_bf16 v[124:127], v[56:59], a[108:111], v[124:127]
  v_mfma_f32_16x16x32_bf16 v[124:127], v[60:63], a[124:127], v[124:127]
  s_waitcnt lgkmcnt(0)
  v_mfma_f32_16x16x32_bf16 v[96:99], v[32:35], a[128:131], v[96:99]
  v_mfma_f32_16x16x32_bf16 v[104:107], v[32:35], a[132:135], v[104:107]
  v_mfma_f32_16x16x32_bf16 v[112:115], v[32:35], a[136:139], v[112:115]
  v_mfma_f32_16x16x32_bf16 v[120:123], v[32:35], a[140:143], v[120:123]
  v_mfma_f32_16x16x32_bf16 v[124:127], v[36:39], a[140:143], v[124:127]
  v_mfma_f32_16x16x32_bf16 v[116:119], v[36:39], a[136:139], v[116:119]
  v_mfma_f32_16x16x32_bf16 v[108:111], v[36:39], a[132:135], v[108:111]
  v_mfma_f32_16x16x32_bf16 v[100:103], v[36:39], a[128:131], v[100:103]
  s_waitcnt vmcnt(2)
  s_barrier
  ds_read_b128 v[56:59], v164 offset:0
  ds_read_b128 v[32:35], v164 offset:1024
  ds_read_b128 v[40:43], v165 offset:2048
  ds_read_b128 v[44:47], v165 offset:2656
  v_cvt_pk_bf16_f32 v220, v96, v97
  v_cvt_pk_bf16_f32 v221, v98, v99
  v_cvt_pk_bf16_f32 v222, v100, v101
  v_cvt_pk_bf16_f32 v223, v102, v103
  v_cvt_pk_bf16_f32 v224, v104, v105
  s_waitcnt lgkmcnt(3)
  v_mfma_f32_32x32x8_bf16 v[64:79], v[56:57], v[136:137], 0
  s_waitcnt lgkmcnt(2)
  v_mfma_f32_32x32x16_bf16 v[64:79], v[32:35], v[128:131], v[64:79]
  v_cvt_pk_bf16_f32 v225, v106, v107
  v_cvt_pk_bf16_f32 v226, v108, v109
  v_cvt_pk_bf16_f32 v227, v110, v111
  v_cvt_pk_bf16_f32 v228, v112, v113
  v_cvt_pk_bf16_f32 v229, v114, v115
  v_cvt_pk_bf16_f32 v230, v116, v117
  v_cvt_pk_bf16_f32 v231, v118, v119
  v_cvt_pk_bf16_f32 v232, v120, v121
  v_cvt_pk_bf16_f32 v233, v122, v123
  v_cvt_pk_bf16_f32 v234, v124, v125
  v_cvt_pk_bf16_f32 v235, v126, v127
  s_nop 0
  v_exp_f32 v64, v64
  v_exp_f32 v65, v65
  ds_read_b128 v[36:39], v164 offset:3264
  v_exp_f32 v66, v66
  v_exp_f32 v67, v67
  v_perm_b32 v24, v65, v64, s14
  v_perm_b32 v25, v67, v66, s14
  v_exp_f32 v68, v68
  v_mfma_f32_32x32x8_bf16 v[80:95], v[56:57], v[144:145], 0
  s_add_u32 s91, s74, 81920
  v_exp_f32 v69, v69
  v_exp_f32 v70, v70
  v_exp_f32 v71, v71
  v_perm_b32 v26, v69, v68, s14
  v_perm_b32 v27, v71, v70, s14
  v_exp_f32 v72, v72
  v_mfma_f32_32x32x16_bf16 v[80:95], v[32:35], v[132:135], v[80:95]
  ds_read_b128 v[48:51], v165 offset:4288
  v_exp_f32 v73, v73
  v_exp_f32 v74, v74
  v_exp_f32 v75, v75
  v_perm_b32 v28, v73, v72, s14
  v_perm_b32 v29, v75, v74, s14
  v_exp_f32 v76, v76
  s_waitcnt lgkmcnt(3)
  v_mfma_f32_32x32x16_bf16 v[96:111], v[40:43], v[24:27], 0
PAD10:
  s_cbranch_execz PAD14
  ds_read_b128 v[52:55], v165 offset:4896
  v_exp_f32 v77, v77
  v_exp_f32 v78, v78
  v_exp_f32 v79, v79
  v_perm_b32 v30, v77, v76, s14
  v_perm_b32 v31, v79, v78, s14
  v_exp_f32 v80, v80
  v_exp_f32 v81, v81
  s_waitcnt lgkmcnt(3)
  v_mfma_f32_32x32x16_bf16 v[96:111], v[44:47], v[28:31], v[96:111]
  buffer_store_dwordx4 v[172:175], v21, s[64:67], s91 offen offset:0 sc1
  v_exp_f32 v82, v82
  v_exp_f32 v83, v83
  v_perm_b32 v24, v81, v80, s14
  v_perm_b32 v25, v83, v82, s14
  v_exp_f32 v84, v84
  v_mfma_f32_32x32x8_bf16 v[64:79], v[56:57], v[138:139], 0
  s_waitcnt lgkmcnt(0)
  v_exp_f32 v85, v85
  v_exp_f32 v86, v86
  v_exp_f32 v87, v87
  v_perm_b32 v26, v85, v84, s14
  v_perm_b32 v27, v87, v86, s14
  v_exp_f32 v88, v88
  v_mfma_f32_32x32x16_bf16 v[64:79], v[36:39], v[128:131], v[64:79]
  s_add_u32 m0, s9, 81920
  s_add_u32 s88, s86, 81920
  buffer_load_dwordx4 v21, s[64:67], s88 offen lds
  v_exp_f32 v89, v89
  v_exp_f32 v90, v90
  v_exp_f32 v91, v91
  v_perm_b32 v28, v89, v88, s14
  v_perm_b32 v29, v91, v90, s14
  v_exp_f32 v92, v92
  v_mfma_f32_32x32x16_bf16 v[112:127], v[40:43], v[24:27], 0
  buffer_store_dwordx4 v[176:179], v21, s[64:67], s91 offen offset:1024 sc1
  v_exp_f32 v93, v93
  v_exp_f32 v94, v94
  v_exp_f32 v95, v95
  v_perm_b32 v30, v93, v92, s14
  v_perm_b32 v31, v95, v94, s14
  v_exp_f32 v64, v64
  v_exp_f32 v65, v65
  v_mfma_f32_32x32x16_bf16 v[112:127], v[44:47], v[28:31], v[112:127]
  ds_read_b128 v[32:35], v164 offset:5504
  v_exp_f32 v66, v66
  v_exp_f32 v67, v67
  v_perm_b32 v24, v65, v64, s14
  v_perm_b32 v25, v67, v66, s14
  v_exp_f32 v68, v68
  v_mfma_f32_32x32x8_bf16 v[80:95], v[56:57], v[146:147], 0
  v_exp_f32 v69, v69
  v_exp_f32 v70, v70
  v_exp_f32 v71, v71
  v_perm_b32 v26, v69, v68, s14
  v_perm_b32 v27, v71, v70, s14
  v_exp_f32 v72, v72
  v_mfma_f32_32x32x16_bf16 v[80:95], v[36:39], v[132:135], v[80:95]
  ds_read_b128 v[40:43], v165 offset:6528
  v_exp_f32 v73, v73
  v_exp_f32 v74, v74
  v_exp_f32 v75, v75
  v_perm_b32 v28, v73, v72, s14
  v_perm_b32 v29, v75, v74, s14
  v_exp_f32 v76, v76
  v_mfma_f32_32x32x16_bf16 v[96:111], v[48:51], v[24:27], v[96:111]
  ds_read_b128 v[44:47], v165 offset:7136
  v_exp_f32 v77, v77
  v_exp_f32 v78, v78
  v_exp_f32 v79, v79
  v_perm_b32 v30, v77, v76, s14
  v_perm_b32 v31, v79, v78, s14
  v_exp_f32 v80, v80
  v_exp_f32 v81, v81
  v_mfma_f32_32x32x16_bf16 v[96:111], v[52:55], v[28:31], v[96:111]
  buffer_load_dwordx4 v21, s[64:67], s88 offen offset:1024 lds
  v_exp_f32 v82, v82
  v_exp_f32 v83, v83
  v_perm_b32 v24, v81, v80, s14
  v_perm_b32 v25, v83, v82, s14
  v_exp_f32 v84, v84
  v_mfma_f32_32x32x8_bf16 v[64:79], v[58:59], v[136:137], 0
  s_waitcnt lgkmcnt(0)
  v_exp_f32 v85, v85
  v_exp_f32 v86, v86
  v_exp_f32 v87, v87
  v_perm_b32 v26, v85, v84, s14
  v_perm_b32 v27, v87, v86, s14
  v_exp_f32 v88, v88
  v_mfma_f32_32x32x16_bf16 v[64:79], v[32:35], v[128:131], v[64:79]
  buffer_store_dwordx4 v[180:183], v21, s[64:67], s91 offen offset:2048 sc1
  v_exp_f32 v89, v89
  v_exp_f32 v90, v90
  v_exp_f32 v91, v91
  v_perm_b32 v28, v89, v88, s14
  v_perm_b32 v29, v91, v90, s14
  v_exp_f32 v92, v92
  v_mfma_f32_32x32x16_bf16 v[112:127], v[48:51], v[24:27], v[112:127]
  buffer_load_dwordx4 v21, s[64:67], s88 offen offset:2048 lds
  v_exp_f32 v93, v93
  v_exp_f32 v94, v94
  v_exp_f32 v95, v95
  v_perm_b32 v30, v93, v92, s14
  v_perm_b32 v31, v95, v94, s14
  v_exp_f32 v64, v64
  v_exp_f32 v65, v65
  v_mfma_f32_32x32x16_bf16 v[112:127], v[52:55], v[28:31], v[112:127]
  ds_read_b128 v[36:39], v164 offset:7744
  v_exp_f32 v66, v66
  v_exp_f32 v67, v67
  v_perm_b32 v24, v65, v64, s14
  v_perm_b32 v25, v67, v66, s14
  v_exp_f32 v68, v68
  v_mfma_f32_32x32x8_bf16 v[80:95], v[58:59], v[144:145], 0
  v_exp_f32 v69, v69
  v_exp_f32 v70, v70
  v_exp_f32 v71, v71
  v_perm_b32 v26, v69, v68, s14
  v_perm_b32 v27, v71, v70, s14
  v_exp_f32 v72, v72
  v_mfma_f32_32x32x16_bf16 v[80:95], v[32:35], v[132:135], v[80:95]
  ds_read_b128 v[48:51], v165 offset:8768
  v_exp_f32 v73, v73
  v_exp_f32 v74, v74
  v_exp_f32 v75, v75
  v_perm_b32 v28, v73, v72, s14
  v_perm_b32 v29, v75, v74, s14
  v_exp_f32 v76, v76
  v_mfma_f32_32x32x16_bf16 v[96:111], v[40:43], v[24:27], v[96:111]
  ds_read_b128 v[52:55], v165 offset:9376
  v_exp_f32 v77, v77
  v_exp_f32 v78, v78
  v_exp_f32 v79, v79
  v_perm_b32 v30, v77, v76, s14
  v_perm_b32 v31, v79, v78, s14
  v_exp_f32 v80, v80
  v_exp_f32 v81, v81
  v_mfma_f32_32x32x16_bf16 v[96:111], v[44:47], v[28:31], v[96:111]
  buffer_store_dwordx4 v[184:187], v21, s[64:67], s91 offen offset:3072 sc1
  v_exp_f32 v82, v82
  v_exp_f32 v83, v83
  v_perm_b32 v24, v81, v80, s14
  v_perm_b32 v25, v83, v82, s14
  v_exp_f32 v84, v84
  v_mfma_f32_32x32x8_bf16 v[64:79], v[58:59], v[138:139], 0
  s_waitcnt lgkmcnt(0)
  v_exp_f32 v85, v85
  v_exp_f32 v86, v86
  v_exp_f32 v87, v87
  v_perm_b32 v26, v85, v84, s14
  v_perm_b32 v27, v87, v86, s14
  v_exp_f32 v88, v88
  v_mfma_f32_32x32x16_bf16 v[64:79], v[36:39], v[128:131], v[64:79]
  buffer_load_dwordx4 v21, s[64:67], s88 offen offset:3072 lds
  s_add_u32 m0, s9, 98304
  s_add_u32 s88, s86, 98304
  v_exp_f32 v89, v89
  v_exp_f32 v90, v90
  v_exp_f32 v91, v91
  v_perm_b32 v28, v89, v88, s14
  v_perm_b32 v29, v91, v90, s14
  v_exp_f32 v92, v92
  v_mfma_f32_32x32x16_bf16 v[112:127], v[40:43], v[24:27], v[112:127]
  buffer_load_dwordx4 v21, s[64:67], s88 offen lds
  v_exp_f32 v93, v93
  v_exp_f32 v94, v94
  v_exp_f32 v95, v95
  v_perm_b32 v30, v93, v92, s14
  v_perm_b32 v31, v95, v94, s14
  v_exp_f32 v64, v64
  v_exp_f32 v65, v65
  v_mfma_f32_32x32x16_bf16 v[112:127], v[44:47], v[28:31], v[112:127]
  ds_read_b128 v[32:35], v164 offset:9984
  v_exp_f32 v66, v66
  v_exp_f32 v67, v67
  v_perm_b32 v24, v65, v64, s14
  v_perm_b32 v25, v67, v66, s14
  v_exp_f32 v68, v68
  v_mfma_f32_32x32x8_bf16 v[80:95], v[58:59], v[146:147], 0
  s_add_u32 s91, s74, 98304
  v_exp_f32 v69, v69
  v_exp_f32 v70, v70
  v_exp_f32 v71, v71
  v_perm_b32 v26, v69, v68, s14
  v_perm_b32 v27, v71, v70, s14
  v_exp_f32 v72, v72
  v_mfma_f32_32x32x16_bf16 v[80:95], v[36:39], v[132:135], v[80:95]
  ds_read_b128 v[40:43], v165 offset:11008
  v_exp_f32 v73, v73
  v_exp_f32 v74, v74
  v_exp_f32 v75, v75
  v_perm_b32 v28, v73, v72, s14
  v_perm_b32 v29, v75, v74, s14
  v_exp_f32 v76, v76
  v_mfma_f32_32x32x16_bf16 v[96:111], v[48:51], v[24:27], v[96:111]
  ds_read_b128 v[44:47], v165 offset:11616
  ds_read_b128 v[60:63], v164 offset:18944
  v_exp_f32 v77, v77
  v_exp_f32 v78, v78
  v_exp_f32 v79, v79
  v_perm_b32 v30, v77, v76, s14
  v_perm_b32 v31, v79, v78, s14
  v_exp_f32 v80, v80
  v_exp_f32 v81, v81
  v_mfma_f32_32x32x16_bf16 v[96:111], v[52:55], v[28:31], v[96:111]
  buffer_store_dwordx4 v[204:207], v21, s[64:67], s91 offen offset:0 sc1
  v_exp_f32 v82, v82
  v_exp_f32 v83, v83
  v_perm_b32 v24, v81, v80, s14
  v_perm_b32 v25, v83, v82, s14
  v_exp_f32 v84, v84
  v_mfma_f32_32x32x8_bf16 v[64:79], v[56:57], v[140:141], 0
  s_waitcnt lgkmcnt(0)
  v_exp_f32 v85, v85
  v_exp_f32 v86, v86
  v_exp_f32 v87, v87
  v_perm_b32 v26, v85, v84, s14
  v_perm_b32 v27, v87, v86, s14
  v_exp_f32 v88, v88
  v_mfma_f32_32x32x16_bf16 v[64:79], v[32:35], v[128:131], v[64:79]
  buffer_load_dwordx4 v21, s[64:67], s88 offen offset:1024 lds
  v_exp_f32 v89, v89
  v_exp_f32 v90, v90
  v_exp_f32 v91, v91
  v_perm_b32 v28, v89, v88, s14
  v_perm_b32 v29, v91, v90, s14
  v_exp_f32 v92, v92
  v_mfma_f32_32x32x16_bf16 v[112:127], v[48:51], v[24:27], v[112:127]
  buffer_store_dwordx4 v[208:211], v21, s[64:67], s91 offen offset:1024 sc1
  v_exp_f32 v93, v93
  v_exp_f32 v94, v94
  v_exp_f32 v95, v95
  v_perm_b32 v30, v93, v92, s14
  v_perm_b32 v31, v95, v94, s14
  v_exp_f32 v64, v64
  v_exp_f32 v65, v65
  v_mfma_f32_32x32x16_bf16 v[112:127], v[52:55], v[28:31], v[112:127]
  ds_read_b128 v[36:39], v164 offset:12224
  v_exp_f32 v66, v66
  v_exp_f32 v67, v67
  v_perm_b32 v24, v65, v64, s14
  v_perm_b32 v25, v67, v66, s14
  v_exp_f32 v68, v68
  v_mfma_f32_32x32x8_bf16 v[80:95], v[56:57], v[148:149], 0
  v_exp_f32 v69, v69
  v_exp_f32 v70, v70
  v_exp_f32 v71, v71
  v_perm_b32 v26, v69, v68, s14
  v_perm_b32 v27, v71, v70, s14
  v_exp_f32 v72, v72
  v_mfma_f32_32x32x16_bf16 v[80:95], v[32:35], v[132:135], v[80:95]
  ds_read_b128 v[48:51], v165 offset:13248
  v_exp_f32 v73, v73
  v_exp_f32 v74, v74
  v_exp_f32 v75, v75
  v_perm_b32 v28, v73, v72, s14
  v_perm_b32 v29, v75, v74, s14
  v_exp_f32 v76, v76
  v_mfma_f32_32x32x16_bf16 v[96:111], v[40:43], v[24:27], v[96:111]
  ds_read_b128 v[52:55], v165 offset:13856
  v_exp_f32 v77, v77
  v_exp_f32 v78, v78
  v_exp_f32 v79, v79
  v_perm_b32 v30, v77, v76, s14
  v_perm_b32 v31, v79, v78, s14
  v_exp_f32 v80, v80
  v_exp_f32 v81, v81
  v_mfma_f32_32x32x16_bf16 v[96:111], v[44:47], v[28:31], v[96:111]
  buffer_load_dwordx4 v21, s[64:67], s88 offen offset:2048 lds
  v_exp_f32 v82, v82
  v_exp_f32 v83, v83
  v_perm_b32 v24, v81, v80, s14
  v_perm_b32 v25, v83, v82, s14
  v_exp_f32 v84, v84
  v_mfma_f32_32x32x8_bf16 v[64:79], v[56:57], v[142:143], 0
  s_waitcnt lgkmcnt(0)
  v_exp_f32 v85, v85
  v_exp_f32 v86, v86
  v_exp_f32 v87, v87
  v_perm_b32 v26, v85, v84, s14
  v_perm_b32 v27, v87, v86, s14
  v_exp_f32 v88, v88
  v_mfma_f32_32x32x16_bf16 v[64:79], v[36:39], v[128:131], v[64:79]
  buffer_store_dwordx4 v[212:215], v21, s[64:67], s91 offen offset:2048 sc1
  v_exp_f32 v89, v89
  v_exp_f32 v90, v90
  v_exp_f32 v91, v91
  v_perm_b32 v28, v89, v88, s14
  v_perm_b32 v29, v91, v90, s14
  v_exp_f32 v92, v92
  v_mfma_f32_32x32x16_bf16 v[112:127], v[40:43], v[24:27], v[112:127]
  buffer_load_dwordx4 v21, s[64:67], s88 offen offset:3072 lds
  v_exp_f32 v93, v93
  v_exp_f32 v94, v94
  v_exp_f32 v95, v95
  v_perm_b32 v30, v93, v92, s14
  v_perm_b32 v31, v95, v94, s14
  v_exp_f32 v64, v64
  v_exp_f32 v65, v65
  v_mfma_f32_32x32x16_bf16 v[112:127], v[44:47], v[28:31], v[112:127]
  ds_read_b128 v[32:35], v164 offset:14464
  v_exp_f32 v66, v66
  v_exp_f32 v67, v67
  v_perm_b32 v24, v65, v64, s14
  v_perm_b32 v25, v67, v66, s14
  v_exp_f32 v68, v68
  v_mfma_f32_32x32x8_bf16 v[80:95], v[56:57], v[150:151], 0
  s_add_u32 m0, s9, 114688
  s_add_u32 s88, s86, 114688
  v_exp_f32 v69, v69
  v_exp_f32 v70, v70
  v_exp_f32 v71, v71
  v_perm_b32 v26, v69, v68, s14
  v_perm_b32 v27, v71, v70, s14
  v_exp_f32 v72, v72
  v_mfma_f32_32x32x16_bf16 v[80:95], v[36:39], v[132:135], v[80:95]
  ds_read_b128 v[40:43], v165 offset:15488
  v_exp_f32 v73, v73
  v_exp_f32 v74, v74
  v_exp_f32 v75, v75
  v_perm_b32 v28, v73, v72, s14
  v_perm_b32 v29, v75, v74, s14
  v_exp_f32 v76, v76
  v_mfma_f32_32x32x16_bf16 v[96:111], v[48:51], v[24:27], v[96:111]
  ds_read_b128 v[44:47], v165 offset:16096
  v_exp_f32 v77, v77
  v_exp_f32 v78, v78
  v_exp_f32 v79, v79
  v_perm_b32 v30, v77, v76, s14
  v_perm_b32 v31, v79, v78, s14
  v_exp_f32 v80, v80
  v_exp_f32 v81, v81
  v_mfma_f32_32x32x16_bf16 v[96:111], v[52:55], v[28:31], v[96:111]
  buffer_store_dwordx4 v[216:219], v21, s[64:67], s91 offen offset:3072 sc1
  v_exp_f32 v82, v82
  v_exp_f32 v83, v83
  v_perm_b32 v24, v81, v80, s14
  v_perm_b32 v25, v83, v82, s14
  v_exp_f32 v84, v84
  v_mfma_f32_32x32x8_bf16 v[64:79], v[58:59], v[140:141], 0
  s_waitcnt lgkmcnt(0)
  v_exp_f32 v85, v85
  v_exp_f32 v86, v86
  v_exp_f32 v87, v87
  v_perm_b32 v26, v85, v84, s14
  v_perm_b32 v27, v87, v86, s14
  v_exp_f32 v88, v88
  v_mfma_f32_32x32x16_bf16 v[64:79], v[32:35], v[128:131], v[64:79]
  buffer_load_dwordx4 v21, s[64:67], s88 offen lds
  v_exp_f32 v89, v89
  v_exp_f32 v90, v90
  v_exp_f32 v91, v91
  v_perm_b32 v28, v89, v88, s14
  v_perm_b32 v29, v91, v90, s14
  v_exp_f32 v92, v92
  v_mfma_f32_32x32x16_bf16 v[112:127], v[48:51], v[24:27], v[112:127]
  buffer_load_dwordx4 v21, s[64:67], s88 offen offset:1024 lds
  v_exp_f32 v93, v93
  v_exp_f32 v94, v94
  v_exp_f32 v95, v95
  v_perm_b32 v30, v93, v92, s14
  v_perm_b32 v31, v95, v94, s14
  v_exp_f32 v64, v64
  v_exp_f32 v65, v65
  v_mfma_f32_32x32x16_bf16 v[112:127], v[52:55], v[28:31], v[112:127]
  ds_read_b128 v[36:39], v164 offset:16704
  v_exp_f32 v66, v66
  v_exp_f32 v67, v67
  v_perm_b32 v24, v65, v64, s14
  v_perm_b32 v25, v67, v66, s14
  v_exp_f32 v68, v68
  v_mfma_f32_32x32x8_bf16 v[80:95], v[58:59], v[148:149], 0
  s_add_u32 s91, s74, 114688
  v_exp_f32 v69, v69
  v_exp_f32 v70, v70
  v_exp_f32 v71, v71
  v_perm_b32 v26, v69, v68, s14
  v_perm_b32 v27, v71, v70, s14
  v_exp_f32 v72, v72
  v_mfma_f32_32x32x16_bf16 v[80:95], v[32:35], v[132:135], v[80:95]
  ds_read_b128 v[48:51], v165 offset:17728
  v_exp_f32 v73, v73
  v_exp_f32 v74, v74
  v_exp_f32 v75, v75
  v_perm_b32 v28, v73, v72, s14
  v_perm_b32 v29, v75, v74, s14
  v_exp_f32 v76, v76
  v_mfma_f32_32x32x16_bf16 v[96:111], v[40:43], v[24:27], v[96:111]
  ds_read_b128 v[52:55], v165 offset:18336
  v_exp_f32 v77, v77
  v_exp_f32 v78, v78
  v_exp_f32 v79, v79
  v_perm_b32 v30, v77, v76, s14
  v_perm_b32 v31, v79, v78, s14
  v_exp_f32 v80, v80
  v_exp_f32 v81, v81
  v_mfma_f32_32x32x16_bf16 v[96:111], v[44:47], v[28:31], v[96:111]
  buffer_store_dwordx4 v[188:191], v21, s[64:67], s91 offen offset:0 sc1
  v_exp_f32 v82, v82
  v_exp_f32 v83, v83
  v_perm_b32 v24, v81, v80, s14
  v_perm_b32 v25, v83, v82, s14
  v_exp_f32 v84, v84
  v_mfma_f32_32x32x8_bf16 v[64:79], v[58:59], v[142:143], 0
  s_waitcnt lgkmcnt(0)
  v_exp_f32 v85, v85
  v_exp_f32 v86, v86
  v_exp_f32 v87, v87
  v_perm_b32 v26, v85, v84, s14
  v_perm_b32 v27, v87, v86, s14
  v_exp_f32 v88, v88
  v_mfma_f32_32x32x16_bf16 v[64:79], v[36:39], v[128:131], v[64:79]
  buffer_load_dwordx4 v21, s[64:67], s88 offen offset:2048 lds
  v_exp_f32 v89, v89
  v_exp_f32 v90, v90
  v_exp_f32 v91, v91
  v_perm_b32 v28, v89, v88, s14
  v_perm_b32 v29, v91, v90, s14
  v_exp_f32 v92, v92
  v_mfma_f32_32x32x16_bf16 v[112:127], v[40:43], v[24:27], v[112:127]
  buffer_store_dwordx4 v[192:195], v21, s[64:67], s91 offen offset:1024 sc1
  v_exp_f32 v93, v93
  v_exp_f32 v94, v94
  v_exp_f32 v95, v95
  v_perm_b32 v30, v93, v92, s14
  v_perm_b32 v31, v95, v94, s14
  v_exp_f32 v64, v64
  v_exp_f32 v65, v65
  v_mfma_f32_32x32x16_bf16 v[112:127], v[44:47], v[28:31], v[112:127]
  ds_read_b128 v[32:35], v164 offset:19968
  v_exp_f32 v66, v66
  v_exp_f32 v67, v67
  v_perm_b32 v24, v65, v64, s14
  v_perm_b32 v25, v67, v66, s14
  v_exp_f32 v68, v68
  v_mfma_f32_32x32x8_bf16 v[80:95], v[58:59], v[150:151], 0
  v_exp_f32 v69, v69
  v_exp_f32 v70, v70
  v_exp_f32 v71, v71
  v_perm_b32 v26, v69, v68, s14
  v_perm_b32 v27, v71, v70, s14
  v_exp_f32 v72, v72
  v_mfma_f32_32x32x16_bf16 v[80:95], v[36:39], v[132:135], v[80:95]
  ds_read_b128 v[40:43], v165 offset:20992
  v_exp_f32 v73, v73
  v_exp_f32 v74, v74
  v_exp_f32 v75, v75
  v_perm_b32 v28, v73, v72, s14
  v_perm_b32 v29, v75, v74, s14
  v_exp_f32 v76, v76
  v_mfma_f32_32x32x16_bf16 v[96:111], v[48:51], v[24:27], v[96:111]
  ds_read_b128 v[44:47], v165 offset:21600
  v_exp_f32 v77, v77
  v_exp_f32 v78, v78
  v_exp_f32 v79, v79
  v_perm_b32 v30, v77, v76, s14
  v_perm_b32 v31, v79, v78, s14
  v_exp_f32 v80, v80
  v_exp_f32 v81, v81
  v_mfma_f32_32x32x16_bf16 v[96:111], v[52:55], v[28:31], v[96:111]
  buffer_load_dwordx4 v21, s[64:67], s88 offen offset:3072 lds
  s_add_u32 m0, s9, 131072
  s_add_u32 s88, s86, 131072
  v_exp_f32 v82, v82
  v_exp_f32 v83, v83
  v_perm_b32 v24, v81, v80, s14
  v_perm_b32 v25, v83, v82, s14
  v_exp_f32 v84, v84
  v_mfma_f32_32x32x8_bf16 v[64:79], v[60:61], v[136:137], 0
  s_waitcnt lgkmcnt(0)
  v_exp_f32 v85, v85
  v_exp_f32 v86, v86
  v_exp_f32 v87, v87
  v_perm_b32 v26, v85, v84, s14
  v_perm_b32 v27, v87, v86, s14
  v_exp_f32 v88, v88
  v_mfma_f32_32x32x16_bf16 v[64:79], v[32:35], v[128:131], v[64:79]
  buffer_store_dwordx4 v[196:199], v21, s[64:67], s91 offen offset:2048 sc1
  v_exp_f32 v89, v89
  v_exp_f32 v90, v90
  v_exp_f32 v91, v91
  v_perm_b32 v28, v89, v88, s14
  v_perm_b32 v29, v91, v90, s14
  v_exp_f32 v92, v92
  v_mfma_f32_32x32x16_bf16 v[112:127], v[48:51], v[24:27], v[112:127]
  buffer_load_dwordx4 v21, s[64:67], s88 offen lds
  v_exp_f32 v93, v93
  v_exp_f32 v94, v94
  v_exp_f32 v95, v95
  v_perm_b32 v30, v93, v92, s14
  v_perm_b32 v31, v95, v94, s14
  v_exp_f32 v64, v64
  v_exp_f32 v65, v65
  v_mfma_f32_32x32x16_bf16 v[112:127], v[52:55], v[28:31], v[112:127]
  ds_read_b128 v[36:39], v164 offset:22208
  v_exp_f32 v66, v66
  v_exp_f32 v67, v67
  v_perm_b32 v24, v65, v64, s14
  v_perm_b32 v25, v67, v66, s14
  v_exp_f32 v68, v68
  v_mfma_f32_32x32x8_bf16 v[80:95], v[60:61], v[144:145], 0
  v_exp_f32 v69, v69
  v_exp_f32 v70, v70
  v_exp_f32 v71, v71
  v_perm_b32 v26, v69, v68, s14
  v_perm_b32 v27, v71, v70, s14
  v_exp_f32 v72, v72
  v_mfma_f32_32x32x16_bf16 v[80:95], v[32:35], v[132:135], v[80:95]
  ds_read_b128 v[48:51], v165 offset:23232
  v_exp_f32 v73, v73
  v_exp_f32 v74, v74
  v_exp_f32 v75, v75
  v_perm_b32 v28, v73, v72, s14
  v_perm_b32 v29, v75, v74, s14
  v_exp_f32 v76, v76
  v_mfma_f32_32x32x16_bf16 v[96:111], v[40:43], v[24:27], v[96:111]
  ds_read_b128 v[52:55], v165 offset:23840
  v_exp_f32 v77, v77
  v_exp_f32 v78, v78
  v_exp_f32 v79, v79
  v_perm_b32 v30, v77, v76, s14
  v_perm_b32 v31, v79, v78, s14
  v_exp_f32 v80, v80
  v_exp_f32 v81, v81
  v_mfma_f32_32x32x16_bf16 v[96:111], v[44:47], v[28:31], v[96:111]
  buffer_store_dwordx4 v[200:203], v21, s[64:67], s91 offen offset:3072 sc1
  v_exp_f32 v82, v82
  v_exp_f32 v83, v83
  v_perm_b32 v24, v81, v80, s14
  v_perm_b32 v25, v83, v82, s14
  v_exp_f32 v84, v84
  v_mfma_f32_32x32x8_bf16 v[64:79], v[60:61], v[138:139], 0
  s_waitcnt lgkmcnt(0)
  v_exp_f32 v85, v85
  v_exp_f32 v86, v86
  v_exp_f32 v87, v87
  v_perm_b32 v26, v85, v84, s14
  v_perm_b32 v27, v87, v86, s14
  v_exp_f32 v88, v88
  v_mfma_f32_32x32x16_bf16 v[64:79], v[36:39], v[128:131], v[64:79]
  buffer_load_dwordx4 v21, s[64:67], s88 offen offset:1024 lds
  v_exp_f32 v89, v89
  v_exp_f32 v90, v90
  v_exp_f32 v91, v91
  v_perm_b32 v28, v89, v88, s14
  v_perm_b32 v29, v91, v90, s14
  v_exp_f32 v92, v92
  v_mfma_f32_32x32x16_bf16 v[112:127], v[40:43], v[24:27], v[112:127]
  buffer_load_dwordx4 v21, s[64:67], s88 offen offset:2048 lds
  v_exp_f32 v93, v93
  v_exp_f32 v94, v94
  v_exp_f32 v95, v95
  v_perm_b32 v30, v93, v92, s14
  v_perm_b32 v31, v95, v94, s14
  v_exp_f32 v64, v64
  v_exp_f32 v65, v65
  v_mfma_f32_32x32x16_bf16 v[112:127], v[44:47], v[28:31], v[112:127]
  ds_read_b128 v[32:35], v164 offset:24448
  v_exp_f32 v66, v66
  v_exp_f32 v67, v67
  v_perm_b32 v24, v65, v64, s14
  v_perm_b32 v25, v67, v66, s14
  v_exp_f32 v68, v68
  v_mfma_f32_32x32x8_bf16 v[80:95], v[60:61], v[146:147], 0
  s_add_u32 s91, s74, 131072
  v_exp_f32 v69, v69
  v_exp_f32 v70, v70
  v_exp_f32 v71, v71
  v_perm_b32 v26, v69, v68, s14
  v_perm_b32 v27, v71, v70, s14
  v_exp_f32 v72, v72
  v_mfma_f32_32x32x16_bf16 v[80:95], v[36:39], v[132:135], v[80:95]
  ds_read_b128 v[40:43], v165 offset:25472
  v_exp_f32 v73, v73
  v_exp_f32 v74, v74
  v_exp_f32 v75, v75
  v_perm_b32 v28, v73, v72, s14
  v_perm_b32 v29, v75, v74, s14
  v_exp_f32 v76, v76
  v_mfma_f32_32x32x16_bf16 v[96:111], v[48:51], v[24:27], v[96:111]
  ds_read_b128 v[44:47], v165 offset:26080
  v_exp_f32 v77, v77
  v_exp_f32 v78, v78
  v_exp_f32 v79, v79
  v_perm_b32 v30, v77, v76, s14
  v_perm_b32 v31, v79, v78, s14
  v_exp_f32 v80, v80
  v_exp_f32 v81, v81
  v_mfma_f32_32x32x16_bf16 v[96:111], v[52:55], v[28:31], v[96:111]
  buffer_store_dwordx4 v[220:223], v21, s[64:67], s91 offen offset:0 sc1
  v_exp_f32 v82, v82
  v_exp_f32 v83, v83
  v_perm_b32 v24, v81, v80, s14
  v_perm_b32 v25, v83, v82, s14
  v_exp_f32 v84, v84
  v_mfma_f32_32x32x8_bf16 v[64:79], v[62:63], v[136:137], 0
  s_waitcnt lgkmcnt(0)
  v_exp_f32 v85, v85
  v_exp_f32 v86, v86
  v_exp_f32 v87, v87
  v_perm_b32 v26, v85, v84, s14
  v_perm_b32 v27, v87, v86, s14
  v_exp_f32 v88, v88
  v_mfma_f32_32x32x16_bf16 v[64:79], v[32:35], v[128:131], v[64:79]
  buffer_load_dwordx4 v21, s[64:67], s88 offen offset:3072 lds
  v_exp_f32 v89, v89
  v_exp_f32 v90, v90
  v_exp_f32 v91, v91
  v_perm_b32 v28, v89, v88, s14
  v_perm_b32 v29, v91, v90, s14
  v_exp_f32 v92, v92
  v_mfma_f32_32x32x16_bf16 v[112:127], v[48:51], v[24:27], v[112:127]
  buffer_store_dwordx4 v[224:227], v21, s[64:67], s91 offen offset:1024 sc1
  v_exp_f32 v93, v93
  v_exp_f32 v94, v94
  v_exp_f32 v95, v95
  v_perm_b32 v30, v93, v92, s14
  v_perm_b32 v31, v95, v94, s14
  v_exp_f32 v64, v64
  v_exp_f32 v65, v65
  v_mfma_f32_32x32x16_bf16 v[112:127], v[52:55], v[28:31], v[112:127]
  ds_read_b128 v[36:39], v164 offset:26688
  v_exp_f32 v66, v66
  v_exp_f32 v67, v67
  v_perm_b32 v24, v65, v64, s14
  v_perm_b32 v25, v67, v66, s14
  v_exp_f32 v68, v68
  v_mfma_f32_32x32x8_bf16 v[80:95], v[62:63], v[144:145], 0
  s_lshr_b32 s88, s9, 2
  s_add_u32 m0, s88, 147456
  s_add_u32 s88, s88, 37896192
  v_exp_f32 v69, v69
  v_exp_f32 v70, v70
  v_exp_f32 v71, v71
  v_perm_b32 v26, v69, v68, s14
  v_perm_b32 v27, v71, v70, s14
  v_exp_f32 v72, v72
  v_mfma_f32_32x32x16_bf16 v[80:95], v[32:35], v[132:135], v[80:95]
  ds_read_b128 v[48:51], v165 offset:27712
  v_exp_f32 v73, v73
  v_exp_f32 v74, v74
  v_exp_f32 v75, v75
  v_perm_b32 v28, v73, v72, s14
  v_perm_b32 v29, v75, v74, s14
  v_exp_f32 v76, v76
  v_mfma_f32_32x32x16_bf16 v[96:111], v[40:43], v[24:27], v[96:111]
  ds_read_b128 v[52:55], v165 offset:28320
  v_exp_f32 v77, v77
  v_exp_f32 v78, v78
  v_exp_f32 v79, v79
  v_perm_b32 v30, v77, v76, s14
  v_perm_b32 v31, v79, v78, s14
  v_exp_f32 v80, v80
  v_exp_f32 v81, v81
  v_mfma_f32_32x32x16_bf16 v[96:111], v[44:47], v[28:31], v[96:111]
  buffer_load_dwordx4 v21, s[64:67], s88 offen lds
  v_exp_f32 v82, v82
  v_exp_f32 v83, v83
  v_perm_b32 v24, v81, v80, s14
  v_perm_b32 v25, v83, v82, s14
  v_exp_f32 v84, v84
  v_mfma_f32_32x32x8_bf16 v[64:79], v[62:63], v[138:139], 0
  s_waitcnt lgkmcnt(0)
  v_exp_f32 v85, v85
  v_exp_f32 v86, v86
  v_exp_f32 v87, v87
  v_perm_b32 v26, v85, v84, s14
  v_perm_b32 v27, v87, v86, s14
  v_exp_f32 v88, v88
  v_mfma_f32_32x32x16_bf16 v[64:79], v[36:39], v[128:131], v[64:79]
  buffer_store_dwordx4 v[228:231], v21, s[64:67], s91 offen offset:2048 sc1
  v_exp_f32 v89, v89
  v_exp_f32 v90, v90
  v_exp_f32 v91, v91
  v_perm_b32 v28, v89, v88, s14
  v_perm_b32 v29, v91, v90, s14
  v_exp_f32 v92, v92
  v_mfma_f32_32x32x16_bf16 v[112:127], v[40:43], v[24:27], v[112:127]
  buffer_store_dwordx4 v[168:171], v21, s[64:67], s96 offen sc1
  v_exp_f32 v93, v93
  v_exp_f32 v94, v94
  v_exp_f32 v95, v95
  v_perm_b32 v30, v93, v92, s14
  v_perm_b32 v31, v95, v94, s14
  v_exp_f32 v64, v64
  v_exp_f32 v65, v65
  v_mfma_f32_32x32x16_bf16 v[112:127], v[44:47], v[28:31], v[112:127]
PAD11:
  s_cbranch_execz PAD15
  ds_read_b128 v[32:35], v164 offset:28928
  v_exp_f32 v66, v66
  v_exp_f32 v67, v67
  v_perm_b32 v24, v65, v64, s14
  v_perm_b32 v25, v67, v66, s14
  v_exp_f32 v68, v68
  v_mfma_f32_32x32x8_bf16 v[80:95], v[62:63], v[146:147], 0
  v_exp_f32 v69, v69
  v_exp_f32 v70, v70
  v_exp_f32 v71, v71
  v_perm_b32 v26, v69, v68, s14
  v_perm_b32 v27, v71, v70, s14
  v_exp_f32 v72, v72
  v_mfma_f32_32x32x16_bf16 v[80:95], v[36:39], v[132:135], v[80:95]
  ds_read_b128 v[40:43], v165 offset:29952
  v_exp_f32 v73, v73
  v_exp_f32 v74, v74
  v_exp_f32 v75, v75
  v_perm_b32 v28, v73, v72, s14
  v_perm_b32 v29, v75, v74, s14
  v_exp_f32 v76, v76
  v_mfma_f32_32x32x16_bf16 v[96:111], v[48:51], v[24:27], v[96:111]
  ds_read_b128 v[44:47], v165 offset:30560
  ds_read_b128 v[56:59], v164 offset:37888
  v_exp_f32 v77, v77
  v_exp_f32 v78, v78
  v_exp_f32 v79, v79
  v_perm_b32 v30, v77, v76, s14
  v_perm_b32 v31, v79, v78, s14
  v_exp_f32 v80, v80
  v_exp_f32 v81, v81
  v_mfma_f32_32x32x16_bf16 v[96:111], v[52:55], v[28:31], v[96:111]
  buffer_store_dwordx4 v[232:235], v21, s[64:67], s91 offen offset:3072 sc1
  v_exp_f32 v82, v82
  v_exp_f32 v83, v83
  v_perm_b32 v24, v81, v80, s14
  v_perm_b32 v25, v83, v82, s14
  v_exp_f32 v84, v84
  v_mfma_f32_32x32x8_bf16 v[64:79], v[60:61], v[140:141], 0
  s_waitcnt lgkmcnt(0)
  v_exp_f32 v85, v85
  v_exp_f32 v86, v86
  v_exp_f32 v87, v87
  v_perm_b32 v26, v85, v84, s14
  v_perm_b32 v27, v87, v86, s14
  v_exp_f32 v88, v88
  v_mfma_f32_32x32x16_bf16 v[64:79], v[32:35], v[128:131], v[64:79]
  buffer_store_dwordx4 v[168:171], v21, s[64:67], s96 offen offset:1024 sc1
  v_exp_f32 v89, v89
  v_exp_f32 v90, v90
  v_exp_f32 v91, v91
  v_perm_b32 v28, v89, v88, s14
  v_perm_b32 v29, v91, v90, s14
  v_exp_f32 v92, v92
  v_mfma_f32_32x32x16_bf16 v[112:127], v[48:51], v[24:27], v[112:127]
  buffer_store_dword v168, v243, s[64:67], s96 offen offset:2048 sc1
  v_exp_f32 v93, v93
  v_exp_f32 v94, v94
  v_exp_f32 v95, v95
  v_perm_b32 v30, v93, v92, s14
  v_perm_b32 v31, v95, v94, s14
  v_exp_f32 v64, v64
  v_exp_f32 v65, v65
  v_mfma_f32_32x32x16_bf16 v[112:127], v[52:55], v[28:31], v[112:127]
  ds_read_b128 v[36:39], v164 offset:31168
  v_exp_f32 v66, v66
  v_exp_f32 v67, v67
  v_perm_b32 v24, v65, v64, s14
  v_perm_b32 v25, v67, v66, s14
  v_exp_f32 v68, v68
  v_mfma_f32_32x32x8_bf16 v[80:95], v[60:61], v[148:149], 0
  s_add_u32 s87, s81, s8
  v_exp_f32 v69, v69
  v_exp_f32 v70, v70
  v_exp_f32 v71, v71
  v_perm_b32 v26, v69, v68, s14
  v_perm_b32 v27, v71, v70, s14
  v_exp_f32 v72, v72
  v_mfma_f32_32x32x16_bf16 v[80:95], v[32:35], v[132:135], v[80:95]
  ds_read_b128 v[48:51], v165 offset:32192
  v_exp_f32 v73, v73
  v_exp_f32 v74, v74
  v_exp_f32 v75, v75
  v_perm_b32 v28, v73, v72, s14
  v_perm_b32 v29, v75, v74, s14
  v_exp_f32 v76, v76
  v_mfma_f32_32x32x16_bf16 v[96:111], v[40:43], v[24:27], v[96:111]
  ds_read_b128 v[52:55], v165 offset:32800
  v_exp_f32 v77, v77
  v_exp_f32 v78, v78
  v_exp_f32 v79, v79
  v_perm_b32 v30, v77, v76, s14
  v_perm_b32 v31, v79, v78, s14
  v_exp_f32 v80, v80
  v_exp_f32 v81, v81
  v_mfma_f32_32x32x16_bf16 v[96:111], v[44:47], v[28:31], v[96:111]
  buffer_load_dwordx4 a[144:147], v245, s[64:67], s87 offen
  v_exp_f32 v82, v82
  v_exp_f32 v83, v83
  v_perm_b32 v24, v81, v80, s14
  v_perm_b32 v25, v83, v82, s14
  v_exp_f32 v84, v84
  v_mfma_f32_32x32x8_bf16 v[64:79], v[60:61], v[142:143], 0
  s_waitcnt lgkmcnt(0)
  v_exp_f32 v85, v85
  v_exp_f32 v86, v86
  v_exp_f32 v87, v87
  v_perm_b32 v26, v85, v84, s14
  v_perm_b32 v27, v87, v86, s14
  v_exp_f32 v88, v88
  v_mfma_f32_32x32x16_bf16 v[64:79], v[36:39], v[128:131], v[64:79]
  buffer_load_dwordx4 a[148:151], v245, s[64:67], s87 offen offset:1024
  v_exp_f32 v89, v89
  v_exp_f32 v90, v90
  v_exp_f32 v91, v91
  v_perm_b32 v28, v89, v88, s14
  v_perm_b32 v29, v91, v90, s14
  v_exp_f32 v92, v92
  v_mfma_f32_32x32x16_bf16 v[112:127], v[40:43], v[24:27], v[112:127]
  buffer_load_dwordx4 a[152:155], v245, s[64:67], s87 offen offset:2048
  v_exp_f32 v93, v93
  v_exp_f32 v94, v94
  v_exp_f32 v95, v95
  v_perm_b32 v30, v93, v92, s14
  v_perm_b32 v31, v95, v94, s14
  v_exp_f32 v64, v64
  v_exp_f32 v65, v65
  v_mfma_f32_32x32x16_bf16 v[112:127], v[44:47], v[28:31], v[112:127]
  ds_read_b128 v[32:35], v164 offset:33408
  v_exp_f32 v66, v66
  v_exp_f32 v67, v67
  v_perm_b32 v24, v65, v64, s14
  v_perm_b32 v25, v67, v66, s14
  v_exp_f32 v68, v68
  v_mfma_f32_32x32x8_bf16 v[80:95], v[60:61], v[150:151], 0
  v_exp_f32 v69, v69
  v_exp_f32 v70, v70
  v_exp_f32 v71, v71
  v_perm_b32 v26, v69, v68, s14
  v_perm_b32 v27, v71, v70, s14
  v_exp_f32 v72, v72
  v_mfma_f32_32x32x16_bf16 v[80:95], v[36:39], v[132:135], v[80:95]
  ds_read_b128 v[40:43], v165 offset:34432
  v_exp_f32 v73, v73
  v_exp_f32 v74, v74
  v_exp_f32 v75, v75
  v_perm_b32 v28, v73, v72, s14
  v_perm_b32 v29, v75, v74, s14
  v_exp_f32 v76, v76
  v_mfma_f32_32x32x16_bf16 v[96:111], v[48:51], v[24:27], v[96:111]
  ds_read_b128 v[44:47], v165 offset:35040
  v_exp_f32 v77, v77
  v_exp_f32 v78, v78
  v_exp_f32 v79, v79
  v_perm_b32 v30, v77, v76, s14
  v_perm_b32 v31, v79, v78, s14
  v_exp_f32 v80, v80
  v_exp_f32 v81, v81
  v_mfma_f32_32x32x16_bf16 v[96:111], v[52:55], v[28:31], v[96:111]
  buffer_load_dwordx4 a[156:159], v245, s[64:67], s87 offen offset:3072
  v_exp_f32 v82, v82
  v_exp_f32 v83, v83
  v_perm_b32 v24, v81, v80, s14
  v_perm_b32 v25, v83, v82, s14
  v_exp_f32 v84, v84
  v_mfma_f32_32x32x8_bf16 v[64:79], v[62:63], v[140:141], 0
  s_waitcnt lgkmcnt(0)
  v_exp_f32 v85, v85
  v_exp_f32 v86, v86
  v_exp_f32 v87, v87
  v_perm_b32 v26, v85, v84, s14
  v_perm_b32 v27, v87, v86, s14
  v_exp_f32 v88, v88
  v_mfma_f32_32x32x16_bf16 v[64:79], v[32:35], v[128:131], v[64:79]
  buffer_load_dwordx4 a[160:163], v250, s[64:67], s87 offen
  v_exp_f32 v89, v89
  v_exp_f32 v90, v90
  v_exp_f32 v91, v91
  v_perm_b32 v28, v89, v88, s14
  v_perm_b32 v29, v91, v90, s14
  v_exp_f32 v92, v92
  v_mfma_f32_32x32x16_bf16 v[112:127], v[48:51], v[24:27], v[112:127]
  buffer_load_dwordx4 a[164:167], v250, s[64:67], s87 offen offset:1024
  v_exp_f32 v93, v93
  v_exp_f32 v94, v94
  v_exp_f32 v95, v95
  v_perm_b32 v30, v93, v92, s14
  v_perm_b32 v31, v95, v94, s14
  v_exp_f32 v64, v64
  v_exp_f32 v65, v65
  v_mfma_f32_32x32x16_bf16 v[112:127], v[52:55], v[28:31], v[112:127]
  ds_read_b128 v[36:39], v164 offset:35648
  v_exp_f32 v66, v66
  v_exp_f32 v67, v67
  v_perm_b32 v24, v65, v64, s14
  v_perm_b32 v25, v67, v66, s14
  v_exp_f32 v68, v68
  v_mfma_f32_32x32x8_bf16 v[80:95], v[62:63], v[148:149], 0
  v_exp_f32 v69, v69
  v_exp_f32 v70, v70
  v_exp_f32 v71, v71
  v_perm_b32 v26, v69, v68, s14
  v_perm_b32 v27, v71, v70, s14
  v_exp_f32 v72, v72
  v_mfma_f32_32x32x16_bf16 v[80:95], v[32:35], v[132:135], v[80:95]
  ds_read_b128 v[48:51], v165 offset:36672
  v_exp_f32 v73, v73
  v_exp_f32 v74, v74
  v_exp_f32 v75, v75
  v_perm_b32 v28, v73, v72, s14
  v_perm_b32 v29, v75, v74, s14
  v_exp_f32 v76, v76
  v_mfma_f32_32x32x16_bf16 v[96:111], v[40:43], v[24:27], v[96:111]
  ds_read_b128 v[52:55], v165 offset:37280
  v_exp_f32 v77, v77
  v_exp_f32 v78, v78
  v_exp_f32 v79, v79
  v_perm_b32 v30, v77, v76, s14
  v_perm_b32 v31, v79, v78, s14
  v_exp_f32 v80, v80
  v_exp_f32 v81, v81
  v_mfma_f32_32x32x16_bf16 v[96:111], v[44:47], v[28:31], v[96:111]
  buffer_load_dwordx4 a[168:171], v250, s[64:67], s87 offen offset:2048
  v_exp_f32 v82, v82
  v_exp_f32 v83, v83
  v_perm_b32 v24, v81, v80, s14
  v_perm_b32 v25, v83, v82, s14
  v_exp_f32 v84, v84
  v_mfma_f32_32x32x8_bf16 v[64:79], v[62:63], v[142:143], 0
  s_waitcnt lgkmcnt(0)
  v_exp_f32 v85, v85
  v_exp_f32 v86, v86
  v_exp_f32 v87, v87
  v_perm_b32 v26, v85, v84, s14
  v_perm_b32 v27, v87, v86, s14
  v_exp_f32 v88, v88
  v_mfma_f32_32x32x16_bf16 v[64:79], v[36:39], v[128:131], v[64:79]
  buffer_load_dwordx4 a[172:175], v250, s[64:67], s87 offen offset:3072
  v_exp_f32 v89, v89
  v_exp_f32 v90, v90
  v_exp_f32 v91, v91
  v_perm_b32 v28, v89, v88, s14
  v_perm_b32 v29, v91, v90, s14
  v_exp_f32 v92, v92
  v_mfma_f32_32x32x16_bf16 v[112:127], v[40:43], v[24:27], v[112:127]
  buffer_load_dwordx4 a[176:179], v167, s[64:67], s87 offen
  v_exp_f32 v93, v93
  v_exp_f32 v94, v94
  v_exp_f32 v95, v95
  v_perm_b32 v30, v93, v92, s14
  v_perm_b32 v31, v95, v94, s14
  v_exp_f32 v64, v64
  v_exp_f32 v65, v65
  v_mfma_f32_32x32x16_bf16 v[112:127], v[44:47], v[28:31], v[112:127]
  ds_read_b128 v[32:35], v164 offset:38912
  v_exp_f32 v66, v66
  v_exp_f32 v67, v67
  v_perm_b32 v24, v65, v64, s14
  v_perm_b32 v25, v67, v66, s14
  v_exp_f32 v68, v68
  v_mfma_f32_32x32x8_bf16 v[80:95], v[62:63], v[150:151], 0
  s_add_u32 s87, s87, 18432
  v_exp_f32 v69, v69
  v_exp_f32 v70, v70
  v_exp_f32 v71, v71
  v_perm_b32 v26, v69, v68, s14
  v_perm_b32 v27, v71, v70, s14
  v_exp_f32 v72, v72
  v_mfma_f32_32x32x16_bf16 v[80:95], v[36:39], v[132:135], v[80:95]
  ds_read_b128 v[40:43], v165 offset:39936
  v_exp_f32 v73, v73
  v_exp_f32 v74, v74
  v_exp_f32 v75, v75
  v_perm_b32 v28, v73, v72, s14
  v_perm_b32 v29, v75, v74, s14
  v_exp_f32 v76, v76
  v_mfma_f32_32x32x16_bf16 v[96:111], v[48:51], v[24:27], v[96:111]
  ds_read_b128 v[44:47], v165 offset:40544
  v_exp_f32 v77, v77
  v_exp_f32 v78, v78
  v_exp_f32 v79, v79
  v_perm_b32 v30, v77, v76, s14
  v_perm_b32 v31, v79, v78, s14
  v_exp_f32 v80, v80
  v_exp_f32 v81, v81
  v_mfma_f32_32x32x16_bf16 v[96:111], v[52:55], v[28:31], v[96:111]
  buffer_load_dwordx4 a[180:183], v245, s[64:67], s87 offen
  v_exp_f32 v82, v82
  v_exp_f32 v83, v83
  v_perm_b32 v24, v81, v80, s14
  v_perm_b32 v25, v83, v82, s14
  v_exp_f32 v84, v84
  v_mfma_f32_32x32x8_bf16 v[64:79], v[56:57], v[136:137], 0
  s_waitcnt lgkmcnt(0)
  v_exp_f32 v85, v85
  v_exp_f32 v86, v86
  v_exp_f32 v87, v87
  v_perm_b32 v26, v85, v84, s14
  v_perm_b32 v27, v87, v86, s14
  v_exp_f32 v88, v88
  v_mfma_f32_32x32x16_bf16 v[64:79], v[32:35], v[128:131], v[64:79]
  buffer_load_dwordx4 a[184:187], v245, s[64:67], s87 offen offset:1024
  v_exp_f32 v89, v89
  v_exp_f32 v90, v90
  v_exp_f32 v91, v91
  v_perm_b32 v28, v89, v88, s14
  v_perm_b32 v29, v91, v90, s14
  v_exp_f32 v92, v92
  v_mfma_f32_32x32x16_bf16 v[112:127], v[48:51], v[24:27], v[112:127]
  buffer_load_dwordx4 a[188:191], v245, s[64:67], s87 offen offset:2048
  v_exp_f32 v93, v93
  v_exp_f32 v94, v94
  v_exp_f32 v95, v95
  v_perm_b32 v30, v93, v92, s14
  v_perm_b32 v31, v95, v94, s14
  v_add_u32 v164, 37888, v164
  v_add_u32 v165, 37888, v165
  v_exp_f32 v64, v64
  v_exp_f32 v65, v65
  v_mfma_f32_32x32x16_bf16 v[112:127], v[52:55], v[28:31], v[112:127]
  ds_read_b128 v[36:39], v164 offset:3264
  v_exp_f32 v66, v66
  v_exp_f32 v67, v67
  v_perm_b32 v24, v65, v64, s14
  v_perm_b32 v25, v67, v66, s14
  v_exp_f32 v68, v68
  v_mfma_f32_32x32x8_bf16 v[80:95], v[56:57], v[144:145], 0
  v_exp_f32 v69, v69
  v_exp_f32 v70, v70
  v_exp_f32 v71, v71
  v_perm_b32 v26, v69, v68, s14
  v_perm_b32 v27, v71, v70, s14
  v_exp_f32 v72, v72
  v_mfma_f32_32x32x16_bf16 v[80:95], v[32:35], v[132:135], v[80:95]
  ds_read_b128 v[48:51], v165 offset:4288
  v_exp_f32 v73, v73
  v_exp_f32 v74, v74
  v_exp_f32 v75, v75
  v_perm_b32 v28, v73, v72, s14
  v_perm_b32 v29, v75, v74, s14
  v_exp_f32 v76, v76
  v_mfma_f32_32x32x16_bf16 v[96:111], v[40:43], v[24:27], v[96:111]
  ds_read_b128 v[52:55], v165 offset:4896
  v_exp_f32 v77, v77
  v_exp_f32 v78, v78
  v_exp_f32 v79, v79
  v_perm_b32 v30, v77, v76, s14
  v_perm_b32 v31, v79, v78, s14
  v_exp_f32 v80, v80
  v_exp_f32 v81, v81
  v_mfma_f32_32x32x16_bf16 v[96:111], v[44:47], v[28:31], v[96:111]
  buffer_load_dwordx4 a[192:195], v245, s[64:67], s87 offen offset:3072
  v_exp_f32 v82, v82
  v_exp_f32 v83, v83
  v_perm_b32 v24, v81, v80, s14
  v_perm_b32 v25, v83, v82, s14
  v_exp_f32 v84, v84
  v_mfma_f32_32x32x8_bf16 v[64:79], v[56:57], v[138:139], 0
  s_waitcnt lgkmcnt(0)
  v_exp_f32 v85, v85
  v_exp_f32 v86, v86
  v_exp_f32 v87, v87
  v_perm_b32 v26, v85, v84, s14
  v_perm_b32 v27, v87, v86, s14
  v_exp_f32 v88, v88
  v_mfma_f32_32x32x16_bf16 v[64:79], v[36:39], v[128:131], v[64:79]
  buffer_load_dwordx4 a[196:199], v250, s[64:67], s87 offen
  v_exp_f32 v89, v89
  v_exp_f32 v90, v90
  v_exp_f32 v91, v91
  v_perm_b32 v28, v89, v88, s14
  v_perm_b32 v29, v91, v90, s14
  v_exp_f32 v92, v92
  v_mfma_f32_32x32x16_bf16 v[112:127], v[40:43], v[24:27], v[112:127]
  buffer_load_dwordx4 a[200:203], v250, s[64:67], s87 offen offset:1024
  v_exp_f32 v93, v93
  v_exp_f32 v94, v94
  v_exp_f32 v95, v95
  v_perm_b32 v30, v93, v92, s14
  v_perm_b32 v31, v95, v94, s14
  v_exp_f32 v64, v64
  v_exp_f32 v65, v65
  v_mfma_f32_32x32x16_bf16 v[112:127], v[44:47], v[28:31], v[112:127]
  ds_read_b128 v[32:35], v164 offset:5504
  v_exp_f32 v66, v66
  v_exp_f32 v67, v67
  v_perm_b32 v24, v65, v64, s14
  v_perm_b32 v25, v67, v66, s14
  v_exp_f32 v68, v68
  v_mfma_f32_32x32x8_bf16 v[80:95], v[56:57], v[146:147], 0
  v_exp_f32 v69, v69
  v_exp_f32 v70, v70
  v_exp_f32 v71, v71
  v_perm_b32 v26, v69, v68, s14
  v_perm_b32 v27, v71, v70, s14
  v_exp_f32 v72, v72
  v_mfma_f32_32x32x16_bf16 v[80:95], v[36:39], v[132:135], v[80:95]
  ds_read_b128 v[40:43], v165 offset:6528
  v_exp_f32 v73, v73
  v_exp_f32 v74, v74
  v_exp_f32 v75, v75
  v_perm_b32 v28, v73, v72, s14
  v_perm_b32 v29, v75, v74, s14
  v_exp_f32 v76, v76
  v_mfma_f32_32x32x16_bf16 v[96:111], v[48:51], v[24:27], v[96:111]
  ds_read_b128 v[44:47], v165 offset:7136
  v_exp_f32 v77, v77
  v_exp_f32 v78, v78
  v_exp_f32 v79, v79
  v_perm_b32 v30, v77, v76, s14
  v_perm_b32 v31, v79, v78, s14
  v_exp_f32 v80, v80
  v_exp_f32 v81, v81
  v_mfma_f32_32x32x16_bf16 v[96:111], v[52:55], v[28:31], v[96:111]
  s_waitcnt vmcnt(15)
  s_barrier
  buffer_store_dword v166, v244, s[64:67], 0 offen sc1
  v_exp_f32 v82, v82
  v_exp_f32 v83, v83
  v_perm_b32 v24, v81, v80, s14
  v_perm_b32 v25, v83, v82, s14
  v_exp_f32 v84, v84
  v_mfma_f32_32x32x8_bf16 v[64:79], v[58:59], v[136:137], 0
  s_waitcnt lgkmcnt(0)
  v_exp_f32 v85, v85
  v_exp_f32 v86, v86
  v_exp_f32 v87, v87
  v_perm_b32 v26, v85, v84, s14
  v_perm_b32 v27, v87, v86, s14
  v_exp_f32 v88, v88
  v_mfma_f32_32x32x16_bf16 v[64:79], v[32:35], v[128:131], v[64:79]
  buffer_load_dwordx4 a[204:207], v250, s[64:67], s87 offen offset:2048
  v_exp_f32 v89, v89
  v_exp_f32 v90, v90
  v_exp_f32 v91, v91
  v_perm_b32 v28, v89, v88, s14
  v_perm_b32 v29, v91, v90, s14
  v_exp_f32 v92, v92
  v_mfma_f32_32x32x16_bf16 v[112:127], v[48:51], v[24:27], v[112:127]
  buffer_load_dwordx4 a[208:211], v250, s[64:67], s87 offen offset:3072
  v_exp_f32 v93, v93
  v_exp_f32 v94, v94
  v_exp_f32 v95, v95
  v_perm_b32 v30, v93, v92, s14
  v_perm_b32 v31, v95, v94, s14
  v_exp_f32 v64, v64
  v_exp_f32 v65, v65
  v_mfma_f32_32x32x16_bf16 v[112:127], v[52:55], v[28:31], v[112:127]
  ds_read_b128 v[36:39], v164 offset:7744
  v_exp_f32 v66, v66
  v_exp_f32 v67, v67
  v_perm_b32 v24, v65, v64, s14
  v_perm_b32 v25, v67, v66, s14
  v_exp_f32 v68, v68
  v_mfma_f32_32x32x8_bf16 v[80:95], v[58:59], v[144:145], 0
  v_exp_f32 v69, v69
  v_exp_f32 v70, v70
  v_exp_f32 v71, v71
  v_perm_b32 v26, v69, v68, s14
  v_perm_b32 v27, v71, v70, s14
  v_exp_f32 v72, v72
  v_mfma_f32_32x32x16_bf16 v[80:95], v[32:35], v[132:135], v[80:95]
  ds_read_b128 v[48:51], v165 offset:8768
  v_exp_f32 v73, v73
  v_exp_f32 v74, v74
  v_exp_f32 v75, v75
  v_perm_b32 v28, v73, v72, s14
  v_perm_b32 v29, v75, v74, s14
  v_exp_f32 v76, v76
  v_mfma_f32_32x32x16_bf16 v[96:111], v[40:43], v[24:27], v[96:111]
  ds_read_b128 v[52:55], v165 offset:9376
  v_exp_f32 v77, v77
  v_exp_f32 v78, v78
  v_exp_f32 v79, v79
  v_perm_b32 v30, v77, v76, s14
  v_perm_b32 v31, v79, v78, s14
  v_exp_f32 v80, v80
  v_exp_f32 v81, v81
  v_mfma_f32_32x32x16_bf16 v[96:111], v[44:47], v[28:31], v[96:111]
  buffer_load_dwordx4 a[212:215], v167, s[64:67], s87 offen
  s_add_u32 s87, s87, 18432
  v_exp_f32 v82, v82
  v_exp_f32 v83, v83
  v_perm_b32 v24, v81, v80, s14
  v_perm_b32 v25, v83, v82, s14
  v_exp_f32 v84, v84
  v_mfma_f32_32x32x8_bf16 v[64:79], v[58:59], v[138:139], 0
  s_waitcnt lgkmcnt(0)
  v_exp_f32 v85, v85
  v_exp_f32 v86, v86
  v_exp_f32 v87, v87
  v_perm_b32 v26, v85, v84, s14
  v_perm_b32 v27, v87, v86, s14
  v_exp_f32 v88, v88
  v_mfma_f32_32x32x16_bf16 v[64:79], v[36:39], v[128:131], v[64:79]
  buffer_load_dwordx4 a[216:219], v245, s[64:67], s87 offen
  v_exp_f32 v89, v89
  v_exp_f32 v90, v90
  v_exp_f32 v91, v91
  v_perm_b32 v28, v89, v88, s14
  v_perm_b32 v29, v91, v90, s14
  v_exp_f32 v92, v92
  v_mfma_f32_32x32x16_bf16 v[112:127], v[40:43], v[24:27], v[112:127]
  buffer_load_dwordx4 a[220:223], v245, s[64:67], s87 offen offset:1024
  v_exp_f32 v93, v93
  v_exp_f32 v94, v94
  v_exp_f32 v95, v95
  v_perm_b32 v30, v93, v92, s14
  v_perm_b32 v31, v95, v94, s14
  v_exp_f32 v64, v64
  v_exp_f32 v65, v65
  v_mfma_f32_32x32x16_bf16 v[112:127], v[44:47], v[28:31], v[112:127]
  ds_read_b128 v[32:35], v164 offset:9984
  v_exp_f32 v66, v66
  v_exp_f32 v67, v67
  v_perm_b32 v24, v65, v64, s14
  v_perm_b32 v25, v67, v66, s14
  v_exp_f32 v68, v68
  v_mfma_f32_32x32x8_bf16 v[80:95], v[58:59], v[146:147], 0
  v_exp_f32 v69, v69
  v_exp_f32 v70, v70
  v_exp_f32 v71, v71
  v_perm_b32 v26, v69, v68, s14
  v_perm_b32 v27, v71, v70, s14
  v_exp_f32 v72, v72
  v_mfma_f32_32x32x16_bf16 v[80:95], v[36:39], v[132:135], v[80:95]
  ds_read_b128 v[40:43], v165 offset:11008
  v_exp_f32 v73, v73
  v_exp_f32 v74, v74
  v_exp_f32 v75, v75
  v_perm_b32 v28, v73, v72, s14
  v_perm_b32 v29, v75, v74, s14
  v_exp_f32 v76, v76
  v_mfma_f32_32x32x16_bf16 v[96:111], v[48:51], v[24:27], v[96:111]
  ds_read_b128 v[44:47], v165 offset:11616
  ds_read_b128 v[60:63], v164 offset:18944
  v_exp_f32 v77, v77
  v_exp_f32 v78, v78
  v_exp_f32 v79, v79
  v_perm_b32 v30, v77, v76, s14
  v_perm_b32 v31, v79, v78, s14
  v_exp_f32 v80, v80
  v_exp_f32 v81, v81
  v_mfma_f32_32x32x16_bf16 v[96:111], v[52:55], v[28:31], v[96:111]
  buffer_load_dwordx4 a[224:227], v245, s[64:67], s87 offen offset:2048
  v_exp_f32 v82, v82
  v_exp_f32 v83, v83
  v_perm_b32 v24, v81, v80, s14
  v_perm_b32 v25, v83, v82, s14
  v_exp_f32 v84, v84
  v_mfma_f32_32x32x8_bf16 v[64:79], v[56:57], v[140:141], 0
  s_waitcnt lgkmcnt(0)
  v_exp_f32 v85, v85
  v_exp_f32 v86, v86
  v_exp_f32 v87, v87
  v_perm_b32 v26, v85, v84, s14
  v_perm_b32 v27, v87, v86, s14
  v_exp_f32 v88, v88
  v_mfma_f32_32x32x16_bf16 v[64:79], v[32:35], v[128:131], v[64:79]
  buffer_load_dwordx4 a[228:231], v245, s[64:67], s87 offen offset:3072
  v_exp_f32 v89, v89
  v_exp_f32 v90, v90
  v_exp_f32 v91, v91
  v_perm_b32 v28, v89, v88, s14
  v_perm_b32 v29, v91, v90, s14
  v_exp_f32 v92, v92
  v_mfma_f32_32x32x16_bf16 v[112:127], v[48:51], v[24:27], v[112:127]
  buffer_load_dwordx4 a[232:235], v250, s[64:67], s87 offen
  v_exp_f32 v93, v93
  v_exp_f32 v94, v94
  v_exp_f32 v95, v95
  v_perm_b32 v30, v93, v92, s14
  v_perm_b32 v31, v95, v94, s14
  v_exp_f32 v64, v64
  v_exp_f32 v65, v65
  v_mfma_f32_32x32x16_bf16 v[112:127], v[52:55], v[28:31], v[112:127]
  ds_read_b128 v[36:39], v164 offset:12224
  v_exp_f32 v66, v66
  v_exp_f32 v67, v67
  v_perm_b32 v24, v65, v64, s14
  v_perm_b32 v25, v67, v66, s14
  v_exp_f32 v68, v68
  v_mfma_f32_32x32x8_bf16 v[80:95], v[56:57], v[148:149], 0
  v_exp_f32 v69, v69
  v_exp_f32 v70, v70
  v_exp_f32 v71, v71
  v_perm_b32 v26, v69, v68, s14
  v_perm_b32 v27, v71, v70, s14
  v_exp_f32 v72, v72
  v_mfma_f32_32x32x16_bf16 v[80:95], v[32:35], v[132:135], v[80:95]
  ds_read_b128 v[48:51], v165 offset:13248
  v_exp_f32 v73, v73
  v_exp_f32 v74, v74
  v_exp_f32 v75, v75
  v_perm_b32 v28, v73, v72, s14
  v_perm_b32 v29, v75, v74, s14
  v_exp_f32 v76, v76
  v_mfma_f32_32x32x16_bf16 v[96:111], v[40:43], v[24:27], v[96:111]
  ds_read_b128 v[52:55], v165 offset:13856
  v_exp_f32 v77, v77
  v_exp_f32 v78, v78
  v_exp_f32 v79, v79
  v_perm_b32 v30, v77, v76, s14
  v_perm_b32 v31, v79, v78, s14
  v_exp_f32 v80, v80
  v_exp_f32 v81, v81
  v_mfma_f32_32x32x16_bf16 v[96:111], v[44:47], v[28:31], v[96:111]
  buffer_load_dwordx4 a[236:239], v250, s[64:67], s87 offen offset:1024
  v_exp_f32 v82, v82
  v_exp_f32 v83, v83
  v_perm_b32 v24, v81, v80, s14
  v_perm_b32 v25, v83, v82, s14
  v_exp_f32 v84, v84
  v_mfma_f32_32x32x8_bf16 v[64:79], v[56:57], v[142:143], 0
  s_waitcnt lgkmcnt(0)
  v_exp_f32 v85, v85
  v_exp_f32 v86, v86
  v_exp_f32 v87, v87
  v_perm_b32 v26, v85, v84, s14
  v_perm_b32 v27, v87, v86, s14
  v_exp_f32 v88, v88
  v_mfma_f32_32x32x16_bf16 v[64:79], v[36:39], v[128:131], v[64:79]
  buffer_load_dwordx4 a[240:243], v250, s[64:67], s87 offen offset:2048
  v_exp_f32 v89, v89
  v_exp_f32 v90, v90
  v_exp_f32 v91, v91
  v_perm_b32 v28, v89, v88, s14
  v_perm_b32 v29, v91, v90, s14
  v_exp_f32 v92, v92
  v_mfma_f32_32x32x16_bf16 v[112:127], v[40:43], v[24:27], v[112:127]
  buffer_load_dwordx4 a[244:247], v250, s[64:67], s87 offen offset:3072
  v_exp_f32 v93, v93
  v_exp_f32 v94, v94
  v_exp_f32 v95, v95
  v_perm_b32 v30, v93, v92, s14
  v_perm_b32 v31, v95, v94, s14
  v_exp_f32 v64, v64
  v_exp_f32 v65, v65
  v_mfma_f32_32x32x16_bf16 v[112:127], v[44:47], v[28:31], v[112:127]
  ds_read_b128 v[32:35], v164 offset:14464
  v_exp_f32 v66, v66
  v_exp_f32 v67, v67
  v_perm_b32 v24, v65, v64, s14
  v_perm_b32 v25, v67, v66, s14
  v_exp_f32 v68, v68
  v_mfma_f32_32x32x8_bf16 v[80:95], v[56:57], v[150:151], 0
  v_exp_f32 v69, v69
  v_exp_f32 v70, v70
  v_exp_f32 v71, v71
  v_perm_b32 v26, v69, v68, s14
  v_perm_b32 v27, v71, v70, s14
  v_exp_f32 v72, v72
  v_mfma_f32_32x32x16_bf16 v[80:95], v[36:39], v[132:135], v[80:95]
  ds_read_b128 v[40:43], v165 offset:15488
  v_exp_f32 v73, v73
  v_exp_f32 v74, v74
  v_exp_f32 v75, v75
  v_perm_b32 v28, v73, v72, s14
  v_perm_b32 v29, v75, v74, s14
  v_exp_f32 v76, v76
  v_mfma_f32_32x32x16_bf16 v[96:111], v[48:51], v[24:27], v[96:111]
  ds_read_b128 v[44:47], v165 offset:16096
  v_exp_f32 v77, v77
  v_exp_f32 v78, v78
  v_exp_f32 v79, v79
  v_perm_b32 v30, v77, v76, s14
  v_perm_b32 v31, v79, v78, s14
  v_exp_f32 v80, v80
  v_exp_f32 v81, v81
  v_mfma_f32_32x32x16_bf16 v[96:111], v[52:55], v[28:31], v[96:111]
  buffer_load_dwordx4 a[248:251], v167, s[64:67], s87 offen
  s_add_u32 s87, s87, 18432
  v_exp_f32 v82, v82
  v_exp_f32 v83, v83
  v_perm_b32 v24, v81, v80, s14
  v_perm_b32 v25, v83, v82, s14
  v_exp_f32 v84, v84
  v_mfma_f32_32x32x8_bf16 v[64:79], v[58:59], v[140:141], 0
  s_waitcnt lgkmcnt(0)
  v_exp_f32 v85, v85
  v_exp_f32 v86, v86
  v_exp_f32 v87, v87
  v_perm_b32 v26, v85, v84, s14
  v_perm_b32 v27, v87, v86, s14
  v_exp_f32 v88, v88
  v_mfma_f32_32x32x16_bf16 v[64:79], v[32:35], v[128:131], v[64:79]
PAD12:
  s_cbranch_execz PAD16
  buffer_load_dwordx4 a[252:255], v245, s[64:67], s87 offen
  v_exp_f32 v89, v89
  v_exp_f32 v90, v90
  v_exp_f32 v91, v91
  v_perm_b32 v28, v89, v88, s14
  v_perm_b32 v29, v91, v90, s14
  v_exp_f32 v92, v92
  v_mfma_f32_32x32x16_bf16 v[112:127], v[48:51], v[24:27], v[112:127]
  buffer_load_dwordx4 a[0:3], v245, s[64:67], s87 offen offset:1024
  v_exp_f32 v93, v93
  v_exp_f32 v94, v94
  v_exp_f32 v95, v95
  v_perm_b32 v30, v93, v92, s14
  v_perm_b32 v31, v95, v94, s14
  v_exp_f32 v64, v64
  v_exp_f32 v65, v65
  v_mfma_f32_32x32x16_bf16 v[112:127], v[52:55], v[28:31], v[112:127]
  ds_read_b128 v[36:39], v164 offset:16704
  v_exp_f32 v66, v66
  v_exp_f32 v67, v67
  v_perm_b32 v24, v65, v64, s14
  v_perm_b32 v25, v67, v66, s14
  v_exp_f32 v68, v68
  v_mfma_f32_32x32x8_bf16 v[80:95], v[58:59], v[148:149], 0
  v_exp_f32 v69, v69
  v_exp_f32 v70, v70
  v_exp_f32 v71, v71
  v_perm_b32 v26, v69, v68, s14
  v_perm_b32 v27, v71, v70, s14
  v_exp_f32 v72, v72
  v_mfma_f32_32x32x16_bf16 v[80:95], v[32:35], v[132:135], v[80:95]
  ds_read_b128 v[48:51], v165 offset:17728
  v_exp_f32 v73, v73
  v_exp_f32 v74, v74
  v_exp_f32 v75, v75
  v_perm_b32 v28, v73, v72, s14
  v_perm_b32 v29, v75, v74, s14
  v_exp_f32 v76, v76
  v_mfma_f32_32x32x16_bf16 v[96:111], v[40:43], v[24:27], v[96:111]
  ds_read_b128 v[52:55], v165 offset:18336
  v_exp_f32 v77, v77
  v_exp_f32 v78, v78
  v_exp_f32 v79, v79
  v_perm_b32 v30, v77, v76, s14
  v_perm_b32 v31, v79, v78, s14
  v_exp_f32 v80, v80
  v_exp_f32 v81, v81
  v_mfma_f32_32x32x16_bf16 v[96:111], v[44:47], v[28:31], v[96:111]
  buffer_load_dwordx4 a[4:7], v245, s[64:67], s87 offen offset:2048
  v_exp_f32 v82, v82
  v_exp_f32 v83, v83
  v_perm_b32 v24, v81, v80, s14
  v_perm_b32 v25, v83, v82, s14
  v_exp_f32 v84, v84
  v_mfma_f32_32x32x8_bf16 v[64:79], v[58:59], v[142:143], 0
  s_waitcnt lgkmcnt(0)
  v_exp_f32 v85, v85
  v_exp_f32 v86, v86
  v_exp_f32 v87, v87
  v_perm_b32 v26, v85, v84, s14
  v_perm_b32 v27, v87, v86, s14
  v_exp_f32 v88, v88
  v_mfma_f32_32x32x16_bf16 v[64:79], v[36:39], v[128:131], v[64:79]
  buffer_load_dwordx4 a[8:11], v245, s[64:67], s87 offen offset:3072
  v_exp_f32 v89, v89
  v_exp_f32 v90, v90
  v_exp_f32 v91, v91
  v_perm_b32 v28, v89, v88, s14
  v_perm_b32 v29, v91, v90, s14
  v_exp_f32 v92, v92
  v_mfma_f32_32x32x16_bf16 v[112:127], v[40:43], v[24:27], v[112:127]
  buffer_load_dwordx4 a[12:15], v250, s[64:67], s87 offen
  v_exp_f32 v93, v93
  v_exp_f32 v94, v94
  v_exp_f32 v95, v95
  v_perm_b32 v30, v93, v92, s14
  v_perm_b32 v31, v95, v94, s14
  v_exp_f32 v64, v64
  v_exp_f32 v65, v65
  v_mfma_f32_32x32x16_bf16 v[112:127], v[44:47], v[28:31], v[112:127]
  ds_read_b128 v[32:35], v164 offset:19968
  v_exp_f32 v66, v66
  v_exp_f32 v67, v67
  v_perm_b32 v24, v65, v64, s14
  v_perm_b32 v25, v67, v66, s14
  v_exp_f32 v68, v68
  v_mfma_f32_32x32x8_bf16 v[80:95], v[58:59], v[150:151], 0
  v_exp_f32 v69, v69
  v_exp_f32 v70, v70
  v_exp_f32 v71, v71
  v_perm_b32 v26, v69, v68, s14
  v_perm_b32 v27, v71, v70, s14
  v_exp_f32 v72, v72
  v_mfma_f32_32x32x16_bf16 v[80:95], v[36:39], v[132:135], v[80:95]
  ds_read_b128 v[40:43], v165 offset:20992
  v_exp_f32 v73, v73
  v_exp_f32 v74, v74
  v_exp_f32 v75, v75
  v_perm_b32 v28, v73, v72, s14
  v_perm_b32 v29, v75, v74, s14
  v_exp_f32 v76, v76
  v_mfma_f32_32x32x16_bf16 v[96:111], v[48:51], v[24:27], v[96:111]
  ds_read_b128 v[44:47], v165 offset:21600
  v_exp_f32 v77, v77
  v_exp_f32 v78, v78
  v_exp_f32 v79, v79
  v_perm_b32 v30, v77, v76, s14
  v_perm_b32 v31, v79, v78, s14
  v_exp_f32 v80, v80
  v_exp_f32 v81, v81
  v_mfma_f32_32x32x16_bf16 v[96:111], v[52:55], v[28:31], v[96:111]
  buffer_load_dwordx4 a[16:19], v250, s[64:67], s87 offen offset:1024
  v_exp_f32 v82, v82
  v_exp_f32 v83, v83
  v_perm_b32 v24, v81, v80, s14
  v_perm_b32 v25, v83, v82, s14
  v_exp_f32 v84, v84
  v_mfma_f32_32x32x8_bf16 v[64:79], v[60:61], v[136:137], 0
  s_waitcnt lgkmcnt(0)
  v_exp_f32 v85, v85
  v_exp_f32 v86, v86
  v_exp_f32 v87, v87
  v_perm_b32 v26, v85, v84, s14
  v_perm_b32 v27, v87, v86, s14
  v_exp_f32 v88, v88
  v_mfma_f32_32x32x16_bf16 v[64:79], v[32:35], v[128:131], v[64:79]
  buffer_load_dwordx4 a[20:23], v250, s[64:67], s87 offen offset:2048
  v_exp_f32 v89, v89
  v_exp_f32 v90, v90
  v_exp_f32 v91, v91
  v_perm_b32 v28, v89, v88, s14
  v_perm_b32 v29, v91, v90, s14
  v_exp_f32 v92, v92
  v_mfma_f32_32x32x16_bf16 v[112:127], v[48:51], v[24:27], v[112:127]
  buffer_load_dwordx4 a[24:27], v250, s[64:67], s87 offen offset:3072
  v_exp_f32 v93, v93
  v_exp_f32 v94, v94
  v_exp_f32 v95, v95
  v_perm_b32 v30, v93, v92, s14
  v_perm_b32 v31, v95, v94, s14
  v_exp_f32 v64, v64
  v_exp_f32 v65, v65
  v_mfma_f32_32x32x16_bf16 v[112:127], v[52:55], v[28:31], v[112:127]
  ds_read_b128 v[36:39], v164 offset:22208
  v_exp_f32 v66, v66
  v_exp_f32 v67, v67
  v_perm_b32 v24, v65, v64, s14
  v_perm_b32 v25, v67, v66, s14
  v_exp_f32 v68, v68
  v_mfma_f32_32x32x8_bf16 v[80:95], v[60:61], v[144:145], 0
  v_exp_f32 v69, v69
  v_exp_f32 v70, v70
  v_exp_f32 v71, v71
  v_perm_b32 v26, v69, v68, s14
  v_perm_b32 v27, v71, v70, s14
  v_exp_f32 v72, v72
  v_mfma_f32_32x32x16_bf16 v[80:95], v[32:35], v[132:135], v[80:95]
  ds_read_b128 v[48:51], v165 offset:23232
  v_exp_f32 v73, v73
  v_exp_f32 v74, v74
  v_exp_f32 v75, v75
  v_perm_b32 v28, v73, v72, s14
  v_perm_b32 v29, v75, v74, s14
  v_exp_f32 v76, v76
  v_mfma_f32_32x32x16_bf16 v[96:111], v[40:43], v[24:27], v[96:111]
  ds_read_b128 v[52:55], v165 offset:23840
  v_exp_f32 v77, v77
  v_exp_f32 v78, v78
  v_exp_f32 v79, v79
  v_perm_b32 v30, v77, v76, s14
  v_perm_b32 v31, v79, v78, s14
  v_exp_f32 v80, v80
  v_exp_f32 v81, v81
  v_mfma_f32_32x32x16_bf16 v[96:111], v[44:47], v[28:31], v[96:111]
  buffer_load_dwordx4 a[28:31], v167, s[64:67], s87 offen
  s_add_u32 s87, s82, s8
  v_exp_f32 v82, v82
  v_exp_f32 v83, v83
  v_perm_b32 v24, v81, v80, s14
  v_perm_b32 v25, v83, v82, s14
  v_exp_f32 v84, v84
  v_mfma_f32_32x32x8_bf16 v[64:79], v[60:61], v[138:139], 0
  s_waitcnt lgkmcnt(0)
  v_exp_f32 v85, v85
  v_exp_f32 v86, v86
  v_exp_f32 v87, v87
  v_perm_b32 v26, v85, v84, s14
  v_perm_b32 v27, v87, v86, s14
  v_exp_f32 v88, v88
  v_mfma_f32_32x32x16_bf16 v[64:79], v[36:39], v[128:131], v[64:79]
  buffer_load_dwordx4 a[32:35], v245, s[64:67], s87 offen
  v_exp_f32 v89, v89
  v_exp_f32 v90, v90
  v_exp_f32 v91, v91
  v_perm_b32 v28, v89, v88, s14
  v_perm_b32 v29, v91, v90, s14
  v_exp_f32 v92, v92
  v_mfma_f32_32x32x16_bf16 v[112:127], v[40:43], v[24:27], v[112:127]
  buffer_load_dwordx4 a[36:39], v245, s[64:67], s87 offen offset:1024
  v_exp_f32 v93, v93
  v_exp_f32 v94, v94
  v_exp_f32 v95, v95
  v_perm_b32 v30, v93, v92, s14
  v_perm_b32 v31, v95, v94, s14
  v_exp_f32 v64, v64
  v_exp_f32 v65, v65
  v_mfma_f32_32x32x16_bf16 v[112:127], v[44:47], v[28:31], v[112:127]
  ds_read_b128 v[32:35], v164 offset:24448
  v_exp_f32 v66, v66
  v_exp_f32 v67, v67
  v_perm_b32 v24, v65, v64, s14
  v_perm_b32 v25, v67, v66, s14
  v_exp_f32 v68, v68
  v_mfma_f32_32x32x8_bf16 v[80:95], v[60:61], v[146:147], 0
  v_exp_f32 v69, v69
  v_exp_f32 v70, v70
  v_exp_f32 v71, v71
  v_perm_b32 v26, v69, v68, s14
  v_perm_b32 v27, v71, v70, s14
  v_exp_f32 v72, v72
  v_mfma_f32_32x32x16_bf16 v[80:95], v[36:39], v[132:135], v[80:95]
  ds_read_b128 v[40:43], v165 offset:25472
  v_exp_f32 v73, v73
  v_exp_f32 v74, v74
  v_exp_f32 v75, v75
  v_perm_b32 v28, v73, v72, s14
  v_perm_b32 v29, v75, v74, s14
  v_exp_f32 v76, v76
  v_mfma_f32_32x32x16_bf16 v[96:111], v[48:51], v[24:27], v[96:111]
  ds_read_b128 v[44:47], v165 offset:26080
  v_exp_f32 v77, v77
  v_exp_f32 v78, v78
  v_exp_f32 v79, v79
  v_perm_b32 v30, v77, v76, s14
  v_perm_b32 v31, v79, v78, s14
  v_exp_f32 v80, v80
  v_exp_f32 v81, v81
  v_mfma_f32_32x32x16_bf16 v[96:111], v[52:55], v[28:31], v[96:111]
  buffer_load_dwordx4 a[40:43], v245, s[64:67], s87 offen offset:2048
  v_exp_f32 v82, v82
  v_exp_f32 v83, v83
  v_perm_b32 v24, v81, v80, s14
  v_perm_b32 v25, v83, v82, s14
  v_exp_f32 v84, v84
  v_mfma_f32_32x32x8_bf16 v[64:79], v[62:63], v[136:137], 0
  s_waitcnt lgkmcnt(0)
  v_exp_f32 v85, v85
  v_exp_f32 v86, v86
  v_exp_f32 v87, v87
  v_perm_b32 v26, v85, v84, s14
  v_perm_b32 v27, v87, v86, s14
  v_exp_f32 v88, v88
  v_mfma_f32_32x32x16_bf16 v[64:79], v[32:35], v[128:131], v[64:79]
  buffer_load_dwordx4 a[44:47], v245, s[64:67], s87 offen offset:3072
  v_exp_f32 v89, v89
  v_exp_f32 v90, v90
  v_exp_f32 v91, v91
  v_perm_b32 v28, v89, v88, s14
  v_perm_b32 v29, v91, v90, s14
  v_exp_f32 v92, v92
  v_mfma_f32_32x32x16_bf16 v[112:127], v[48:51], v[24:27], v[112:127]
  buffer_load_dwordx4 a[48:51], v248, s[64:67], s87 offen
  v_exp_f32 v93, v93
  v_exp_f32 v94, v94
  v_exp_f32 v95, v95
  v_perm_b32 v30, v93, v92, s14
  v_perm_b32 v31, v95, v94, s14
  v_exp_f32 v64, v64
  v_exp_f32 v65, v65
  v_mfma_f32_32x32x16_bf16 v[112:127], v[52:55], v[28:31], v[112:127]
  ds_read_b128 v[36:39], v164 offset:26688
  v_exp_f32 v66, v66
  v_exp_f32 v67, v67
  v_perm_b32 v24, v65, v64, s14
  v_perm_b32 v25, v67, v66, s14
  v_exp_f32 v68, v68
  v_mfma_f32_32x32x8_bf16 v[80:95], v[62:63], v[144:145], 0
  s_add_u32 s87, s81, s15
  v_exp_f32 v69, v69
  v_exp_f32 v70, v70
  v_exp_f32 v71, v71
  v_perm_b32 v26, v69, v68, s14
  v_perm_b32 v27, v71, v70, s14
  v_exp_f32 v72, v72
  v_mfma_f32_32x32x16_bf16 v[80:95], v[32:35], v[132:135], v[80:95]
  ds_read_b128 v[48:51], v165 offset:27712
  v_exp_f32 v73, v73
  v_exp_f32 v74, v74
  v_exp_f32 v75, v75
  v_perm_b32 v28, v73, v72, s14
  v_perm_b32 v29, v75, v74, s14
  v_exp_f32 v76, v76
  v_mfma_f32_32x32x16_bf16 v[96:111], v[40:43], v[24:27], v[96:111]
  ds_read_b128 v[52:55], v165 offset:28320
  v_exp_f32 v77, v77
  v_exp_f32 v78, v78
  v_exp_f32 v79, v79
  v_perm_b32 v30, v77, v76, s14
  v_perm_b32 v31, v79, v78, s14
  v_exp_f32 v80, v80
  v_exp_f32 v81, v81
  v_mfma_f32_32x32x16_bf16 v[96:111], v[44:47], v[28:31], v[96:111]
  buffer_load_dwordx4 a[52:55], v245, s[64:67], s87 offen
  v_exp_f32 v82, v82
  v_exp_f32 v83, v83
  v_perm_b32 v24, v81, v80, s14
  v_perm_b32 v25, v83, v82, s14
  v_exp_f32 v84, v84
  v_mfma_f32_32x32x8_bf16 v[64:79], v[62:63], v[138:139], 0
  s_waitcnt lgkmcnt(0)
  v_exp_f32 v85, v85
  v_exp_f32 v86, v86
  v_exp_f32 v87, v87
  v_perm_b32 v26, v85, v84, s14
  v_perm_b32 v27, v87, v86, s14
  v_exp_f32 v88, v88
  v_mfma_f32_32x32x16_bf16 v[64:79], v[36:39], v[128:131], v[64:79]
  buffer_load_dwordx4 a[56:59], v245, s[64:67], s87 offen offset:1024
  v_exp_f32 v89, v89
  v_exp_f32 v90, v90
  v_exp_f32 v91, v91
  v_perm_b32 v28, v89, v88, s14
  v_perm_b32 v29, v91, v90, s14
  v_exp_f32 v92, v92
  v_mfma_f32_32x32x16_bf16 v[112:127], v[40:43], v[24:27], v[112:127]
  buffer_load_dwordx4 a[60:63], v245, s[64:67], s87 offen offset:2048
  v_exp_f32 v93, v93
  v_exp_f32 v94, v94
  v_exp_f32 v95, v95
  v_perm_b32 v30, v93, v92, s14
  v_perm_b32 v31, v95, v94, s14
  v_exp_f32 v64, v64
  v_exp_f32 v65, v65
  v_mfma_f32_32x32x16_bf16 v[112:127], v[44:47], v[28:31], v[112:127]
  ds_read_b128 v[32:35], v164 offset:28928
  v_exp_f32 v66, v66
  v_exp_f32 v67, v67
  v_perm_b32 v24, v65, v64, s14
  v_perm_b32 v25, v67, v66, s14
  v_exp_f32 v68, v68
  v_mfma_f32_32x32x8_bf16 v[80:95], v[62:63], v[146:147], 0
  v_exp_f32 v69, v69
  v_exp_f32 v70, v70
  v_exp_f32 v71, v71
  v_perm_b32 v26, v69, v68, s14
  v_perm_b32 v27, v71, v70, s14
  v_exp_f32 v72, v72
  v_mfma_f32_32x32x16_bf16 v[80:95], v[36:39], v[132:135], v[80:95]
  ds_read_b128 v[40:43], v165 offset:29952
  v_exp_f32 v73, v73
  v_exp_f32 v74, v74
  v_exp_f32 v75, v75
  v_perm_b32 v28, v73, v72, s14
  v_perm_b32 v29, v75, v74, s14
  v_exp_f32 v76, v76
  v_mfma_f32_32x32x16_bf16 v[96:111], v[48:51], v[24:27], v[96:111]
  ds_read_b128 v[44:47], v165 offset:30560
  ds_read_b128 v[56:59], v164 offset:37888
  v_exp_f32 v77, v77
  v_exp_f32 v78, v78
  v_exp_f32 v79, v79
  v_perm_b32 v30, v77, v76, s14
  v_perm_b32 v31, v79, v78, s14
  v_exp_f32 v80, v80
  v_exp_f32 v81, v81
  v_mfma_f32_32x32x16_bf16 v[96:111], v[52:55], v[28:31], v[96:111]
  buffer_load_dword v252, v249, s[64:67], 0 offen sc1
  v_exp_f32 v82, v82
  v_exp_f32 v83, v83
  v_perm_b32 v24, v81, v80, s14
  v_perm_b32 v25, v83, v82, s14
  v_exp_f32 v84, v84
  v_mfma_f32_32x32x8_bf16 v[64:79], v[60:61], v[140:141], 0
  s_waitcnt lgkmcnt(0)
  v_exp_f32 v85, v85
  v_exp_f32 v86, v86
  v_exp_f32 v87, v87
  v_perm_b32 v26, v85, v84, s14
  v_perm_b32 v27, v87, v86, s14
  v_exp_f32 v88, v88
  v_mfma_f32_32x32x16_bf16 v[64:79], v[32:35], v[128:131], v[64:79]
  buffer_load_dwordx4 a[64:67], v245, s[64:67], s87 offen offset:3072
  v_exp_f32 v89, v89
  v_exp_f32 v90, v90
  v_exp_f32 v91, v91
  v_perm_b32 v28, v89, v88, s14
  v_perm_b32 v29, v91, v90, s14
  v_exp_f32 v92, v92
  v_mfma_f32_32x32x16_bf16 v[112:127], v[48:51], v[24:27], v[112:127]
  buffer_load_dwordx4 a[68:71], v250, s[64:67], s87 offen
  v_exp_f32 v93, v93
  v_exp_f32 v94, v94
  v_exp_f32 v95, v95
  v_perm_b32 v30, v93, v92, s14
  v_perm_b32 v31, v95, v94, s14
  v_exp_f32 v64, v64
  v_exp_f32 v65, v65
  v_mfma_f32_32x32x16_bf16 v[112:127], v[52:55], v[28:31], v[112:127]
  ds_read_b128 v[36:39], v164 offset:31168
  v_exp_f32 v66, v66
  v_exp_f32 v67, v67
  v_perm_b32 v24, v65, v64, s14
  v_perm_b32 v25, v67, v66, s14
  v_exp_f32 v68, v68
  v_mfma_f32_32x32x8_bf16 v[80:95], v[60:61], v[148:149], 0
  v_exp_f32 v69, v69
  v_exp_f32 v70, v70
  v_exp_f32 v71, v71
  v_perm_b32 v26, v69, v68, s14
  v_perm_b32 v27, v71, v70, s14
  v_exp_f32 v72, v72
  v_mfma_f32_32x32x16_bf16 v[80:95], v[32:35], v[132:135], v[80:95]
  ds_read_b128 v[48:51], v165 offset:32192
  v_exp_f32 v73, v73
  v_exp_f32 v74, v74
  v_exp_f32 v75, v75
  v_perm_b32 v28, v73, v72, s14
  v_perm_b32 v29, v75, v74, s14
  v_exp_f32 v76, v76
  v_mfma_f32_32x32x16_bf16 v[96:111], v[40:43], v[24:27], v[96:111]
  ds_read_b128 v[52:55], v165 offset:32800
  v_exp_f32 v77, v77
  v_exp_f32 v78, v78
  v_exp_f32 v79, v79
  v_perm_b32 v30, v77, v76, s14
  v_perm_b32 v31, v79, v78, s14
  v_exp_f32 v80, v80
  v_exp_f32 v81, v81
  v_mfma_f32_32x32x16_bf16 v[96:111], v[44:47], v[28:31], v[96:111]
  buffer_load_dwordx4 a[72:75], v250, s[64:67], s87 offen offset:1024
  v_exp_f32 v82, v82
  v_exp_f32 v83, v83
  v_perm_b32 v24, v81, v80, s14
  v_perm_b32 v25, v83, v82, s14
  v_exp_f32 v84, v84
  v_mfma_f32_32x32x8_bf16 v[64:79], v[60:61], v[142:143], 0
  s_waitcnt lgkmcnt(0)
  v_exp_f32 v85, v85
  v_exp_f32 v86, v86
  v_exp_f32 v87, v87
  v_perm_b32 v26, v85, v84, s14
  v_perm_b32 v27, v87, v86, s14
  v_exp_f32 v88, v88
  v_mfma_f32_32x32x16_bf16 v[64:79], v[36:39], v[128:131], v[64:79]
  buffer_load_dwordx4 a[76:79], v250, s[64:67], s87 offen offset:2048
  v_exp_f32 v89, v89
  v_exp_f32 v90, v90
  v_exp_f32 v91, v91
  v_perm_b32 v28, v89, v88, s14
  v_perm_b32 v29, v91, v90, s14
  v_exp_f32 v92, v92
  v_mfma_f32_32x32x16_bf16 v[112:127], v[40:43], v[24:27], v[112:127]
  buffer_load_dwordx4 a[80:83], v250, s[64:67], s87 offen offset:3072
  v_exp_f32 v93, v93
  v_exp_f32 v94, v94
  v_exp_f32 v95, v95
  v_perm_b32 v30, v93, v92, s14
  v_perm_b32 v31, v95, v94, s14
  v_exp_f32 v64, v64
  v_exp_f32 v65, v65
  v_mfma_f32_32x32x16_bf16 v[112:127], v[44:47], v[28:31], v[112:127]
  ds_read_b128 v[32:35], v164 offset:33408
  v_exp_f32 v66, v66
  v_exp_f32 v67, v67
  v_perm_b32 v24, v65, v64, s14
  v_perm_b32 v25, v67, v66, s14
  v_exp_f32 v68, v68
  v_mfma_f32_32x32x8_bf16 v[80:95], v[60:61], v[150:151], 0
  v_exp_f32 v69, v69
  v_exp_f32 v70, v70
  v_exp_f32 v71, v71
  v_perm_b32 v26, v69, v68, s14
  v_perm_b32 v27, v71, v70, s14
  v_exp_f32 v72, v72
  v_mfma_f32_32x32x16_bf16 v[80:95], v[36:39], v[132:135], v[80:95]
  ds_read_b128 v[40:43], v165 offset:34432
  v_exp_f32 v73, v73
  v_exp_f32 v74, v74
  v_exp_f32 v75, v75
  v_perm_b32 v28, v73, v72, s14
  v_perm_b32 v29, v75, v74, s14
  v_exp_f32 v76, v76
  v_mfma_f32_32x32x16_bf16 v[96:111], v[48:51], v[24:27], v[96:111]
  ds_read_b128 v[44:47], v165 offset:35040
  v_exp_f32 v77, v77
  v_exp_f32 v78, v78
  v_exp_f32 v79, v79
  v_perm_b32 v30, v77, v76, s14
  v_perm_b32 v31, v79, v78, s14
  v_exp_f32 v80, v80
  v_exp_f32 v81, v81
  v_mfma_f32_32x32x16_bf16 v[96:111], v[52:55], v[28:31], v[96:111]
  buffer_load_dwordx4 a[84:87], v167, s[64:67], s87 offen
  s_add_u32 s87, s87, 18432
  v_exp_f32 v82, v82
  v_exp_f32 v83, v83
  v_perm_b32 v24, v81, v80, s14
  v_perm_b32 v25, v83, v82, s14
  v_exp_f32 v84, v84
  v_mfma_f32_32x32x8_bf16 v[64:79], v[62:63], v[140:141], 0
  s_waitcnt lgkmcnt(0)
  v_exp_f32 v85, v85
  v_exp_f32 v86, v86
  v_exp_f32 v87, v87
  v_perm_b32 v26, v85, v84, s14
  v_perm_b32 v27, v87, v86, s14
  v_exp_f32 v88, v88
  v_mfma_f32_32x32x16_bf16 v[64:79], v[32:35], v[128:131], v[64:79]
  buffer_load_dwordx4 a[88:91], v245, s[64:67], s87 offen
  v_exp_f32 v89, v89
  v_exp_f32 v90, v90
  v_exp_f32 v91, v91
  v_perm_b32 v28, v89, v88, s14
  v_perm_b32 v29, v91, v90, s14
  v_exp_f32 v92, v92
  v_mfma_f32_32x32x16_bf16 v[112:127], v[48:51], v[24:27], v[112:127]
  buffer_load_dwordx4 a[92:95], v245, s[64:67], s87 offen offset:1024
  v_exp_f32 v93, v93
  v_exp_f32 v94, v94
  v_exp_f32 v95, v95
  v_perm_b32 v30, v93, v92, s14
  v_perm_b32 v31, v95, v94, s14
  v_exp_f32 v64, v64
  v_exp_f32 v65, v65
  v_mfma_f32_32x32x16_bf16 v[112:127], v[52:55], v[28:31], v[112:127]
  ds_read_b128 v[36:39], v164 offset:35648
  v_exp_f32 v66, v66
  v_exp_f32 v67, v67
  v_perm_b32 v24, v65, v64, s14
  v_perm_b32 v25, v67, v66, s14
  v_exp_f32 v68, v68
  v_mfma_f32_32x32x8_bf16 v[80:95], v[62:63], v[148:149], 0
  v_exp_f32 v69, v69
  v_exp_f32 v70, v70
  v_exp_f32 v71, v71
  v_perm_b32 v26, v69, v68, s14
  v_perm_b32 v27, v71, v70, s14
  v_exp_f32 v72, v72
  v_mfma_f32_32x32x16_bf16 v[80:95], v[32:35], v[132:135], v[80:95]
  ds_read_b128 v[48:51], v165 offset:36672
  v_exp_f32 v73, v73
  v_exp_f32 v74, v74
  v_exp_f32 v75, v75
  v_perm_b32 v28, v73, v72, s14
  v_perm_b32 v29, v75, v74, s14
  v_exp_f32 v76, v76
  v_mfma_f32_32x32x16_bf16 v[96:111], v[40:43], v[24:27], v[96:111]
  ds_read_b128 v[52:55], v165 offset:37280
  v_exp_f32 v77, v77
  v_exp_f32 v78, v78
  v_exp_f32 v79, v79
  v_perm_b32 v30, v77, v76, s14
  v_perm_b32 v31, v79, v78, s14
  v_exp_f32 v80, v80
  v_exp_f32 v81, v81
  v_mfma_f32_32x32x16_bf16 v[96:111], v[44:47], v[28:31], v[96:111]
  buffer_load_dwordx4 a[96:99], v245, s[64:67], s87 offen offset:2048
  v_exp_f32 v82, v82
  v_exp_f32 v83, v83
  v_perm_b32 v24, v81, v80, s14
  v_perm_b32 v25, v83, v82, s14
  v_exp_f32 v84, v84
  v_mfma_f32_32x32x8_bf16 v[64:79], v[62:63], v[142:143], 0
  s_waitcnt lgkmcnt(0)
  v_exp_f32 v85, v85
  v_exp_f32 v86, v86
  v_exp_f32 v87, v87
  v_perm_b32 v26, v85, v84, s14
  v_perm_b32 v27, v87, v86, s14
  v_exp_f32 v88, v88
  v_mfma_f32_32x32x16_bf16 v[64:79], v[36:39], v[128:131], v[64:79]
  buffer_load_dwordx4 a[100:103], v245, s[64:67], s87 offen offset:3072
  v_exp_f32 v89, v89
  v_exp_f32 v90, v90
  v_exp_f32 v91, v91
  v_perm_b32 v28, v89, v88, s14
  v_perm_b32 v29, v91, v90, s14
  v_exp_f32 v92, v92
  v_mfma_f32_32x32x16_bf16 v[112:127], v[40:43], v[24:27], v[112:127]
  s_waitcnt vmcnt(10)
  v_cmp_le_u32 vcc, 1, v252
  s_nop 0
  s_cmp_eq_u32 vcc_lo, 131071
  s_cbranch_scc0 PP_spin
PP_go:
  v_readlane_b32 s43, v252, 16
  v_exp_f32 v93, v93
  v_exp_f32 v94, v94
  v_exp_f32 v95, v95
  v_perm_b32 v30, v93, v92, s14
  v_perm_b32 v31, v95, v94, s14
  v_exp_f32 v64, v64
  v_exp_f32 v65, v65
  v_mfma_f32_32x32x16_bf16 v[112:127], v[44:47], v[28:31], v[112:127]
  ds_read_b128 v[32:35], v164 offset:38912
  v_exp_f32 v66, v66
  v_exp_f32 v67, v67
  v_perm_b32 v24, v65, v64, s14
  v_perm_b32 v25, v67, v66, s14
  v_exp_f32 v68, v68
  v_mfma_f32_32x32x8_bf16 v[80:95], v[62:63], v[150:151], 0
  v_exp_f32 v69, v69
  v_exp_f32 v70, v70
  v_exp_f32 v71, v71
  v_perm_b32 v26, v69, v68, s14
  v_perm_b32 v27, v71, v70, s14
  v_exp_f32 v72, v72
  v_mfma_f32_32x32x16_bf16 v[80:95], v[36:39], v[132:135], v[80:95]
  ds_read_b128 v[40:43], v165 offset:39936
  v_exp_f32 v73, v73
  v_exp_f32 v74, v74
  v_exp_f32 v75, v75
  v_perm_b32 v28, v73, v72, s14
  v_perm_b32 v29, v75, v74, s14
  v_exp_f32 v76, v76
  v_mfma_f32_32x32x16_bf16 v[96:111], v[48:51], v[24:27], v[96:111]
  ds_read_b128 v[44:47], v165 offset:40544
  v_exp_f32 v77, v77
  v_exp_f32 v78, v78
  v_exp_f32 v79, v79
  v_perm_b32 v30, v77, v76, s14
  v_perm_b32 v31, v79, v78, s14
  v_exp_f32 v80, v80
  v_exp_f32 v81, v81
  v_mfma_f32_32x32x16_bf16 v[96:111], v[52:55], v[28:31], v[96:111]
  buffer_load_dwordx4 v[192:195], v163, s[64:67], s80 offen sc1
  v_exp_f32 v82, v82
  v_exp_f32 v83, v83
  v_perm_b32 v24, v81, v80, s14
  v_perm_b32 v25, v83, v82, s14
  v_exp_f32 v84, v84
  v_mfma_f32_32x32x8_bf16 v[64:79], v[56:57], v[136:137], 0
  s_waitcnt lgkmcnt(0)
  v_exp_f32 v85, v85
  v_exp_f32 v86, v86
  v_exp_f32 v87, v87
  v_perm_b32 v26, v85, v84, s14
  v_perm_b32 v27, v87, v86, s14
  v_exp_f32 v88, v88
  v_mfma_f32_32x32x16_bf16 v[64:79], v[32:35], v[128:131], v[64:79]
  buffer_load_dwordx4 v[196:199], v163, s[64:67], s80 offen offset:512 sc1
  v_exp_f32 v89, v89
  v_exp_f32 v90, v90
  v_exp_f32 v91, v91
  v_perm_b32 v28, v89, v88, s14
  v_perm_b32 v29, v91, v90, s14
  v_exp_f32 v92, v92
  v_mfma_f32_32x32x16_bf16 v[112:127], v[48:51], v[24:27], v[112:127]
  buffer_load_dwordx4 a[104:107], v250, s[64:67], s87 offen
  v_exp_f32 v93, v93
  v_exp_f32 v94, v94
  v_exp_f32 v95, v95
  v_perm_b32 v30, v93, v92, s14
  v_perm_b32 v31, v95, v94, s14
  v_add_u32 v164, 37888, v164
  v_add_u32 v165, 37888, v165
  v_exp_f32 v64, v64
  v_exp_f32 v65, v65
  v_mfma_f32_32x32x16_bf16 v[112:127], v[52:55], v[28:31], v[112:127]
  ds_read_b128 v[36:39], v164 offset:3264
  v_exp_f32 v66, v66
  v_exp_f32 v67, v67
  v_perm_b32 v24, v65, v64, s14
  v_perm_b32 v25, v67, v66, s14
  v_exp_f32 v68, v68
  v_mfma_f32_32x32x8_bf16 v[80:95], v[56:57], v[144:145], 0
  v_exp_f32 v69, v69
  v_exp_f32 v70, v70
  v_exp_f32 v71, v71
  v_perm_b32 v26, v69, v68, s14
  v_perm_b32 v27, v71, v70, s14
  v_exp_f32 v72, v72
  v_mfma_f32_32x32x16_bf16 v[80:95], v[32:35], v[132:135], v[80:95]
  ds_read_b128 v[48:51], v165 offset:4288
  v_exp_f32 v73, v73
  v_exp_f32 v74, v74
  v_exp_f32 v75, v75
  v_perm_b32 v28, v73, v72, s14
  v_perm_b32 v29, v75, v74, s14
  v_exp_f32 v76, v76
  v_mfma_f32_32x32x16_bf16 v[96:111], v[40:43], v[24:27], v[96:111]
  ds_read_b128 v[52:55], v165 offset:4896
  v_exp_f32 v77, v77
  v_exp_f32 v78, v78
  v_exp_f32 v79, v79
  v_perm_b32 v30, v77, v76, s14
  v_perm_b32 v31, v79, v78, s14
  v_exp_f32 v80, v80
  v_exp_f32 v81, v81
  v_mfma_f32_32x32x16_bf16 v[96:111], v[44:47], v[28:31], v[96:111]
  buffer_load_dwordx4 v[200:203], v246, s[64:67], s80 offen sc1
  v_exp_f32 v82, v82
  v_exp_f32 v83, v83
  v_perm_b32 v24, v81, v80, s14
  v_perm_b32 v25, v83, v82, s14
  v_exp_f32 v84, v84
  v_mfma_f32_32x32x8_bf16 v[64:79], v[56:57], v[138:139], 0
PAD13:
  s_cbranch_execz HOPBACK
  s_waitcnt lgkmcnt(0)
  v_exp_f32 v85, v85
  v_exp_f32 v86, v86
  v_exp_f32 v87, v87
  v_perm_b32 v26, v85, v84, s14
  v_perm_b32 v27, v87, v86, s14
  v_exp_f32 v88, v88
  v_mfma_f32_32x32x16_bf16 v[64:79], v[36:39], v[128:131], v[64:79]
  buffer_load_dwordx4 a[108:111], v250, s[64:67], s87 offen offset:1024
  v_exp_f32 v89, v89
  v_exp_f32 v90, v90
  v_exp_f32 v91, v91
  v_perm_b32 v28, v89, v88, s14
  v_perm_b32 v29, v91, v90, s14
  v_exp_f32 v92, v92
  v_mfma_f32_32x32x16_bf16 v[112:127], v[40:43], v[24:27], v[112:127]
  buffer_load_dwordx4 v[204:207], v246, s[64:67], s80 offen offset:512 sc1
  v_exp_f32 v93, v93
  v_exp_f32 v94, v94
  v_exp_f32 v95, v95
  v_perm_b32 v30, v93, v92, s14
  v_perm_b32 v31, v95, v94, s14
  v_exp_f32 v64, v64
  v_exp_f32 v65, v65
  v_mfma_f32_32x32x16_bf16 v[112:127], v[44:47], v[28:31], v[112:127]
  ds_read_b128 v[32:35], v164 offset:5504
  v_exp_f32 v66, v66
  v_exp_f32 v67, v67
  v_perm_b32 v24, v65, v64, s14
  v_perm_b32 v25, v67, v66, s14
  v_exp_f32 v68, v68
  v_mfma_f32_32x32x8_bf16 v[80:95], v[56:57], v[146:147], 0
  v_exp_f32 v69, v69
  v_exp_f32 v70, v70
  v_exp_f32 v71, v71
  v_perm_b32 v26, v69, v68, s14
  v_perm_b32 v27, v71, v70, s14
  v_exp_f32 v72, v72
  v_mfma_f32_32x32x16_bf16 v[80:95], v[36:39], v[132:135], v[80:95]
  ds_read_b128 v[40:43], v165 offset:6528
  v_exp_f32 v73, v73
  v_exp_f32 v74, v74
  v_exp_f32 v75, v75
  v_perm_b32 v28, v73, v72, s14
  v_perm_b32 v29, v75, v74, s14
  v_exp_f32 v76, v76
  v_mfma_f32_32x32x16_bf16 v[96:111], v[48:51], v[24:27], v[96:111]
  ds_read_b128 v[44:47], v165 offset:7136
  v_exp_f32 v77, v77
  v_exp_f32 v78, v78
  v_exp_f32 v79, v79
  v_perm_b32 v30, v77, v76, s14
  v_perm_b32 v31, v79, v78, s14
  v_exp_f32 v80, v80
  v_exp_f32 v81, v81
  v_mfma_f32_32x32x16_bf16 v[96:111], v[52:55], v[28:31], v[96:111]
  buffer_load_dwordx4 a[112:115], v250, s[64:67], s87 offen offset:2048
  v_exp_f32 v82, v82
  v_exp_f32 v83, v83
  v_perm_b32 v24, v81, v80, s14
  v_perm_b32 v25, v83, v82, s14
  v_exp_f32 v84, v84
  v_mfma_f32_32x32x8_bf16 v[64:79], v[58:59], v[136:137], 0
  s_waitcnt lgkmcnt(0)
  v_exp_f32 v85, v85
  v_exp_f32 v86, v86
  v_exp_f32 v87, v87
  v_perm_b32 v26, v85, v84, s14
  v_perm_b32 v27, v87, v86, s14
  v_exp_f32 v88, v88
  v_mfma_f32_32x32x16_bf16 v[64:79], v[32:35], v[128:131], v[64:79]
  buffer_load_dwordx4 v[208:211], v247, s[64:67], s80 offen sc1
  v_exp_f32 v89, v89
  v_exp_f32 v90, v90
  v_exp_f32 v91, v91
  v_perm_b32 v28, v89, v88, s14
  v_perm_b32 v29, v91, v90, s14
  v_exp_f32 v92, v92
  v_mfma_f32_32x32x16_bf16 v[112:127], v[48:51], v[24:27], v[112:127]
  buffer_load_dwordx4 a[116:119], v250, s[64:67], s87 offen offset:3072
  v_exp_f32 v93, v93
  v_exp_f32 v94, v94
  v_exp_f32 v95, v95
  v_perm_b32 v30, v93, v92, s14
  v_perm_b32 v31, v95, v94, s14
  v_exp_f32 v64, v64
  v_exp_f32 v65, v65
  v_mfma_f32_32x32x16_bf16 v[112:127], v[52:55], v[28:31], v[112:127]
  ds_read_b128 v[36:39], v164 offset:7744
  v_exp_f32 v66, v66
  v_exp_f32 v67, v67
  v_perm_b32 v24, v65, v64, s14
  v_perm_b32 v25, v67, v66, s14
  v_exp_f32 v68, v68
  v_mfma_f32_32x32x8_bf16 v[80:95], v[58:59], v[144:145], 0
  s_add_u32 s80, s80, 294912
  v_exp_f32 v69, v69
  v_exp_f32 v70, v70
  v_exp_f32 v71, v71
  v_perm_b32 v26, v69, v68, s14
  v_perm_b32 v27, v71, v70, s14
  v_exp_f32 v72, v72
  v_mfma_f32_32x32x16_bf16 v[80:95], v[32:35], v[132:135], v[80:95]
  ds_read_b128 v[48:51], v165 offset:8768
  v_exp_f32 v73, v73
  v_exp_f32 v74, v74
  v_exp_f32 v75, v75
  v_perm_b32 v28, v73, v72, s14
  v_perm_b32 v29, v75, v74, s14
  v_exp_f32 v76, v76
  v_mfma_f32_32x32x16_bf16 v[96:111], v[40:43], v[24:27], v[96:111]
  ds_read_b128 v[52:55], v165 offset:9376
  v_exp_f32 v77, v77
  v_exp_f32 v78, v78
  v_exp_f32 v79, v79
  v_perm_b32 v30, v77, v76, s14
  v_perm_b32 v31, v79, v78, s14
  v_exp_f32 v80, v80
  v_exp_f32 v81, v81
  v_mfma_f32_32x32x16_bf16 v[96:111], v[44:47], v[28:31], v[96:111]
  buffer_load_dwordx4 v[212:215], v163, s[64:67], s80 offen sc1
  v_exp_f32 v82, v82
  v_exp_f32 v83, v83
  v_perm_b32 v24, v81, v80, s14
  v_perm_b32 v25, v83, v82, s14
  v_exp_f32 v84, v84
  v_mfma_f32_32x32x8_bf16 v[64:79], v[58:59], v[138:139], 0
  s_waitcnt lgkmcnt(0)
  v_exp_f32 v85, v85
  v_exp_f32 v86, v86
  v_exp_f32 v87, v87
  v_perm_b32 v26, v85, v84, s14
  v_perm_b32 v27, v87, v86, s14
  v_exp_f32 v88, v88
  v_mfma_f32_32x32x16_bf16 v[64:79], v[36:39], v[128:131], v[64:79]
  buffer_load_dwordx4 a[120:123], v167, s[64:67], s87 offen
  v_exp_f32 v89, v89
  v_exp_f32 v90, v90
  v_exp_f32 v91, v91
  v_perm_b32 v28, v89, v88, s14
  v_perm_b32 v29, v91, v90, s14
  v_exp_f32 v92, v92
  v_mfma_f32_32x32x16_bf16 v[112:127], v[40:43], v[24:27], v[112:127]
  buffer_load_dwordx4 v[216:219], v163, s[64:67], s80 offen offset:512 sc1
  v_exp_f32 v93, v93
  v_exp_f32 v94, v94
  v_exp_f32 v95, v95
  v_perm_b32 v30, v93, v92, s14
  v_perm_b32 v31, v95, v94, s14
  v_exp_f32 v64, v64
  v_exp_f32 v65, v65
  v_mfma_f32_32x32x16_bf16 v[112:127], v[44:47], v[28:31], v[112:127]
  ds_read_b128 v[32:35], v164 offset:9984
  v_exp_f32 v66, v66
  v_exp_f32 v67, v67
  v_perm_b32 v24, v65, v64, s14
  v_perm_b32 v25, v67, v66, s14
  v_exp_f32 v68, v68
  v_mfma_f32_32x32x8_bf16 v[80:95], v[58:59], v[146:147], 0
  s_add_u32 s87, s87, 18432
  v_exp_f32 v69, v69
  v_exp_f32 v70, v70
  v_exp_f32 v71, v71
  v_perm_b32 v26, v69, v68, s14
  v_perm_b32 v27, v71, v70, s14
  v_exp_f32 v72, v72
  v_mfma_f32_32x32x16_bf16 v[80:95], v[36:39], v[132:135], v[80:95]
  ds_read_b128 v[40:43], v165 offset:11008
  v_exp_f32 v73, v73
  v_exp_f32 v74, v74
  v_exp_f32 v75, v75
  v_perm_b32 v28, v73, v72, s14
  v_perm_b32 v29, v75, v74, s14
  v_exp_f32 v76, v76
  v_mfma_f32_32x32x16_bf16 v[96:111], v[48:51], v[24:27], v[96:111]
  ds_read_b128 v[44:47], v165 offset:11616
  ds_read_b128 v[60:63], v164 offset:18944
  v_exp_f32 v77, v77
  v_exp_f32 v78, v78
  v_exp_f32 v79, v79
  v_perm_b32 v30, v77, v76, s14
  v_perm_b32 v31, v79, v78, s14
  v_exp_f32 v80, v80
  v_exp_f32 v81, v81
  v_mfma_f32_32x32x16_bf16 v[96:111], v[52:55], v[28:31], v[96:111]
  buffer_load_dwordx4 a[124:127], v245, s[64:67], s87 offen
  v_exp_f32 v82, v82
  v_exp_f32 v83, v83
  v_perm_b32 v24, v81, v80, s14
  v_perm_b32 v25, v83, v82, s14
  v_exp_f32 v84, v84
  v_mfma_f32_32x32x8_bf16 v[64:79], v[56:57], v[140:141], 0
  s_waitcnt lgkmcnt(0)
  v_exp_f32 v85, v85
  v_exp_f32 v86, v86
  v_exp_f32 v87, v87
  v_perm_b32 v26, v85, v84, s14
  v_perm_b32 v27, v87, v86, s14
  v_exp_f32 v88, v88
  v_mfma_f32_32x32x16_bf16 v[64:79], v[32:35], v[128:131], v[64:79]
  buffer_load_dwordx4 v[220:223], v246, s[64:67], s80 offen sc1
  v_exp_f32 v89, v89
  v_exp_f32 v90, v90
  v_exp_f32 v91, v91
  v_perm_b32 v28, v89, v88, s14
  v_perm_b32 v29, v91, v90, s14
  v_exp_f32 v92, v92
  v_mfma_f32_32x32x16_bf16 v[112:127], v[48:51], v[24:27], v[112:127]
  buffer_load_dwordx4 a[128:131], v245, s[64:67], s87 offen offset:1024
  v_exp_f32 v93, v93
  v_exp_f32 v94, v94
  v_exp_f32 v95, v95
  v_perm_b32 v30, v93, v92, s14
  v_perm_b32 v31, v95, v94, s14
  v_exp_f32 v64, v64
  v_exp_f32 v65, v65
  v_mfma_f32_32x32x16_bf16 v[112:127], v[52:55], v[28:31], v[112:127]
  ds_read_b128 v[36:39], v164 offset:12224
  v_exp_f32 v66, v66
  v_exp_f32 v67, v67
  v_perm_b32 v24, v65, v64, s14
  v_perm_b32 v25, v67, v66, s14
  v_exp_f32 v68, v68
  v_mfma_f32_32x32x8_bf16 v[80:95], v[56:57], v[148:149], 0
  s_waitcnt vmcnt(9)
  v_exp_f32 v69, v69
  v_exp_f32 v70, v70
  v_exp_f32 v71, v71
  v_mfma_f32_16x16x32_bf16 v[172:175], v[152:155], v[192:195], 0
  v_perm_b32 v26, v69, v68, s14
  v_perm_b32 v27, v71, v70, s14
  v_exp_f32 v72, v72
  v_mfma_f32_32x32x16_bf16 v[80:95], v[32:35], v[132:135], v[80:95]
  ds_read_b128 v[48:51], v165 offset:13248
  v_exp_f32 v73, v73
  v_exp_f32 v74, v74
  v_exp_f32 v75, v75
  v_mfma_f32_16x16x32_bf16 v[176:179], v[152:155], v[196:199], 0
  v_perm_b32 v28, v73, v72, s14
  v_perm_b32 v29, v75, v74, s14
  v_exp_f32 v76, v76
  v_mfma_f32_32x32x16_bf16 v[96:111], v[40:43], v[24:27], v[96:111]
  ds_read_b128 v[52:55], v165 offset:13856
  v_exp_f32 v77, v77
  v_exp_f32 v78, v78
  v_exp_f32 v79, v79
  v_perm_b32 v30, v77, v76, s14
  v_perm_b32 v31, v79, v78, s14
  v_exp_f32 v80, v80
  v_exp_f32 v81, v81
  v_mfma_f32_32x32x16_bf16 v[96:111], v[44:47], v[28:31], v[96:111]
  buffer_load_dwordx4 v[224:227], v246, s[64:67], s80 offen offset:512 sc1
  s_add_u32 s80, s80, 294912
  v_exp_f32 v82, v82
  v_exp_f32 v83, v83
  v_perm_b32 v24, v81, v80, s14
  v_perm_b32 v25, v83, v82, s14
  v_exp_f32 v84, v84
  v_mfma_f32_32x32x8_bf16 v[64:79], v[56:57], v[142:143], 0
  s_waitcnt lgkmcnt(0)
  v_exp_f32 v85, v85
  v_exp_f32 v86, v86
  v_exp_f32 v87, v87
  v_mfma_f32_16x16x32_bf16 v[180:183], v[152:155], v[200:203], 0
  v_perm_b32 v26, v85, v84, s14
  v_perm_b32 v27, v87, v86, s14
  v_exp_f32 v88, v88
  v_mfma_f32_32x32x16_bf16 v[64:79], v[36:39], v[128:131], v[64:79]
  buffer_load_dwordx4 a[132:135], v245, s[64:67], s87 offen offset:2048
  v_exp_f32 v89, v89
  v_exp_f32 v90, v90
  v_exp_f32 v91, v91
  v_mfma_f32_16x16x32_bf16 v[184:187], v[152:155], v[204:207], 0
  v_perm_b32 v28, v89, v88, s14
  v_perm_b32 v29, v91, v90, s14
  v_exp_f32 v92, v92
  v_mfma_f32_32x32x16_bf16 v[112:127], v[40:43], v[24:27], v[112:127]
  buffer_load_dwordx4 v[228:231], v163, s[64:67], s80 offen sc1
  v_exp_f32 v93, v93
  v_exp_f32 v94, v94
  v_exp_f32 v95, v95
  v_perm_b32 v30, v93, v92, s14
  v_perm_b32 v31, v95, v94, s14
  v_exp_f32 v64, v64
  v_exp_f32 v65, v65
  v_mfma_f32_32x32x16_bf16 v[112:127], v[44:47], v[28:31], v[112:127]
  ds_read_b128 v[32:35], v164 offset:14464
  v_exp_f32 v66, v66
  v_exp_f32 v67, v67
  v_perm_b32 v24, v65, v64, s14
  v_perm_b32 v25, v67, v66, s14
  v_exp_f32 v68, v68
  v_mfma_f32_32x32x8_bf16 v[80:95], v[56:57], v[150:151], 0
  v_exp_f32 v69, v69
  v_exp_f32 v70, v70
  v_exp_f32 v71, v71
  v_perm_b32 v26, v69, v68, s14
  v_perm_b32 v27, v71, v70, s14
  v_exp_f32 v72, v72
  v_mfma_f32_32x32x16_bf16 v[80:95], v[36:39], v[132:135], v[80:95]
  ds_read_b128 v[40:43], v165 offset:15488
  v_exp_f32 v73, v73
  v_exp_f32 v74, v74
  v_exp_f32 v75, v75
  v_perm_b32 v28, v73, v72, s14
  v_perm_b32 v29, v75, v74, s14
  v_exp_f32 v76, v76
  v_mfma_f32_32x32x16_bf16 v[96:111], v[48:51], v[24:27], v[96:111]
  ds_read_b128 v[44:47], v165 offset:16096
  v_exp_f32 v77, v77
  v_exp_f32 v78, v78
  v_exp_f32 v79, v79
  v_perm_b32 v30, v77, v76, s14
  v_perm_b32 v31, v79, v78, s14
  v_exp_f32 v80, v80
  v_exp_f32 v81, v81
  v_mfma_f32_32x32x16_bf16 v[96:111], v[52:55], v[28:31], v[96:111]
  buffer_load_dwordx4 a[136:139], v245, s[64:67], s87 offen offset:3072
  v_exp_f32 v82, v82
  v_exp_f32 v83, v83
  v_perm_b32 v24, v81, v80, s14
  v_perm_b32 v25, v83, v82, s14
  v_exp_f32 v84, v84
  v_mfma_f32_32x32x8_bf16 v[64:79], v[58:59], v[140:141], 0
  s_waitcnt lgkmcnt(0)
  v_exp_f32 v85, v85
  v_exp_f32 v86, v86
  v_exp_f32 v87, v87
  v_perm_b32 v26, v85, v84, s14
  v_perm_b32 v27, v87, v86, s14
  v_exp_f32 v88, v88
  v_mfma_f32_32x32x16_bf16 v[64:79], v[32:35], v[128:131], v[64:79]
  buffer_load_dwordx4 v[232:235], v163, s[64:67], s80 offen offset:512 sc1
  v_exp_f32 v89, v89
  v_exp_f32 v90, v90
  v_exp_f32 v91, v91
  v_perm_b32 v28, v89, v88, s14
  v_perm_b32 v29, v91, v90, s14
  v_exp_f32 v92, v92
  v_mfma_f32_32x32x16_bf16 v[112:127], v[48:51], v[24:27], v[112:127]
  buffer_load_dwordx4 a[140:143], v250, s[64:67], s87 offen
  v_exp_f32 v93, v93
  v_exp_f32 v94, v94
  v_exp_f32 v95, v95
  v_perm_b32 v30, v93, v92, s14
  v_perm_b32 v31, v95, v94, s14
  v_exp_f32 v64, v64
  v_exp_f32 v65, v65
  v_mfma_f32_32x32x16_bf16 v[112:127], v[52:55], v[28:31], v[112:127]
  ds_read_b128 v[36:39], v164 offset:16704
  v_exp_f32 v66, v66
  v_exp_f32 v67, v67
  v_perm_b32 v24, v65, v64, s14
  v_perm_b32 v25, v67, v66, s14
  v_exp_f32 v68, v68
  v_mfma_f32_32x32x8_bf16 v[80:95], v[58:59], v[148:149], 0
  s_waitcnt vmcnt(9)
  v_exp_f32 v69, v69
  v_exp_f32 v70, v70
  v_exp_f32 v71, v71
  v_mfma_f32_16x16x32_bf16 v[188:191], v[152:155], v[208:211], 0
  v_perm_b32 v26, v69, v68, s14
  v_perm_b32 v27, v71, v70, s14
  v_exp_f32 v72, v72
  v_mfma_f32_32x32x16_bf16 v[80:95], v[32:35], v[132:135], v[80:95]
  ds_read_b128 v[48:51], v165 offset:17728
  v_exp_f32 v73, v73
  v_exp_f32 v74, v74
  v_exp_f32 v75, v75
  v_mfma_f32_16x16x32_bf16 v[172:175], v[152:155], v[212:215], v[172:175]
  v_perm_b32 v28, v73, v72, s14
  v_perm_b32 v29, v75, v74, s14
  v_exp_f32 v76, v76
  v_mfma_f32_32x32x16_bf16 v[96:111], v[40:43], v[24:27], v[96:111]
  ds_read_b128 v[52:55], v165 offset:18336
  v_exp_f32 v77, v77
  v_exp_f32 v78, v78
  v_exp_f32 v79, v79
  v_perm_b32 v30, v77, v76, s14
  v_perm_b32 v31, v79, v78, s14
  v_exp_f32 v80, v80
  v_exp_f32 v81, v81
  v_mfma_f32_32x32x16_bf16 v[96:111], v[44:47], v[28:31], v[96:111]
  buffer_load_dwordx4 v[192:195], v246, s[64:67], s80 offen sc1
  v_exp_f32 v82, v82
  v_exp_f32 v83, v83
  v_perm_b32 v24, v81, v80, s14
  v_perm_b32 v25, v83, v82, s14
  v_exp_f32 v84, v84
  v_mfma_f32_32x32x8_bf16 v[64:79], v[58:59], v[142:143], 0
  s_waitcnt lgkmcnt(0)
  v_exp_f32 v85, v85
  v_exp_f32 v86, v86
  v_exp_f32 v87, v87
  v_mfma_f32_16x16x32_bf16 v[176:179], v[152:155], v[216:219], v[176:179]
  v_perm_b32 v26, v85, v84, s14
  v_perm_b32 v27, v87, v86, s14
  v_exp_f32 v88, v88
  v_mfma_f32_32x32x16_bf16 v[64:79], v[36:39], v[128:131], v[64:79]
  buffer_load_dwordx4 v[4:7], v250, s[64:67], s87 offen offset:1024
  v_exp_f32 v89, v89
  v_exp_f32 v90, v90
  v_exp_f32 v91, v91
  v_perm_b32 v28, v89, v88, s14
  v_perm_b32 v29, v91, v90, s14
  v_exp_f32 v92, v92
  v_mfma_f32_32x32x16_bf16 v[112:127], v[40:43], v[24:27], v[112:127]
  buffer_load_dwordx4 v[196:199], v246, s[64:67], s80 offen offset:512 sc1
  v_exp_f32 v93, v93
  v_exp_f32 v94, v94
  v_exp_f32 v95, v95
  v_perm_b32 v30, v93, v92, s14
  v_perm_b32 v31, v95, v94, s14
  v_exp_f32 v64, v64
  v_exp_f32 v65, v65
  v_mfma_f32_32x32x16_bf16 v[112:127], v[44:47], v[28:31], v[112:127]
  ds_read_b128 v[32:35], v164 offset:19968
  v_exp_f32 v66, v66
  v_exp_f32 v67, v67
  v_perm_b32 v24, v65, v64, s14
  v_perm_b32 v25, v67, v66, s14
  v_exp_f32 v68, v68
  v_mfma_f32_32x32x8_bf16 v[80:95], v[58:59], v[150:151], 0
  v_exp_f32 v69, v69
  v_exp_f32 v70, v70
  v_exp_f32 v71, v71
  v_perm_b32 v26, v69, v68, s14
  v_perm_b32 v27, v71, v70, s14
  v_exp_f32 v72, v72
  v_mfma_f32_32x32x16_bf16 v[80:95], v[36:39], v[132:135], v[80:95]
  ds_read_b128 v[40:43], v165 offset:20992
  v_exp_f32 v73, v73
  v_exp_f32 v74, v74
  v_exp_f32 v75, v75
  v_perm_b32 v28, v73, v72, s14
  v_perm_b32 v29, v75, v74, s14
  v_exp_f32 v76, v76
  v_mfma_f32_32x32x16_bf16 v[96:111], v[48:51], v[24:27], v[96:111]
  ds_read_b128 v[44:47], v165 offset:21600
  v_exp_f32 v77, v77
  v_exp_f32 v78, v78
  v_exp_f32 v79, v79
  v_perm_b32 v30, v77, v76, s14
  v_perm_b32 v31, v79, v78, s14
  v_exp_f32 v80, v80
  v_exp_f32 v81, v81
  v_mfma_f32_32x32x16_bf16 v[96:111], v[52:55], v[28:31], v[96:111]
  buffer_load_dwordx4 v[200:203], v247, s[64:67], s80 offen sc1
  v_exp_f32 v82, v82
  v_exp_f32 v83, v83
  v_perm_b32 v24, v81, v80, s14
  v_perm_b32 v25, v83, v82, s14
  v_exp_f32 v84, v84
  v_mfma_f32_32x32x8_bf16 v[64:79], v[60:61], v[136:137], 0
  s_waitcnt lgkmcnt(0)
  v_exp_f32 v85, v85
  v_exp_f32 v86, v86
  v_exp_f32 v87, v87
  v_perm_b32 v26, v85, v84, s14
  v_perm_b32 v27, v87, v86, s14
  v_exp_f32 v88, v88
  v_mfma_f32_32x32x16_bf16 v[64:79], v[32:35], v[128:131], v[64:79]
  buffer_load_dwordx4 v[8:11], v250, s[64:67], s87 offen offset:2048
  v_exp_f32 v89, v89
  v_exp_f32 v90, v90
  v_exp_f32 v91, v91
  v_perm_b32 v28, v89, v88, s14
  v_perm_b32 v29, v91, v90, s14
  v_exp_f32 v92, v92
  v_mfma_f32_32x32x16_bf16 v[112:127], v[48:51], v[24:27], v[112:127]
  buffer_load_dwordx4 v[12:15], v250, s[64:67], s87 offen offset:3072
  v_exp_f32 v93, v93
  v_exp_f32 v94, v94
  v_exp_f32 v95, v95
  v_perm_b32 v30, v93, v92, s14
  v_perm_b32 v31, v95, v94, s14
  v_exp_f32 v64, v64
  v_exp_f32 v65, v65
  v_mfma_f32_32x32x16_bf16 v[112:127], v[52:55], v[28:31], v[112:127]
  ds_read_b128 v[36:39], v164 offset:22208
  v_exp_f32 v66, v66
  v_exp_f32 v67, v67
  v_perm_b32 v24, v65, v64, s14
  v_perm_b32 v25, v67, v66, s14
  v_exp_f32 v68, v68
  v_mfma_f32_32x32x8_bf16 v[80:95], v[60:61], v[144:145], 0
  s_add_u32 s80, s80, 294912
  s_waitcnt vmcnt(9)
  v_exp_f32 v69, v69
  v_exp_f32 v70, v70
  v_exp_f32 v71, v71
  v_mfma_f32_16x16x32_bf16 v[180:183], v[152:155], v[220:223], v[180:183]
  v_perm_b32 v26, v69, v68, s14
  v_perm_b32 v27, v71, v70, s14
  v_exp_f32 v72, v72
  v_mfma_f32_32x32x16_bf16 v[80:95], v[32:35], v[132:135], v[80:95]
  ds_read_b128 v[48:51], v165 offset:23232
  v_exp_f32 v73, v73
  v_exp_f32 v74, v74
  v_exp_f32 v75, v75
  v_mfma_f32_16x16x32_bf16 v[184:187], v[152:155], v[224:227], v[184:187]
  v_perm_b32 v28, v73, v72, s14
  v_perm_b32 v29, v75, v74, s14
  v_exp_f32 v76, v76
  v_mfma_f32_32x32x16_bf16 v[96:111], v[40:43], v[24:27], v[96:111]
  ds_read_b128 v[52:55], v165 offset:23840
  v_exp_f32 v77, v77
  v_exp_f32 v78, v78
  v_exp_f32 v79, v79
  v_perm_b32 v30, v77, v76, s14
  v_perm_b32 v31, v79, v78, s14
  v_exp_f32 v80, v80
  v_exp_f32 v81, v81
  v_mfma_f32_32x32x16_bf16 v[96:111], v[44:47], v[28:31], v[96:111]
  buffer_load_dwordx4 v[204:207], v163, s[64:67], s80 offen sc1
  v_exp_f32 v82, v82
  v_exp_f32 v83, v83
  v_perm_b32 v24, v81, v80, s14
  v_perm_b32 v25, v83, v82, s14
  v_exp_f32 v84, v84
  v_mfma_f32_32x32x8_bf16 v[64:79], v[60:61], v[138:139], 0
  s_waitcnt lgkmcnt(0)
  v_exp_f32 v85, v85
  v_exp_f32 v86, v86
  v_exp_f32 v87, v87
  v_mfma_f32_16x16x32_bf16 v[172:175], v[152:155], v[228:231], v[172:175]
  v_perm_b32 v26, v85, v84, s14
  v_perm_b32 v27, v87, v86, s14
  v_exp_f32 v88, v88
  v_mfma_f32_32x32x16_bf16 v[64:79], v[36:39], v[128:131], v[64:79]
  buffer_load_dwordx4 v[16:19], v167, s[64:67], s87 offen
  v_exp_f32 v89, v89
  v_exp_f32 v90, v90
  v_exp_f32 v91, v91
  v_perm_b32 v28, v89, v88, s14
  v_perm_b32 v29, v91, v90, s14
  v_exp_f32 v92, v92
  v_mfma_f32_32x32x16_bf16 v[112:127], v[40:43], v[24:27], v[112:127]
  buffer_load_dwordx4 v[208:211], v163, s[64:67], s80 offen offset:512 sc1
  v_exp_f32 v93, v93
  v_exp_f32 v94, v94
  v_exp_f32 v95, v95
  v_perm_b32 v30, v93, v92, s14
  v_perm_b32 v31, v95, v94, s14
  v_exp_f32 v64, v64
  v_exp_f32 v65, v65
  v_mfma_f32_32x32x16_bf16 v[112:127], v[44:47], v[28:31], v[112:127]
  ds_read_b128 v[32:35], v164 offset:24448
  v_exp_f32 v66, v66
  v_exp_f32 v67, v67
  v_perm_b32 v24, v65, v64, s14
  v_perm_b32 v25, v67, v66, s14
  v_exp_f32 v68, v68
  v_mfma_f32_32x32x8_bf16 v[80:95], v[60:61], v[146:147], 0
  s_add_u32 s87, s87, 18432
  v_exp_f32 v69, v69
  v_exp_f32 v70, v70
  v_exp_f32 v71, v71
  v_perm_b32 v26, v69, v68, s14
  v_perm_b32 v27, v71, v70, s14
  v_exp_f32 v72, v72
  v_mfma_f32_32x32x16_bf16 v[80:95], v[36:39], v[132:135], v[80:95]
  ds_read_b128 v[40:43], v165 offset:25472
  v_exp_f32 v73, v73
  v_exp_f32 v74, v74
  v_exp_f32 v75, v75
  v_perm_b32 v28, v73, v72, s14
  v_perm_b32 v29, v75, v74, s14
  v_exp_f32 v76, v76
  v_mfma_f32_32x32x16_bf16 v[96:111], v[48:51], v[24:27], v[96:111]
  ds_read_b128 v[44:47], v165 offset:26080
  v_exp_f32 v77, v77
  v_exp_f32 v78, v78
  v_exp_f32 v79, v79
  v_perm_b32 v30, v77, v76, s14
  v_perm_b32 v31, v79, v78, s14
  v_exp_f32 v80, v80
  v_exp_f32 v81, v81
  v_mfma_f32_32x32x16_bf16 v[96:111], v[52:55], v[28:31], v[96:111]
  buffer_load_dwordx4 v[212:215], v246, s[64:67], s80 offen sc1
  v_exp_f32 v82, v82
  v_exp_f32 v83, v83
  v_perm_b32 v24, v81, v80, s14
  v_perm_b32 v25, v83, v82, s14
  v_exp_f32 v84, v84
  v_mfma_f32_32x32x8_bf16 v[64:79], v[62:63], v[136:137], 0
  s_waitcnt lgkmcnt(0)
  v_exp_f32 v85, v85
  v_exp_f32 v86, v86
  v_exp_f32 v87, v87
  v_perm_b32 v26, v85, v84, s14
  v_perm_b32 v27, v87, v86, s14
  v_exp_f32 v88, v88
  v_mfma_f32_32x32x16_bf16 v[64:79], v[32:35], v[128:131], v[64:79]
  buffer_load_dwordx4 v[156:159], v245, s[64:67], s87 offen
  v_exp_f32 v89, v89
  v_exp_f32 v90, v90
  v_exp_f32 v91, v91
  v_perm_b32 v28, v89, v88, s14
  v_perm_b32 v29, v91, v90, s14
  v_exp_f32 v92, v92
  v_mfma_f32_32x32x16_bf16 v[112:127], v[48:51], v[24:27], v[112:127]
  buffer_load_dwordx4 v[168:171], v245, s[64:67], s87 offen offset:1024
  v_exp_f32 v93, v93
  v_exp_f32 v94, v94
  v_exp_f32 v95, v95
  v_perm_b32 v30, v93, v92, s14
  v_perm_b32 v31, v95, v94, s14
  v_exp_f32 v64, v64
  v_exp_f32 v65, v65
  v_mfma_f32_32x32x16_bf16 v[112:127], v[52:55], v[28:31], v[112:127]
  ds_read_b128 v[36:39], v164 offset:26688
  v_exp_f32 v66, v66
  v_exp_f32 v67, v67
  v_perm_b32 v24, v65, v64, s14
  v_perm_b32 v25, v67, v66, s14
  v_exp_f32 v68, v68
  v_mfma_f32_32x32x8_bf16 v[80:95], v[62:63], v[144:145], 0
  s_waitcnt vmcnt(9)
  v_exp_f32 v69, v69
  v_exp_f32 v70, v70
  v_exp_f32 v71, v71
  v_mfma_f32_16x16x32_bf16 v[176:179], v[152:155], v[232:235], v[176:179]
  v_perm_b32 v26, v69, v68, s14
  v_perm_b32 v27, v71, v70, s14
  v_exp_f32 v72, v72
  v_mfma_f32_32x32x16_bf16 v[80:95], v[32:35], v[132:135], v[80:95]
  ds_read_b128 v[48:51], v165 offset:27712
  v_exp_f32 v73, v73
  v_exp_f32 v74, v74
  v_exp_f32 v75, v75
  v_mfma_f32_16x16x32_bf16 v[180:183], v[152:155], v[192:195], v[180:183]
  v_perm_b32 v28, v73, v72, s14
  v_perm_b32 v29, v75, v74, s14
  v_exp_f32 v76, v76
  v_mfma_f32_32x32x16_bf16 v[96:111], v[40:43], v[24:27], v[96:111]
  ds_read_b128 v[52:55], v165 offset:28320
  v_exp_f32 v77, v77
  v_exp_f32 v78, v78
  v_exp_f32 v79, v79
  v_perm_b32 v30, v77, v76, s14
  v_perm_b32 v31, v79, v78, s14
  v_exp_f32 v80, v80
  v_exp_f32 v81, v81
  v_mfma_f32_32x32x16_bf16 v[96:111], v[44:47], v[28:31], v[96:111]
  buffer_load_dwordx4 v[216:219], v246, s[64:67], s80 offen offset:512 sc1
  s_add_u32 s80, s80, 294912
  v_exp_f32 v82, v82
  v_exp_f32 v83, v83
  v_perm_b32 v24, v81, v80, s14
  v_perm_b32 v25, v83, v82, s14
  v_exp_f32 v84, v84
  v_mfma_f32_32x32x8_bf16 v[64:79], v[62:63], v[138:139], 0
  s_waitcnt lgkmcnt(0)
  v_exp_f32 v85, v85
  v_exp_f32 v86, v86
  v_exp_f32 v87, v87
  v_mfma_f32_16x16x32_bf16 v[184:187], v[152:155], v[196:199], v[184:187]
  v_perm_b32 v26, v85, v84, s14
  v_perm_b32 v27, v87, v86, s14
  v_exp_f32 v88, v88
  v_mfma_f32_32x32x16_bf16 v[64:79], v[36:39], v[128:131], v[64:79]
  buffer_load_dwordx4 v[220:223], v163, s[64:67], s80 offen sc1
  v_exp_f32 v89, v89
  v_exp_f32 v90, v90
  v_exp_f32 v91, v91
  v_perm_b32 v28, v89, v88, s14
  v_perm_b32 v29, v91, v90, s14
  v_exp_f32 v92, v92
  v_mfma_f32_32x32x16_bf16 v[112:127], v[40:43], v[24:27], v[112:127]
  v_exp_f32 v93, v93
  v_exp_f32 v94, v94
  v_exp_f32 v95, v95
  v_perm_b32 v30, v93, v92, s14
  v_perm_b32 v31, v95, v94, s14
  v_exp_f32 v64, v64
  v_exp_f32 v65, v65
  v_mfma_f32_32x32x16_bf16 v[112:127], v[44:47], v[28:31], v[112:127]
  ds_read_b128 v[32:35], v164 offset:28928
  v_exp_f32 v66, v66
  v_exp_f32 v67, v67
  v_perm_b32 v24, v65, v64, s14
  v_perm_b32 v25, v67, v66, s14
  v_exp_f32 v68, v68
  v_mfma_f32_32x32x8_bf16 v[80:95], v[62:63], v[146:147], 0
PAD14:
  s_cbranch_execz HOPBACK
  v_exp_f32 v69, v69
  v_exp_f32 v70, v70
  v_exp_f32 v71, v71
  v_perm_b32 v26, v69, v68, s14
  v_perm_b32 v27, v71, v70, s14
  v_exp_f32 v72, v72
  v_mfma_f32_32x32x16_bf16 v[80:95], v[36:39], v[132:135], v[80:95]
  ds_read_b128 v[40:43], v165 offset:29952
  v_exp_f32 v73, v73
  v_exp_f32 v74, v74
  v_exp_f32 v75, v75
  v_perm_b32 v28, v73, v72, s14
  v_perm_b32 v29, v75, v74, s14
  v_exp_f32 v76, v76
  v_mfma_f32_32x32x16_bf16 v[96:111], v[48:51], v[24:27], v[96:111]
  ds_read_b128 v[44:47], v165 offset:30560
  ds_read_b128 v[56:59], v164 offset:37888
  v_exp_f32 v77, v77
  v_exp_f32 v78, v78
  v_exp_f32 v79, v79
  v_perm_b32 v30, v77, v76, s14
  v_perm_b32 v31, v79, v78, s14
  v_exp_f32 v80, v80
  v_exp_f32 v81, v81
  v_mfma_f32_32x32x16_bf16 v[96:111], v[52:55], v[28:31], v[96:111]
  buffer_load_dwordx4 v[224:227], v163, s[64:67], s80 offen offset:512 sc1
  v_exp_f32 v82, v82
  v_exp_f32 v83, v83
  v_perm_b32 v24, v81, v80, s14
  v_perm_b32 v25, v83, v82, s14
  v_exp_f32 v84, v84
  v_mfma_f32_32x32x8_bf16 v[64:79], v[60:61], v[140:141], 0
  s_waitcnt lgkmcnt(0)
  v_exp_f32 v85, v85
  v_exp_f32 v86, v86
  v_exp_f32 v87, v87
  v_perm_b32 v26, v85, v84, s14
  v_perm_b32 v27, v87, v86, s14
  v_exp_f32 v88, v88
  v_mfma_f32_32x32x16_bf16 v[64:79], v[32:35], v[128:131], v[64:79]
  v_exp_f32 v89, v89
  v_exp_f32 v90, v90
  v_exp_f32 v91, v91
  v_perm_b32 v28, v89, v88, s14
  v_perm_b32 v29, v91, v90, s14
  v_exp_f32 v92, v92
  v_mfma_f32_32x32x16_bf16 v[112:127], v[48:51], v[24:27], v[112:127]
  v_exp_f32 v93, v93
  v_exp_f32 v94, v94
  v_exp_f32 v95, v95
  v_perm_b32 v30, v93, v92, s14
  v_perm_b32 v31, v95, v94, s14
  v_exp_f32 v64, v64
  v_exp_f32 v65, v65
  v_mfma_f32_32x32x16_bf16 v[112:127], v[52:55], v[28:31], v[112:127]
  ds_read_b128 v[36:39], v164 offset:31168
  v_exp_f32 v66, v66
  v_exp_f32 v67, v67
  v_perm_b32 v24, v65, v64, s14
  v_perm_b32 v25, v67, v66, s14
  v_exp_f32 v68, v68
  v_mfma_f32_32x32x8_bf16 v[80:95], v[60:61], v[148:149], 0
  s_waitcnt vmcnt(6)
  v_exp_f32 v69, v69
  v_exp_f32 v70, v70
  v_exp_f32 v71, v71
  v_mfma_f32_16x16x32_bf16 v[188:191], v[152:155], v[200:203], v[188:191]
  v_perm_b32 v26, v69, v68, s14
  v_perm_b32 v27, v71, v70, s14
  v_exp_f32 v72, v72
  v_mfma_f32_32x32x16_bf16 v[80:95], v[32:35], v[132:135], v[80:95]
  ds_read_b128 v[48:51], v165 offset:32192
  v_exp_f32 v73, v73
  v_exp_f32 v74, v74
  v_exp_f32 v75, v75
  v_mfma_f32_16x16x32_bf16 v[172:175], v[152:155], v[204:207], v[172:175]
  v_perm_b32 v28, v73, v72, s14
  v_perm_b32 v29, v75, v74, s14
  v_exp_f32 v76, v76
  v_mfma_f32_32x32x16_bf16 v[96:111], v[40:43], v[24:27], v[96:111]
  ds_read_b128 v[52:55], v165 offset:32800
  v_exp_f32 v77, v77
  v_exp_f32 v78, v78
  v_exp_f32 v79, v79
  v_perm_b32 v30, v77, v76, s14
  v_perm_b32 v31, v79, v78, s14
  v_exp_f32 v80, v80
  v_exp_f32 v81, v81
  v_mfma_f32_32x32x16_bf16 v[96:111], v[44:47], v[28:31], v[96:111]
  buffer_load_dwordx4 v[228:231], v246, s[64:67], s80 offen sc1
  v_exp_f32 v82, v82
  v_exp_f32 v83, v83
  v_perm_b32 v24, v81, v80, s14
  v_perm_b32 v25, v83, v82, s14
  v_exp_f32 v84, v84
  v_mfma_f32_32x32x8_bf16 v[64:79], v[60:61], v[142:143], 0
  s_waitcnt lgkmcnt(0)
  v_exp_f32 v85, v85
  v_exp_f32 v86, v86
  v_exp_f32 v87, v87
  v_mfma_f32_16x16x32_bf16 v[176:179], v[152:155], v[208:211], v[176:179]
  v_perm_b32 v26, v85, v84, s14
  v_perm_b32 v27, v87, v86, s14
  v_exp_f32 v88, v88
  v_mfma_f32_32x32x16_bf16 v[64:79], v[36:39], v[128:131], v[64:79]
  buffer_load_dwordx4 v[232:235], v246, s[64:67], s80 offen offset:512 sc1
  v_exp_f32 v89, v89
  v_exp_f32 v90, v90
  v_exp_f32 v91, v91
  v_perm_b32 v28, v89, v88, s14
  v_perm_b32 v29, v91, v90, s14
  v_exp_f32 v92, v92
  v_mfma_f32_32x32x16_bf16 v[112:127], v[40:43], v[24:27], v[112:127]
  v_exp_f32 v93, v93
  v_exp_f32 v94, v94
  v_exp_f32 v95, v95
  v_perm_b32 v30, v93, v92, s14
  v_perm_b32 v31, v95, v94, s14
  v_exp_f32 v64, v64
  v_exp_f32 v65, v65
  v_mfma_f32_32x32x16_bf16 v[112:127], v[44:47], v[28:31], v[112:127]
  ds_read_b128 v[32:35], v164 offset:33408
  v_exp_f32 v66, v66
  v_exp_f32 v67, v67
  v_perm_b32 v24, v65, v64, s14
  v_perm_b32 v25, v67, v66, s14
  v_exp_f32 v68, v68
  v_mfma_f32_32x32x8_bf16 v[80:95], v[60:61], v[150:151], 0
  v_exp_f32 v69, v69
  v_exp_f32 v70, v70
  v_exp_f32 v71, v71
  v_perm_b32 v26, v69, v68, s14
  v_perm_b32 v27, v71, v70, s14
  v_exp_f32 v72, v72
  v_mfma_f32_32x32x16_bf16 v[80:95], v[36:39], v[132:135], v[80:95]
  ds_read_b128 v[40:43], v165 offset:34432
  v_exp_f32 v73, v73
  v_exp_f32 v74, v74
  v_exp_f32 v75, v75
  v_perm_b32 v28, v73, v72, s14
  v_perm_b32 v29, v75, v74, s14
  v_exp_f32 v76, v76
  v_mfma_f32_32x32x16_bf16 v[96:111], v[48:51], v[24:27], v[96:111]
  ds_read_b128 v[44:47], v165 offset:35040
  v_exp_f32 v77, v77
  v_exp_f32 v78, v78
  v_exp_f32 v79, v79
  v_perm_b32 v30, v77, v76, s14
  v_perm_b32 v31, v79, v78, s14
  v_exp_f32 v80, v80
  v_exp_f32 v81, v81
  v_mfma_f32_32x32x16_bf16 v[96:111], v[52:55], v[28:31], v[96:111]
  buffer_load_dwordx4 v[192:195], v247, s[64:67], s80 offen sc1
  s_add_u32 s80, s80, 294912
  v_exp_f32 v82, v82
  v_exp_f32 v83, v83
  v_perm_b32 v24, v81, v80, s14
  v_perm_b32 v25, v83, v82, s14
  v_exp_f32 v84, v84
  v_mfma_f32_32x32x8_bf16 v[64:79], v[62:63], v[140:141], 0
  s_waitcnt lgkmcnt(0)
  v_exp_f32 v85, v85
  v_exp_f32 v86, v86
  v_exp_f32 v87, v87
  v_perm_b32 v26, v85, v84, s14
  v_perm_b32 v27, v87, v86, s14
  v_exp_f32 v88, v88
  v_mfma_f32_32x32x16_bf16 v[64:79], v[32:35], v[128:131], v[64:79]
  v_exp_f32 v89, v89
  v_exp_f32 v90, v90
  v_exp_f32 v91, v91
  v_perm_b32 v28, v89, v88, s14
  v_perm_b32 v29, v91, v90, s14
  v_exp_f32 v92, v92
  v_mfma_f32_32x32x16_bf16 v[112:127], v[48:51], v[24:27], v[112:127]
  buffer_load_dwordx4 v[196:199], v163, s[64:67], s80 offen sc1
  v_exp_f32 v93, v93
  v_exp_f32 v94, v94
  v_exp_f32 v95, v95
  v_perm_b32 v30, v93, v92, s14
  v_perm_b32 v31, v95, v94, s14
  v_exp_f32 v64, v64
  v_exp_f32 v65, v65
  v_mfma_f32_32x32x16_bf16 v[112:127], v[52:55], v[28:31], v[112:127]
  ds_read_b128 v[36:39], v164 offset:35648
  v_exp_f32 v66, v66
  v_exp_f32 v67, v67
  v_perm_b32 v24, v65, v64, s14
  v_perm_b32 v25, v67, v66, s14
  v_exp_f32 v68, v68
  v_mfma_f32_32x32x8_bf16 v[80:95], v[62:63], v[148:149], 0
  s_waitcnt vmcnt(5)
  v_exp_f32 v69, v69
  v_exp_f32 v70, v70
  v_exp_f32 v71, v71
  v_mfma_f32_16x16x32_bf16 v[180:183], v[152:155], v[212:215], v[180:183]
  v_perm_b32 v26, v69, v68, s14
  v_perm_b32 v27, v71, v70, s14
  v_exp_f32 v72, v72
  v_mfma_f32_32x32x16_bf16 v[80:95], v[32:35], v[132:135], v[80:95]
  ds_read_b128 v[48:51], v165 offset:36672
  v_exp_f32 v73, v73
  v_exp_f32 v74, v74
  v_exp_f32 v75, v75
  v_mfma_f32_16x16x32_bf16 v[184:187], v[152:155], v[216:219], v[184:187]
  v_perm_b32 v28, v73, v72, s14
  v_perm_b32 v29, v75, v74, s14
  v_exp_f32 v76, v76
  v_mfma_f32_32x32x16_bf16 v[96:111], v[40:43], v[24:27], v[96:111]
  ds_read_b128 v[52:55], v165 offset:37280
  v_exp_f32 v77, v77
  v_exp_f32 v78, v78
  v_exp_f32 v79, v79
  v_perm_b32 v30, v77, v76, s14
  v_perm_b32 v31, v79, v78, s14
  v_exp_f32 v80, v80
  v_exp_f32 v81, v81
  v_mfma_f32_32x32x16_bf16 v[96:111], v[44:47], v[28:31], v[96:111]
  v_exp_f32 v82, v82
  v_exp_f32 v83, v83
  v_perm_b32 v24, v81, v80, s14
  v_perm_b32 v25, v83, v82, s14
  v_exp_f32 v84, v84
  v_mfma_f32_32x32x8_bf16 v[64:79], v[62:63], v[142:143], 0
  s_waitcnt lgkmcnt(0)
  v_exp_f32 v85, v85
  v_exp_f32 v86, v86
  v_exp_f32 v87, v87
  v_mfma_f32_16x16x32_bf16 v[172:175], v[152:155], v[220:223], v[172:175]
  v_perm_b32 v26, v85, v84, s14
  v_perm_b32 v27, v87, v86, s14
  v_exp_f32 v88, v88
  v_mfma_f32_32x32x16_bf16 v[64:79], v[36:39], v[128:131], v[64:79]
  buffer_load_dwordx4 v[200:203], v163, s[64:67], s80 offen offset:512 sc1
  v_exp_f32 v89, v89
  v_exp_f32 v90, v90
  v_exp_f32 v91, v91
  v_perm_b32 v28, v89, v88, s14
  v_perm_b32 v29, v91, v90, s14
  v_exp_f32 v92, v92
  v_mfma_f32_32x32x16_bf16 v[112:127], v[40:43], v[24:27], v[112:127]
  v_exp_f32 v93, v93
  v_exp_f32 v94, v94
  v_exp_f32 v95, v95
  v_perm_b32 v30, v93, v92, s14
  v_perm_b32 v31, v95, v94, s14
  v_exp_f32 v64, v64
  v_exp_f32 v65, v65
  v_mfma_f32_32x32x16_bf16 v[112:127], v[44:47], v[28:31], v[112:127]
  ds_read_b128 v[32:35], v164 offset:38912
  v_exp_f32 v66, v66
  v_exp_f32 v67, v67
  v_perm_b32 v24, v65, v64, s14
  v_perm_b32 v25, v67, v66, s14
  v_exp_f32 v68, v68
  v_mfma_f32_32x32x8_bf16 v[80:95], v[62:63], v[150:151], 0
  v_exp_f32 v69, v69
  v_exp_f32 v70, v70
  v_exp_f32 v71, v71
  v_perm_b32 v26, v69, v68, s14
  v_perm_b32 v27, v71, v70, s14
  v_exp_f32 v72, v72
  v_mfma_f32_32x32x16_bf16 v[80:95], v[36:39], v[132:135], v[80:95]
  ds_read_b128 v[40:43], v165 offset:39936
  v_exp_f32 v73, v73
  v_exp_f32 v74, v74
  v_exp_f32 v75, v75
  v_perm_b32 v28, v73, v72, s14
  v_perm_b32 v29, v75, v74, s14
  v_exp_f32 v76, v76
  v_mfma_f32_32x32x16_bf16 v[96:111], v[48:51], v[24:27], v[96:111]
  ds_read_b128 v[44:47], v165 offset:40544
  v_exp_f32 v77, v77
  v_exp_f32 v78, v78
  v_exp_f32 v79, v79
  v_perm_b32 v30, v77, v76, s14
  v_perm_b32 v31, v79, v78, s14
  v_exp_f32 v80, v80
  v_exp_f32 v81, v81
  v_mfma_f32_32x32x16_bf16 v[96:111], v[52:55], v[28:31], v[96:111]
  buffer_load_dwordx4 v[204:207], v246, s[64:67], s80 offen sc1
  v_exp_f32 v82, v82
  v_exp_f32 v83, v83
  v_perm_b32 v24, v81, v80, s14
  v_perm_b32 v25, v83, v82, s14
  v_exp_f32 v84, v84
  v_mfma_f32_32x32x8_bf16 v[64:79], v[56:57], v[136:137], 0
  s_waitcnt lgkmcnt(0)
  v_exp_f32 v85, v85
  v_exp_f32 v86, v86
  v_exp_f32 v87, v87
  v_perm_b32 v26, v85, v84, s14
  v_perm_b32 v27, v87, v86, s14
  v_exp_f32 v88, v88
  v_mfma_f32_32x32x16_bf16 v[64:79], v[32:35], v[128:131], v[64:79]
  v_exp_f32 v89, v89
  v_exp_f32 v90, v90
  v_exp_f32 v91, v91
  v_perm_b32 v28, v89, v88, s14
  v_perm_b32 v29, v91, v90, s14
  v_exp_f32 v92, v92
  v_mfma_f32_32x32x16_bf16 v[112:127], v[48:51], v[24:27], v[112:127]
  buffer_load_dwordx4 v[208:211], v246, s[64:67], s80 offen offset:512 sc1
  v_exp_f32 v93, v93
  v_exp_f32 v94, v94
  v_exp_f32 v95, v95
  v_perm_b32 v30, v93, v92, s14
  v_perm_b32 v31, v95, v94, s14
  v_add_u32 v164, 37888, v164
  v_add_u32 v165, 37888, v165
  v_exp_f32 v64, v64
  v_exp_f32 v65, v65
  v_mfma_f32_32x32x16_bf16 v[112:127], v[52:55], v[28:31], v[112:127]
  ds_read_b128 v[36:39], v164 offset:3264
  v_exp_f32 v66, v66
  v_exp_f32 v67, v67
  v_perm_b32 v24, v65, v64, s14
  v_perm_b32 v25, v67, v66, s14
  v_exp_f32 v68, v68
  v_mfma_f32_32x32x8_bf16 v[80:95], v[56:57], v[144:145], 0
  s_add_u32 s80, s80, 294912
  s_waitcnt vmcnt(5)
  v_exp_f32 v69, v69
  v_exp_f32 v70, v70
  v_exp_f32 v71, v71
  v_mfma_f32_16x16x32_bf16 v[176:179], v[152:155], v[224:227], v[176:179]
  v_perm_b32 v26, v69, v68, s14
  v_perm_b32 v27, v71, v70, s14
  v_exp_f32 v72, v72
  v_mfma_f32_32x32x16_bf16 v[80:95], v[32:35], v[132:135], v[80:95]
  ds_read_b128 v[48:51], v165 offset:4288
  v_exp_f32 v73, v73
  v_exp_f32 v74, v74
  v_exp_f32 v75, v75
  v_mfma_f32_16x16x32_bf16 v[180:183], v[152:155], v[228:231], v[180:183]
  v_perm_b32 v28, v73, v72, s14
  v_perm_b32 v29, v75, v74, s14
  v_exp_f32 v76, v76
  v_mfma_f32_32x32x16_bf16 v[96:111], v[40:43], v[24:27], v[96:111]
  ds_read_b128 v[52:55], v165 offset:4896
  v_exp_f32 v77, v77
  v_exp_f32 v78, v78
  v_exp_f32 v79, v79
  v_perm_b32 v30, v77, v76, s14
  v_perm_b32 v31, v79, v78, s14
  v_exp_f32 v80, v80
  v_exp_f32 v81, v81
  v_mfma_f32_32x32x16_bf16 v[96:111], v[44:47], v[28:31], v[96:111]
  v_exp_f32 v82, v82
  v_exp_f32 v83, v83
  v_perm_b32 v24, v81, v80, s14
  v_perm_b32 v25, v83, v82, s14
  v_exp_f32 v84, v84
  v_mfma_f32_32x32x8_bf16 v[64:79], v[56:57], v[138:139], 0
  s_waitcnt lgkmcnt(0)
  v_exp_f32 v85, v85
  v_exp_f32 v86, v86
  v_exp_f32 v87, v87
  v_mfma_f32_16x16x32_bf16 v[184:187], v[152:155], v[232:235], v[184:187]
  v_perm_b32 v26, v85, v84, s14
  v_perm_b32 v27, v87, v86, s14
  v_exp_f32 v88, v88
  v_mfma_f32_32x32x16_bf16 v[64:79], v[36:39], v[128:131], v[64:79]
  buffer_load_dwordx4 v[212:215], v163, s[64:67], s80 offen sc1
  v_exp_f32 v89, v89
  v_exp_f32 v90, v90
  v_exp_f32 v91, v91
  v_perm_b32 v28, v89, v88, s14
  v_perm_b32 v29, v91, v90, s14
  v_exp_f32 v92, v92
  v_mfma_f32_32x32x16_bf16 v[112:127], v[40:43], v[24:27], v[112:127]
  v_exp_f32 v93, v93
  v_exp_f32 v94, v94
  v_exp_f32 v95, v95
  v_perm_b32 v30, v93, v92, s14
  v_perm_b32 v31, v95, v94, s14
  v_exp_f32 v64, v64
  v_exp_f32 v65, v65
  v_mfma_f32_32x32x16_bf16 v[112:127], v[44:47], v[28:31], v[112:127]
  ds_read_b128 v[32:35], v164 offset:5504
  v_exp_f32 v66, v66
  v_exp_f32 v67, v67
  v_perm_b32 v24, v65, v64, s14
  v_perm_b32 v25, v67, v66, s14
  v_exp_f32 v68, v68
  v_mfma_f32_32x32x8_bf16 v[80:95], v[56:57], v[146:147], 0
  v_exp_f32 v69, v69
  v_exp_f32 v70, v70
  v_exp_f32 v71, v71
  v_perm_b32 v26, v69, v68, s14
  v_perm_b32 v27, v71, v70, s14
  v_exp_f32 v72, v72
  v_mfma_f32_32x32x16_bf16 v[80:95], v[36:39], v[132:135], v[80:95]
  ds_read_b128 v[40:43], v165 offset:6528
  v_exp_f32 v73, v73
  v_exp_f32 v74, v74
  v_exp_f32 v75, v75
  v_perm_b32 v28, v73, v72, s14
  v_perm_b32 v29, v75, v74, s14
  v_exp_f32 v76, v76
  v_mfma_f32_32x32x16_bf16 v[96:111], v[48:51], v[24:27], v[96:111]
  ds_read_b128 v[44:47], v165 offset:7136
  v_exp_f32 v77, v77
  v_exp_f32 v78, v78
  v_exp_f32 v79, v79
  v_perm_b32 v30, v77, v76, s14
  v_perm_b32 v31, v79, v78, s14
  v_exp_f32 v80, v80
  v_exp_f32 v81, v81
  v_mfma_f32_32x32x16_bf16 v[96:111], v[52:55], v[28:31], v[96:111]
  buffer_load_dwordx4 v[216:219], v163, s[64:67], s80 offen offset:512 sc1
  v_exp_f32 v82, v82
  v_exp_f32 v83, v83
  v_perm_b32 v24, v81, v80, s14
  v_perm_b32 v25, v83, v82, s14
  v_exp_f32 v84, v84
  v_mfma_f32_32x32x8_bf16 v[64:79], v[58:59], v[136:137], 0
  s_waitcnt lgkmcnt(0)
  v_exp_f32 v85, v85
  v_exp_f32 v86, v86
  v_exp_f32 v87, v87
  v_perm_b32 v26, v85, v84, s14
  v_perm_b32 v27, v87, v86, s14
  v_exp_f32 v88, v88
  v_mfma_f32_32x32x16_bf16 v[64:79], v[32:35], v[128:131], v[64:79]
  v_exp_f32 v89, v89
  v_exp_f32 v90, v90
  v_exp_f32 v91, v91
  v_perm_b32 v28, v89, v88, s14
  v_perm_b32 v29, v91, v90, s14
  v_exp_f32 v92, v92
  v_mfma_f32_32x32x16_bf16 v[112:127], v[48:51], v[24:27], v[112:127]
  buffer_load_dwordx4 v[220:223], v246, s[64:67], s80 offen sc1
  v_exp_f32 v93, v93
  v_exp_f32 v94, v94
  v_exp_f32 v95, v95
  v_perm_b32 v30, v93, v92, s14
  v_perm_b32 v31, v95, v94, s14
  v_exp_f32 v64, v64
  v_exp_f32 v65, v65
  v_mfma_f32_32x32x16_bf16 v[112:127], v[52:55], v[28:31], v[112:127]
  ds_read_b128 v[36:39], v164 offset:7744
  v_exp_f32 v66, v66
  v_exp_f32 v67, v67
  v_perm_b32 v24, v65, v64, s14
  v_perm_b32 v25, v67, v66, s14
  v_exp_f32 v68, v68
  v_mfma_f32_32x32x8_bf16 v[80:95], v[58:59], v[144:145], 0
  s_waitcnt vmcnt(5)
  v_exp_f32 v69, v69
  v_exp_f32 v70, v70
  v_exp_f32 v71, v71
  v_mfma_f32_16x16x32_bf16 v[188:191], v[152:155], v[192:195], v[188:191]
  v_perm_b32 v26, v69, v68, s14
  v_perm_b32 v27, v71, v70, s14
  v_exp_f32 v72, v72
  v_mfma_f32_32x32x16_bf16 v[80:95], v[32:35], v[132:135], v[80:95]
  ds_read_b128 v[48:51], v165 offset:8768
  v_exp_f32 v73, v73
  v_exp_f32 v74, v74
  v_exp_f32 v75, v75
  v_mfma_f32_16x16x32_bf16 v[172:175], v[152:155], v[196:199], v[172:175]
  v_perm_b32 v28, v73, v72, s14
  v_perm_b32 v29, v75, v74, s14
  v_exp_f32 v76, v76
  v_mfma_f32_32x32x16_bf16 v[96:111], v[40:43], v[24:27], v[96:111]
  ds_read_b128 v[52:55], v165 offset:9376
  v_exp_f32 v77, v77
  v_exp_f32 v78, v78
  v_exp_f32 v79, v79
  v_perm_b32 v30, v77, v76, s14
  v_perm_b32 v31, v79, v78, s14
  v_exp_f32 v80, v80
  v_exp_f32 v81, v81
  v_mfma_f32_32x32x16_bf16 v[96:111], v[44:47], v[28:31], v[96:111]
  v_exp_f32 v82, v82
  v_exp_f32 v83, v83
  v_perm_b32 v24, v81, v80, s14
  v_perm_b32 v25, v83, v82, s14
  v_exp_f32 v84, v84
  v_mfma_f32_32x32x8_bf16 v[64:79], v[58:59], v[138:139], 0
  s_waitcnt lgkmcnt(0)
  v_exp_f32 v85, v85
  v_exp_f32 v86, v86
  v_exp_f32 v87, v87
  v_mfma_f32_16x16x32_bf16 v[176:179], v[152:155], v[200:203], v[176:179]
  v_perm_b32 v26, v85, v84, s14
  v_perm_b32 v27, v87, v86, s14
  v_exp_f32 v88, v88
  v_mfma_f32_32x32x16_bf16 v[64:79], v[36:39], v[128:131], v[64:79]
  buffer_load_dwordx4 v[224:227], v246, s[64:67], s80 offen offset:512 sc1
  v_exp_f32 v89, v89
  v_exp_f32 v90, v90
  v_exp_f32 v91, v91
  v_perm_b32 v28, v89, v88, s14
  v_perm_b32 v29, v91, v90, s14
  v_exp_f32 v92, v92
  v_mfma_f32_32x32x16_bf16 v[112:127], v[40:43], v[24:27], v[112:127]
  v_exp_f32 v93, v93
  v_exp_f32 v94, v94
  v_exp_f32 v95, v95
  v_perm_b32 v30, v93, v92, s14
  v_perm_b32 v31, v95, v94, s14
  v_exp_f32 v64, v64
  v_exp_f32 v65, v65
  v_mfma_f32_32x32x16_bf16 v[112:127], v[44:47], v[28:31], v[112:127]
  ds_read_b128 v[32:35], v164 offset:9984
  v_exp_f32 v66, v66
  v_exp_f32 v67, v67
  v_perm_b32 v24, v65, v64, s14
  v_perm_b32 v25, v67, v66, s14
  v_exp_f32 v68, v68
  v_mfma_f32_32x32x8_bf16 v[80:95], v[58:59], v[146:147], 0
  v_exp_f32 v69, v69
  v_exp_f32 v70, v70
  v_exp_f32 v71, v71
  v_perm_b32 v26, v69, v68, s14
  v_perm_b32 v27, v71, v70, s14
  v_exp_f32 v72, v72
  v_mfma_f32_32x32x16_bf16 v[80:95], v[36:39], v[132:135], v[80:95]
  ds_read_b128 v[40:43], v165 offset:11008
  v_exp_f32 v73, v73
  v_exp_f32 v74, v74
  v_exp_f32 v75, v75
  v_perm_b32 v28, v73, v72, s14
  v_perm_b32 v29, v75, v74, s14
  v_exp_f32 v76, v76
  v_mfma_f32_32x32x16_bf16 v[96:111], v[48:51], v[24:27], v[96:111]
  ds_read_b128 v[44:47], v165 offset:11616
  ds_read_b128 v[60:63], v164 offset:18944
  v_exp_f32 v77, v77
  v_exp_f32 v78, v78
  v_exp_f32 v79, v79
  v_perm_b32 v30, v77, v76, s14
  v_perm_b32 v31, v79, v78, s14
  v_exp_f32 v80, v80
  v_exp_f32 v81, v81
  v_mfma_f32_32x32x16_bf16 v[96:111], v[52:55], v[28:31], v[96:111]
  buffer_load_dwordx4 v[228:231], v247, s[64:67], s80 offen sc1
  s_add_u32 s80, s80, 294912
  v_exp_f32 v82, v82
  v_exp_f32 v83, v83
  v_perm_b32 v24, v81, v80, s14
  v_perm_b32 v25, v83, v82, s14
  v_exp_f32 v84, v84
  v_mfma_f32_32x32x8_bf16 v[64:79], v[56:57], v[140:141], 0
  s_waitcnt lgkmcnt(0)
  v_exp_f32 v85, v85
  v_exp_f32 v86, v86
  v_exp_f32 v87, v87
  v_perm_b32 v26, v85, v84, s14
  v_perm_b32 v27, v87, v86, s14
  v_exp_f32 v88, v88
  v_mfma_f32_32x32x16_bf16 v[64:79], v[32:35], v[128:131], v[64:79]
  v_exp_f32 v89, v89
  v_exp_f32 v90, v90
  v_exp_f32 v91, v91
  v_perm_b32 v28, v89, v88, s14
  v_perm_b32 v29, v91, v90, s14
  v_exp_f32 v92, v92
  v_mfma_f32_32x32x16_bf16 v[112:127], v[48:51], v[24:27], v[112:127]
  buffer_load_dwordx4 v[232:235], v163, s[64:67], s80 offen sc1
  v_exp_f32 v93, v93
  v_exp_f32 v94, v94
  v_exp_f32 v95, v95
  v_perm_b32 v30, v93, v92, s14
  v_perm_b32 v31, v95, v94, s14
  v_exp_f32 v64, v64
  v_exp_f32 v65, v65
  v_mfma_f32_32x32x16_bf16 v[112:127], v[52:55], v[28:31], v[112:127]
  ds_read_b128 v[36:39], v164 offset:12224
  v_exp_f32 v66, v66
  v_exp_f32 v67, v67
  v_perm_b32 v24, v65, v64, s14
  v_perm_b32 v25, v67, v66, s14
  v_exp_f32 v68, v68
  v_mfma_f32_32x32x8_bf16 v[80:95], v[56:57], v[148:149], 0
  s_waitcnt vmcnt(5)
  v_exp_f32 v69, v69
  v_exp_f32 v70, v70
  v_exp_f32 v71, v71
  v_mfma_f32_16x16x32_bf16 v[180:183], v[152:155], v[204:207], v[180:183]
  v_perm_b32 v26, v69, v68, s14
  v_perm_b32 v27, v71, v70, s14
  v_exp_f32 v72, v72
  v_mfma_f32_32x32x16_bf16 v[80:95], v[32:35], v[132:135], v[80:95]
  ds_read_b128 v[48:51], v165 offset:13248
  v_exp_f32 v73, v73
  v_exp_f32 v74, v74
  v_exp_f32 v75, v75
  v_mfma_f32_16x16x32_bf16 v[184:187], v[152:155], v[208:211], v[184:187]
  v_perm_b32 v28, v73, v72, s14
  v_perm_b32 v29, v75, v74, s14
  v_exp_f32 v76, v76
  v_mfma_f32_32x32x16_bf16 v[96:111], v[40:43], v[24:27], v[96:111]
  ds_read_b128 v[52:55], v165 offset:13856
  v_exp_f32 v77, v77
  v_exp_f32 v78, v78
  v_exp_f32 v79, v79
  v_perm_b32 v30, v77, v76, s14
  v_perm_b32 v31, v79, v78, s14
  v_exp_f32 v80, v80
  v_exp_f32 v81, v81
  v_mfma_f32_32x32x16_bf16 v[96:111], v[44:47], v[28:31], v[96:111]
  buffer_load_dwordx4 v[192:195], v163, s[64:67], s80 offen offset:512 sc1
  v_exp_f32 v82, v82
  v_exp_f32 v83, v83
  v_perm_b32 v24, v81, v80, s14
  v_perm_b32 v25, v83, v82, s14
  v_exp_f32 v84, v84
  v_mfma_f32_32x32x8_bf16 v[64:79], v[56:57], v[142:143], 0
  s_waitcnt lgkmcnt(0)
  v_exp_f32 v85, v85
  v_exp_f32 v86, v86
  v_exp_f32 v87, v87
  v_mfma_f32_16x16x32_bf16 v[172:175], v[152:155], v[212:215], v[172:175]
  v_perm_b32 v26, v85, v84, s14
  v_perm_b32 v27, v87, v86, s14
  v_exp_f32 v88, v88
  v_mfma_f32_32x32x16_bf16 v[64:79], v[36:39], v[128:131], v[64:79]
  v_exp_f32 v89, v89
  v_exp_f32 v90, v90
  v_exp_f32 v91, v91
  v_perm_b32 v28, v89, v88, s14
  v_perm_b32 v29, v91, v90, s14
  v_exp_f32 v92, v92
  v_mfma_f32_32x32x16_bf16 v[112:127], v[40:43], v[24:27], v[112:127]
  buffer_load_dwordx4 v[204:207], v245, s[64:67], s87 offen offset:2048
  v_exp_f32 v93, v93
  v_exp_f32 v94, v94
  v_exp_f32 v95, v95
  v_perm_b32 v30, v93, v92, s14
  v_perm_b32 v31, v95, v94, s14
  v_exp_f32 v64, v64
  v_exp_f32 v65, v65
  v_mfma_f32_32x32x16_bf16 v[112:127], v[44:47], v[28:31], v[112:127]
  ds_read_b128 v[32:35], v164 offset:14464
  v_exp_f32 v66, v66
  v_exp_f32 v67, v67
  v_perm_b32 v24, v65, v64, s14
  v_perm_b32 v25, v67, v66, s14
  v_exp_f32 v68, v68
  v_mfma_f32_32x32x8_bf16 v[80:95], v[56:57], v[150:151], 0
  v_exp_f32 v69, v69
  v_exp_f32 v70, v70
  v_exp_f32 v71, v71
  v_perm_b32 v26, v69, v68, s14
  v_perm_b32 v27, v71, v70, s14
  v_exp_f32 v72, v72
  v_mfma_f32_32x32x16_bf16 v[80:95], v[36:39], v[132:135], v[80:95]
  ds_read_b128 v[40:43], v165 offset:15488
  v_exp_f32 v73, v73
  v_exp_f32 v74, v74
  v_exp_f32 v75, v75
  v_perm_b32 v28, v73, v72, s14
  v_perm_b32 v29, v75, v74, s14
  v_exp_f32 v76, v76
  v_mfma_f32_32x32x16_bf16 v[96:111], v[48:51], v[24:27], v[96:111]
  ds_read_b128 v[44:47], v165 offset:16096
  v_exp_f32 v77, v77
  v_exp_f32 v78, v78
  v_exp_f32 v79, v79
  v_perm_b32 v30, v77, v76, s14
  v_perm_b32 v31, v79, v78, s14
  v_exp_f32 v80, v80
  v_exp_f32 v81, v81
  v_mfma_f32_32x32x16_bf16 v[96:111], v[52:55], v[28:31], v[96:111]
  buffer_load_dwordx4 v[196:199], v246, s[64:67], s80 offen sc1
  v_exp_f32 v82, v82
  v_exp_f32 v83, v83
  v_perm_b32 v24, v81, v80, s14
  v_perm_b32 v25, v83, v82, s14
  v_exp_f32 v84, v84
  v_mfma_f32_32x32x8_bf16 v[64:79], v[58:59], v[140:141], 0
  s_waitcnt lgkmcnt(0)
  v_exp_f32 v85, v85
  v_exp_f32 v86, v86
  v_exp_f32 v87, v87
  v_perm_b32 v26, v85, v84, s14
  v_perm_b32 v27, v87, v86, s14
  v_exp_f32 v88, v88
  v_mfma_f32_32x32x16_bf16 v[64:79], v[32:35], v[128:131], v[64:79]
  buffer_load_dwordx4 v[208:211], v245, s[64:67], s87 offen offset:3072
  v_exp_f32 v89, v89
  v_exp_f32 v90, v90
  v_exp_f32 v91, v91
  v_perm_b32 v28, v89, v88, s14
  v_perm_b32 v29, v91, v90, s14
  v_exp_f32 v92, v92
  v_mfma_f32_32x32x16_bf16 v[112:127], v[48:51], v[24:27], v[112:127]
  buffer_load_dwordx4 v[200:203], v246, s[64:67], s80 offen offset:512 sc1
  v_exp_f32 v93, v93
  v_exp_f32 v94, v94
  v_exp_f32 v95, v95
  v_perm_b32 v30, v93, v92, s14
  v_perm_b32 v31, v95, v94, s14
  v_exp_f32 v64, v64
  v_exp_f32 v65, v65
  v_mfma_f32_32x32x16_bf16 v[112:127], v[52:55], v[28:31], v[112:127]
PAD15:
  s_cbranch_execz HOPBACK
  ds_read_b128 v[36:39], v164 offset:16704
  v_exp_f32 v66, v66
  v_exp_f32 v67, v67
  v_perm_b32 v24, v65, v64, s14
  v_perm_b32 v25, v67, v66, s14
  v_exp_f32 v68, v68
  v_mfma_f32_32x32x8_bf16 v[80:95], v[58:59], v[148:149], 0
  s_waitcnt vmcnt(7)
  v_exp_f32 v69, v69
  v_exp_f32 v70, v70
  v_exp_f32 v71, v71
  v_mfma_f32_16x16x32_bf16 v[176:179], v[152:155], v[216:219], v[176:179]
  v_perm_b32 v26, v69, v68, s14
  v_perm_b32 v27, v71, v70, s14
  v_exp_f32 v72, v72
  v_mfma_f32_32x32x16_bf16 v[80:95], v[32:35], v[132:135], v[80:95]
  ds_read_b128 v[48:51], v165 offset:17728
  v_exp_f32 v73, v73
  v_exp_f32 v74, v74
  v_exp_f32 v75, v75
  v_mfma_f32_16x16x32_bf16 v[180:183], v[152:155], v[220:223], v[180:183]
  v_perm_b32 v28, v73, v72, s14
  v_perm_b32 v29, v75, v74, s14
  v_exp_f32 v76, v76
  v_mfma_f32_32x32x16_bf16 v[96:111], v[40:43], v[24:27], v[96:111]
  ds_read_b128 v[52:55], v165 offset:18336
  v_exp_f32 v77, v77
  v_exp_f32 v78, v78
  v_exp_f32 v79, v79
  v_perm_b32 v30, v77, v76, s14
  v_perm_b32 v31, v79, v78, s14
  v_exp_f32 v80, v80
  v_exp_f32 v81, v81
  v_mfma_f32_32x32x16_bf16 v[96:111], v[44:47], v[28:31], v[96:111]
  buffer_load_dwordx4 v[212:215], v250, s[64:67], s87 offen
  v_exp_f32 v82, v82
  v_exp_f32 v83, v83
  v_perm_b32 v24, v81, v80, s14
  v_perm_b32 v25, v83, v82, s14
  v_exp_f32 v84, v84
  v_mfma_f32_32x32x8_bf16 v[64:79], v[58:59], v[142:143], 0
  s_waitcnt lgkmcnt(0)
  v_exp_f32 v85, v85
  v_exp_f32 v86, v86
  v_exp_f32 v87, v87
  v_mfma_f32_16x16x32_bf16 v[184:187], v[152:155], v[224:227], v[184:187]
  v_perm_b32 v26, v85, v84, s14
  v_perm_b32 v27, v87, v86, s14
  v_exp_f32 v88, v88
  v_mfma_f32_32x32x16_bf16 v[64:79], v[36:39], v[128:131], v[64:79]
  v_exp_f32 v89, v89
  v_exp_f32 v90, v90
  v_exp_f32 v91, v91
  v_perm_b32 v28, v89, v88, s14
  v_perm_b32 v29, v91, v90, s14
  v_exp_f32 v92, v92
  v_mfma_f32_32x32x16_bf16 v[112:127], v[40:43], v[24:27], v[112:127]
  buffer_load_dwordx4 v[216:219], v250, s[64:67], s87 offen offset:1024
  v_exp_f32 v93, v93
  v_exp_f32 v94, v94
  v_exp_f32 v95, v95
  v_perm_b32 v30, v93, v92, s14
  v_perm_b32 v31, v95, v94, s14
  v_exp_f32 v64, v64
  v_exp_f32 v65, v65
  v_mfma_f32_32x32x16_bf16 v[112:127], v[44:47], v[28:31], v[112:127]
  ds_read_b128 v[32:35], v164 offset:19968
  v_exp_f32 v66, v66
  v_exp_f32 v67, v67
  v_perm_b32 v24, v65, v64, s14
  v_perm_b32 v25, v67, v66, s14
  v_exp_f32 v68, v68
  v_mfma_f32_32x32x8_bf16 v[80:95], v[58:59], v[150:151], 0
  v_exp_f32 v69, v69
  v_exp_f32 v70, v70
  v_exp_f32 v71, v71
  v_perm_b32 v26, v69, v68, s14
  v_perm_b32 v27, v71, v70, s14
  v_exp_f32 v72, v72
  v_mfma_f32_32x32x16_bf16 v[80:95], v[36:39], v[132:135], v[80:95]
  ds_read_b128 v[40:43], v165 offset:20992
  v_exp_f32 v73, v73
  v_exp_f32 v74, v74
  v_exp_f32 v75, v75
  v_perm_b32 v28, v73, v72, s14
  v_perm_b32 v29, v75, v74, s14
  v_exp_f32 v76, v76
  v_mfma_f32_32x32x16_bf16 v[96:111], v[48:51], v[24:27], v[96:111]
  ds_read_b128 v[44:47], v165 offset:21600
  v_exp_f32 v77, v77
  v_exp_f32 v78, v78
  v_exp_f32 v79, v79
  v_perm_b32 v30, v77, v76, s14
  v_perm_b32 v31, v79, v78, s14
  v_exp_f32 v80, v80
  v_exp_f32 v81, v81
  v_mfma_f32_32x32x16_bf16 v[96:111], v[52:55], v[28:31], v[96:111]
  buffer_load_dwordx4 v[220:223], v250, s[64:67], s87 offen offset:2048
  v_exp_f32 v82, v82
  v_exp_f32 v83, v83
  v_perm_b32 v24, v81, v80, s14
  v_perm_b32 v25, v83, v82, s14
  v_exp_f32 v84, v84
  v_mfma_f32_32x32x8_bf16 v[64:79], v[60:61], v[136:137], 0
  s_waitcnt lgkmcnt(0)
  v_exp_f32 v85, v85
  v_exp_f32 v86, v86
  v_exp_f32 v87, v87
  v_perm_b32 v26, v85, v84, s14
  v_perm_b32 v27, v87, v86, s14
  v_exp_f32 v88, v88
  v_mfma_f32_32x32x16_bf16 v[64:79], v[32:35], v[128:131], v[64:79]
  buffer_load_dwordx4 v[224:227], v250, s[64:67], s87 offen offset:3072
  v_exp_f32 v89, v89
  v_exp_f32 v90, v90
  v_exp_f32 v91, v91
  v_perm_b32 v28, v89, v88, s14
  v_perm_b32 v29, v91, v90, s14
  v_exp_f32 v92, v92
  v_mfma_f32_32x32x16_bf16 v[112:127], v[48:51], v[24:27], v[112:127]
  v_exp_f32 v93, v93
  v_exp_f32 v94, v94
  v_exp_f32 v95, v95
  v_perm_b32 v30, v93, v92, s14
  v_perm_b32 v31, v95, v94, s14
  v_exp_f32 v64, v64
  v_exp_f32 v65, v65
  v_mfma_f32_32x32x16_bf16 v[112:127], v[52:55], v[28:31], v[112:127]
  ds_read_b128 v[36:39], v164 offset:22208
  v_exp_f32 v66, v66
  v_exp_f32 v67, v67
  v_perm_b32 v24, v65, v64, s14
  v_perm_b32 v25, v67, v66, s14
  v_exp_f32 v68, v68
  v_mfma_f32_32x32x8_bf16 v[80:95], v[60:61], v[144:145], 0
  s_waitcnt vmcnt(8)
  v_exp_f32 v69, v69
  v_exp_f32 v70, v70
  v_exp_f32 v71, v71
  v_mfma_f32_16x16x32_bf16 v[188:191], v[152:155], v[228:231], v[188:191]
  v_perm_b32 v26, v69, v68, s14
  v_perm_b32 v27, v71, v70, s14
  v_exp_f32 v72, v72
  v_mfma_f32_32x32x16_bf16 v[80:95], v[32:35], v[132:135], v[80:95]
  ds_read_b128 v[48:51], v165 offset:23232
  v_exp_f32 v73, v73
  v_exp_f32 v74, v74
  v_exp_f32 v75, v75
  v_mfma_f32_16x16x32_bf16 v[172:175], v[152:155], v[232:235], v[172:175]
  v_perm_b32 v28, v73, v72, s14
  v_perm_b32 v29, v75, v74, s14
  v_exp_f32 v76, v76
  v_mfma_f32_32x32x16_bf16 v[96:111], v[40:43], v[24:27], v[96:111]
  ds_read_b128 v[52:55], v165 offset:23840
  v_exp_f32 v77, v77
  v_exp_f32 v78, v78
  v_exp_f32 v79, v79
  v_perm_b32 v30, v77, v76, s14
  v_perm_b32 v31, v79, v78, s14
  v_exp_f32 v80, v80
  v_exp_f32 v81, v81
  v_mfma_f32_32x32x16_bf16 v[96:111], v[44:47], v[28:31], v[96:111]
  v_min_u32 v243, 17, v0
  v_lshlrev_b32 v243, 7, v243
  buffer_load_dword v253, v243, s[64:67], s96 offen sc1
  v_exp_f32 v82, v82
  v_exp_f32 v83, v83
  v_perm_b32 v24, v81, v80, s14
  v_perm_b32 v25, v83, v82, s14
  v_exp_f32 v84, v84
  v_mfma_f32_32x32x8_bf16 v[64:79], v[60:61], v[138:139], 0
  s_waitcnt lgkmcnt(0)
  v_exp_f32 v85, v85
  v_exp_f32 v86, v86
  v_exp_f32 v87, v87
  v_mfma_f32_16x16x32_bf16 v[176:179], v[152:155], v[192:195], v[176:179]
  v_perm_b32 v26, v85, v84, s14
  v_perm_b32 v27, v87, v86, s14
  v_exp_f32 v88, v88
  v_mfma_f32_32x32x16_bf16 v[64:79], v[36:39], v[128:131], v[64:79]
  v_exp_f32 v89, v89
  v_exp_f32 v90, v90
  v_exp_f32 v91, v91
  v_perm_b32 v28, v89, v88, s14
  v_perm_b32 v29, v91, v90, s14
  v_exp_f32 v92, v92
  v_mfma_f32_32x32x16_bf16 v[112:127], v[40:43], v[24:27], v[112:127]
  buffer_load_dwordx4 v[192:195], v167, s[64:67], s87 offen
  v_exp_f32 v93, v93
  v_exp_f32 v94, v94
  v_exp_f32 v95, v95
  v_perm_b32 v30, v93, v92, s14
  v_perm_b32 v31, v95, v94, s14
  v_exp_f32 v64, v64
  v_exp_f32 v65, v65
  v_mfma_f32_32x32x16_bf16 v[112:127], v[44:47], v[28:31], v[112:127]
  ds_read_b128 v[32:35], v164 offset:24448
  v_exp_f32 v66, v66
  v_exp_f32 v67, v67
  v_perm_b32 v24, v65, v64, s14
  v_perm_b32 v25, v67, v66, s14
  v_exp_f32 v68, v68
  v_mfma_f32_32x32x8_bf16 v[80:95], v[60:61], v[146:147], 0
  s_add_u32 s87, s82, s15
  v_exp_f32 v69, v69
  v_exp_f32 v70, v70
  v_exp_f32 v71, v71
  v_perm_b32 v26, v69, v68, s14
  v_perm_b32 v27, v71, v70, s14
  v_exp_f32 v72, v72
  v_mfma_f32_32x32x16_bf16 v[80:95], v[36:39], v[132:135], v[80:95]
  ds_read_b128 v[40:43], v165 offset:25472
  v_exp_f32 v73, v73
  v_exp_f32 v74, v74
  v_exp_f32 v75, v75
  v_perm_b32 v28, v73, v72, s14
  v_perm_b32 v29, v75, v74, s14
  v_exp_f32 v76, v76
  v_mfma_f32_32x32x16_bf16 v[96:111], v[48:51], v[24:27], v[96:111]
  ds_read_b128 v[44:47], v165 offset:26080
  v_exp_f32 v77, v77
  v_exp_f32 v78, v78
  v_exp_f32 v79, v79
  v_perm_b32 v30, v77, v76, s14
  v_perm_b32 v31, v79, v78, s14
  v_exp_f32 v80, v80
  v_exp_f32 v81, v81
  v_mfma_f32_32x32x16_bf16 v[96:111], v[52:55], v[28:31], v[96:111]
  buffer_load_dwordx4 v[228:231], v245, s[64:67], s87 offen
  v_exp_f32 v82, v82
  v_exp_f32 v83, v83
  v_perm_b32 v24, v81, v80, s14
  v_perm_b32 v25, v83, v82, s14
  v_exp_f32 v84, v84
  v_mfma_f32_32x32x8_bf16 v[64:79], v[62:63], v[136:137], 0
  s_waitcnt lgkmcnt(0)
  v_exp_f32 v85, v85
  v_exp_f32 v86, v86
  v_exp_f32 v87, v87
  v_perm_b32 v26, v85, v84, s14
  v_perm_b32 v27, v87, v86, s14
  v_exp_f32 v88, v88
  v_mfma_f32_32x32x16_bf16 v[64:79], v[32:35], v[128:131], v[64:79]
  buffer_load_dwordx4 v[232:235], v245, s[64:67], s87 offen offset:1024
  v_exp_f32 v89, v89
  v_exp_f32 v90, v90
  v_exp_f32 v91, v91
  v_perm_b32 v28, v89, v88, s14
  v_perm_b32 v29, v91, v90, s14
  v_exp_f32 v92, v92
  v_mfma_f32_32x32x16_bf16 v[112:127], v[48:51], v[24:27], v[112:127]
  v_exp_f32 v93, v93
  v_exp_f32 v94, v94
  v_exp_f32 v95, v95
  v_perm_b32 v30, v93, v92, s14
  v_perm_b32 v31, v95, v94, s14
  v_exp_f32 v64, v64
  v_exp_f32 v65, v65
  v_mfma_f32_32x32x16_bf16 v[112:127], v[52:55], v[28:31], v[112:127]
  ds_read_b128 v[36:39], v164 offset:26688
  v_exp_f32 v66, v66
  v_exp_f32 v67, v67
  v_perm_b32 v24, v65, v64, s14
  v_perm_b32 v25, v67, v66, s14
  v_exp_f32 v68, v68
  v_mfma_f32_32x32x8_bf16 v[80:95], v[62:63], v[144:145], 0
  s_waitcnt vmcnt(8)
  v_exp_f32 v69, v69
  v_exp_f32 v70, v70
  v_exp_f32 v71, v71
  v_mfma_f32_16x16x32_bf16 v[180:183], v[152:155], v[196:199], v[180:183]
  v_perm_b32 v26, v69, v68, s14
  v_perm_b32 v27, v71, v70, s14
  v_exp_f32 v72, v72
  v_mfma_f32_32x32x16_bf16 v[80:95], v[32:35], v[132:135], v[80:95]
  ds_read_b128 v[48:51], v165 offset:27712
  v_exp_f32 v73, v73
  v_exp_f32 v74, v74
  v_exp_f32 v75, v75
  v_mfma_f32_16x16x32_bf16 v[184:187], v[152:155], v[200:203], v[184:187]
  v_perm_b32 v28, v73, v72, s14
  v_perm_b32 v29, v75, v74, s14
  v_exp_f32 v76, v76
  v_mfma_f32_32x32x16_bf16 v[96:111], v[40:43], v[24:27], v[96:111]
  ds_read_b128 v[52:55], v165 offset:28320
  v_exp_f32 v77, v77
  v_exp_f32 v78, v78
  v_exp_f32 v79, v79
  v_perm_b32 v30, v77, v76, s14
  v_perm_b32 v31, v79, v78, s14
  v_exp_f32 v80, v80
  v_exp_f32 v81, v81
  v_mfma_f32_32x32x16_bf16 v[96:111], v[44:47], v[28:31], v[96:111]
  v_exp_f32 v82, v82
  v_exp_f32 v83, v83
  v_perm_b32 v24, v81, v80, s14
  v_perm_b32 v25, v83, v82, s14
  v_exp_f32 v84, v84
  v_mfma_f32_32x32x8_bf16 v[64:79], v[62:63], v[138:139], 0
  s_waitcnt lgkmcnt(0)
  v_exp_f32 v85, v85
  v_exp_f32 v86, v86
  v_exp_f32 v87, v87
  v_perm_b32 v26, v85, v84, s14
  v_perm_b32 v27, v87, v86, s14
  v_exp_f32 v88, v88
  v_mfma_f32_32x32x16_bf16 v[64:79], v[36:39], v[128:131], v[64:79]
  v_exp_f32 v89, v89
  v_exp_f32 v90, v90
  v_exp_f32 v91, v91
  v_perm_b32 v28, v89, v88, s14
  v_perm_b32 v29, v91, v90, s14
  v_exp_f32 v92, v92
  v_mfma_f32_32x32x16_bf16 v[112:127], v[40:43], v[24:27], v[112:127]
  buffer_load_dwordx4 v[196:199], v245, s[64:67], s87 offen offset:2048
  v_exp_f32 v93, v93
  v_exp_f32 v94, v94
  v_exp_f32 v95, v95
  v_perm_b32 v30, v93, v92, s14
  v_perm_b32 v31, v95, v94, s14
  v_exp_f32 v64, v64
  v_exp_f32 v65, v65
  v_mfma_f32_32x32x16_bf16 v[112:127], v[44:47], v[28:31], v[112:127]
  ds_read_b128 v[32:35], v164 offset:28928
  v_exp_f32 v66, v66
  v_exp_f32 v67, v67
  v_perm_b32 v24, v65, v64, s14
  v_perm_b32 v25, v67, v66, s14
  v_exp_f32 v68, v68
  v_mfma_f32_32x32x8_bf16 v[80:95], v[62:63], v[146:147], 0
  v_exp_f32 v69, v69
  v_exp_f32 v70, v70
  v_exp_f32 v71, v71
  v_perm_b32 v26, v69, v68, s14
  v_perm_b32 v27, v71, v70, s14
  v_exp_f32 v72, v72
  v_mfma_f32_32x32x16_bf16 v[80:95], v[36:39], v[132:135], v[80:95]
  ds_read_b128 v[40:43], v165 offset:29952
  v_exp_f32 v73, v73
  v_exp_f32 v74, v74
  v_exp_f32 v75, v75
  v_perm_b32 v28, v73, v72, s14
  v_perm_b32 v29, v75, v74, s14
  v_exp_f32 v76, v76
  v_mfma_f32_32x32x16_bf16 v[96:111], v[48:51], v[24:27], v[96:111]
  ds_read_b128 v[44:47], v165 offset:30560
  v_exp_f32 v77, v77
  v_exp_f32 v78, v78
  v_exp_f32 v79, v79
  v_perm_b32 v30, v77, v76, s14
  v_perm_b32 v31, v79, v78, s14
  v_exp_f32 v80, v80
  v_exp_f32 v81, v81
  v_mfma_f32_32x32x16_bf16 v[96:111], v[52:55], v[28:31], v[96:111]
  buffer_load_dwordx4 v[200:203], v245, s[64:67], s87 offen offset:3072
  v_exp_f32 v82, v82
  v_exp_f32 v83, v83
  v_perm_b32 v24, v81, v80, s14
  v_perm_b32 v25, v83, v82, s14
  v_exp_f32 v84, v84
  v_mfma_f32_32x32x8_bf16 v[64:79], v[60:61], v[140:141], 0
  s_waitcnt lgkmcnt(0)
  v_exp_f32 v85, v85
  v_exp_f32 v86, v86
  v_exp_f32 v87, v87
  v_perm_b32 v26, v85, v84, s14
  v_perm_b32 v27, v87, v86, s14
  v_exp_f32 v88, v88
  v_mfma_f32_32x32x16_bf16 v[64:79], v[32:35], v[128:131], v[64:79]
  buffer_load_dwordx4 v[152:155], v248, s[64:67], s87 offen
  v_exp_f32 v89, v89
  v_exp_f32 v90, v90
  v_exp_f32 v91, v91
  v_perm_b32 v28, v89, v88, s14
  v_perm_b32 v29, v91, v90, s14
  v_exp_f32 v92, v92
  v_mfma_f32_32x32x16_bf16 v[112:127], v[48:51], v[24:27], v[112:127]
  v_exp_f32 v93, v93
  v_exp_f32 v94, v94
  v_exp_f32 v95, v95
  v_perm_b32 v30, v93, v92, s14
  v_perm_b32 v31, v95, v94, s14
  v_exp_f32 v64, v64
  v_exp_f32 v65, v65
  v_mfma_f32_32x32x16_bf16 v[112:127], v[52:55], v[28:31], v[112:127]
  ds_read_b128 v[36:39], v164 offset:31168
  v_exp_f32 v66, v66
  v_exp_f32 v67, v67
  v_perm_b32 v24, v65, v64, s14
  v_perm_b32 v25, v67, v66, s14
  v_exp_f32 v68, v68
  v_mfma_f32_32x32x8_bf16 v[80:95], v[60:61], v[148:149], 0
  v_exp_f32 v69, v69
  v_exp_f32 v70, v70
  v_exp_f32 v71, v71
  v_perm_b32 v26, v69, v68, s14
  v_perm_b32 v27, v71, v70, s14
  v_exp_f32 v72, v72
  v_mfma_f32_32x32x16_bf16 v[80:95], v[32:35], v[132:135], v[80:95]
  ds_read_b128 v[48:51], v165 offset:32192
  v_exp_f32 v73, v73
  v_exp_f32 v74, v74
  v_exp_f32 v75, v75
  v_perm_b32 v28, v73, v72, s14
  v_perm_b32 v29, v75, v74, s14
  v_exp_f32 v76, v76
  v_mfma_f32_32x32x16_bf16 v[96:111], v[40:43], v[24:27], v[96:111]
  ds_read_b128 v[52:55], v165 offset:32800
  v_exp_f32 v77, v77
  v_exp_f32 v78, v78
  v_exp_f32 v79, v79
  v_perm_b32 v30, v77, v76, s14
  v_perm_b32 v31, v79, v78, s14
  v_exp_f32 v80, v80
  v_exp_f32 v81, v81
  v_mfma_f32_32x32x16_bf16 v[96:111], v[44:47], v[28:31], v[96:111]
  v_exp_f32 v82, v82
  v_exp_f32 v83, v83
  v_perm_b32 v24, v81, v80, s14
  v_perm_b32 v25, v83, v82, s14
  v_exp_f32 v84, v84
  v_mfma_f32_32x32x8_bf16 v[64:79], v[60:61], v[142:143], 0
  s_waitcnt lgkmcnt(0)
  v_exp_f32 v85, v85
  v_exp_f32 v86, v86
  v_exp_f32 v87, v87
  v_perm_b32 v26, v85, v84, s14
  v_perm_b32 v27, v87, v86, s14
  v_exp_f32 v88, v88
  v_mfma_f32_32x32x16_bf16 v[64:79], v[36:39], v[128:131], v[64:79]
  v_exp_f32 v89, v89
  v_exp_f32 v90, v90
  v_exp_f32 v91, v91
  v_perm_b32 v28, v89, v88, s14
  v_perm_b32 v29, v91, v90, s14
  v_exp_f32 v92, v92
  v_mfma_f32_32x32x16_bf16 v[112:127], v[40:43], v[24:27], v[112:127]
  v_exp_f32 v93, v93
  v_exp_f32 v94, v94
  v_exp_f32 v95, v95
  v_perm_b32 v30, v93, v92, s14
  v_perm_b32 v31, v95, v94, s14
  v_exp_f32 v64, v64
  v_exp_f32 v65, v65
  v_mfma_f32_32x32x16_bf16 v[112:127], v[44:47], v[28:31], v[112:127]
  ds_read_b128 v[32:35], v164 offset:33408
  v_exp_f32 v66, v66
  v_exp_f32 v67, v67
  v_perm_b32 v24, v65, v64, s14
  v_perm_b32 v25, v67, v66, s14
  v_exp_f32 v68, v68
  v_mfma_f32_32x32x8_bf16 v[80:95], v[60:61], v[150:151], 0
  v_exp_f32 v69, v69
  v_exp_f32 v70, v70
  v_exp_f32 v71, v71
  v_perm_b32 v26, v69, v68, s14
  v_perm_b32 v27, v71, v70, s14
  v_exp_f32 v72, v72
  v_mfma_f32_32x32x16_bf16 v[80:95], v[36:39], v[132:135], v[80:95]
  ds_read_b128 v[40:43], v165 offset:34432
  v_exp_f32 v73, v73
  v_exp_f32 v74, v74
  v_exp_f32 v75, v75
  v_perm_b32 v28, v73, v72, s14
  v_perm_b32 v29, v75, v74, s14
  v_exp_f32 v76, v76
  v_mfma_f32_32x32x16_bf16 v[96:111], v[48:51], v[24:27], v[96:111]
  ds_read_b128 v[44:47], v165 offset:35040
  v_exp_f32 v77, v77
  v_exp_f32 v78, v78
  v_exp_f32 v79, v79
  v_perm_b32 v30, v77, v76, s14
  v_perm_b32 v31, v79, v78, s14
  v_exp_f32 v80, v80
  v_exp_f32 v81, v81
  v_mfma_f32_32x32x16_bf16 v[96:111], v[52:55], v[28:31], v[96:111]
  v_exp_f32 v82, v82
  v_exp_f32 v83, v83
  v_perm_b32 v24, v81, v80, s14
  v_perm_b32 v25, v83, v82, s14
  v_exp_f32 v84, v84
  v_mfma_f32_32x32x8_bf16 v[64:79], v[62:63], v[140:141], 0
  s_waitcnt lgkmcnt(0)
  v_exp_f32 v85, v85
  v_exp_f32 v86, v86
  v_exp_f32 v87, v87
  v_perm_b32 v26, v85, v84, s14
  v_perm_b32 v27, v87, v86, s14
  v_exp_f32 v88, v88
  v_mfma_f32_32x32x16_bf16 v[64:79], v[32:35], v[128:131], v[64:79]
  v_exp_f32 v89, v89
  v_exp_f32 v90, v90
  v_exp_f32 v91, v91
  v_perm_b32 v28, v89, v88, s14
  v_perm_b32 v29, v91, v90, s14
  v_exp_f32 v92, v92
  v_mfma_f32_32x32x16_bf16 v[112:127], v[48:51], v[24:27], v[112:127]
  v_exp_f32 v93, v93
  v_exp_f32 v94, v94
  v_exp_f32 v95, v95
  v_perm_b32 v30, v93, v92, s14
  v_perm_b32 v31, v95, v94, s14
  v_exp_f32 v64, v64
  v_exp_f32 v65, v65
  v_mfma_f32_32x32x16_bf16 v[112:127], v[52:55], v[28:31], v[112:127]
  ds_read_b128 v[36:39], v164 offset:35648
  v_exp_f32 v66, v66
  v_exp_f32 v67, v67
  v_perm_b32 v24, v65, v64, s14
  v_perm_b32 v25, v67, v66, s14
  v_exp_f32 v68, v68
  v_mfma_f32_32x32x8_bf16 v[80:95], v[62:63], v[148:149], 0
  v_exp_f32 v69, v69
  v_exp_f32 v70, v70
  v_exp_f32 v71, v71
  v_perm_b32 v26, v69, v68, s14
  v_perm_b32 v27, v71, v70, s14
  v_exp_f32 v72, v72
  v_mfma_f32_32x32x16_bf16 v[80:95], v[32:35], v[132:135], v[80:95]
  ds_read_b128 v[48:51], v165 offset:36672
  v_exp_f32 v73, v73
  v_exp_f32 v74, v74
  v_exp_f32 v75, v75
  v_perm_b32 v28, v73, v72, s14
  v_perm_b32 v29, v75, v74, s14
  v_exp_f32 v76, v76
  v_mfma_f32_32x32x16_bf16 v[96:111], v[40:43], v[24:27], v[96:111]
  ds_read_b128 v[52:55], v165 offset:37280
  v_exp_f32 v77, v77
  v_exp_f32 v78, v78
  v_exp_f32 v79, v79
  v_perm_b32 v30, v77, v76, s14
  v_perm_b32 v31, v79, v78, s14
  v_exp_f32 v80, v80
  v_exp_f32 v81, v81
  v_mfma_f32_32x32x16_bf16 v[96:111], v[44:47], v[28:31], v[96:111]
  v_exp_f32 v82, v82
  v_exp_f32 v83, v83
  v_perm_b32 v24, v81, v80, s14
  v_perm_b32 v25, v83, v82, s14
  v_exp_f32 v84, v84
  v_mfma_f32_32x32x8_bf16 v[64:79], v[62:63], v[142:143], 0
  s_waitcnt lgkmcnt(0)
  v_exp_f32 v85, v85
  v_exp_f32 v86, v86
  v_exp_f32 v87, v87
  v_perm_b32 v26, v85, v84, s14
  v_perm_b32 v27, v87, v86, s14
  v_exp_f32 v88, v88
  v_mfma_f32_32x32x16_bf16 v[64:79], v[36:39], v[128:131], v[64:79]
  v_exp_f32 v89, v89
  v_exp_f32 v90, v90
  v_exp_f32 v91, v91
  v_perm_b32 v28, v89, v88, s14
  v_perm_b32 v29, v91, v90, s14
  v_exp_f32 v92, v92
  v_mfma_f32_32x32x16_bf16 v[112:127], v[40:43], v[24:27], v[112:127]
  v_exp_f32 v93, v93
  v_exp_f32 v94, v94
  v_exp_f32 v95, v95
  v_perm_b32 v30, v93, v92, s14
  v_perm_b32 v31, v95, v94, s14
  v_exp_f32 v64, v64
  v_exp_f32 v65, v65
  v_mfma_f32_32x32x16_bf16 v[112:127], v[44:47], v[28:31], v[112:127]
  v_exp_f32 v66, v66
  v_exp_f32 v67, v67
  v_perm_b32 v24, v65, v64, s14
  v_perm_b32 v25, v67, v66, s14
  v_exp_f32 v68, v68
  v_mfma_f32_32x32x8_bf16 v[80:95], v[62:63], v[150:151], 0
  v_exp_f32 v69, v69
  v_exp_f32 v70, v70
  v_exp_f32 v71, v71
  v_perm_b32 v26, v69, v68, s14
  v_perm_b32 v27, v71, v70, s14
  v_exp_f32 v72, v72
  v_mfma_f32_32x32x16_bf16 v[80:95], v[36:39], v[132:135], v[80:95]
  v_exp_f32 v73, v73
  v_exp_f32 v74, v74
  v_exp_f32 v75, v75
  v_perm_b32 v28, v73, v72, s14
  v_perm_b32 v29, v75, v74, s14
  v_exp_f32 v76, v76
  v_mfma_f32_32x32x16_bf16 v[96:111], v[48:51], v[24:27], v[96:111]
  v_exp_f32 v77, v77
  v_exp_f32 v78, v78
  v_exp_f32 v79, v79
  v_perm_b32 v30, v77, v76, s14
  v_perm_b32 v31, v79, v78, s14
  v_exp_f32 v80, v80
  v_exp_f32 v81, v81
  v_mfma_f32_32x32x16_bf16 v[96:111], v[52:55], v[28:31], v[96:111]
  v_exp_f32 v82, v82
  v_exp_f32 v83, v83
  v_perm_b32 v24, v81, v80, s14
  v_perm_b32 v25, v83, v82, s14
  v_exp_f32 v84, v84
  v_exp_f32 v85, v85
  v_exp_f32 v86, v86
  v_exp_f32 v87, v87
  v_perm_b32 v26, v85, v84, s14
  v_perm_b32 v27, v87, v86, s14
  v_exp_f32 v88, v88
  v_exp_f32 v89, v89
  v_exp_f32 v90, v90
  v_exp_f32 v91, v91
  v_perm_b32 v28, v89, v88, s14
  v_perm_b32 v29, v91, v90, s14
  v_exp_f32 v92, v92
  v_mfma_f32_32x32x16_bf16 v[112:127], v[48:51], v[24:27], v[112:127]
  v_exp_f32 v93, v93
  v_exp_f32 v94, v94
  v_exp_f32 v95, v95
  v_perm_b32 v30, v93, v92, s14
  v_perm_b32 v31, v95, v94, s14
  s_nop 1
  v_mfma_f32_32x32x16_bf16 v[112:127], v[52:55], v[28:31], v[112:127]
  s_lshl_b32 s10, s3, 11
  v_add_u32 v1, s10, v21
  v_and_b32 v2, 15, v0
  v_lshlrev_b32 v2, 4, v2
  v_bfe_u32 v3, v0, 4, 1
  v_lshl_add_u32 v2, v3, 2, v2
  s_lshl_b32 s10, s3, 8
  s_add_u32 s10, s10, 8192
  v_add_u32 v2, s10, v2
  v_lshrrev_b32 v3, 5, v0
  v_lshl_add_u32 v20, v3, 20, v2
  v_lshl_add_u32 v2, v3, 29, v2
  v_add_u32 v20, 154560, v20
  v_mov_b32 v236, v106
  v_mov_b32 v237, v106
  v_mov_b32 v238, v122
  v_mov_b32 v239, v122
  v_permlane32_swap_b32 v236, v237
  s_nop 0
  v_permlane32_swap_b32 v238, v239
  v_subrev_u32 v237, 813694976, v236
  v_subrev_u32 v239, 813694976, v238
  v_max_u32 v237, v237, v239
  v_cmp_lt_u32 vcc, 587202560, v237
  s_nop 0
  s_cmp_lg_u64 vcc, 0
  s_cbranch_scc1 A_fb
A_ok:
  v_rcp_f32 v236, v236
  v_rcp_f32 v238, v238
  v_add_u32 v3, 154560, v1
  v_mul_f32 v236, v236, v251
  v_mul_f32 v238, v238, v251
  v_mul_f32 v96, v96, v236
  v_mul_f32 v97, v97, v236
  v_mul_f32 v98, v98, v236
  v_mul_f32 v99, v99, v236
  v_mul_f32 v100, v100, v236
  v_mul_f32 v101, v101, v236
  v_mul_f32 v102, v102, v236
  v_mul_f32 v103, v103, v236
  v_mul_f32 v104, v104, v236
  v_mul_f32 v105, v105, v236
  v_cvt_pk_bf16_f32 v96, v96, v97
  v_cvt_pk_bf16_f32 v97, v98, v99
  v_cvt_pk_bf16_f32 v98, v100, v101
  v_cvt_pk_bf16_f32 v99, v102, v103
  v_cvt_pk_bf16_f32 v100, v104, v105
  s_cmp_lg_u32 s42, s43
  s_cbranch_scc1 OS0
  buffer_store_dwordx4 v[96:99], v1, s[64:67], s83 offen offset:0
  buffer_store_dword v100, v2, s[64:67], s83 offen offset:0
OS0b:
  ds_write_b128 v3, v[96:99] offset:0
  ds_write_b32 v20, v100 offset:0
  v_mul_f32 v112, v112, v238
  v_mul_f32 v113, v113, v238
  v_mul_f32 v114, v114, v238
  v_mul_f32 v115, v115, v238
  v_mul_f32 v116, v116, v238
  v_mul_f32 v117, v117, v238
  v_mul_f32 v118, v118, v238
  v_mul_f32 v119, v119, v238
  v_mul_f32 v120, v120, v238
  v_mul_f32 v121, v121, v238
  v_cvt_pk_bf16_f32 v112, v112, v113
  v_cvt_pk_bf16_f32 v113, v114, v115
  v_cvt_pk_bf16_f32 v114, v116, v117
  v_cvt_pk_bf16_f32 v115, v118, v119
  v_cvt_pk_bf16_f32 v116, v120, v121
  s_cmp_lg_u32 s42, s43
  s_cbranch_scc1 OS1
  buffer_store_dwordx4 v[112:115], v1, s[64:67], s83 offen offset:1024
  buffer_store_dword v116, v2, s[64:67], s83 offen offset:8
OS1b:
  ds_write_b128 v3, v[112:115] offset:1024
  ds_write_b32 v20, v116 offset:8
  v_sub_f32 v251, 1.0, v251
  v_add_u32 v240, 154560, v245
  v_add_u32 v241, 154560, v250
  v_add_u32 v242, 154560, v167
  s_waitcnt lgkmcnt(0)
  s_barrier
  ds_read_b128 v[24:27], v240 offset:0
  ds_read_b128 v[28:31], v240 offset:1024
  ds_read_b128 v[32:35], v240 offset:2048
  ds_read_b128 v[36:39], v240 offset:3072
  ds_read_b128 v[40:43], v241 offset:0
PAD16:
  s_cbranch_execz HOPBACK
  ds_read_b128 v[44:47], v241 offset:1024
  ds_read_b128 v[48:51], v241 offset:2048
  ds_read_b128 v[52:55], v241 offset:3072
  ds_read_b128 v[56:59], v242 offset:0
  v_mul_f32 v172, v172, v251
  v_mul_f32 v173, v173, v251
  v_mul_f32 v174, v174, v251
  v_mul_f32 v175, v175, v251
  v_mul_f32 v176, v176, v251
  v_mul_f32 v177, v177, v251
  v_mul_f32 v178, v178, v251
  v_mul_f32 v179, v179, v251
  v_mul_f32 v180, v180, v251
  v_mul_f32 v181, v181, v251
  v_mul_f32 v182, v182, v251
  v_mul_f32 v183, v183, v251
  v_mul_f32 v184, v184, v251
  v_mul_f32 v185, v185, v251
  v_mul_f32 v186, v186, v251
  v_mul_f32 v187, v187, v251
  v_mul_f32 v188, v188, v251
  v_mul_f32 v189, v189, v251
  v_mul_f32 v190, v190, v251
  v_mul_f32 v191, v191, v251
  s_waitcnt lgkmcnt(8)
  v_mfma_f32_16x16x32_bf16 v[172:175], a[144:147], v[24:27], v[172:175]
  v_and_b32 v20, 15, v0
  s_waitcnt lgkmcnt(7)
  v_mfma_f32_16x16x32_bf16 v[172:175], a[148:151], v[28:31], v[172:175]
  v_mul_u32_u24 v20, 1152, v20
  s_waitcnt lgkmcnt(6)
  v_mfma_f32_16x16x32_bf16 v[172:175], a[152:155], v[32:35], v[172:175]
  v_and_b32 v3, 48, v0
  s_waitcnt lgkmcnt(5)
  v_mfma_f32_16x16x32_bf16 v[172:175], a[156:159], v[36:39], v[172:175]
  v_add_u32 v20, v20, v3
  s_waitcnt lgkmcnt(4)
  v_mfma_f32_16x16x32_bf16 v[172:175], a[160:163], v[40:43], v[172:175]
  s_mul_i32 s10, s6, 18432
  s_waitcnt lgkmcnt(3)
  v_mfma_f32_16x16x32_bf16 v[172:175], a[164:167], v[44:47], v[172:175]
  s_mul_i32 s11, s7, 576
  s_waitcnt lgkmcnt(2)
  v_mfma_f32_16x16x32_bf16 v[172:175], a[168:171], v[48:51], v[172:175]
  s_add_u32 s10, s10, s11
  s_waitcnt lgkmcnt(1)
  v_mfma_f32_16x16x32_bf16 v[172:175], a[172:175], v[52:55], v[172:175]
  s_lshl_b32 s11, s3, 7
  s_waitcnt lgkmcnt(0)
  v_mfma_f32_16x16x32_bf16 v[172:175], a[176:179], v[56:59], v[172:175]
  s_add_u32 s11, s11, s10
  v_mfma_f32_16x16x32_bf16 v[176:179], a[180:183], v[24:27], v[176:179]
  s_and_b32 s12, s3, 1
  v_mfma_f32_16x16x32_bf16 v[176:179], a[184:187], v[28:31], v[176:179]
  s_lshl_b32 s12, s12, 4
  v_mfma_f32_16x16x32_bf16 v[176:179], a[188:191], v[32:35], v[176:179]
  buffer_load_dwordx4 v[128:131], v245, s[64:67], s84 offen sc1
  v_mfma_f32_16x16x32_bf16 v[176:179], a[192:195], v[36:39], v[176:179]
  s_add_u32 s10, s10, s12
  v_mfma_f32_16x16x32_bf16 v[176:179], a[196:199], v[40:43], v[176:179]
  buffer_load_dwordx4 v[132:135], v245, s[64:67], s84 offen offset:1024 sc1
  v_mfma_f32_16x16x32_bf16 v[176:179], a[200:203], v[44:47], v[176:179]
  s_and_b32 s12, s72, 1073741824
  v_mfma_f32_16x16x32_bf16 v[176:179], a[204:207], v[48:51], v[176:179]
  buffer_load_dwordx4 v[136:139], v245, s[64:67], s84 offen offset:2048 sc1
  v_mfma_f32_16x16x32_bf16 v[176:179], a[208:211], v[52:55], v[176:179]
  v_and_b32 v3, 16, v0
  v_mfma_f32_16x16x32_bf16 v[176:179], a[212:215], v[56:59], v[176:179]
  buffer_load_dwordx4 v[140:143], v245, s[64:67], s84 offen offset:3072 sc1
  v_mfma_f32_16x16x32_bf16 v[180:183], a[216:219], v[24:27], v[180:183]
  v_lshrrev_b32 v3, 1, v3
  v_mfma_f32_16x16x32_bf16 v[180:183], a[220:223], v[28:31], v[180:183]
  buffer_load_dwordx4 v[144:147], v250, s[64:67], s84 offen sc1
  v_mfma_f32_16x16x32_bf16 v[180:183], a[224:227], v[32:35], v[180:183]
  v_sub_u32 v3, v20, v3
  v_mfma_f32_16x16x32_bf16 v[180:183], a[228:231], v[36:39], v[180:183]
  buffer_load_dwordx4 v[148:151], v250, s[64:67], s84 offen offset:1024 sc1
  v_mfma_f32_16x16x32_bf16 v[180:183], a[232:235], v[40:43], v[180:183]
  v_add_u32 v3, s12, v3
  v_mfma_f32_16x16x32_bf16 v[180:183], a[236:239], v[44:47], v[180:183]
  buffer_load_dwordx4 v[64:67], v250, s[64:67], s84 offen offset:2048 sc1
  v_mfma_f32_16x16x32_bf16 v[180:183], a[240:243], v[48:51], v[180:183]
  s_mov_b32 s85, 0
  v_mfma_f32_16x16x32_bf16 v[180:183], a[244:247], v[52:55], v[180:183]
  buffer_load_dwordx4 v[68:71], v250, s[64:67], s84 offen offset:3072 sc1
  v_mfma_f32_16x16x32_bf16 v[180:183], a[248:251], v[56:59], v[180:183]
  v_mfma_f32_16x16x32_bf16 v[184:187], a[252:255], v[24:27], v[184:187]
  buffer_load_dwordx4 v[72:75], v167, s[64:67], s84 offen sc1
  v_mfma_f32_16x16x32_bf16 v[184:187], a[0:3], v[28:31], v[184:187]
  v_mfma_f32_16x16x32_bf16 v[184:187], a[4:7], v[32:35], v[184:187]
  v_mfma_f32_16x16x32_bf16 v[184:187], a[8:11], v[36:39], v[184:187]
  v_mfma_f32_16x16x32_bf16 v[184:187], a[12:15], v[40:43], v[184:187]
  v_mfma_f32_16x16x32_bf16 v[184:187], a[16:19], v[44:47], v[184:187]
  v_mfma_f32_16x16x32_bf16 v[184:187], a[20:23], v[48:51], v[184:187]
  v_mfma_f32_16x16x32_bf16 v[184:187], a[24:27], v[52:55], v[184:187]
  v_mfma_f32_16x16x32_bf16 v[184:187], a[28:31], v[56:59], v[184:187]
  v_mfma_f32_16x16x32_bf16 v[188:191], a[32:35], v[24:27], v[188:191]
  v_mfma_f32_16x16x32_bf16 v[188:191], a[36:39], v[28:31], v[188:191]
  v_mfma_f32_16x16x32_bf16 v[188:191], a[40:43], v[32:35], v[188:191]
  v_mfma_f32_16x16x32_bf16 v[188:191], a[44:47], v[36:39], v[188:191]
  v_mfma_f32_16x16x32_bf16 v[188:191], a[48:51], v[40:43], v[188:191]
  s_waitcnt vmcnt(8)
  v_max3_u32 v236, v128, v129, 0
  v_max3_u32 v236, v130, v131, v236
  s_waitcnt vmcnt(7)
  v_max3_u32 v236, v132, v133, v236
  v_max3_u32 v236, v134, v135, v236
  s_waitcnt vmcnt(6)
  v_max3_u32 v236, v136, v137, v236
  v_max3_u32 v236, v138, v139, v236
  s_waitcnt vmcnt(5)
  v_max3_u32 v236, v140, v141, v236
  v_max3_u32 v236, v142, v143, v236
  s_waitcnt vmcnt(4)
  v_max3_u32 v236, v144, v145, v236
  v_max3_u32 v236, v146, v147, v236
  s_waitcnt vmcnt(3)
  v_max3_u32 v236, v148, v149, v236
  v_max3_u32 v236, v150, v151, v236
  s_waitcnt vmcnt(2)
  v_max3_u32 v236, v64, v65, v236
  v_max3_u32 v236, v66, v67, v236
  s_waitcnt vmcnt(1)
  v_max3_u32 v236, v68, v69, v236
  v_max3_u32 v236, v70, v71, v236
  s_waitcnt vmcnt(0)
  v_max3_u32 v236, v72, v73, v236
  v_max3_u32 v236, v74, v75, v236
  v_cmp_eq_u32 vcc, -1, v236
  s_nop 0
  s_cmp_lg_u64 vcc, 0
  s_cbranch_scc1 PO_spin
PO_done:
  v_mfma_f32_16x16x32_bf16 v[188:191], v[228:231], v[128:131], v[188:191]
  v_mfma_f32_16x16x32_bf16 v[188:191], v[232:235], v[132:135], v[188:191]
  v_mfma_f32_16x16x32_bf16 v[188:191], v[196:199], v[136:139], v[188:191]
  v_mfma_f32_16x16x32_bf16 v[188:191], v[200:203], v[140:143], v[188:191]
  v_mfma_f32_16x16x32_bf16 v[188:191], v[152:155], v[144:147], v[188:191]
  v_mfma_f32_16x16x32_bf16 v[172:175], a[52:55], v[128:131], v[172:175]
  v_mfma_f32_16x16x32_bf16 v[172:175], a[56:59], v[132:135], v[172:175]
  v_mfma_f32_16x16x32_bf16 v[172:175], a[60:63], v[136:139], v[172:175]
  v_mfma_f32_16x16x32_bf16 v[172:175], a[64:67], v[140:143], v[172:175]
  v_mfma_f32_16x16x32_bf16 v[172:175], a[68:71], v[144:147], v[172:175]
  v_mfma_f32_16x16x32_bf16 v[172:175], a[72:75], v[148:151], v[172:175]
  v_mfma_f32_16x16x32_bf16 v[172:175], a[76:79], v[64:67], v[172:175]
  v_mfma_f32_16x16x32_bf16 v[172:175], a[80:83], v[68:71], v[172:175]
  ds_write_b128 v1, v[188:191]
  v_mfma_f32_16x16x32_bf16 v[172:175], a[84:87], v[72:75], v[172:175]
  v_mfma_f32_16x16x32_bf16 v[176:179], a[88:91], v[128:131], v[176:179]
  v_xor_b32 v2, 4096, v1
  v_mfma_f32_16x16x32_bf16 v[176:179], a[92:95], v[132:135], v[176:179]
  v_mfma_f32_16x16x32_bf16 v[176:179], a[96:99], v[136:139], v[176:179]
  v_mfma_f32_16x16x32_bf16 v[176:179], a[100:103], v[140:143], v[176:179]
  v_mfma_f32_16x16x32_bf16 v[176:179], a[104:107], v[144:147], v[176:179]
  v_mfma_f32_16x16x32_bf16 v[176:179], a[108:111], v[148:151], v[176:179]
  s_waitcnt lgkmcnt(0)
  s_barrier
  v_mfma_f32_16x16x32_bf16 v[176:179], a[112:115], v[64:67], v[176:179]
  ds_read_b128 v[60:63], v2
  v_mfma_f32_16x16x32_bf16 v[176:179], a[116:119], v[68:71], v[176:179]
  v_cvt_pk_bf16_f32 v172, v172, v173
  v_cvt_pk_bf16_f32 v173, v174, v175
  v_mfma_f32_16x16x32_bf16 v[176:179], a[120:123], v[72:75], v[176:179]
  v_mfma_f32_16x16x32_bf16 v[180:183], a[124:127], v[128:131], v[180:183]
  v_mfma_f32_16x16x32_bf16 v[180:183], a[128:131], v[132:135], v[180:183]
  v_mfma_f32_16x16x32_bf16 v[180:183], a[132:135], v[136:139], v[180:183]
  v_mfma_f32_16x16x32_bf16 v[180:183], a[136:139], v[140:143], v[180:183]
  v_mfma_f32_16x16x32_bf16 v[180:183], a[140:143], v[144:147], v[180:183]
  s_waitcnt lgkmcnt(0)
  v_add_f32 v188, v188, v60
  v_add_f32 v189, v189, v61
  v_mfma_f32_16x16x32_bf16 v[180:183], v[4:7], v[148:151], v[180:183]
  v_add_f32 v190, v190, v62
  v_add_f32 v191, v191, v63
  v_mfma_f32_16x16x32_bf16 v[180:183], v[8:11], v[64:67], v[180:183]
  v_cvt_pk_bf16_f32 v174, v176, v177
  v_cvt_pk_bf16_f32 v175, v178, v179
  v_mfma_f32_16x16x32_bf16 v[180:183], v[12:15], v[68:71], v[180:183]
  v_mfma_f32_16x16x32_bf16 v[180:183], v[16:19], v[72:75], v[180:183]
  v_permlane16_swap_b32 v172, v174
  v_permlane16_swap_b32 v173, v175
  v_mfma_f32_16x16x32_bf16 v[184:187], v[156:159], v[128:131], v[184:187]
  v_cvt_pk_bf16_f32 v188, v188, v189
  v_cvt_pk_bf16_f32 v189, v190, v191
  v_mfma_f32_16x16x32_bf16 v[184:187], v[168:171], v[132:135], v[184:187]
  buffer_store_dwordx2 v[188:189], v3, s[52:55], s10 offen offset:512
  v_mfma_f32_16x16x32_bf16 v[184:187], v[204:207], v[136:139], v[184:187]
  v_mfma_f32_16x16x32_bf16 v[184:187], v[208:211], v[140:143], v[184:187]
  buffer_store_dwordx4 v[172:175], v20, s[52:55], s11 offen
  v_mfma_f32_16x16x32_bf16 v[184:187], v[212:215], v[144:147], v[184:187]
  v_mfma_f32_16x16x32_bf16 v[184:187], v[216:219], v[148:151], v[184:187]
  v_mfma_f32_16x16x32_bf16 v[184:187], v[220:223], v[64:67], v[184:187]
  v_mfma_f32_16x16x32_bf16 v[184:187], v[224:227], v[68:71], v[184:187]
  v_cvt_pk_bf16_f32 v180, v180, v181
  v_cvt_pk_bf16_f32 v181, v182, v183
  v_mfma_f32_16x16x32_bf16 v[184:187], v[192:195], v[72:75], v[184:187]
  s_nop 7
  v_cvt_pk_bf16_f32 v182, v184, v185
  v_cvt_pk_bf16_f32 v183, v186, v187
  s_nop 0
  v_permlane16_swap_b32 v180, v182
  v_permlane16_swap_b32 v181, v183
  buffer_store_dwordx4 v[180:183], v20, s[52:55], s11 offen offset:64
K_exit:
  s_endpgm
PO_spin:
PO_sp2:
  s_add_u32 s85, s85, 1
  s_cmp_gt_u32 s85, 0x8000
  s_cbranch_scc1 PO_done
  buffer_load_dwordx4 v[128:131], v245, s[64:67], s84 offen sc1
  buffer_load_dwordx4 v[132:135], v245, s[64:67], s84 offen offset:1024 sc1
  buffer_load_dwordx4 v[136:139], v245, s[64:67], s84 offen offset:2048 sc1
  buffer_load_dwordx4 v[140:143], v245, s[64:67], s84 offen offset:3072 sc1
  buffer_load_dwordx4 v[144:147], v250, s[64:67], s84 offen sc1
  buffer_load_dwordx4 v[148:151], v250, s[64:67], s84 offen offset:1024 sc1
  buffer_load_dwordx4 v[64:67], v250, s[64:67], s84 offen offset:2048 sc1
  buffer_load_dwordx4 v[68:71], v250, s[64:67], s84 offen offset:3072 sc1
  buffer_load_dwordx4 v[72:75], v167, s[64:67], s84 offen sc1
  s_waitcnt vmcnt(0)
  v_max3_u32 v236, v128, v129, 0
  v_max3_u32 v236, v130, v131, v236
  v_max3_u32 v236, v132, v133, v236
  v_max3_u32 v236, v134, v135, v236
  v_max3_u32 v236, v136, v137, v236
  v_max3_u32 v236, v138, v139, v236
  v_max3_u32 v236, v140, v141, v236
  v_max3_u32 v236, v142, v143, v236
  v_max3_u32 v236, v144, v145, v236
  v_max3_u32 v236, v146, v147, v236
  v_max3_u32 v236, v148, v149, v236
  v_max3_u32 v236, v150, v151, v236
  v_max3_u32 v236, v64, v65, v236
  v_max3_u32 v236, v66, v67, v236
  v_max3_u32 v236, v68, v69, v236
  v_max3_u32 v236, v70, v71, v236
  v_max3_u32 v236, v72, v73, v236
  v_max3_u32 v236, v74, v75, v236
  v_cmp_eq_u32 vcc, -1, v236
  s_nop 0
  s_cmp_lg_u64 vcc, 0
  s_cbranch_scc1 PO_sp2
  s_branch PO_done
PK_spin:
  s_mov_b32 s85, 0
PK_sp2:
  s_sleep 24
  buffer_load_dword v252, v249, s[68:71], 0 offen sc1
  s_add_u32 s85, s85, 1
  s_waitcnt vmcnt(0)
  v_cmp_le_u32 vcc, 64, v252
  s_cmp_gt_u32 s85, 0x80000
  s_cbranch_scc1 PK_go
  s_cmp_eq_u32 vcc_lo, 15
  s_cbranch_scc0 PK_sp2
  s_branch PK_go
PP_spin:
  s_mov_b32 s85, 0
PP_sp2:
  s_sleep 12
  buffer_load_dword v252, v249, s[64:67], 0 offen sc1
  s_add_u32 s85, s85, 1
  s_waitcnt vmcnt(0)
  v_cmp_le_u32 vcc, 1, v252
  s_cmp_gt_u32 s85, 0x80000
  s_cbranch_scc1 PP_go
  s_cmp_eq_u32 vcc_lo, 131071
  s_cbranch_scc0 PP_sp2
  s_branch PP_go
OS0:
  buffer_store_dwordx4 v[96:99], v1, s[64:67], s83 offen offset:0 sc1
  buffer_store_dword v100, v2, s[64:67], s83 offen offset:0 sc1
  s_branch OS0b
OS1:
  buffer_store_dwordx4 v[112:115], v1, s[64:67], s83 offen offset:1024 sc1
  buffer_store_dword v116, v2, s[64:67], s83 offen offset:8 sc1
  s_branch OS1b
A_fb:
  v_lshlrev_b32 v164, 4, v0
  v_and_b32 v236, 31, v0
  v_mov_b32 v237, 0x10000
  v_cmp_lt_u32 vcc, 18, v236
  v_lshrrev_b32 v238, 5, v0
  v_mul_u32_u24 v238, 304, v238
  v_cndmask_b32 v236, v236, v237, vcc
  v_lshl_add_u32 v165, v236, 4, v238
  v_mov_b32 v240, 0xff800000
  s_mov_b32 s13, 8
A_f10:
  ds_read_b128 v[56:59], v164 offset:0
  ds_read_b128 v[32:35], v164 offset:1024
  s_waitcnt lgkmcnt(0)
  v_mfma_f32_32x32x8_bf16 v[64:79], v[56:57], v[136:137], 0
  v_mfma_f32_32x32x16_bf16 v[64:79], v[32:35], v[128:131], v[64:79]
  s_nop 11
  v_max3_f32 v240, v64, v65, v240
  v_max3_f32 v240, v66, v67, v240
  v_max3_f32 v240, v68, v69, v240
  v_max3_f32 v240, v70, v71, v240
  v_max3_f32 v240, v72, v73, v240
  v_max3_f32 v240, v74, v75, v240
  v_max3_f32 v240, v76, v77, v240
  v_max3_f32 v240, v78, v79, v240
  ds_read_b128 v[36:39], v164 offset:3264
  s_waitcnt lgkmcnt(0)
  v_mfma_f32_32x32x8_bf16 v[64:79], v[56:57], v[138:139], 0
  v_mfma_f32_32x32x16_bf16 v[64:79], v[36:39], v[128:131], v[64:79]
  s_nop 11
  v_max3_f32 v240, v64, v65, v240
  v_max3_f32 v240, v66, v67, v240
  v_max3_f32 v240, v68, v69, v240
  v_max3_f32 v240, v70, v71, v240
  v_max3_f32 v240, v72, v73, v240
  v_max3_f32 v240, v74, v75, v240
  v_max3_f32 v240, v76, v77, v240
  v_max3_f32 v240, v78, v79, v240
  ds_read_b128 v[32:35], v164 offset:5504
  s_waitcnt lgkmcnt(0)
  v_mfma_f32_32x32x8_bf16 v[64:79], v[58:59], v[136:137], 0
  v_mfma_f32_32x32x16_bf16 v[64:79], v[32:35], v[128:131], v[64:79]
  s_nop 11
  v_max3_f32 v240, v64, v65, v240
  v_max3_f32 v240, v66, v67, v240
  v_max3_f32 v240, v68, v69, v240
  v_max3_f32 v240, v70, v71, v240
  v_max3_f32 v240, v72, v73, v240
  v_max3_f32 v240, v74, v75, v240
  v_max3_f32 v240, v76, v77, v240
  v_max3_f32 v240, v78, v79, v240
  ds_read_b128 v[36:39], v164 offset:7744
  s_waitcnt lgkmcnt(0)
  v_mfma_f32_32x32x8_bf16 v[64:79], v[58:59], v[138:139], 0
  v_mfma_f32_32x32x16_bf16 v[64:79], v[36:39], v[128:131], v[64:79]
  s_nop 11
  v_max3_f32 v240, v64, v65, v240
  v_max3_f32 v240, v66, v67, v240
  v_max3_f32 v240, v68, v69, v240
  v_max3_f32 v240, v70, v71, v240
  v_max3_f32 v240, v72, v73, v240
  v_max3_f32 v240, v74, v75, v240
  v_max3_f32 v240, v76, v77, v240
  v_max3_f32 v240, v78, v79, v240
  ds_read_b128 v[32:35], v164 offset:9984
  s_waitcnt lgkmcnt(0)
  v_mfma_f32_32x32x8_bf16 v[64:79], v[56:57], v[140:141], 0
  v_mfma_f32_32x32x16_bf16 v[64:79], v[32:35], v[128:131], v[64:79]
  s_nop 11
  v_max3_f32 v240, v64, v65, v240
  v_max3_f32 v240, v66, v67, v240
  v_max3_f32 v240, v68, v69, v240
  v_max3_f32 v240, v70, v71, v240
  v_max3_f32 v240, v72, v73, v240
  v_max3_f32 v240, v74, v75, v240
  v_max3_f32 v240, v76, v77, v240
  v_max3_f32 v240, v78, v79, v240
  ds_read_b128 v[36:39], v164 offset:12224
  s_waitcnt lgkmcnt(0)
  v_mfma_f32_32x32x8_bf16 v[64:79], v[56:57], v[142:143], 0
  v_mfma_f32_32x32x16_bf16 v[64:79], v[36:39], v[128:131], v[64:79]
  s_nop 11
  v_max3_f32 v240, v64, v65, v240
  v_max3_f32 v240, v66, v67, v240
  v_max3_f32 v240, v68, v69, v240
  v_max3_f32 v240, v70, v71, v240
  v_max3_f32 v240, v72, v73, v240
  v_max3_f32 v240, v74, v75, v240
  v_max3_f32 v240, v76, v77, v240
  v_max3_f32 v240, v78, v79, v240
  ds_read_b128 v[32:35], v164 offset:14464
  s_waitcnt lgkmcnt(0)
  v_mfma_f32_32x32x8_bf16 v[64:79], v[58:59], v[140:141], 0
  v_mfma_f32_32x32x16_bf16 v[64:79], v[32:35], v[128:131], v[64:79]
  s_nop 11
  v_max3_f32 v240, v64, v65, v240
  v_max3_f32 v240, v66, v67, v240
  v_max3_f32 v240, v68, v69, v240
  v_max3_f32 v240, v70, v71, v240
  v_max3_f32 v240, v72, v73, v240
  v_max3_f32 v240, v74, v75, v240
  v_max3_f32 v240, v76, v77, v240
  v_max3_f32 v240, v78, v79, v240
  ds_read_b128 v[36:39], v164 offset:16704
  s_waitcnt lgkmcnt(0)
  v_mfma_f32_32x32x8_bf16 v[64:79], v[58:59], v[142:143], 0
  v_mfma_f32_32x32x16_bf16 v[64:79], v[36:39], v[128:131], v[64:79]
  s_nop 11
  v_max3_f32 v240, v64, v65, v240
  v_max3_f32 v240, v66, v67, v240
  v_max3_f32 v240, v68, v69, v240
  v_max3_f32 v240, v70, v71, v240
  v_max3_f32 v240, v72, v73, v240
  v_max3_f32 v240, v74, v75, v240
  v_max3_f32 v240, v76, v77, v240
  v_max3_f32 v240, v78, v79, v240
  v_add_u32 v164, 18944, v164
  s_sub_u32 s13, s13, 1
  s_cmp_lg_u32 s13, 0
  s_cbranch_scc1 A_f10
  v_mov_b32 v241, v240
  s_nop 1
  v_permlane32_swap_b32 v240, v241
  v_max_f32 v240, v240, v241
  v_lshlrev_b32 v164, 4, v0
  v_and_b32 v236, 31, v0
  v_mov_b32 v237, 0x10000
  v_cmp_lt_u32 vcc, 18, v236
  v_lshrrev_b32 v238, 5, v0
  v_mul_u32_u24 v238, 304, v238
  v_cndmask_b32 v236, v236, v237, vcc
  v_lshl_add_u32 v165, v236, 4, v238
  v_sub_f32 v80, 0, v240
  v_mov_b32 v96, 0
  v_sub_f32 v81, 0, v240
  v_mov_b32 v97, 0
  v_sub_f32 v82, 0, v240
  v_mov_b32 v98, 0
  v_sub_f32 v83, 0, v240
  v_mov_b32 v99, 0
  v_sub_f32 v84, 0, v240
  v_mov_b32 v100, 0
  v_sub_f32 v85, 0, v240
  v_mov_b32 v101, 0
  v_sub_f32 v86, 0, v240
  v_mov_b32 v102, 0
  v_sub_f32 v87, 0, v240
  v_mov_b32 v103, 0
  v_sub_f32 v88, 0, v240
  v_mov_b32 v104, 0
  v_sub_f32 v89, 0, v240
  v_mov_b32 v105, 0
  v_sub_f32 v90, 0, v240
  v_mov_b32 v106, 0
  v_sub_f32 v91, 0, v240
  v_mov_b32 v107, 0
  v_sub_f32 v92, 0, v240
  v_mov_b32 v108, 0
  v_sub_f32 v93, 0, v240
  v_mov_b32 v109, 0
  v_sub_f32 v94, 0, v240
  v_mov_b32 v110, 0
  v_sub_f32 v95, 0, v240
  v_mov_b32 v111, 0
  s_mov_b32 s13, 8
A_f20:
  ds_read_b128 v[56:59], v164 offset:0
  ds_read_b128 v[32:35], v164 offset:1024
  ds_read_b128 v[40:43], v165 offset:2048
  ds_read_b128 v[44:47], v165 offset:2656
  s_waitcnt lgkmcnt(0)
  v_mfma_f32_32x32x8_bf16 v[64:79], v[56:57], v[136:137], v[80:95]
  v_mfma_f32_32x32x16_bf16 v[64:79], v[32:35], v[128:131], v[64:79]
  s_nop 11
  v_exp_f32 v64, v64
  v_exp_f32 v65, v65
  v_exp_f32 v66, v66
  v_exp_f32 v67, v67
  v_exp_f32 v68, v68
  v_exp_f32 v69, v69
  v_exp_f32 v70, v70
  v_exp_f32 v71, v71
  v_exp_f32 v72, v72
  v_exp_f32 v73, v73
  v_exp_f32 v74, v74
  v_exp_f32 v75, v75
  v_exp_f32 v76, v76
  v_exp_f32 v77, v77
  v_exp_f32 v78, v78
  v_exp_f32 v79, v79
  v_cvt_pk_bf16_f32 v24, v64, v65
  v_cvt_pk_bf16_f32 v25, v66, v67
  v_cvt_pk_bf16_f32 v26, v68, v69
  v_cvt_pk_bf16_f32 v27, v70, v71
  v_cvt_pk_bf16_f32 v28, v72, v73
  v_cvt_pk_bf16_f32 v29, v74, v75
  v_cvt_pk_bf16_f32 v30, v76, v77
  v_cvt_pk_bf16_f32 v31, v78, v79
  v_mfma_f32_32x32x16_bf16 v[96:111], v[40:43], v[24:27], v[96:111]
  s_nop 0
  v_mfma_f32_32x32x16_bf16 v[96:111], v[44:47], v[28:31], v[96:111]
  ds_read_b128 v[36:39], v164 offset:3264
  ds_read_b128 v[48:51], v165 offset:4288
  ds_read_b128 v[52:55], v165 offset:4896
  s_waitcnt lgkmcnt(0)
  v_mfma_f32_32x32x8_bf16 v[64:79], v[56:57], v[138:139], v[80:95]
  v_mfma_f32_32x32x16_bf16 v[64:79], v[36:39], v[128:131], v[64:79]
  s_nop 11
  v_exp_f32 v64, v64
  v_exp_f32 v65, v65
  v_exp_f32 v66, v66
  v_exp_f32 v67, v67
  v_exp_f32 v68, v68
  v_exp_f32 v69, v69
  v_exp_f32 v70, v70
  v_exp_f32 v71, v71
  v_exp_f32 v72, v72
  v_exp_f32 v73, v73
  v_exp_f32 v74, v74
  v_exp_f32 v75, v75
  v_exp_f32 v76, v76
  v_exp_f32 v77, v77
  v_exp_f32 v78, v78
  v_exp_f32 v79, v79
  v_cvt_pk_bf16_f32 v24, v64, v65
  v_cvt_pk_bf16_f32 v25, v66, v67
  v_cvt_pk_bf16_f32 v26, v68, v69
  v_cvt_pk_bf16_f32 v27, v70, v71
  v_cvt_pk_bf16_f32 v28, v72, v73
  v_cvt_pk_bf16_f32 v29, v74, v75
  v_cvt_pk_bf16_f32 v30, v76, v77
  v_cvt_pk_bf16_f32 v31, v78, v79
  v_mfma_f32_32x32x16_bf16 v[96:111], v[48:51], v[24:27], v[96:111]
  s_nop 0
  v_mfma_f32_32x32x16_bf16 v[96:111], v[52:55], v[28:31], v[96:111]
  ds_read_b128 v[32:35], v164 offset:5504
  ds_read_b128 v[40:43], v165 offset:6528
  ds_read_b128 v[44:47], v165 offset:7136
  s_waitcnt lgkmcnt(0)
  v_mfma_f32_32x32x8_bf16 v[64:79], v[58:59], v[136:137], v[80:95]
  v_mfma_f32_32x32x16_bf16 v[64:79], v[32:35], v[128:131], v[64:79]
  s_nop 11
  v_exp_f32 v64, v64
  v_exp_f32 v65, v65
  v_exp_f32 v66, v66
  v_exp_f32 v67, v67
  v_exp_f32 v68, v68
  v_exp_f32 v69, v69
  v_exp_f32 v70, v70
  v_exp_f32 v71, v71
  v_exp_f32 v72, v72
  v_exp_f32 v73, v73
  v_exp_f32 v74, v74
  v_exp_f32 v75, v75
  v_exp_f32 v76, v76
  v_exp_f32 v77, v77
  v_exp_f32 v78, v78
  v_exp_f32 v79, v79
  v_cvt_pk_bf16_f32 v24, v64, v65
  v_cvt_pk_bf16_f32 v25, v66, v67
  v_cvt_pk_bf16_f32 v26, v68, v69
  v_cvt_pk_bf16_f32 v27, v70, v71
  v_cvt_pk_bf16_f32 v28, v72, v73
  v_cvt_pk_bf16_f32 v29, v74, v75
  v_cvt_pk_bf16_f32 v30, v76, v77
  v_cvt_pk_bf16_f32 v31, v78, v79
  v_mfma_f32_32x32x16_bf16 v[96:111], v[40:43], v[24:27], v[96:111]
  s_nop 0
  v_mfma_f32_32x32x16_bf16 v[96:111], v[44:47], v[28:31], v[96:111]
  ds_read_b128 v[36:39], v164 offset:7744
  ds_read_b128 v[48:51], v165 offset:8768
  ds_read_b128 v[52:55], v165 offset:9376
  s_waitcnt lgkmcnt(0)
  v_mfma_f32_32x32x8_bf16 v[64:79], v[58:59], v[138:139], v[80:95]
  v_mfma_f32_32x32x16_bf16 v[64:79], v[36:39], v[128:131], v[64:79]
  s_nop 11
  v_exp_f32 v64, v64
  v_exp_f32 v65, v65
  v_exp_f32 v66, v66
  v_exp_f32 v67, v67
  v_exp_f32 v68, v68
  v_exp_f32 v69, v69
  v_exp_f32 v70, v70
  v_exp_f32 v71, v71
  v_exp_f32 v72, v72
  v_exp_f32 v73, v73
  v_exp_f32 v74, v74
  v_exp_f32 v75, v75
  v_exp_f32 v76, v76
  v_exp_f32 v77, v77
  v_exp_f32 v78, v78
  v_exp_f32 v79, v79
  v_cvt_pk_bf16_f32 v24, v64, v65
  v_cvt_pk_bf16_f32 v25, v66, v67
  v_cvt_pk_bf16_f32 v26, v68, v69
  v_cvt_pk_bf16_f32 v27, v70, v71
  v_cvt_pk_bf16_f32 v28, v72, v73
  v_cvt_pk_bf16_f32 v29, v74, v75
  v_cvt_pk_bf16_f32 v30, v76, v77
  v_cvt_pk_bf16_f32 v31, v78, v79
  v_mfma_f32_32x32x16_bf16 v[96:111], v[48:51], v[24:27], v[96:111]
  s_nop 0
  v_mfma_f32_32x32x16_bf16 v[96:111], v[52:55], v[28:31], v[96:111]
  ds_read_b128 v[32:35], v164 offset:9984
  ds_read_b128 v[40:43], v165 offset:11008
  ds_read_b128 v[44:47], v165 offset:11616
  s_waitcnt lgkmcnt(0)
  v_mfma_f32_32x32x8_bf16 v[64:79], v[56:57], v[140:141], v[80:95]
  v_mfma_f32_32x32x16_bf16 v[64:79], v[32:35], v[128:131], v[64:79]
  s_nop 11
  v_exp_f32 v64, v64
  v_exp_f32 v65, v65
  v_exp_f32 v66, v66
  v_exp_f32 v67, v67
  v_exp_f32 v68, v68
  v_exp_f32 v69, v69
  v_exp_f32 v70, v70
  v_exp_f32 v71, v71
  v_exp_f32 v72, v72
  v_exp_f32 v73, v73
  v_exp_f32 v74, v74
  v_exp_f32 v75, v75
  v_exp_f32 v76, v76
  v_exp_f32 v77, v77
  v_exp_f32 v78, v78
  v_exp_f32 v79, v79
  v_cvt_pk_bf16_f32 v24, v64, v65
  v_cvt_pk_bf16_f32 v25, v66, v67
  v_cvt_pk_bf16_f32 v26, v68, v69
  v_cvt_pk_bf16_f32 v27, v70, v71
  v_cvt_pk_bf16_f32 v28, v72, v73
  v_cvt_pk_bf16_f32 v29, v74, v75
  v_cvt_pk_bf16_f32 v30, v76, v77
  v_cvt_pk_bf16_f32 v31, v78, v79
  v_mfma_f32_32x32x16_bf16 v[96:111], v[40:43], v[24:27], v[96:111]
  s_nop 0
  v_mfma_f32_32x32x16_bf16 v[96:111], v[44:47], v[28:31], v[96:111]
  ds_read_b128 v[36:39], v164 offset:12224
  ds_read_b128 v[48:51], v165 offset:13248
  ds_read_b128 v[52:55], v165 offset:13856
  s_waitcnt lgkmcnt(0)
  v_mfma_f32_32x32x8_bf16 v[64:79], v[56:57], v[142:143], v[80:95]
  v_mfma_f32_32x32x16_bf16 v[64:79], v[36:39], v[128:131], v[64:79]
  s_nop 11
  v_exp_f32 v64, v64
  v_exp_f32 v65, v65
  v_exp_f32 v66, v66
  v_exp_f32 v67, v67
  v_exp_f32 v68, v68
  v_exp_f32 v69, v69
  v_exp_f32 v70, v70
  v_exp_f32 v71, v71
  v_exp_f32 v72, v72
  v_exp_f32 v73, v73
  v_exp_f32 v74, v74
  v_exp_f32 v75, v75
  v_exp_f32 v76, v76
  v_exp_f32 v77, v77
  v_exp_f32 v78, v78
  v_exp_f32 v79, v79
  v_cvt_pk_bf16_f32 v24, v64, v65
  v_cvt_pk_bf16_f32 v25, v66, v67
  v_cvt_pk_bf16_f32 v26, v68, v69
  v_cvt_pk_bf16_f32 v27, v70, v71
  v_cvt_pk_bf16_f32 v28, v72, v73
  v_cvt_pk_bf16_f32 v29, v74, v75
  v_cvt_pk_bf16_f32 v30, v76, v77
  v_cvt_pk_bf16_f32 v31, v78, v79
  v_mfma_f32_32x32x16_bf16 v[96:111], v[48:51], v[24:27], v[96:111]
  s_nop 0
  v_mfma_f32_32x32x16_bf16 v[96:111], v[52:55], v[28:31], v[96:111]
  ds_read_b128 v[32:35], v164 offset:14464
  ds_read_b128 v[40:43], v165 offset:15488
  ds_read_b128 v[44:47], v165 offset:16096
  s_waitcnt lgkmcnt(0)
  v_mfma_f32_32x32x8_bf16 v[64:79], v[58:59], v[140:141], v[80:95]
  v_mfma_f32_32x32x16_bf16 v[64:79], v[32:35], v[128:131], v[64:79]
  s_nop 11
  v_exp_f32 v64, v64
  v_exp_f32 v65, v65
  v_exp_f32 v66, v66
  v_exp_f32 v67, v67
  v_exp_f32 v68, v68
  v_exp_f32 v69, v69
  v_exp_f32 v70, v70
  v_exp_f32 v71, v71
  v_exp_f32 v72, v72
  v_exp_f32 v73, v73
  v_exp_f32 v74, v74
  v_exp_f32 v75, v75
  v_exp_f32 v76, v76
  v_exp_f32 v77, v77
  v_exp_f32 v78, v78
  v_exp_f32 v79, v79
  v_cvt_pk_bf16_f32 v24, v64, v65
  v_cvt_pk_bf16_f32 v25, v66, v67
  v_cvt_pk_bf16_f32 v26, v68, v69
  v_cvt_pk_bf16_f32 v27, v70, v71
  v_cvt_pk_bf16_f32 v28, v72, v73
  v_cvt_pk_bf16_f32 v29, v74, v75
  v_cvt_pk_bf16_f32 v30, v76, v77
  v_cvt_pk_bf16_f32 v31, v78, v79
  v_mfma_f32_32x32x16_bf16 v[96:111], v[40:43], v[24:27], v[96:111]
  s_nop 0
  v_mfma_f32_32x32x16_bf16 v[96:111], v[44:47], v[28:31], v[96:111]
  ds_read_b128 v[36:39], v164 offset:16704
  ds_read_b128 v[48:51], v165 offset:17728
  ds_read_b128 v[52:55], v165 offset:18336
  s_waitcnt lgkmcnt(0)
  v_mfma_f32_32x32x8_bf16 v[64:79], v[58:59], v[142:143], v[80:95]
  v_mfma_f32_32x32x16_bf16 v[64:79], v[36:39], v[128:131], v[64:79]
  s_nop 11
  v_exp_f32 v64, v64
  v_exp_f32 v65, v65
  v_exp_f32 v66, v66
  v_exp_f32 v67, v67
  v_exp_f32 v68, v68
  v_exp_f32 v69, v69
  v_exp_f32 v70, v70
  v_exp_f32 v71, v71
  v_exp_f32 v72, v72
  v_exp_f32 v73, v73
  v_exp_f32 v74, v74
  v_exp_f32 v75, v75
  v_exp_f32 v76, v76
  v_exp_f32 v77, v77
  v_exp_f32 v78, v78
  v_exp_f32 v79, v79
  v_cvt_pk_bf16_f32 v24, v64, v65
  v_cvt_pk_bf16_f32 v25, v66, v67
  v_cvt_pk_bf16_f32 v26, v68, v69
  v_cvt_pk_bf16_f32 v27, v70, v71
  v_cvt_pk_bf16_f32 v28, v72, v73
  v_cvt_pk_bf16_f32 v29, v74, v75
  v_cvt_pk_bf16_f32 v30, v76, v77
  v_cvt_pk_bf16_f32 v31, v78, v79
  v_mfma_f32_32x32x16_bf16 v[96:111], v[48:51], v[24:27], v[96:111]
  s_nop 0
  v_mfma_f32_32x32x16_bf16 v[96:111], v[52:55], v[28:31], v[96:111]
  v_add_u32 v164, 18944, v164
  v_add_u32 v165, 18944, v165
  s_sub_u32 s13, s13, 1
  s_cmp_lg_u32 s13, 0
  s_cbranch_scc1 A_f20
  v_lshlrev_b32 v164, 4, v0
  v_and_b32 v236, 31, v0
  v_mov_b32 v237, 0x10000
  v_cmp_lt_u32 vcc, 18, v236
  v_lshrrev_b32 v238, 5, v0
  v_mul_u32_u24 v238, 304, v238
  v_cndmask_b32 v236, v236, v237, vcc
  v_lshl_add_u32 v165, v236, 4, v238
  v_mov_b32 v240, 0xff800000
  s_mov_b32 s13, 8
A_f11:
  ds_read_b128 v[56:59], v164 offset:0
  ds_read_b128 v[32:35], v164 offset:1024
  s_waitcnt lgkmcnt(0)
  v_mfma_f32_32x32x8_bf16 v[64:79], v[56:57], v[144:145], 0
  v_mfma_f32_32x32x16_bf16 v[64:79], v[32:35], v[132:135], v[64:79]
  s_nop 11
  v_max3_f32 v240, v64, v65, v240
  v_max3_f32 v240, v66, v67, v240
  v_max3_f32 v240, v68, v69, v240
  v_max3_f32 v240, v70, v71, v240
  v_max3_f32 v240, v72, v73, v240
  v_max3_f32 v240, v74, v75, v240
  v_max3_f32 v240, v76, v77, v240
  v_max3_f32 v240, v78, v79, v240
  ds_read_b128 v[36:39], v164 offset:3264
  s_waitcnt lgkmcnt(0)
  v_mfma_f32_32x32x8_bf16 v[64:79], v[56:57], v[146:147], 0
  v_mfma_f32_32x32x16_bf16 v[64:79], v[36:39], v[132:135], v[64:79]
  s_nop 11
  v_max3_f32 v240, v64, v65, v240
  v_max3_f32 v240, v66, v67, v240
  v_max3_f32 v240, v68, v69, v240
  v_max3_f32 v240, v70, v71, v240
  v_max3_f32 v240, v72, v73, v240
  v_max3_f32 v240, v74, v75, v240
  v_max3_f32 v240, v76, v77, v240
  v_max3_f32 v240, v78, v79, v240
  ds_read_b128 v[32:35], v164 offset:5504
  s_waitcnt lgkmcnt(0)
  v_mfma_f32_32x32x8_bf16 v[64:79], v[58:59], v[144:145], 0
  v_mfma_f32_32x32x16_bf16 v[64:79], v[32:35], v[132:135], v[64:79]
  s_nop 11
  v_max3_f32 v240, v64, v65, v240
  v_max3_f32 v240, v66, v67, v240
  v_max3_f32 v240, v68, v69, v240
  v_max3_f32 v240, v70, v71, v240
  v_max3_f32 v240, v72, v73, v240
  v_max3_f32 v240, v74, v75, v240
  v_max3_f32 v240, v76, v77, v240
  v_max3_f32 v240, v78, v79, v240
  ds_read_b128 v[36:39], v164 offset:7744
  s_waitcnt lgkmcnt(0)
  v_mfma_f32_32x32x8_bf16 v[64:79], v[58:59], v[146:147], 0
  v_mfma_f32_32x32x16_bf16 v[64:79], v[36:39], v[132:135], v[64:79]
  s_nop 11
  v_max3_f32 v240, v64, v65, v240
  v_max3_f32 v240, v66, v67, v240
  v_max3_f32 v240, v68, v69, v240
  v_max3_f32 v240, v70, v71, v240
  v_max3_f32 v240, v72, v73, v240
  v_max3_f32 v240, v74, v75, v240
  v_max3_f32 v240, v76, v77, v240
  v_max3_f32 v240, v78, v79, v240
  ds_read_b128 v[32:35], v164 offset:9984
  s_waitcnt lgkmcnt(0)
  v_mfma_f32_32x32x8_bf16 v[64:79], v[56:57], v[148:149], 0
  v_mfma_f32_32x32x16_bf16 v[64:79], v[32:35], v[132:135], v[64:79]
  s_nop 11
  v_max3_f32 v240, v64, v65, v240
  v_max3_f32 v240, v66, v67, v240
  v_max3_f32 v240, v68, v69, v240
  v_max3_f32 v240, v70, v71, v240
  v_max3_f32 v240, v72, v73, v240
  v_max3_f32 v240, v74, v75, v240
  v_max3_f32 v240, v76, v77, v240
  v_max3_f32 v240, v78, v79, v240
  ds_read_b128 v[36:39], v164 offset:12224
  s_waitcnt lgkmcnt(0)
  v_mfma_f32_32x32x8_bf16 v[64:79], v[56:57], v[150:151], 0
  v_mfma_f32_32x32x16_bf16 v[64:79], v[36:39], v[132:135], v[64:79]
  s_nop 11
  v_max3_f32 v240, v64, v65, v240
  v_max3_f32 v240, v66, v67, v240
  v_max3_f32 v240, v68, v69, v240
  v_max3_f32 v240, v70, v71, v240
  v_max3_f32 v240, v72, v73, v240
  v_max3_f32 v240, v74, v75, v240
  v_max3_f32 v240, v76, v77, v240
  v_max3_f32 v240, v78, v79, v240
  ds_read_b128 v[32:35], v164 offset:14464
  s_waitcnt lgkmcnt(0)
  v_mfma_f32_32x32x8_bf16 v[64:79], v[58:59], v[148:149], 0
  v_mfma_f32_32x32x16_bf16 v[64:79], v[32:35], v[132:135], v[64:79]
  s_nop 11
  v_max3_f32 v240, v64, v65, v240
  v_max3_f32 v240, v66, v67, v240
  v_max3_f32 v240, v68, v69, v240
  v_max3_f32 v240, v70, v71, v240
  v_max3_f32 v240, v72, v73, v240
  v_max3_f32 v240, v74, v75, v240
  v_max3_f32 v240, v76, v77, v240
  v_max3_f32 v240, v78, v79, v240
  ds_read_b128 v[36:39], v164 offset:16704
  s_waitcnt lgkmcnt(0)
  v_mfma_f32_32x32x8_bf16 v[64:79], v[58:59], v[150:151], 0
  v_mfma_f32_32x32x16_bf16 v[64:79], v[36:39], v[132:135], v[64:79]
  s_nop 11
  v_max3_f32 v240, v64, v65, v240
  v_max3_f32 v240, v66, v67, v240
  v_max3_f32 v240, v68, v69, v240
  v_max3_f32 v240, v70, v71, v240
  v_max3_f32 v240, v72, v73, v240
  v_max3_f32 v240, v74, v75, v240
  v_max3_f32 v240, v76, v77, v240
  v_max3_f32 v240, v78, v79, v240
  v_add_u32 v164, 18944, v164
  s_sub_u32 s13, s13, 1
  s_cmp_lg_u32 s13, 0
  s_cbranch_scc1 A_f11
  v_mov_b32 v241, v240
  s_nop 1
  v_permlane32_swap_b32 v240, v241
  v_max_f32 v240, v240, v241
  v_lshlrev_b32 v164, 4, v0
  v_and_b32 v236, 31, v0
  v_mov_b32 v237, 0x10000
  v_cmp_lt_u32 vcc, 18, v236
  v_lshrrev_b32 v238, 5, v0
  v_mul_u32_u24 v238, 304, v238
  v_cndmask_b32 v236, v236, v237, vcc
  v_lshl_add_u32 v165, v236, 4, v238
  v_sub_f32 v80, 0, v240
  v_mov_b32 v112, 0
  v_sub_f32 v81, 0, v240
  v_mov_b32 v113, 0
  v_sub_f32 v82, 0, v240
  v_mov_b32 v114, 0
  v_sub_f32 v83, 0, v240
  v_mov_b32 v115, 0
  v_sub_f32 v84, 0, v240
  v_mov_b32 v116, 0
  v_sub_f32 v85, 0, v240
  v_mov_b32 v117, 0
  v_sub_f32 v86, 0, v240
  v_mov_b32 v118, 0
  v_sub_f32 v87, 0, v240
  v_mov_b32 v119, 0
  v_sub_f32 v88, 0, v240
  v_mov_b32 v120, 0
  v_sub_f32 v89, 0, v240
  v_mov_b32 v121, 0
  v_sub_f32 v90, 0, v240
  v_mov_b32 v122, 0
  v_sub_f32 v91, 0, v240
  v_mov_b32 v123, 0
  v_sub_f32 v92, 0, v240
  v_mov_b32 v124, 0
  v_sub_f32 v93, 0, v240
  v_mov_b32 v125, 0
  v_sub_f32 v94, 0, v240
  v_mov_b32 v126, 0
  v_sub_f32 v95, 0, v240
  v_mov_b32 v127, 0
  s_mov_b32 s13, 8
A_f21:
  ds_read_b128 v[56:59], v164 offset:0
  ds_read_b128 v[32:35], v164 offset:1024
  ds_read_b128 v[40:43], v165 offset:2048
  ds_read_b128 v[44:47], v165 offset:2656
  s_waitcnt lgkmcnt(0)
  v_mfma_f32_32x32x8_bf16 v[64:79], v[56:57], v[144:145], v[80:95]
  v_mfma_f32_32x32x16_bf16 v[64:79], v[32:35], v[132:135], v[64:79]
  s_nop 11
  v_exp_f32 v64, v64
  v_exp_f32 v65, v65
  v_exp_f32 v66, v66
  v_exp_f32 v67, v67
  v_exp_f32 v68, v68
  v_exp_f32 v69, v69
  v_exp_f32 v70, v70
  v_exp_f32 v71, v71
  v_exp_f32 v72, v72
  v_exp_f32 v73, v73
  v_exp_f32 v74, v74
  v_exp_f32 v75, v75
  v_exp_f32 v76, v76
  v_exp_f32 v77, v77
  v_exp_f32 v78, v78
  v_exp_f32 v79, v79
  v_cvt_pk_bf16_f32 v24, v64, v65
  v_cvt_pk_bf16_f32 v25, v66, v67
  v_cvt_pk_bf16_f32 v26, v68, v69
  v_cvt_pk_bf16_f32 v27, v70, v71
  v_cvt_pk_bf16_f32 v28, v72, v73
  v_cvt_pk_bf16_f32 v29, v74, v75
  v_cvt_pk_bf16_f32 v30, v76, v77
  v_cvt_pk_bf16_f32 v31, v78, v79
  v_mfma_f32_32x32x16_bf16 v[112:127], v[40:43], v[24:27], v[112:127]
  s_nop 0
  v_mfma_f32_32x32x16_bf16 v[112:127], v[44:47], v[28:31], v[112:127]
  ds_read_b128 v[36:39], v164 offset:3264
  ds_read_b128 v[48:51], v165 offset:4288
  ds_read_b128 v[52:55], v165 offset:4896
  s_waitcnt lgkmcnt(0)
  v_mfma_f32_32x32x8_bf16 v[64:79], v[56:57], v[146:147], v[80:95]
  v_mfma_f32_32x32x16_bf16 v[64:79], v[36:39], v[132:135], v[64:79]
  s_nop 11
  v_exp_f32 v64, v64
  v_exp_f32 v65, v65
  v_exp_f32 v66, v66
  v_exp_f32 v67, v67
  v_exp_f32 v68, v68
  v_exp_f32 v69, v69
  v_exp_f32 v70, v70
  v_exp_f32 v71, v71
  v_exp_f32 v72, v72
  v_exp_f32 v73, v73
  v_exp_f32 v74, v74
  v_exp_f32 v75, v75
  v_exp_f32 v76, v76
  v_exp_f32 v77, v77
  v_exp_f32 v78, v78
  v_exp_f32 v79, v79
  v_cvt_pk_bf16_f32 v24, v64, v65
  v_cvt_pk_bf16_f32 v25, v66, v67
  v_cvt_pk_bf16_f32 v26, v68, v69
  v_cvt_pk_bf16_f32 v27, v70, v71
  v_cvt_pk_bf16_f32 v28, v72, v73
  v_cvt_pk_bf16_f32 v29, v74, v75
  v_cvt_pk_bf16_f32 v30, v76, v77
  v_cvt_pk_bf16_f32 v31, v78, v79
  v_mfma_f32_32x32x16_bf16 v[112:127], v[48:51], v[24:27], v[112:127]
  s_nop 0
  v_mfma_f32_32x32x16_bf16 v[112:127], v[52:55], v[28:31], v[112:127]
  ds_read_b128 v[32:35], v164 offset:5504
  ds_read_b128 v[40:43], v165 offset:6528
  ds_read_b128 v[44:47], v165 offset:7136
  s_waitcnt lgkmcnt(0)
  v_mfma_f32_32x32x8_bf16 v[64:79], v[58:59], v[144:145], v[80:95]
  v_mfma_f32_32x32x16_bf16 v[64:79], v[32:35], v[132:135], v[64:79]
  s_nop 11
  v_exp_f32 v64, v64
  v_exp_f32 v65, v65
  v_exp_f32 v66, v66
  v_exp_f32 v67, v67
  v_exp_f32 v68, v68
  v_exp_f32 v69, v69
  v_exp_f32 v70, v70
  v_exp_f32 v71, v71
  v_exp_f32 v72, v72
  v_exp_f32 v73, v73
  v_exp_f32 v74, v74
  v_exp_f32 v75, v75
  v_exp_f32 v76, v76
  v_exp_f32 v77, v77
  v_exp_f32 v78, v78
  v_exp_f32 v79, v79
  v_cvt_pk_bf16_f32 v24, v64, v65
  v_cvt_pk_bf16_f32 v25, v66, v67
  v_cvt_pk_bf16_f32 v26, v68, v69
  v_cvt_pk_bf16_f32 v27, v70, v71
  v_cvt_pk_bf16_f32 v28, v72, v73
  v_cvt_pk_bf16_f32 v29, v74, v75
  v_cvt_pk_bf16_f32 v30, v76, v77
  v_cvt_pk_bf16_f32 v31, v78, v79
  v_mfma_f32_32x32x16_bf16 v[112:127], v[40:43], v[24:27], v[112:127]
  s_nop 0
  v_mfma_f32_32x32x16_bf16 v[112:127], v[44:47], v[28:31], v[112:127]
  ds_read_b128 v[36:39], v164 offset:7744
  ds_read_b128 v[48:51], v165 offset:8768
  ds_read_b128 v[52:55], v165 offset:9376
  s_waitcnt lgkmcnt(0)
  v_mfma_f32_32x32x8_bf16 v[64:79], v[58:59], v[146:147], v[80:95]
  v_mfma_f32_32x32x16_bf16 v[64:79], v[36:39], v[132:135], v[64:79]
  s_nop 11
  v_exp_f32 v64, v64
  v_exp_f32 v65, v65
  v_exp_f32 v66, v66
  v_exp_f32 v67, v67
  v_exp_f32 v68, v68
  v_exp_f32 v69, v69
  v_exp_f32 v70, v70
  v_exp_f32 v71, v71
  v_exp_f32 v72, v72
  v_exp_f32 v73, v73
  v_exp_f32 v74, v74
  v_exp_f32 v75, v75
  v_exp_f32 v76, v76
  v_exp_f32 v77, v77
  v_exp_f32 v78, v78
  v_exp_f32 v79, v79
  v_cvt_pk_bf16_f32 v24, v64, v65
  v_cvt_pk_bf16_f32 v25, v66, v67
  v_cvt_pk_bf16_f32 v26, v68, v69
  v_cvt_pk_bf16_f32 v27, v70, v71
  v_cvt_pk_bf16_f32 v28, v72, v73
  v_cvt_pk_bf16_f32 v29, v74, v75
  v_cvt_pk_bf16_f32 v30, v76, v77
  v_cvt_pk_bf16_f32 v31, v78, v79
  v_mfma_f32_32x32x16_bf16 v[112:127], v[48:51], v[24:27], v[112:127]
  s_nop 0
  v_mfma_f32_32x32x16_bf16 v[112:127], v[52:55], v[28:31], v[112:127]
  ds_read_b128 v[32:35], v164 offset:9984
  ds_read_b128 v[40:43], v165 offset:11008
  ds_read_b128 v[44:47], v165 offset:11616
  s_waitcnt lgkmcnt(0)
  v_mfma_f32_32x32x8_bf16 v[64:79], v[56:57], v[148:149], v[80:95]
  v_mfma_f32_32x32x16_bf16 v[64:79], v[32:35], v[132:135], v[64:79]
  s_nop 11
  v_exp_f32 v64, v64
  v_exp_f32 v65, v65
  v_exp_f32 v66, v66
  v_exp_f32 v67, v67
  v_exp_f32 v68, v68
  v_exp_f32 v69, v69
  v_exp_f32 v70, v70
  v_exp_f32 v71, v71
  v_exp_f32 v72, v72
  v_exp_f32 v73, v73
  v_exp_f32 v74, v74
  v_exp_f32 v75, v75
  v_exp_f32 v76, v76
  v_exp_f32 v77, v77
  v_exp_f32 v78, v78
  v_exp_f32 v79, v79
  v_cvt_pk_bf16_f32 v24, v64, v65
  v_cvt_pk_bf16_f32 v25, v66, v67
  v_cvt_pk_bf16_f32 v26, v68, v69
  v_cvt_pk_bf16_f32 v27, v70, v71
  v_cvt_pk_bf16_f32 v28, v72, v73
  v_cvt_pk_bf16_f32 v29, v74, v75
  v_cvt_pk_bf16_f32 v30, v76, v77
  v_cvt_pk_bf16_f32 v31, v78, v79
  v_mfma_f32_32x32x16_bf16 v[112:127], v[40:43], v[24:27], v[112:127]
  s_nop 0
  v_mfma_f32_32x32x16_bf16 v[112:127], v[44:47], v[28:31], v[112:127]
  ds_read_b128 v[36:39], v164 offset:12224
  ds_read_b128 v[48:51], v165 offset:13248
  ds_read_b128 v[52:55], v165 offset:13856
  s_waitcnt lgkmcnt(0)
  v_mfma_f32_32x32x8_bf16 v[64:79], v[56:57], v[150:151], v[80:95]
  v_mfma_f32_32x32x16_bf16 v[64:79], v[36:39], v[132:135], v[64:79]
  s_nop 11
  v_exp_f32 v64, v64
  v_exp_f32 v65, v65
  v_exp_f32 v66, v66
  v_exp_f32 v67, v67
  v_exp_f32 v68, v68
  v_exp_f32 v69, v69
  v_exp_f32 v70, v70
  v_exp_f32 v71, v71
  v_exp_f32 v72, v72
  v_exp_f32 v73, v73
  v_exp_f32 v74, v74
  v_exp_f32 v75, v75
  v_exp_f32 v76, v76
  v_exp_f32 v77, v77
  v_exp_f32 v78, v78
  v_exp_f32 v79, v79
  v_cvt_pk_bf16_f32 v24, v64, v65
  v_cvt_pk_bf16_f32 v25, v66, v67
  v_cvt_pk_bf16_f32 v26, v68, v69
  v_cvt_pk_bf16_f32 v27, v70, v71
  v_cvt_pk_bf16_f32 v28, v72, v73
  v_cvt_pk_bf16_f32 v29, v74, v75
  v_cvt_pk_bf16_f32 v30, v76, v77
  v_cvt_pk_bf16_f32 v31, v78, v79
  v_mfma_f32_32x32x16_bf16 v[112:127], v[48:51], v[24:27], v[112:127]
  s_nop 0
  v_mfma_f32_32x32x16_bf16 v[112:127], v[52:55], v[28:31], v[112:127]
  ds_read_b128 v[32:35], v164 offset:14464
  ds_read_b128 v[40:43], v165 offset:15488
  ds_read_b128 v[44:47], v165 offset:16096
  s_waitcnt lgkmcnt(0)
  v_mfma_f32_32x32x8_bf16 v[64:79], v[58:59], v[148:149], v[80:95]
  v_mfma_f32_32x32x16_bf16 v[64:79], v[32:35], v[132:135], v[64:79]
  s_nop 11
  v_exp_f32 v64, v64
  v_exp_f32 v65, v65
  v_exp_f32 v66, v66
  v_exp_f32 v67, v67
  v_exp_f32 v68, v68
  v_exp_f32 v69, v69
  v_exp_f32 v70, v70
  v_exp_f32 v71, v71
  v_exp_f32 v72, v72
  v_exp_f32 v73, v73
  v_exp_f32 v74, v74
  v_exp_f32 v75, v75
  v_exp_f32 v76, v76
  v_exp_f32 v77, v77
  v_exp_f32 v78, v78
  v_exp_f32 v79, v79
  v_cvt_pk_bf16_f32 v24, v64, v65
  v_cvt_pk_bf16_f32 v25, v66, v67
  v_cvt_pk_bf16_f32 v26, v68, v69
  v_cvt_pk_bf16_f32 v27, v70, v71
  v_cvt_pk_bf16_f32 v28, v72, v73
  v_cvt_pk_bf16_f32 v29, v74, v75
  v_cvt_pk_bf16_f32 v30, v76, v77
  v_cvt_pk_bf16_f32 v31, v78, v79
  v_mfma_f32_32x32x16_bf16 v[112:127], v[40:43], v[24:27], v[112:127]
  s_nop 0
  v_mfma_f32_32x32x16_bf16 v[112:127], v[44:47], v[28:31], v[112:127]
  ds_read_b128 v[36:39], v164 offset:16704
  ds_read_b128 v[48:51], v165 offset:17728
  ds_read_b128 v[52:55], v165 offset:18336
  s_waitcnt lgkmcnt(0)
  v_mfma_f32_32x32x8_bf16 v[64:79], v[58:59], v[150:151], v[80:95]
  v_mfma_f32_32x32x16_bf16 v[64:79], v[36:39], v[132:135], v[64:79]
  s_nop 11
  v_exp_f32 v64, v64
  v_exp_f32 v65, v65
  v_exp_f32 v66, v66
  v_exp_f32 v67, v67
  v_exp_f32 v68, v68
  v_exp_f32 v69, v69
  v_exp_f32 v70, v70
  v_exp_f32 v71, v71
  v_exp_f32 v72, v72
  v_exp_f32 v73, v73
  v_exp_f32 v74, v74
  v_exp_f32 v75, v75
  v_exp_f32 v76, v76
  v_exp_f32 v77, v77
  v_exp_f32 v78, v78
  v_exp_f32 v79, v79
  v_cvt_pk_bf16_f32 v24, v64, v65
  v_cvt_pk_bf16_f32 v25, v66, v67
  v_cvt_pk_bf16_f32 v26, v68, v69
  v_cvt_pk_bf16_f32 v27, v70, v71
  v_cvt_pk_bf16_f32 v28, v72, v73
  v_cvt_pk_bf16_f32 v29, v74, v75
  v_cvt_pk_bf16_f32 v30, v76, v77
  v_cvt_pk_bf16_f32 v31, v78, v79
  v_mfma_f32_32x32x16_bf16 v[112:127], v[48:51], v[24:27], v[112:127]
  s_nop 0
  v_mfma_f32_32x32x16_bf16 v[112:127], v[52:55], v[28:31], v[112:127]
  v_add_u32 v164, 18944, v164
  v_add_u32 v165, 18944, v165
  s_sub_u32 s13, s13, 1
  s_cmp_lg_u32 s13, 0
  s_cbranch_scc1 A_f21
  v_mov_b32 v236, v106
  v_mov_b32 v237, v106
  s_nop 4
  v_mov_b32 v238, v122
  v_mov_b32 v239, v122
  v_permlane32_swap_b32 v236, v237
  s_nop 0
  v_permlane32_swap_b32 v238, v239
  s_branch A_ok

.section .rodata,"a"
.p2align 6
.amdhsa_kernel gated_mix__grouped_kv_mqa__glu_gated_geglu__prompt_kernel
  .amdhsa_next_free_vgpr 512
  .amdhsa_next_free_sgpr 102
  .amdhsa_accum_offset 256
  .amdhsa_group_segment_fixed_size 0
  .amdhsa_kernarg_size 104
  .amdhsa_user_sgpr_count 2
  .amdhsa_user_sgpr_kernarg_segment_ptr 1
  .amdhsa_system_sgpr_workgroup_id_x 1
.end_amdhsa_kernel
```
